```python
import torch

def _softmax(x, axis=-1):
    return torch.softmax(x, dim=axis)
def _gelu(x):
    return torch.nn.functional.gelu(x, approximate="tanh")
def _silu(x):
    return torch.nn.functional.silu(x)
def _sigmoid(x):
    return torch.sigmoid(x)
def _layernorm(x, axis=-1, eps=1e-5):
    m = x.mean(dim=axis, keepdim=True)
    v = x.var(dim=axis, keepdim=True, unbiased=False)
    return (x - m) / torch.sqrt(v + eps)
def _scatter_add(tgt, idx, src, axis=0):
    return tgt.clone().index_add_(axis, idx, src)
def _segment_sum(src, seg, n):
    out = torch.zeros((n,) + src.shape[1:], dtype=src.dtype)
    return out.index_add_(0, seg, src)
def _pad(x, pw):
    flat = tuple(v for pair in reversed(pw) for v in pair)
    return torch.nn.functional.pad(x, flat)

kernel_name = 'concat_heads__gqa_block_cached__gqa_block_cached__near_ridge'

def setup_inputs():

    _w = (lambda a: (lambda t: t.to(torch.bfloat16) if t.is_floating_point() else t)(torch.as_tensor(a)))
    def _A_setup():
        B, Sq, D = 16, 144, 448
        Hq, Hkv, Sk, Dh = 16, 8, 1024, 256
        assert Hq % Hkv == 0, (Hq, Hkv)
        return {
            "x": _w((lambda *s: torch.randn(*s, dtype=torch.bfloat16) * 0.8)(B, Sq, D)),
            "k_cache": _w((lambda *s: torch.randn(*s, dtype=torch.bfloat16) * 0.8)(B, Hkv, Sk, Dh)),
            "v_cache": _w((lambda *s: torch.randn(*s, dtype=torch.bfloat16) * 0.05)(B, Hkv, Sk, Dh)),
            "wq": _w((lambda *s: torch.randn(*s, dtype=torch.bfloat16) * 0.8)(D, Hq * Dh) * (D ** -0.5)),
            "wo": _w((lambda *s: torch.randn(*s, dtype=torch.bfloat16) * 0.05)(Hq * Dh, D) * ((Hq * Dh) ** -0.5)),
        }
    _A_in = _A_setup()

    def _B_setup():
        B, Sq, D = 16, 144, 448
        Hq, Hkv, Sk, Dh = 16, 8, 1024, 256
        assert Hq % Hkv == 0, (Hq, Hkv)
        return {
            "x": _w((lambda *s: torch.randn(*s, dtype=torch.bfloat16) * 0.8)(B, Sq, D)),
            "k_cache": _w((lambda *s: torch.randn(*s, dtype=torch.bfloat16) * 0.8)(B, Hkv, Sk, Dh)),
            "v_cache": _w((lambda *s: torch.randn(*s, dtype=torch.bfloat16) * 0.05)(B, Hkv, Sk, Dh)),
            "wq": _w((lambda *s: torch.randn(*s, dtype=torch.bfloat16) * 0.8)(D, Hq * Dh) * (D ** -0.5)),
            "wo": _w((lambda *s: torch.randn(*s, dtype=torch.bfloat16) * 0.05)(Hq * Dh, D) * ((Hq * Dh) ** -0.5)),
        }
    _B_in = _B_setup()

    return {
        "A_x": _A_in["x"],
        "A_k_cache": _A_in["k_cache"],
        "A_v_cache": _A_in["v_cache"],
        "A_wq": _A_in["wq"],
        "A_wo": _A_in["wo"],
        "B_x": _B_in["x"],
        "B_k_cache": _B_in["k_cache"],
        "B_v_cache": _B_in["v_cache"],
        "B_wq": _B_in["wq"],
        "B_wo": _B_in["wo"],
    }

def reference(A_x, A_k_cache, A_v_cache, A_wq, A_wo, B_x, B_k_cache, B_v_cache, B_wq, B_wo):
    def _A_ref(x, k_cache, v_cache, wq, wo):
        B, Sq, D = x.shape
        Hq, Dh = 16, 256
        Hkv = k_cache.shape[1]
        rep = Hq // Hkv
        q = (lambda x, *d: x.permute(*d))((x @ wq).reshape(B, Sq, Hq, Dh), 0, 2, 1, 3)
        k = (lambda x, n, axis: torch.repeat_interleave(x, n, dim=axis))(k_cache, rep, axis=1)
        v = (lambda x, n, axis: torch.repeat_interleave(x, n, dim=axis))(v_cache, rep, axis=1)
        scores = torch.einsum("bhqd,bhkd->bhqk", q, k) * (Dh ** -0.5)
        p = _softmax(scores, axis=-1)
        o = torch.einsum("bhqk,bhkd->bhqd", p, v)
        return (lambda x, *d: x.permute(*d))(o, 0, 2, 1, 3).reshape(B, Sq, Hq * Dh) @ wo

    def _B_ref(x, k_cache, v_cache, wq, wo):
        B, Sq, D = x.shape
        Hq, Dh = 16, 256
        Hkv = k_cache.shape[1]
        rep = Hq // Hkv
        q = (lambda x, *d: x.permute(*d))((x @ wq).reshape(B, Sq, Hq, Dh), 0, 2, 1, 3)
        k = (lambda x, n, axis: torch.repeat_interleave(x, n, dim=axis))(k_cache, rep, axis=1)
        v = (lambda x, n, axis: torch.repeat_interleave(x, n, dim=axis))(v_cache, rep, axis=1)
        scores = torch.einsum("bhqd,bhkd->bhqk", q, k) * (Dh ** -0.5)
        p = _softmax(scores, axis=-1)
        o = torch.einsum("bhqk,bhkd->bhqd", p, v)
        return (lambda x, *d: x.permute(*d))(o, 0, 2, 1, 3).reshape(B, Sq, Hq * Dh) @ wo

    a = _A_ref(A_x, A_k_cache, A_v_cache, A_wq, A_wo)
    b = _B_ref(B_x, B_k_cache, B_v_cache, B_wq, B_wo)
    return torch.concatenate([a, b], axis=-1)
```

```asm
; @launch kernel=concat_heads__gqa_block_cached__gqa_block_cached__near_ridge_kernel grid=(256,1,1) block=(256,1,1) lds=163840
; @launch kernel=reduce_kernel grid=(1008,1,1) block=(256,1,1) lds=0
.amdgcn_target "amdgcn-amd-amdhsa--gfx950"
.text
.globl concat_heads__gqa_block_cached__gqa_block_cached__near_ridge_kernel
.p2align 8
.type concat_heads__gqa_block_cached__gqa_block_cached__near_ridge_kernel,@function
concat_heads__gqa_block_cached__gqa_block_cached__near_ridge_kernel:
s_cmp_ge_u32 s2, 256
s_cbranch_scc0 L_go
s_endpgm
L_go:
s_lshr_b32 s42, s2, 1
s_and_b32 s42, s42, 1
s_lshr_b32 s43, s2, 3
s_and_b32 s43, s43, 3
s_lshl_b32 s43, s43, 1
s_or_b32 s42, s42, s43
s_lshr_b32 s44, s2, 2
s_and_b32 s44, s44, 1
s_lshr_b32 s47, s2, 5
s_lshl_b32 s45, s47, 1
s_and_b32 s43, s2, 1
s_or_b32 s45, s45, s43
s_mov_b32 s50, s47
s_lshl_b32 s43, s44, 4
s_add_u32 s43, s43, s45
s_lshl_b32 s43, s43, 3
s_add_u32 s43, s43, s42
s_mov_b32 s51, s43
s_mul_i32 s46, s44, 40
s_add_u32 s48, s0, s46
s_addc_u32 s49, s1, 0
s_load_dwordx8 s[52:59], s[48:49], 0
s_load_dwordx2 s[60:61], s[48:49], 32
s_load_dwordx2 s[62:63], s[0:1], 96
v_lshrrev_b32 v1, 6, v0
v_and_b32 v2, 63, v0
s_nop 0
v_readfirstlane_b32 s28, v1
s_getpc_b64 s[64:65]
L_pc:
s_lshr_b32 s66, s2, 3
s_lshl_b32 s66, s66, 12
s_lshl_b32 s67, s28, 10
s_add_u32 s66, s66, s67
s_min_u32 s66, s66, R_end-L_pc-1024
v_lshlrev_b32 v16, 4, v2
v_add_u32 v16, s66, v16
v_mov_b32 v17, s65
v_add_co_u32 v16, vcc, s64, v16
s_nop 1
v_addc_co_u32 v17, vcc, 0, v17, vcc
global_load_dwordx4 v[20:23], v[16:17], off
s_waitcnt lgkmcnt(0)
s_mul_i32 s46, s45, 129024
s_add_u32 s52, s52, s46
s_addc_u32 s53, s53, 0
s_mov_b32 s4, s52
s_and_b32 s5, s53, 0xffff
s_mov_b32 s6, 129024
s_mov_b32 s7, 0x20000
s_lshl_b32 s46, s45, 3
s_add_u32 s46, s46, s42
s_lshr_b32 s47, s46, 13
s_lshl_b32 s46, s46, 19
s_add_u32 s54, s54, s46
s_addc_u32 s55, s55, s47
s_mov_b32 s12, s54
s_and_b32 s13, s55, 0xffff
s_mov_b32 s14, 524288
s_mov_b32 s15, 0x20000
s_add_u32 s56, s56, s46
s_addc_u32 s57, s57, s47
s_sub_u32 s56, s56, 16384
s_subb_u32 s57, s57, 0
s_mov_b32 s16, s56
s_and_b32 s17, s57, 0xffff
s_mov_b32 s18, 540672
s_mov_b32 s19, 0x20000
s_lshl_b32 s46, s42, 10
s_add_u32 s58, s58, s46
s_addc_u32 s59, s59, 0
s_mov_b32 s8, s58
s_and_b32 s9, s59, 0xffff
s_mov_b32 s10, 0
s_mov_b32 s11, 0x20000
s_sub_u32 s10, 3670016, s46
s_mul_i32 s46, s42, 458752
s_add_u32 s60, s60, s46
s_addc_u32 s61, s61, 0
s_mov_b32 s20, s60
s_and_b32 s21, s61, 0xffff
s_mov_b32 s22, 458752
s_mov_b32 s23, 0x20000
s_mul_i32 s46, s51, 129024
s_add_u32 s62, s62, s46
s_addc_u32 s63, s63, 0
s_mov_b32 s24, s62
s_and_b32 s25, s63, 0xffff
s_mov_b32 s26, 129024
s_mov_b32 s27, 0x20000
s_lshl_b32 s29, s28, 10
s_lshr_b32 s38, s28, 1
s_and_b32 s39, s28, 1
s_mov_b32 s32, 1035512379
s_mov_b32 s37, 14336
s_mov_b32 s49, 0
v_and_b32 v3, 15, v2
v_lshrrev_b32 v4, 4, v2
s_lshl_b32 s33, s39, 1
v_xor_b32 v5, s33, v4
v_lshrrev_b32 v6, 1, v3
v_xor_b32 v6, v5, v6
s_lshl_b32 s34, s38, 2
v_xor_b32 v7, s34, v6
v_lshlrev_b32 v7, 4, v7
v_lshlrev_b32 v8, 7, v3
v_add_u32 v236, v7, v8
v_xor_b32 v237, 64, v236
v_lshlrev_b32 v7, 4, v5
v_add_u32 v7, v7, v3
v_lshlrev_b32 v7, 4, v7
s_mul_i32 s34, s38, 9216
s_add_u32 s34, s34, 131072
v_add_u32 v242, s34, v7
v_xor_b32 v243, 0x400, v242
v_lshrrev_b32 v9, 2, v3
v_lshrrev_b32 v10, 1, v3
v_and_b32 v10, 1, v10
v_and_b32 v11, 1, v3
v_lshlrev_b32 v11, 3, v11
v_lshlrev_b32 v12, 2, v4
v_add_u32 v12, v12, v9
v_and_b32 v13, 6, v12
s_lshl_b32 s34, s28, 1
v_xor_b32 v14, s34, v10
v_xor_b32 v14, v14, v13
v_lshlrev_b32 v14, 4, v14
v_lshlrev_b32 v15, 7, v12
v_add_u32 v14, v14, v15
v_add_u32 v14, v14, v11
v_add_u32 v238, 65536, v14
v_xor_b32 v239, 32, v238
v_xor_b32 v240, 64, v238
v_xor_b32 v241, 96, v238
v_lshlrev_b32 v12, 3, v4
v_add_u32 v12, v12, v9
v_and_b32 v13, 2, v9
v_and_b32 v15, 1, v4
v_lshlrev_b32 v15, 2, v15
v_or_b32 v13, v13, v15
v_xor_b32 v14, s34, v10
v_xor_b32 v14, v14, v13
v_lshlrev_b32 v14, 4, v14
v_lshlrev_b32 v15, 7, v12
v_add_u32 v14, v14, v15
v_add_u32 v216, v14, v11
v_xor_b32 v217, 32, v216
v_xor_b32 v218, 64, v216
v_xor_b32 v219, 96, v216
v_lshlrev_b32 v7, 4, v2
v_add_u32 v244, 147456, v7
s_lshl_b32 s33, s38, 10
s_lshl_b32 s34, s39, 3
s_add_u32 s33, s33, s34
v_add_u32 v245, s33, v244
s_lshl_b32 s33, s39, 1
v_lshrrev_b32 v7, 1, v4
v_add_u32 v7, s33, v7
v_lshlrev_b32 v7, 4, v7
v_add_u32 v7, v7, v3
v_lshlrev_b32 v7, 4, v7
v_and_b32 v8, 1, v4
v_lshlrev_b32 v8, 3, v8
v_add_u32 v7, v7, v8
s_lshl_b32 s33, s38, 10
s_add_u32 s33, s33, 131072
v_add_u32 v254, s33, v7
v_lshrrev_b32 v7, 3, v2
v_and_b32 v8, 7, v2
s_lshl_b32 s33, s39, 2
v_add_u32 v9, s33, v4
v_xor_b32 v9, v8, v9
v_lshlrev_b32 v9, 4, v9
v_lshlrev_b32 v12, 9, v7
s_lshl_b32 s34, s28, 12
v_add_u32 v12, s34, v12
v_add_u32 v246, v9, v12
v_and_b32 v9, 6, v7
v_xor_b32 v9, v8, v9
v_lshlrev_b32 v9, 4, v9
v_add_u32 v247, v9, v12
v_and_b32 v9, 2, v7
v_or_b32 v9, s33, v9
v_xor_b32 v9, v8, v9
v_lshlrev_b32 v9, 4, v9
v_lshlrev_b32 v12, 13, v7
s_lshl_b32 s34, s28, 16
v_add_u32 v12, s34, v12
v_add_u32 v253, v9, v12
s_mov_b32 s52, 0
s_mov_b32 s53, 262144
s_mov_b32 s54, 524288
s_mov_b32 s55, 786432
s_mov_b32 s56, 1048576
s_mov_b32 s57, 1310720
s_mov_b32 s58, 1572864
s_lshl_b32 s60, s28, 12
v_lshlrev_b32 v255, 4, v2
v_add_u32 v252, 0, v253
s_add_u32 m0, s29, 131072
s_nop 0
buffer_load_dwordx4 v252, s[8:11], s52 offen nt lds
s_add_u32 m0, s29, 135168
s_nop 0
buffer_load_dwordx4 v252, s[8:11], s53 offen nt lds
s_add_u32 m0, s29, 139264
s_nop 0
buffer_load_dwordx4 v252, s[8:11], s54 offen nt lds
s_add_u32 m0, s29, 143360
s_nop 0
buffer_load_dwordx4 v252, s[8:11], s55 offen nt lds
s_add_u32 m0, s29, 147456
s_nop 0
buffer_load_dwordx4 v252, s[8:11], s56 offen nt lds
s_add_u32 m0, s29, 151552
s_nop 0
buffer_load_dwordx4 v252, s[8:11], s57 offen nt lds
s_add_u32 m0, s29, 155648
s_nop 0
buffer_load_dwordx4 v252, s[8:11], s58 offen nt lds
v_lshrrev_b32 v5, 3, v2
v_and_b32 v6, 7, v2
s_lshl_b32 s33, s39, 2
v_add_u32 v7, s33, v4
v_xor_b32 v6, v6, v7
v_lshlrev_b32 v6, 4, v6
v_mul_u32_u24 v5, 896, v5
v_add_u32 v5, v5, v6
s_mul_i32 s33, s28, 7168
v_add_u32 v5, s33, v5
s_lshl_b32 s34, s39, 10
s_mul_i32 s35, s38, 14336
s_sub_u32 s35, 114688, s35
s_lshr_b32 s44, s2, 3
s_and_b32 s44, s44, 3
s_lshl_b32 s44, s44, 1
s_mul_i32 s45, s44, 18432
s_lshl_b32 s46, s44, 7
s_add_u32 s47, s45, s29
s_add_u32 m0, s47, 0
s_add_u32 s40, s46, 0
buffer_load_dwordx4 v5, s[4:7], s40 offen  lds
s_add_u32 m0, s47, 4096
s_add_u32 s40, s46, 28672
buffer_load_dwordx4 v5, s[4:7], s40 offen  lds
s_add_u32 m0, s47, 8192
s_add_u32 s40, s46, 57344
buffer_load_dwordx4 v5, s[4:7], s40 offen  lds
s_add_u32 m0, s47, 12288
s_add_u32 s40, s46, 86016
buffer_load_dwordx4 v5, s[4:7], s40 offen  lds
s_cmp_lg_u32 s38, 0
s_cbranch_scc1 L_xskip0
s_add_u32 s47, s45, s34
s_add_u32 m0, s47, 16384
s_add_u32 s40, s35, s46
buffer_load_dwordx4 v5, s[4:7], s40 offen  lds
L_xskip0:
s_add_u32 s45, s45, 18432
s_add_u32 s46, s46, 128
s_cmp_eq_u32 s46, 896
s_cselect_b32 s45, 0, s45
s_cselect_b32 s46, 0, s46
s_add_u32 s47, s45, s29
s_add_u32 m0, s47, 0
s_add_u32 s40, s46, 0
buffer_load_dwordx4 v5, s[4:7], s40 offen  lds
s_add_u32 m0, s47, 4096
s_add_u32 s40, s46, 28672
buffer_load_dwordx4 v5, s[4:7], s40 offen  lds
s_add_u32 m0, s47, 8192
s_add_u32 s40, s46, 57344
buffer_load_dwordx4 v5, s[4:7], s40 offen  lds
s_add_u32 m0, s47, 12288
s_add_u32 s40, s46, 86016
buffer_load_dwordx4 v5, s[4:7], s40 offen  lds
s_cmp_lg_u32 s38, 0
s_cbranch_scc1 L_xskip1
s_add_u32 s47, s45, s34
s_add_u32 m0, s47, 16384
s_add_u32 s40, s35, s46
buffer_load_dwordx4 v5, s[4:7], s40 offen  lds
L_xskip1:
s_add_u32 s45, s45, 18432
s_add_u32 s46, s46, 128
s_cmp_eq_u32 s46, 896
s_cselect_b32 s45, 0, s45
s_cselect_b32 s46, 0, s46
s_add_u32 s47, s45, s29
s_add_u32 m0, s47, 0
s_add_u32 s40, s46, 0
buffer_load_dwordx4 v5, s[4:7], s40 offen  lds
s_add_u32 m0, s47, 4096
s_add_u32 s40, s46, 28672
buffer_load_dwordx4 v5, s[4:7], s40 offen  lds
s_add_u32 m0, s47, 8192
s_add_u32 s40, s46, 57344
buffer_load_dwordx4 v5, s[4:7], s40 offen  lds
s_add_u32 m0, s47, 12288
s_add_u32 s40, s46, 86016
buffer_load_dwordx4 v5, s[4:7], s40 offen  lds
s_cmp_lg_u32 s38, 0
s_cbranch_scc1 L_xskip2
s_add_u32 s47, s45, s34
s_add_u32 m0, s47, 16384
s_add_u32 s40, s35, s46
buffer_load_dwordx4 v5, s[4:7], s40 offen  lds
L_xskip2:
s_add_u32 s45, s45, 18432
s_add_u32 s46, s46, 128
s_cmp_eq_u32 s46, 896
s_cselect_b32 s45, 0, s45
s_cselect_b32 s46, 0, s46
s_add_u32 s47, s45, s29
s_add_u32 m0, s47, 0
s_add_u32 s40, s46, 0
buffer_load_dwordx4 v5, s[4:7], s40 offen  lds
s_add_u32 m0, s47, 4096
s_add_u32 s40, s46, 28672
buffer_load_dwordx4 v5, s[4:7], s40 offen  lds
s_add_u32 m0, s47, 8192
s_add_u32 s40, s46, 57344
buffer_load_dwordx4 v5, s[4:7], s40 offen  lds
s_add_u32 m0, s47, 12288
s_add_u32 s40, s46, 86016
buffer_load_dwordx4 v5, s[4:7], s40 offen  lds
s_cmp_lg_u32 s38, 0
s_cbranch_scc1 L_xskip3
s_add_u32 s47, s45, s34
s_add_u32 m0, s47, 16384
s_add_u32 s40, s35, s46
buffer_load_dwordx4 v5, s[4:7], s40 offen  lds
L_xskip3:
s_add_u32 s45, s45, 18432
s_add_u32 s46, s46, 128
s_cmp_eq_u32 s46, 896
s_cselect_b32 s45, 0, s45
s_cselect_b32 s46, 0, s46
s_add_u32 s47, s45, s29
s_add_u32 m0, s47, 0
s_add_u32 s40, s46, 0
buffer_load_dwordx4 v5, s[4:7], s40 offen  lds
s_add_u32 m0, s47, 4096
s_add_u32 s40, s46, 28672
buffer_load_dwordx4 v5, s[4:7], s40 offen  lds
s_add_u32 m0, s47, 8192
s_add_u32 s40, s46, 57344
buffer_load_dwordx4 v5, s[4:7], s40 offen  lds
s_add_u32 m0, s47, 12288
s_add_u32 s40, s46, 86016
buffer_load_dwordx4 v5, s[4:7], s40 offen  lds
s_cmp_lg_u32 s38, 0
s_cbranch_scc1 L_xskip4
s_add_u32 s47, s45, s34
s_add_u32 m0, s47, 16384
s_add_u32 s40, s35, s46
buffer_load_dwordx4 v5, s[4:7], s40 offen  lds
L_xskip4:
s_add_u32 s45, s45, 18432
s_add_u32 s46, s46, 128
s_cmp_eq_u32 s46, 896
s_cselect_b32 s45, 0, s45
s_cselect_b32 s46, 0, s46
s_add_u32 s47, s45, s29
s_add_u32 m0, s47, 0
s_add_u32 s40, s46, 0
buffer_load_dwordx4 v5, s[4:7], s40 offen  lds
s_add_u32 m0, s47, 4096
s_add_u32 s40, s46, 28672
buffer_load_dwordx4 v5, s[4:7], s40 offen  lds
s_add_u32 m0, s47, 8192
s_add_u32 s40, s46, 57344
buffer_load_dwordx4 v5, s[4:7], s40 offen  lds
s_add_u32 m0, s47, 12288
s_add_u32 s40, s46, 86016
buffer_load_dwordx4 v5, s[4:7], s40 offen  lds
s_cmp_lg_u32 s38, 0
s_cbranch_scc1 L_xskip5
s_add_u32 s47, s45, s34
s_add_u32 m0, s47, 16384
s_add_u32 s40, s35, s46
buffer_load_dwordx4 v5, s[4:7], s40 offen  lds
L_xskip5:
s_add_u32 s45, s45, 18432
s_add_u32 s46, s46, 128
s_cmp_eq_u32 s46, 896
s_cselect_b32 s45, 0, s45
s_cselect_b32 s46, 0, s46
s_add_u32 s47, s45, s29
s_add_u32 m0, s47, 0
s_add_u32 s40, s46, 0
buffer_load_dwordx4 v5, s[4:7], s40 offen  lds
s_add_u32 m0, s47, 4096
s_add_u32 s40, s46, 28672
buffer_load_dwordx4 v5, s[4:7], s40 offen  lds
s_add_u32 m0, s47, 8192
s_add_u32 s40, s46, 57344
buffer_load_dwordx4 v5, s[4:7], s40 offen  lds
s_add_u32 m0, s47, 12288
s_add_u32 s40, s46, 86016
buffer_load_dwordx4 v5, s[4:7], s40 offen  lds
s_cmp_lg_u32 s38, 0
s_cbranch_scc1 L_xskip6
s_add_u32 s47, s45, s34
s_add_u32 m0, s47, 16384
s_add_u32 s40, s35, s46
buffer_load_dwordx4 v5, s[4:7], s40 offen  lds
L_xskip6:
s_lshl_b32 s44, s50, 2
s_add_u32 s44, s44, s28
s_min_u32 s44, s44, 27
s_sub_u32 s44, s44, s28
s_lshl_b32 s44, s44, 16
s_mov_b32 m0, 161792
s_add_u32 s45, s44, 1835008
buffer_load_dwordx4 v253, s[8:11], s45 offen nt lds
s_add_u32 s45, s44, 128
buffer_load_dwordx4 v253, s[8:11], s45 offen nt lds
s_add_u32 s45, s44, 1835136
buffer_load_dwordx4 v253, s[8:11], s45 offen nt lds
v_lshrrev_b32 v6, 1, v3
v_xor_b32 v6, v6, v4
v_lshlrev_b32 v6, 4, v6
v_lshlrev_b32 v7, 7, v3
v_add_u32 v6, v6, v7
s_lshl_b32 s33, s28, 12
v_add_u32 v8, s33, v6
v_xor_b32 v9, 64, v8
v_add_u32 v10, 16384, v6
v_xor_b32 v11, 64, v10
v_add_u32 v12, 55296, v8
v_add_u32 v13, 55296, v9
v_add_u32 v14, 55296, v10
v_add_u32 v15, 55296, v11
v_add_u32 v248, 131072, v216
v_add_u32 v249, 131072, v217
v_add_u32 v250, 131072, v218
v_add_u32 v251, 131072, v219
s_waitcnt vmcnt(3)
s_barrier
ds_read_b128 a[0:3], v8 offset:0
ds_read_b128 a[4:7], v8 offset:2048
ds_read_b128 a[112:115], v10 offset:0
ds_read_b128 a[8:11], v9 offset:0
ds_read_b128 a[12:15], v9 offset:2048
ds_read_b128 a[116:119], v11 offset:0
ds_read_b128 a[16:19], v8 offset:18432
ds_read_b128 a[20:23], v8 offset:20480
ds_read_b128 a[120:123], v10 offset:18432
ds_read_b128 a[24:27], v9 offset:18432
ds_read_b128 a[28:31], v9 offset:20480
ds_read_b128 a[124:127], v11 offset:18432
s_waitcnt lgkmcnt(3)
ds_read_b128 a[32:35], v8 offset:36864
ds_read_b128 a[36:39], v8 offset:38912
ds_read_b128 a[128:131], v10 offset:36864
ds_read_b128 a[40:43], v9 offset:36864
ds_read_b128 a[44:47], v9 offset:38912
ds_read_b128 a[132:135], v11 offset:36864
ds_read_b128 a[48:51], v12 offset:0
ds_read_b128 a[52:55], v12 offset:2048
ds_read_b128 a[136:139], v14 offset:0
ds_read_b128 a[56:59], v13 offset:0
ds_read_b128 a[60:63], v13 offset:2048
ds_read_b128 a[140:143], v15 offset:0
s_waitcnt lgkmcnt(3)
ds_read_b128 a[64:67], v12 offset:18432
ds_read_b128 a[68:71], v12 offset:20480
ds_read_b128 a[144:147], v14 offset:18432
ds_read_b128 a[72:75], v13 offset:18432
ds_read_b128 a[76:79], v13 offset:20480
ds_read_b128 a[148:151], v15 offset:18432
ds_read_b128 a[80:83], v12 offset:36864
ds_read_b128 a[84:87], v12 offset:38912
ds_read_b128 a[152:155], v14 offset:36864
ds_read_b128 a[88:91], v13 offset:36864
ds_read_b128 a[92:95], v13 offset:38912
ds_read_b128 a[156:159], v15 offset:36864
s_waitcnt lgkmcnt(3)
ds_read_b128 a[96:99], v12 offset:55296
ds_read_b128 a[100:103], v12 offset:57344
ds_read_b128 a[160:163], v14 offset:55296
ds_read_b128 a[104:107], v13 offset:55296
ds_read_b128 a[108:111], v13 offset:57344
ds_read_b128 a[164:167], v15 offset:55296
s_waitcnt lgkmcnt(0)
s_barrier
ds_read_b64_tr_b16 a[176:177], v248 offset:0
ds_read_b64_tr_b16 a[178:179], v248 offset:512
ds_read_b64_tr_b16 a[180:181], v249 offset:0
ds_read_b64_tr_b16 a[182:183], v249 offset:512
ds_read_b64_tr_b16 a[192:193], v250 offset:0
ds_read_b64_tr_b16 a[194:195], v250 offset:512
ds_read_b64_tr_b16 a[196:197], v251 offset:0
ds_read_b64_tr_b16 a[198:199], v251 offset:512
ds_read_b64_tr_b16 a[208:209], v248 offset:4096
ds_read_b64_tr_b16 a[210:211], v248 offset:4608
s_waitcnt lgkmcnt(8)
v_mfma_f32_16x16x32_bf16 v[128:131], a[176:179], a[0:3], 0
ds_read_b64_tr_b16 a[212:213], v249 offset:4096
v_add_u32 v252, 1835008, v253
v_mfma_f32_16x16x32_bf16 v[132:135], a[176:179], a[4:7], 0
ds_read_b64_tr_b16 a[214:215], v249 offset:4608
s_add_u32 m0, s29, 28672
v_mfma_f32_16x16x32_bf16 v[208:211], a[176:179], a[112:115], 0
s_waitcnt lgkmcnt(8)
ds_read_b64_tr_b16 a[224:225], v250 offset:4096
v_mfma_f32_16x16x32_bf16 v[136:139], a[180:183], a[0:3], 0
ds_read_b64_tr_b16 a[226:227], v250 offset:4608
v_mfma_f32_16x16x32_bf16 v[140:143], a[180:183], a[4:7], 0
s_waitcnt lgkmcnt(8)
ds_read_b64_tr_b16 a[228:229], v251 offset:4096
buffer_load_dwordx4 v252, s[8:11], s52 offen nt lds
v_mfma_f32_16x16x32_bf16 v[144:147], a[192:195], a[0:3], 0
ds_read_b64_tr_b16 a[230:231], v251 offset:4608
s_add_u32 m0, s29, 32768
v_mfma_f32_16x16x32_bf16 v[148:151], a[192:195], a[4:7], 0
s_waitcnt lgkmcnt(8)
ds_read_b64_tr_b16 a[240:241], v248 offset:8192
buffer_load_dwordx4 v252, s[8:11], s53 offen nt lds
v_mfma_f32_16x16x32_bf16 v[152:155], a[196:199], a[0:3], 0
ds_read_b64_tr_b16 a[242:243], v248 offset:8704
s_add_u32 m0, s29, 36864
v_mfma_f32_16x16x32_bf16 v[156:159], a[196:199], a[4:7], 0
s_waitcnt lgkmcnt(8)
buffer_load_dwordx4 v252, s[8:11], s54 offen nt lds
v_mfma_f32_16x16x32_bf16 v[128:131], a[208:211], a[8:11], v[128:131]
ds_read_b64_tr_b16 a[244:245], v249 offset:8192
s_add_u32 m0, s29, 40960
v_mfma_f32_16x16x32_bf16 v[132:135], a[208:211], a[12:15], v[132:135]
ds_read_b64_tr_b16 a[246:247], v249 offset:8704
buffer_load_dwordx4 v252, s[8:11], s55 offen nt lds
v_mfma_f32_16x16x32_bf16 v[208:211], a[208:211], a[116:119], v[208:211]
s_waitcnt lgkmcnt(8)
ds_read_b64_tr_b16 a[176:177], v250 offset:8192
s_add_u32 m0, s29, 45056
v_mfma_f32_16x16x32_bf16 v[136:139], a[212:215], a[8:11], v[136:139]
ds_read_b64_tr_b16 a[178:179], v250 offset:8704
buffer_load_dwordx4 v252, s[8:11], s56 offen nt lds
v_mfma_f32_16x16x32_bf16 v[140:143], a[212:215], a[12:15], v[140:143]
s_waitcnt lgkmcnt(8)
ds_read_b64_tr_b16 a[180:181], v251 offset:8192
s_add_u32 m0, s29, 49152
v_mfma_f32_16x16x32_bf16 v[144:147], a[224:227], a[8:11], v[144:147]
ds_read_b64_tr_b16 a[182:183], v251 offset:8704
buffer_load_dwordx4 v252, s[8:11], s57 offen nt lds
v_mfma_f32_16x16x32_bf16 v[148:151], a[224:227], a[12:15], v[148:151]
s_waitcnt lgkmcnt(8)
ds_read_b64_tr_b16 a[192:193], v248 offset:12288
s_add_u32 m0, s29, 53248
v_mfma_f32_16x16x32_bf16 v[152:155], a[228:231], a[8:11], v[152:155]
ds_read_b64_tr_b16 a[194:195], v248 offset:12800
buffer_load_dwordx4 v252, s[8:11], s58 offen nt lds
v_mfma_f32_16x16x32_bf16 v[156:159], a[228:231], a[12:15], v[156:159]
s_waitcnt lgkmcnt(8)
ds_read_b64_tr_b16 a[196:197], v249 offset:12288
v_add_u32 v252, 128, v253
v_mfma_f32_16x16x32_bf16 v[128:131], a[240:243], a[16:19], v[128:131]
ds_read_b64_tr_b16 a[198:199], v249 offset:12800
s_add_u32 m0, s29, 57344
v_mfma_f32_16x16x32_bf16 v[132:135], a[240:243], a[20:23], v[132:135]
buffer_load_dwordx4 v252, s[8:11], s52 offen nt lds
v_mfma_f32_16x16x32_bf16 v[208:211], a[240:243], a[120:123], v[208:211]
s_waitcnt lgkmcnt(8)
ds_read_b64_tr_b16 a[208:209], v250 offset:12288
s_add_u32 m0, s29, 61440
v_mfma_f32_16x16x32_bf16 v[136:139], a[244:247], a[16:19], v[136:139]
ds_read_b64_tr_b16 a[210:211], v250 offset:12800
buffer_load_dwordx4 v252, s[8:11], s53 offen nt lds
v_mfma_f32_16x16x32_bf16 v[140:143], a[244:247], a[20:23], v[140:143]
s_waitcnt lgkmcnt(8)
ds_read_b64_tr_b16 a[212:213], v251 offset:12288
s_add_u32 m0, s29, 65536
v_mfma_f32_16x16x32_bf16 v[144:147], a[176:179], a[16:19], v[144:147]
ds_read_b64_tr_b16 a[214:215], v251 offset:12800
buffer_load_dwordx4 v252, s[8:11], s54 offen nt lds
v_mfma_f32_16x16x32_bf16 v[148:151], a[176:179], a[20:23], v[148:151]
s_waitcnt lgkmcnt(8)
ds_read_b64_tr_b16 a[224:225], v248 offset:16384
s_add_u32 m0, s29, 69632
v_mfma_f32_16x16x32_bf16 v[152:155], a[180:183], a[16:19], v[152:155]
ds_read_b64_tr_b16 a[226:227], v248 offset:16896
buffer_load_dwordx4 v252, s[8:11], s55 offen nt lds
v_mfma_f32_16x16x32_bf16 v[156:159], a[180:183], a[20:23], v[156:159]
s_waitcnt lgkmcnt(8)
ds_read_b64_tr_b16 a[228:229], v249 offset:16384
s_add_u32 m0, s29, 73728
v_mfma_f32_16x16x32_bf16 v[128:131], a[192:195], a[24:27], v[128:131]
ds_read_b64_tr_b16 a[230:231], v249 offset:16896
buffer_load_dwordx4 v252, s[8:11], s56 offen nt lds
v_mfma_f32_16x16x32_bf16 v[132:135], a[192:195], a[28:31], v[132:135]
ds_read_b64_tr_b16 a[240:241], v250 offset:16384
s_add_u32 m0, s29, 77824
v_mfma_f32_16x16x32_bf16 v[208:211], a[192:195], a[124:127], v[208:211]
s_waitcnt lgkmcnt(9)
ds_read_b64_tr_b16 a[242:243], v250 offset:16896
buffer_load_dwordx4 v252, s[8:11], s57 offen nt lds
v_mfma_f32_16x16x32_bf16 v[136:139], a[196:199], a[24:27], v[136:139]
ds_read_b64_tr_b16 a[244:245], v251 offset:16384
s_add_u32 m0, s29, 81920
v_mfma_f32_16x16x32_bf16 v[140:143], a[196:199], a[28:31], v[140:143]
s_waitcnt lgkmcnt(9)
ds_read_b64_tr_b16 a[246:247], v251 offset:16896
buffer_load_dwordx4 v252, s[8:11], s58 offen nt lds
v_mfma_f32_16x16x32_bf16 v[144:147], a[208:211], a[24:27], v[144:147]
ds_read_b64_tr_b16 a[176:177], v248 offset:20480
v_add_u32 v252, 1835136, v253
v_mfma_f32_16x16x32_bf16 v[148:151], a[208:211], a[28:31], v[148:151]
s_waitcnt lgkmcnt(9)
ds_read_b64_tr_b16 a[178:179], v248 offset:20992
s_add_u32 m0, s29, 86016
v_mfma_f32_16x16x32_bf16 v[152:155], a[212:215], a[24:27], v[152:155]
buffer_load_dwordx4 v252, s[8:11], s52 offen nt lds
v_mfma_f32_16x16x32_bf16 v[156:159], a[212:215], a[28:31], v[156:159]
s_waitcnt lgkmcnt(8)
ds_read_b64_tr_b16 a[180:181], v249 offset:20480
s_add_u32 m0, s29, 90112
v_mfma_f32_16x16x32_bf16 v[128:131], a[224:227], a[32:35], v[128:131]
ds_read_b64_tr_b16 a[182:183], v249 offset:20992
buffer_load_dwordx4 v252, s[8:11], s53 offen nt lds
v_mfma_f32_16x16x32_bf16 v[132:135], a[224:227], a[36:39], v[132:135]
ds_read_b64_tr_b16 a[192:193], v250 offset:20480
s_add_u32 m0, s29, 94208
v_mfma_f32_16x16x32_bf16 v[208:211], a[224:227], a[128:131], v[208:211]
s_waitcnt lgkmcnt(9)
ds_read_b64_tr_b16 a[194:195], v250 offset:20992
buffer_load_dwordx4 v252, s[8:11], s54 offen nt lds
v_mfma_f32_16x16x32_bf16 v[136:139], a[228:231], a[32:35], v[136:139]
ds_read_b64_tr_b16 a[196:197], v251 offset:20480
s_add_u32 m0, s29, 98304
v_mfma_f32_16x16x32_bf16 v[140:143], a[228:231], a[36:39], v[140:143]
s_waitcnt lgkmcnt(9)
ds_read_b64_tr_b16 a[198:199], v251 offset:20992
buffer_load_dwordx4 v252, s[8:11], s55 offen nt lds
v_mfma_f32_16x16x32_bf16 v[144:147], a[240:243], a[32:35], v[144:147]
ds_read_b64_tr_b16 a[208:209], v248 offset:24576
s_add_u32 m0, s29, 102400
v_mfma_f32_16x16x32_bf16 v[148:151], a[240:243], a[36:39], v[148:151]
s_waitcnt lgkmcnt(9)
ds_read_b64_tr_b16 a[210:211], v248 offset:25088
buffer_load_dwordx4 v252, s[8:11], s56 offen nt lds
v_mfma_f32_16x16x32_bf16 v[152:155], a[244:247], a[32:35], v[152:155]
ds_read_b64_tr_b16 a[212:213], v249 offset:24576
s_add_u32 m0, s29, 106496
v_mfma_f32_16x16x32_bf16 v[156:159], a[244:247], a[36:39], v[156:159]
s_waitcnt lgkmcnt(9)
buffer_load_dwordx4 v252, s[8:11], s57 offen nt lds
v_mfma_f32_16x16x32_bf16 v[128:131], a[176:179], a[40:43], v[128:131]
ds_read_b64_tr_b16 a[214:215], v249 offset:25088
s_add_u32 m0, s29, 110592
v_mfma_f32_16x16x32_bf16 v[132:135], a[176:179], a[44:47], v[132:135]
buffer_load_dwordx4 v252, s[8:11], s58 offen nt lds
v_mfma_f32_16x16x32_bf16 v[208:211], a[176:179], a[132:135], v[208:211]
s_waitcnt lgkmcnt(8)
ds_read_b64_tr_b16 a[224:225], v250 offset:24576
s_mov_b32 s30, 16384
v_mfma_f32_16x16x32_bf16 v[136:139], a[180:183], a[40:43], v[136:139]
ds_read_b64_tr_b16 a[226:227], v250 offset:25088
s_add_u32 m0, s29, 114688
s_nop 0
buffer_load_dwordx4 v247, s[16:19], s30 offen offset:0 nt lds
v_mfma_f32_16x16x32_bf16 v[140:143], a[180:183], a[44:47], v[140:143]
s_waitcnt lgkmcnt(8)
ds_read_b64_tr_b16 a[228:229], v251 offset:24576
s_add_u32 m0, s29, 118656
v_mfma_f32_16x16x32_bf16 v[144:147], a[192:195], a[40:43], v[144:147]
ds_read_b64_tr_b16 a[230:231], v251 offset:25088
buffer_load_dwordx4 v247, s[16:19], s30 offen offset:128 nt lds
v_mfma_f32_16x16x32_bf16 v[148:151], a[192:195], a[44:47], v[148:151]
s_waitcnt lgkmcnt(8)
s_add_u32 m0, s29, 122624
v_mfma_f32_16x16x32_bf16 v[152:155], a[196:199], a[40:43], v[152:155]
buffer_load_dwordx4 v247, s[16:19], s30 offen offset:256 nt lds
v_mfma_f32_16x16x32_bf16 v[156:159], a[196:199], a[44:47], v[156:159]
s_waitcnt lgkmcnt(6)
s_add_u32 m0, s29, 126592
v_mfma_f32_16x16x32_bf16 v[128:131], a[208:211], a[48:51], v[128:131]
buffer_load_dwordx4 v247, s[16:19], s30 offen offset:384 nt lds
v_mfma_f32_16x16x32_bf16 v[132:135], a[208:211], a[52:55], v[132:135]
v_mfma_f32_16x16x32_bf16 v[208:211], a[208:211], a[136:139], v[208:211]
s_waitcnt lgkmcnt(4)
v_mfma_f32_16x16x32_bf16 v[136:139], a[212:215], a[48:51], v[136:139]
v_mfma_f32_16x16x32_bf16 v[140:143], a[212:215], a[52:55], v[140:143]
s_waitcnt lgkmcnt(2)
v_mfma_f32_16x16x32_bf16 v[144:147], a[224:227], a[48:51], v[144:147]
v_mfma_f32_16x16x32_bf16 v[148:151], a[224:227], a[52:55], v[148:151]
s_waitcnt lgkmcnt(0)
v_mfma_f32_16x16x32_bf16 v[152:155], a[228:231], a[48:51], v[152:155]
v_mfma_f32_16x16x32_bf16 v[156:159], a[228:231], a[52:55], v[156:159]
s_waitcnt vmcnt(18) lgkmcnt(0)
s_barrier
ds_read_b64_tr_b16 a[176:177], v216 offset:28672
ds_read_b64_tr_b16 a[178:179], v216 offset:29184
ds_read_b64_tr_b16 a[180:181], v217 offset:28672
ds_read_b64_tr_b16 a[182:183], v217 offset:29184
ds_read_b64_tr_b16 a[192:193], v218 offset:28672
ds_read_b64_tr_b16 a[194:195], v218 offset:29184
ds_read_b64_tr_b16 a[196:197], v219 offset:28672
ds_read_b64_tr_b16 a[198:199], v219 offset:29184
ds_read_b64_tr_b16 a[208:209], v216 offset:32768
ds_read_b64_tr_b16 a[210:211], v216 offset:33280
s_waitcnt lgkmcnt(8)
v_mfma_f32_16x16x32_bf16 v[128:131], a[176:179], a[56:59], v[128:131]
ds_read_b64_tr_b16 a[212:213], v217 offset:32768
v_add_u32 v252, 256, v253
v_mfma_f32_16x16x32_bf16 v[132:135], a[176:179], a[60:63], v[132:135]
ds_read_b64_tr_b16 a[214:215], v217 offset:33280
s_add_u32 m0, s29, 0
v_mfma_f32_16x16x32_bf16 v[208:211], a[176:179], a[140:143], v[208:211]
s_waitcnt lgkmcnt(8)
ds_read_b64_tr_b16 a[224:225], v218 offset:32768
v_mfma_f32_16x16x32_bf16 v[136:139], a[180:183], a[56:59], v[136:139]
ds_read_b64_tr_b16 a[226:227], v218 offset:33280
v_mfma_f32_16x16x32_bf16 v[140:143], a[180:183], a[60:63], v[140:143]
s_waitcnt lgkmcnt(8)
ds_read_b64_tr_b16 a[228:229], v219 offset:32768
v_add_u32 v248, 57344, v216
v_mfma_f32_16x16x32_bf16 v[144:147], a[192:195], a[56:59], v[144:147]
ds_read_b64_tr_b16 a[230:231], v219 offset:33280
buffer_load_dwordx4 v252, s[8:11], s52 offen nt lds
v_mfma_f32_16x16x32_bf16 v[148:151], a[192:195], a[60:63], v[148:151]
s_waitcnt lgkmcnt(8)
ds_read_b64_tr_b16 a[240:241], v216 offset:36864
s_add_u32 m0, s29, 4096
v_mfma_f32_16x16x32_bf16 v[152:155], a[196:199], a[56:59], v[152:155]
ds_read_b64_tr_b16 a[242:243], v216 offset:37376
v_add_u32 v249, 57344, v217
v_mfma_f32_16x16x32_bf16 v[156:159], a[196:199], a[60:63], v[156:159]
s_waitcnt lgkmcnt(8)
buffer_load_dwordx4 v252, s[8:11], s53 offen nt lds
v_mfma_f32_16x16x32_bf16 v[128:131], a[208:211], a[64:67], v[128:131]
ds_read_b64_tr_b16 a[244:245], v217 offset:36864
v_add_u32 v250, 57344, v218
v_mfma_f32_16x16x32_bf16 v[132:135], a[208:211], a[68:71], v[132:135]
ds_read_b64_tr_b16 a[246:247], v217 offset:37376
v_add_u32 v251, 57344, v219
v_mfma_f32_16x16x32_bf16 v[208:211], a[208:211], a[144:147], v[208:211]
s_waitcnt lgkmcnt(8)
ds_read_b64_tr_b16 a[176:177], v218 offset:36864
v_mfma_f32_16x16x32_bf16 v[136:139], a[212:215], a[64:67], v[136:139]
ds_read_b64_tr_b16 a[178:179], v218 offset:37376
v_mfma_f32_16x16x32_bf16 v[140:143], a[212:215], a[68:71], v[140:143]
s_waitcnt lgkmcnt(8)
ds_read_b64_tr_b16 a[180:181], v219 offset:36864
s_add_u32 m0, s29, 8192
v_mfma_f32_16x16x32_bf16 v[144:147], a[224:227], a[64:67], v[144:147]
ds_read_b64_tr_b16 a[182:183], v219 offset:37376
v_mfma_f32_16x16x32_bf16 v[148:151], a[224:227], a[68:71], v[148:151]
s_waitcnt lgkmcnt(8)
ds_read_b64_tr_b16 a[192:193], v216 offset:40960
v_mfma_f32_16x16x32_bf16 v[152:155], a[228:231], a[64:67], v[152:155]
ds_read_b64_tr_b16 a[194:195], v216 offset:41472
v_mfma_f32_16x16x32_bf16 v[156:159], a[228:231], a[68:71], v[156:159]
s_waitcnt lgkmcnt(8)
buffer_load_dwordx4 v252, s[8:11], s54 offen nt lds
v_mfma_f32_16x16x32_bf16 v[128:131], a[240:243], a[72:75], v[128:131]
ds_read_b64_tr_b16 a[196:197], v217 offset:40960
v_mfma_f32_16x16x32_bf16 v[132:135], a[240:243], a[76:79], v[132:135]
ds_read_b64_tr_b16 a[198:199], v217 offset:41472
v_mfma_f32_16x16x32_bf16 v[208:211], a[240:243], a[148:151], v[208:211]
s_waitcnt lgkmcnt(8)
ds_read_b64_tr_b16 a[208:209], v218 offset:40960
s_add_u32 m0, s29, 12288
v_mfma_f32_16x16x32_bf16 v[136:139], a[244:247], a[72:75], v[136:139]
ds_read_b64_tr_b16 a[210:211], v218 offset:41472
v_mfma_f32_16x16x32_bf16 v[140:143], a[244:247], a[76:79], v[140:143]
s_waitcnt lgkmcnt(8)
ds_read_b64_tr_b16 a[212:213], v219 offset:40960
v_mfma_f32_16x16x32_bf16 v[144:147], a[176:179], a[72:75], v[144:147]
ds_read_b64_tr_b16 a[214:215], v219 offset:41472
v_mfma_f32_16x16x32_bf16 v[148:151], a[176:179], a[76:79], v[148:151]
s_waitcnt lgkmcnt(8)
ds_read_b64_tr_b16 a[224:225], v216 offset:45056
v_mfma_f32_16x16x32_bf16 v[152:155], a[180:183], a[72:75], v[152:155]
ds_read_b64_tr_b16 a[226:227], v216 offset:45568
v_mfma_f32_16x16x32_bf16 v[156:159], a[180:183], a[76:79], v[156:159]
s_waitcnt lgkmcnt(8)
buffer_load_dwordx4 v252, s[8:11], s55 offen nt lds
v_mfma_f32_16x16x32_bf16 v[128:131], a[192:195], a[80:83], v[128:131]
ds_read_b64_tr_b16 a[228:229], v217 offset:45056
s_add_u32 m0, s29, 16384
v_mfma_f32_16x16x32_bf16 v[132:135], a[192:195], a[84:87], v[132:135]
ds_read_b64_tr_b16 a[230:231], v217 offset:45568
v_mfma_f32_16x16x32_bf16 v[208:211], a[192:195], a[152:155], v[208:211]
s_waitcnt lgkmcnt(8)
ds_read_b64_tr_b16 a[240:241], v218 offset:45056
v_mfma_f32_16x16x32_bf16 v[136:139], a[196:199], a[80:83], v[136:139]
ds_read_b64_tr_b16 a[242:243], v218 offset:45568
v_mfma_f32_16x16x32_bf16 v[140:143], a[196:199], a[84:87], v[140:143]
s_waitcnt lgkmcnt(8)
ds_read_b64_tr_b16 a[244:245], v219 offset:45056
v_mfma_f32_16x16x32_bf16 v[144:147], a[208:211], a[80:83], v[144:147]
ds_read_b64_tr_b16 a[246:247], v219 offset:45568
v_mfma_f32_16x16x32_bf16 v[148:151], a[208:211], a[84:87], v[148:151]
s_waitcnt lgkmcnt(8)
ds_read_b64_tr_b16 a[176:177], v216 offset:49152
buffer_load_dwordx4 v252, s[8:11], s56 offen nt lds
v_mfma_f32_16x16x32_bf16 v[152:155], a[212:215], a[80:83], v[152:155]
ds_read_b64_tr_b16 a[178:179], v216 offset:49664
s_add_u32 m0, s29, 20480
v_mfma_f32_16x16x32_bf16 v[156:159], a[212:215], a[84:87], v[156:159]
s_waitcnt lgkmcnt(8)
ds_read_b64_tr_b16 a[180:181], v217 offset:49152
v_mfma_f32_16x16x32_bf16 v[128:131], a[224:227], a[88:91], v[128:131]
ds_read_b64_tr_b16 a[182:183], v217 offset:49664
v_mfma_f32_16x16x32_bf16 v[132:135], a[224:227], a[92:95], v[132:135]
buffer_load_dwordx4 v252, s[8:11], s57 offen nt lds
v_mfma_f32_16x16x32_bf16 v[208:211], a[224:227], a[156:159], v[208:211]
s_waitcnt lgkmcnt(8)
ds_read_b64_tr_b16 a[192:193], v218 offset:49152
v_mfma_f32_16x16x32_bf16 v[136:139], a[228:231], a[88:91], v[136:139]
ds_read_b64_tr_b16 a[194:195], v218 offset:49664
v_mfma_f32_16x16x32_bf16 v[140:143], a[228:231], a[92:95], v[140:143]
s_waitcnt lgkmcnt(8)
ds_read_b64_tr_b16 a[196:197], v219 offset:49152
v_mfma_f32_16x16x32_bf16 v[144:147], a[240:243], a[88:91], v[144:147]
ds_read_b64_tr_b16 a[198:199], v219 offset:49664
s_add_u32 m0, s29, 24576
v_mfma_f32_16x16x32_bf16 v[148:151], a[240:243], a[92:95], v[148:151]
s_waitcnt lgkmcnt(8)
ds_read_b64_tr_b16 a[208:209], v216 offset:53248
v_mfma_f32_16x16x32_bf16 v[152:155], a[244:247], a[88:91], v[152:155]
ds_read_b64_tr_b16 a[210:211], v216 offset:53760
v_mfma_f32_16x16x32_bf16 v[156:159], a[244:247], a[92:95], v[156:159]
s_waitcnt lgkmcnt(8)
buffer_load_dwordx4 v252, s[8:11], s58 offen nt lds
v_mfma_f32_16x16x32_bf16 v[128:131], a[176:179], a[96:99], v[128:131]
ds_read_b64_tr_b16 a[212:213], v217 offset:53248
v_mfma_f32_16x16x32_bf16 v[132:135], a[176:179], a[100:103], v[132:135]
ds_read_b64_tr_b16 a[214:215], v217 offset:53760
v_mfma_f32_16x16x32_bf16 v[208:211], a[176:179], a[160:163], v[208:211]
s_waitcnt lgkmcnt(8)
ds_read_b64_tr_b16 a[224:225], v218 offset:53248
v_mfma_f32_16x16x32_bf16 v[136:139], a[180:183], a[96:99], v[136:139]
ds_read_b64_tr_b16 a[226:227], v218 offset:53760
v_mfma_f32_16x16x32_bf16 v[140:143], a[180:183], a[100:103], v[140:143]
s_waitcnt lgkmcnt(8)
ds_read_b64_tr_b16 a[228:229], v219 offset:53248
v_mfma_f32_16x16x32_bf16 v[144:147], a[192:195], a[96:99], v[144:147]
ds_read_b64_tr_b16 a[230:231], v219 offset:53760
v_mfma_f32_16x16x32_bf16 v[148:151], a[192:195], a[100:103], v[148:151]
s_waitcnt lgkmcnt(8)
v_mfma_f32_16x16x32_bf16 v[152:155], a[196:199], a[96:99], v[152:155]
v_mfma_f32_16x16x32_bf16 v[156:159], a[196:199], a[100:103], v[156:159]
s_waitcnt lgkmcnt(6)
v_mfma_f32_16x16x32_bf16 v[128:131], a[208:211], a[104:107], v[128:131]
v_mfma_f32_16x16x32_bf16 v[132:135], a[208:211], a[108:111], v[132:135]
v_mfma_f32_16x16x32_bf16 v[208:211], a[208:211], a[164:167], v[208:211]
s_waitcnt lgkmcnt(4)
v_mfma_f32_16x16x32_bf16 v[136:139], a[212:215], a[104:107], v[136:139]
v_mfma_f32_16x16x32_bf16 v[140:143], a[212:215], a[108:111], v[140:143]
s_waitcnt lgkmcnt(2)
v_mfma_f32_16x16x32_bf16 v[144:147], a[224:227], a[104:107], v[144:147]
v_mfma_f32_16x16x32_bf16 v[148:151], a[224:227], a[108:111], v[148:151]
s_waitcnt lgkmcnt(0)
v_mfma_f32_16x16x32_bf16 v[152:155], a[228:231], a[104:107], v[152:155]
v_mfma_f32_16x16x32_bf16 v[156:159], a[228:231], a[108:111], v[156:159]
s_waitcnt vmcnt(11) lgkmcnt(0)
s_barrier
ds_read_b64_tr_b16 a[176:177], v248 offset:0
ds_read_b64_tr_b16 a[178:179], v248 offset:512
ds_read_b64_tr_b16 a[180:181], v249 offset:0
ds_read_b64_tr_b16 a[182:183], v249 offset:512
ds_read_b64_tr_b16 a[192:193], v250 offset:0
ds_read_b64_tr_b16 a[194:195], v250 offset:512
ds_read_b64_tr_b16 a[196:197], v251 offset:0
ds_read_b64_tr_b16 a[198:199], v251 offset:512
ds_read_b64_tr_b16 a[208:209], v248 offset:4096
ds_read_b64_tr_b16 a[210:211], v248 offset:4608
s_waitcnt lgkmcnt(8)
v_mfma_f32_16x16x32_bf16 v[160:163], a[176:179], a[0:3], 0
ds_read_b64_tr_b16 a[212:213], v249 offset:4096
v_add_u32 v252, 1835264, v253
v_mfma_f32_16x16x32_bf16 v[164:167], a[176:179], a[4:7], 0
ds_read_b64_tr_b16 a[214:215], v249 offset:4608
s_add_u32 m0, s29, 28672
v_mfma_f32_16x16x32_bf16 v[212:215], a[176:179], a[112:115], 0
s_waitcnt lgkmcnt(8)
ds_read_b64_tr_b16 a[224:225], v250 offset:4096
v_mul_f32 v128, s32, v128
v_mfma_f32_16x16x32_bf16 v[168:171], a[180:183], a[0:3], 0
ds_read_b64_tr_b16 a[226:227], v250 offset:4608
v_mul_f32 v129, s32, v129
v_mfma_f32_16x16x32_bf16 v[172:175], a[180:183], a[4:7], 0
s_waitcnt lgkmcnt(8)
ds_read_b64_tr_b16 a[228:229], v251 offset:4096
v_mul_f32 v130, s32, v130
v_mfma_f32_16x16x32_bf16 v[176:179], a[192:195], a[0:3], 0
ds_read_b64_tr_b16 a[230:231], v251 offset:4608
buffer_load_dwordx4 v252, s[8:11], s52 offen nt lds
v_mfma_f32_16x16x32_bf16 v[180:183], a[192:195], a[4:7], 0
s_waitcnt lgkmcnt(8)
ds_read_b64_tr_b16 a[240:241], v248 offset:8192
v_mul_f32 v131, s32, v131
v_mfma_f32_16x16x32_bf16 v[184:187], a[196:199], a[0:3], 0
ds_read_b64_tr_b16 a[242:243], v248 offset:8704
v_cvt_pk_bf16_f32 v0, v128, v129
v_mfma_f32_16x16x32_bf16 v[188:191], a[196:199], a[4:7], 0
s_waitcnt lgkmcnt(8)
ds_read_b64_tr_b16 a[244:245], v249 offset:8192
s_add_u32 m0, s29, 32768
v_mfma_f32_16x16x32_bf16 v[160:163], a[208:211], a[8:11], v[160:163]
ds_read_b64_tr_b16 a[246:247], v249 offset:8704
v_cvt_pk_bf16_f32 v1, v130, v131
v_mfma_f32_16x16x32_bf16 v[164:167], a[208:211], a[12:15], v[164:167]
buffer_load_dwordx4 v252, s[8:11], s53 offen nt lds
v_mfma_f32_16x16x32_bf16 v[212:215], a[208:211], a[116:119], v[212:215]
s_waitcnt lgkmcnt(8)
ds_read_b64_tr_b16 a[176:177], v250 offset:8192
v_mul_f32 v136, s32, v136
v_mfma_f32_16x16x32_bf16 v[168:171], a[212:215], a[8:11], v[168:171]
ds_read_b64_tr_b16 a[178:179], v250 offset:8704
v_mul_f32 v137, s32, v137
v_mfma_f32_16x16x32_bf16 v[172:175], a[212:215], a[12:15], v[172:175]
s_waitcnt lgkmcnt(8)
ds_read_b64_tr_b16 a[180:181], v251 offset:8192
v_mul_f32 v138, s32, v138
v_mfma_f32_16x16x32_bf16 v[176:179], a[224:227], a[8:11], v[176:179]
ds_read_b64_tr_b16 a[182:183], v251 offset:8704
v_mul_f32 v139, s32, v139
v_mfma_f32_16x16x32_bf16 v[180:183], a[224:227], a[12:15], v[180:183]
s_waitcnt lgkmcnt(8)
ds_read_b64_tr_b16 a[192:193], v248 offset:12288
s_add_u32 m0, s29, 36864
v_mfma_f32_16x16x32_bf16 v[184:187], a[228:231], a[8:11], v[184:187]
ds_read_b64_tr_b16 a[194:195], v248 offset:12800
v_cvt_pk_bf16_f32 v2, v136, v137
v_mfma_f32_16x16x32_bf16 v[188:191], a[228:231], a[12:15], v[188:191]
s_waitcnt lgkmcnt(8)
buffer_load_dwordx4 v252, s[8:11], s54 offen nt lds
v_mfma_f32_16x16x32_bf16 v[160:163], a[240:243], a[16:19], v[160:163]
ds_read_b64_tr_b16 a[196:197], v249 offset:12288
v_cvt_pk_bf16_f32 v3, v138, v139
v_mfma_f32_16x16x32_bf16 v[164:167], a[240:243], a[20:23], v[164:167]
ds_read_b64_tr_b16 a[198:199], v249 offset:12800
v_mul_f32 v144, s32, v144
v_mfma_f32_16x16x32_bf16 v[212:215], a[240:243], a[120:123], v[212:215]
s_waitcnt lgkmcnt(8)
ds_read_b64_tr_b16 a[208:209], v250 offset:12288
s_add_u32 m0, s29, 40960
v_mfma_f32_16x16x32_bf16 v[168:171], a[244:247], a[16:19], v[168:171]
ds_read_b64_tr_b16 a[210:211], v250 offset:12800
v_mul_f32 v145, s32, v145
v_mfma_f32_16x16x32_bf16 v[172:175], a[244:247], a[20:23], v[172:175]
s_waitcnt lgkmcnt(8)
ds_read_b64_tr_b16 a[212:213], v251 offset:12288
v_mul_f32 v146, s32, v146
v_mfma_f32_16x16x32_bf16 v[176:179], a[176:179], a[16:19], v[176:179]
ds_read_b64_tr_b16 a[214:215], v251 offset:12800
v_permlane32_swap_b32 v0, v2
v_mfma_f32_16x16x32_bf16 v[180:183], a[176:179], a[20:23], v[180:183]
s_waitcnt lgkmcnt(8)
ds_read_b64_tr_b16 a[224:225], v248 offset:16384
v_permlane32_swap_b32 v1, v3
v_mfma_f32_16x16x32_bf16 v[184:187], a[180:183], a[16:19], v[184:187]
ds_read_b64_tr_b16 a[226:227], v248 offset:16896
v_mul_f32 v147, s32, v147
v_mfma_f32_16x16x32_bf16 v[188:191], a[180:183], a[20:23], v[188:191]
s_waitcnt lgkmcnt(8)
buffer_load_dwordx4 v252, s[8:11], s55 offen nt lds
v_mfma_f32_16x16x32_bf16 v[160:163], a[192:195], a[24:27], v[160:163]
ds_read_b64_tr_b16 a[228:229], v249 offset:16384
v_permlane16_swap_b32 v0, v2
v_mfma_f32_16x16x32_bf16 v[164:167], a[192:195], a[28:31], v[164:167]
ds_read_b64_tr_b16 a[230:231], v249 offset:16896
v_permlane16_swap_b32 v1, v3
v_mfma_f32_16x16x32_bf16 v[212:215], a[192:195], a[124:127], v[212:215]
s_waitcnt lgkmcnt(8)
ds_read_b64_tr_b16 a[240:241], v250 offset:16384
s_add_u32 m0, s29, 45056
v_mfma_f32_16x16x32_bf16 v[168:171], a[196:199], a[24:27], v[168:171]
ds_read_b64_tr_b16 a[242:243], v250 offset:16896
v_cvt_pk_bf16_f32 v4, v144, v145
v_mfma_f32_16x16x32_bf16 v[172:175], a[196:199], a[28:31], v[172:175]
s_waitcnt lgkmcnt(8)
ds_read_b64_tr_b16 a[244:245], v251 offset:16384
v_cvt_pk_bf16_f32 v5, v146, v147
v_mfma_f32_16x16x32_bf16 v[176:179], a[208:211], a[24:27], v[176:179]
ds_read_b64_tr_b16 a[246:247], v251 offset:16896
v_mul_f32 v152, s32, v152
v_mfma_f32_16x16x32_bf16 v[180:183], a[208:211], a[28:31], v[180:183]
s_waitcnt lgkmcnt(8)
ds_read_b64_tr_b16 a[176:177], v248 offset:20480
buffer_load_dwordx4 v252, s[8:11], s56 offen nt lds
v_mfma_f32_16x16x32_bf16 v[184:187], a[212:215], a[24:27], v[184:187]
ds_read_b64_tr_b16 a[178:179], v248 offset:20992
s_add_u32 m0, s29, 49152
v_mfma_f32_16x16x32_bf16 v[188:191], a[212:215], a[28:31], v[188:191]
s_waitcnt lgkmcnt(8)
ds_read_b64_tr_b16 a[180:181], v249 offset:20480
v_mul_f32 v153, s32, v153
v_mfma_f32_16x16x32_bf16 v[160:163], a[224:227], a[32:35], v[160:163]
ds_read_b64_tr_b16 a[182:183], v249 offset:20992
v_mul_f32 v154, s32, v154
v_mfma_f32_16x16x32_bf16 v[164:167], a[224:227], a[36:39], v[164:167]
buffer_load_dwordx4 v252, s[8:11], s57 offen nt lds
v_mfma_f32_16x16x32_bf16 v[212:215], a[224:227], a[128:131], v[212:215]
s_waitcnt lgkmcnt(8)
ds_read_b64_tr_b16 a[192:193], v250 offset:20480
v_mul_f32 v155, s32, v155
v_mfma_f32_16x16x32_bf16 v[168:171], a[228:231], a[32:35], v[168:171]
ds_read_b64_tr_b16 a[194:195], v250 offset:20992
v_cvt_pk_bf16_f32 v6, v152, v153
v_mfma_f32_16x16x32_bf16 v[172:175], a[228:231], a[36:39], v[172:175]
s_waitcnt lgkmcnt(8)
ds_read_b64_tr_b16 a[212:213], v251 offset:20480
v_cvt_pk_bf16_f32 v7, v154, v155
v_mfma_f32_16x16x32_bf16 v[176:179], a[240:243], a[32:35], v[176:179]
ds_read_b64_tr_b16 a[214:215], v251 offset:20992
s_add_u32 m0, s29, 53248
v_mfma_f32_16x16x32_bf16 v[180:183], a[240:243], a[36:39], v[180:183]
s_waitcnt lgkmcnt(8)
ds_read_b64_tr_b16 a[224:225], v248 offset:24576
v_mfma_f32_16x16x32_bf16 v[184:187], a[244:247], a[32:35], v[184:187]
ds_read_b64_tr_b16 a[226:227], v248 offset:25088
v_mfma_f32_16x16x32_bf16 v[188:191], a[244:247], a[36:39], v[188:191]
s_waitcnt lgkmcnt(8)
buffer_load_dwordx4 v252, s[8:11], s58 offen nt lds
v_mfma_f32_16x16x32_bf16 v[160:163], a[176:179], a[40:43], v[160:163]
ds_read_b64_tr_b16 a[228:229], v249 offset:24576
v_mfma_f32_16x16x32_bf16 v[164:167], a[176:179], a[44:47], v[164:167]
ds_read_b64_tr_b16 a[230:231], v249 offset:25088
v_mfma_f32_16x16x32_bf16 v[212:215], a[176:179], a[132:135], v[212:215]
s_waitcnt lgkmcnt(8)
ds_read_b64_tr_b16 a[240:241], v250 offset:24576
v_permlane32_swap_b32 v4, v6
v_mfma_f32_16x16x32_bf16 v[168:171], a[180:183], a[40:43], v[168:171]
ds_read_b64_tr_b16 a[242:243], v250 offset:25088
v_mfma_f32_16x16x32_bf16 v[172:175], a[180:183], a[44:47], v[172:175]
s_waitcnt lgkmcnt(8)
ds_read_b64_tr_b16 a[244:245], v251 offset:24576
v_permlane32_swap_b32 v5, v7
v_mfma_f32_16x16x32_bf16 v[176:179], a[192:195], a[40:43], v[176:179]
ds_read_b64_tr_b16 a[246:247], v251 offset:25088
v_permlane16_swap_b32 v4, v6
v_mfma_f32_16x16x32_bf16 v[180:183], a[192:195], a[44:47], v[180:183]
s_waitcnt lgkmcnt(8)
ds_read_b64_tr_b16 a[176:177], v248 offset:28672
v_mfma_f32_16x16x32_bf16 v[184:187], a[212:215], a[40:43], v[184:187]
ds_read_b64_tr_b16 a[178:179], v248 offset:29184
v_permlane16_swap_b32 v5, v7
v_mfma_f32_16x16x32_bf16 v[188:191], a[212:215], a[44:47], v[188:191]
s_waitcnt lgkmcnt(8)
ds_read_b64_tr_b16 a[180:181], v249 offset:28672
v_mfma_f32_16x16x32_bf16 v[160:163], a[224:227], a[48:51], v[160:163]
ds_read_b64_tr_b16 a[182:183], v249 offset:29184
v_mfma_f32_16x16x32_bf16 v[164:167], a[224:227], a[52:55], v[164:167]
ds_read_b64_tr_b16 a[192:193], v250 offset:28672
v_mfma_f32_16x16x32_bf16 v[212:215], a[224:227], a[136:139], v[212:215]
s_waitcnt lgkmcnt(9)
ds_read_b64_tr_b16 a[194:195], v250 offset:29184
v_mfma_f32_16x16x32_bf16 v[168:171], a[228:231], a[48:51], v[168:171]
ds_read_b64_tr_b16 a[196:197], v251 offset:28672
v_mfma_f32_16x16x32_bf16 v[172:175], a[228:231], a[52:55], v[172:175]
s_waitcnt lgkmcnt(9)
ds_read_b64_tr_b16 a[198:199], v251 offset:29184
v_mfma_f32_16x16x32_bf16 v[176:179], a[240:243], a[48:51], v[176:179]
ds_read_b64_tr_b16 a[208:209], v248 offset:32768
v_mfma_f32_16x16x32_bf16 v[180:183], a[240:243], a[52:55], v[180:183]
s_waitcnt lgkmcnt(9)
ds_read_b64_tr_b16 a[210:211], v248 offset:33280
v_mfma_f32_16x16x32_bf16 v[184:187], a[244:247], a[48:51], v[184:187]
v_mfma_f32_16x16x32_bf16 v[188:191], a[244:247], a[52:55], v[188:191]
s_waitcnt vmcnt(7) lgkmcnt(10)
s_barrier
s_waitcnt lgkmcnt(8)
v_mfma_f32_16x16x32_bf16 v[160:163], a[176:179], a[56:59], v[160:163]
ds_read_b64_tr_b16 a[212:213], v249 offset:32768
v_add_u32 v252, 384, v253
v_mfma_f32_16x16x32_bf16 v[164:167], a[176:179], a[60:63], v[164:167]
ds_read_b64_tr_b16 a[214:215], v249 offset:33280
s_add_u32 m0, s29, 57344
v_mfma_f32_16x16x32_bf16 v[212:215], a[176:179], a[140:143], v[212:215]
s_waitcnt lgkmcnt(8)
ds_read_b64_tr_b16 a[224:225], v250 offset:32768
v_mul_f32 v132, s32, v132
v_mfma_f32_16x16x32_bf16 v[168:171], a[180:183], a[56:59], v[168:171]
ds_read_b64_tr_b16 a[226:227], v250 offset:33280
v_mul_f32 v133, s32, v133
v_mfma_f32_16x16x32_bf16 v[172:175], a[180:183], a[60:63], v[172:175]
s_waitcnt lgkmcnt(8)
ds_read_b64_tr_b16 a[228:229], v251 offset:32768
v_mul_f32 v134, s32, v134
v_mfma_f32_16x16x32_bf16 v[176:179], a[192:195], a[56:59], v[176:179]
ds_read_b64_tr_b16 a[230:231], v251 offset:33280
buffer_load_dwordx4 v252, s[8:11], s52 offen nt lds
v_mfma_f32_16x16x32_bf16 v[180:183], a[192:195], a[60:63], v[180:183]
s_waitcnt lgkmcnt(8)
ds_read_b64_tr_b16 a[240:241], v248 offset:36864
v_mul_f32 v135, s32, v135
v_mfma_f32_16x16x32_bf16 v[184:187], a[196:199], a[56:59], v[184:187]
ds_read_b64_tr_b16 a[242:243], v248 offset:37376
v_cvt_pk_bf16_f32 v32, v132, v133
v_mfma_f32_16x16x32_bf16 v[188:191], a[196:199], a[60:63], v[188:191]
s_waitcnt lgkmcnt(8)
ds_read_b64_tr_b16 a[244:245], v249 offset:36864
v_cvt_pk_bf16_f32 v33, v134, v135
v_mfma_f32_16x16x32_bf16 v[160:163], a[208:211], a[64:67], v[160:163]
ds_read_b64_tr_b16 a[246:247], v249 offset:37376
s_add_u32 m0, s29, 61440
v_mfma_f32_16x16x32_bf16 v[164:167], a[208:211], a[68:71], v[164:167]
buffer_load_dwordx4 v252, s[8:11], s53 offen nt lds
v_mfma_f32_16x16x32_bf16 v[212:215], a[208:211], a[144:147], v[212:215]
s_waitcnt lgkmcnt(8)
ds_read_b64_tr_b16 a[176:177], v250 offset:36864
v_mul_f32 v140, s32, v140
v_mfma_f32_16x16x32_bf16 v[168:171], a[212:215], a[64:67], v[168:171]
ds_read_b64_tr_b16 a[178:179], v250 offset:37376
v_mul_f32 v141, s32, v141
v_mfma_f32_16x16x32_bf16 v[172:175], a[212:215], a[68:71], v[172:175]
s_waitcnt lgkmcnt(8)
ds_read_b64_tr_b16 a[180:181], v251 offset:36864
v_mul_f32 v142, s32, v142
v_mfma_f32_16x16x32_bf16 v[176:179], a[224:227], a[64:67], v[176:179]
ds_read_b64_tr_b16 a[182:183], v251 offset:37376
v_mul_f32 v143, s32, v143
v_mfma_f32_16x16x32_bf16 v[180:183], a[224:227], a[68:71], v[180:183]
s_waitcnt lgkmcnt(8)
ds_read_b64_tr_b16 a[192:193], v248 offset:40960
v_cvt_pk_bf16_f32 v34, v140, v141
v_mfma_f32_16x16x32_bf16 v[184:187], a[228:231], a[64:67], v[184:187]
ds_read_b64_tr_b16 a[194:195], v248 offset:41472
v_cvt_pk_bf16_f32 v35, v142, v143
v_mfma_f32_16x16x32_bf16 v[188:191], a[228:231], a[68:71], v[188:191]
s_waitcnt lgkmcnt(8)
v_permlane32_swap_b32 v32, v34
v_mfma_f32_16x16x32_bf16 v[160:163], a[240:243], a[72:75], v[160:163]
ds_read_b64_tr_b16 a[196:197], v249 offset:40960
s_add_u32 m0, s29, 65536
v_mfma_f32_16x16x32_bf16 v[164:167], a[240:243], a[76:79], v[164:167]
ds_read_b64_tr_b16 a[198:199], v249 offset:41472
buffer_load_dwordx4 v252, s[8:11], s54 offen nt lds
v_mfma_f32_16x16x32_bf16 v[212:215], a[240:243], a[148:151], v[212:215]
s_waitcnt lgkmcnt(8)
ds_read_b64_tr_b16 a[208:209], v250 offset:40960
v_mul_f32 v148, s32, v148
v_mfma_f32_16x16x32_bf16 v[168:171], a[244:247], a[72:75], v[168:171]
ds_read_b64_tr_b16 a[210:211], v250 offset:41472
v_permlane32_swap_b32 v33, v35
v_mfma_f32_16x16x32_bf16 v[172:175], a[244:247], a[76:79], v[172:175]
s_waitcnt lgkmcnt(8)
ds_read_b64_tr_b16 a[212:213], v251 offset:40960
v_permlane16_swap_b32 v32, v34
v_mfma_f32_16x16x32_bf16 v[176:179], a[176:179], a[72:75], v[176:179]
ds_read_b64_tr_b16 a[214:215], v251 offset:41472
v_permlane16_swap_b32 v33, v35
v_mfma_f32_16x16x32_bf16 v[180:183], a[176:179], a[76:79], v[180:183]
s_waitcnt lgkmcnt(8)
ds_read_b64_tr_b16 a[224:225], v248 offset:45056
s_add_u32 m0, s29, 69632
v_mfma_f32_16x16x32_bf16 v[184:187], a[180:183], a[72:75], v[184:187]
ds_read_b64_tr_b16 a[226:227], v248 offset:45568
v_mul_f32 v149, s32, v149
v_mfma_f32_16x16x32_bf16 v[188:191], a[180:183], a[76:79], v[188:191]
s_waitcnt lgkmcnt(8)
buffer_load_dwordx4 v252, s[8:11], s55 offen nt lds
v_mfma_f32_16x16x32_bf16 v[160:163], a[192:195], a[80:83], v[160:163]
ds_read_b64_tr_b16 a[228:229], v249 offset:45056
v_mul_f32 v150, s32, v150
v_mfma_f32_16x16x32_bf16 v[164:167], a[192:195], a[84:87], v[164:167]
ds_read_b64_tr_b16 a[230:231], v249 offset:45568
v_mul_f32 v151, s32, v151
v_mfma_f32_16x16x32_bf16 v[212:215], a[192:195], a[152:155], v[212:215]
s_waitcnt lgkmcnt(8)
ds_read_b64_tr_b16 a[240:241], v250 offset:45056
v_cvt_pk_bf16_f32 v36, v148, v149
v_mfma_f32_16x16x32_bf16 v[168:171], a[196:199], a[80:83], v[168:171]
ds_read_b64_tr_b16 a[242:243], v250 offset:45568
v_cvt_pk_bf16_f32 v37, v150, v151
v_mfma_f32_16x16x32_bf16 v[172:175], a[196:199], a[84:87], v[172:175]
s_waitcnt lgkmcnt(8)
ds_read_b64_tr_b16 a[244:245], v251 offset:45056
v_mul_f32 v156, s32, v156
v_mfma_f32_16x16x32_bf16 v[176:179], a[208:211], a[80:83], v[176:179]
ds_read_b64_tr_b16 a[246:247], v251 offset:45568
s_add_u32 m0, s29, 73728
v_mfma_f32_16x16x32_bf16 v[180:183], a[208:211], a[84:87], v[180:183]
s_waitcnt lgkmcnt(8)
ds_read_b64_tr_b16 a[176:177], v248 offset:49152
buffer_load_dwordx4 v252, s[8:11], s56 offen nt lds
v_mfma_f32_16x16x32_bf16 v[184:187], a[212:215], a[80:83], v[184:187]
ds_read_b64_tr_b16 a[178:179], v248 offset:49664
v_mul_f32 v157, s32, v157
v_mfma_f32_16x16x32_bf16 v[188:191], a[212:215], a[84:87], v[188:191]
s_waitcnt lgkmcnt(8)
ds_read_b64_tr_b16 a[180:181], v249 offset:49152
v_mul_f32 v158, s32, v158
v_mfma_f32_16x16x32_bf16 v[160:163], a[224:227], a[88:91], v[160:163]
ds_read_b64_tr_b16 a[182:183], v249 offset:49664
v_mul_f32 v159, s32, v159
v_mfma_f32_16x16x32_bf16 v[164:167], a[224:227], a[92:95], v[164:167]
ds_read_b64_tr_b16 a[192:193], v250 offset:49152
v_cvt_pk_bf16_f32 v38, v156, v157
v_mfma_f32_16x16x32_bf16 v[212:215], a[224:227], a[156:159], v[212:215]
s_waitcnt lgkmcnt(9)
ds_read_b64_tr_b16 a[194:195], v250 offset:49664
v_cvt_pk_bf16_f32 v39, v158, v159
v_mfma_f32_16x16x32_bf16 v[168:171], a[228:231], a[88:91], v[168:171]
v_permlane32_swap_b32 v36, v38
v_mfma_f32_16x16x32_bf16 v[172:175], a[228:231], a[92:95], v[172:175]
s_waitcnt lgkmcnt(8)
ds_read_b64_tr_b16 a[212:213], v251 offset:49152
s_add_u32 m0, s29, 77824
v_mfma_f32_16x16x32_bf16 v[176:179], a[240:243], a[88:91], v[176:179]
ds_read_b64_tr_b16 a[214:215], v251 offset:49664
buffer_load_dwordx4 v252, s[8:11], s57 offen nt lds
v_mfma_f32_16x16x32_bf16 v[180:183], a[240:243], a[92:95], v[180:183]
s_waitcnt lgkmcnt(8)
ds_read_b64_tr_b16 a[224:225], v248 offset:53248
v_permlane32_swap_b32 v37, v39
v_mfma_f32_16x16x32_bf16 v[184:187], a[244:247], a[88:91], v[184:187]
ds_read_b64_tr_b16 a[226:227], v248 offset:53760
v_permlane16_swap_b32 v36, v38
v_mfma_f32_16x16x32_bf16 v[188:191], a[244:247], a[92:95], v[188:191]
s_waitcnt lgkmcnt(8)
v_permlane16_swap_b32 v37, v39
v_mfma_f32_16x16x32_bf16 v[160:163], a[176:179], a[96:99], v[160:163]
ds_read_b64_tr_b16 a[228:229], v249 offset:53248
v_mul_f32 v208, s32, v208
v_mfma_f32_16x16x32_bf16 v[164:167], a[176:179], a[100:103], v[164:167]
ds_read_b64_tr_b16 a[230:231], v249 offset:53760
v_mul_f32 v209, s32, v209
v_mfma_f32_16x16x32_bf16 v[212:215], a[176:179], a[160:163], v[212:215]
s_waitcnt lgkmcnt(8)
ds_read_b64_tr_b16 a[240:241], v250 offset:53248
s_add_u32 m0, s29, 81920
v_mfma_f32_16x16x32_bf16 v[168:171], a[180:183], a[96:99], v[168:171]
ds_read_b64_tr_b16 a[242:243], v250 offset:53760
buffer_load_dwordx4 v252, s[8:11], s58 offen nt lds
v_mfma_f32_16x16x32_bf16 v[172:175], a[180:183], a[100:103], v[172:175]
s_waitcnt lgkmcnt(8)
ds_read_b64_tr_b16 a[244:245], v251 offset:53248
v_mul_f32 v210, s32, v210
v_mfma_f32_16x16x32_bf16 v[176:179], a[192:195], a[96:99], v[176:179]
ds_read_b64_tr_b16 a[246:247], v251 offset:53760
v_mul_f32 v211, s32, v211
v_mfma_f32_16x16x32_bf16 v[180:183], a[192:195], a[100:103], v[180:183]
s_waitcnt lgkmcnt(8)
ds_read_b64_tr_b16 a[176:177], v216 offset:0
v_cvt_pk_bf16_f32 v208, v208, v209
v_mfma_f32_16x16x32_bf16 v[184:187], a[212:215], a[96:99], v[184:187]
ds_read_b64_tr_b16 a[178:179], v216 offset:512
v_cvt_pk_bf16_f32 v209, v210, v211
v_mfma_f32_16x16x32_bf16 v[188:191], a[212:215], a[100:103], v[188:191]
s_waitcnt lgkmcnt(8)
ds_read_b64_tr_b16 a[180:181], v217 offset:0
ds_write_b64 v254, v[208:209] offset:0
v_mfma_f32_16x16x32_bf16 v[160:163], a[224:227], a[104:107], v[160:163]
ds_read_b64_tr_b16 a[182:183], v217 offset:512
v_mfma_f32_16x16x32_bf16 v[164:167], a[224:227], a[108:111], v[164:167]
ds_read_b64_tr_b16 a[192:193], v218 offset:0
v_mfma_f32_16x16x32_bf16 v[212:215], a[224:227], a[164:167], v[212:215]
s_waitcnt lgkmcnt(10)
ds_read_b64_tr_b16 a[194:195], v218 offset:512
v_mfma_f32_16x16x32_bf16 v[168:171], a[228:231], a[104:107], v[168:171]
ds_read_b64_tr_b16 a[196:197], v219 offset:0
v_mfma_f32_16x16x32_bf16 v[172:175], a[228:231], a[108:111], v[172:175]
s_waitcnt lgkmcnt(10)
ds_read_b64_tr_b16 a[198:199], v219 offset:512
v_mfma_f32_16x16x32_bf16 v[176:179], a[240:243], a[104:107], v[176:179]
ds_read_b64_tr_b16 a[208:209], v216 offset:4096
v_mfma_f32_16x16x32_bf16 v[180:183], a[240:243], a[108:111], v[180:183]
s_waitcnt lgkmcnt(10)
ds_read_b64_tr_b16 a[210:211], v216 offset:4608
v_mfma_f32_16x16x32_bf16 v[184:187], a[244:247], a[104:107], v[184:187]
v_mfma_f32_16x16x32_bf16 v[188:191], a[244:247], a[108:111], v[188:191]
s_waitcnt vmcnt(7) lgkmcnt(7)
s_barrier
s_waitcnt lgkmcnt(8)
v_mfma_f32_16x16x32_bf16 v[128:131], a[176:179], a[0:3], 0
ds_read_b64_tr_b16 a[212:213], v217 offset:4096
v_add_u32 v252, 1835392, v253
v_mfma_f32_16x16x32_bf16 v[132:135], a[176:179], a[4:7], 0
ds_read_b64_tr_b16 a[214:215], v217 offset:4608
s_add_u32 m0, s29, 86016
v_mfma_f32_16x16x32_bf16 v[208:211], a[176:179], a[112:115], 0
s_waitcnt lgkmcnt(8)
ds_read_b64_tr_b16 a[224:225], v218 offset:4096
v_mul_f32 v160, s32, v160
v_mfma_f32_16x16x32_bf16 v[136:139], a[180:183], a[0:3], 0
ds_read_b64_tr_b16 a[226:227], v218 offset:4608
v_mul_f32 v161, s32, v161
v_mfma_f32_16x16x32_bf16 v[140:143], a[180:183], a[4:7], 0
s_waitcnt lgkmcnt(8)
ds_read_b64_tr_b16 a[228:229], v219 offset:4096
v_mul_f32 v162, s32, v162
v_mfma_f32_16x16x32_bf16 v[144:147], a[192:195], a[0:3], 0
ds_read_b64_tr_b16 a[230:231], v219 offset:4608
buffer_load_dwordx4 v252, s[8:11], s52 offen nt lds
v_mfma_f32_16x16x32_bf16 v[148:151], a[192:195], a[4:7], 0
s_waitcnt lgkmcnt(8)
ds_read_b64_tr_b16 a[240:241], v216 offset:8192
v_mul_f32 v163, s32, v163
v_mfma_f32_16x16x32_bf16 v[152:155], a[196:199], a[0:3], 0
ds_read_b64_tr_b16 a[242:243], v216 offset:8704
v_cvt_pk_bf16_f32 v8, v160, v161
v_mfma_f32_16x16x32_bf16 v[156:159], a[196:199], a[4:7], 0
s_waitcnt lgkmcnt(8)
ds_read_b64_tr_b16 a[244:245], v217 offset:8192
s_add_u32 m0, s29, 90112
v_mfma_f32_16x16x32_bf16 v[128:131], a[208:211], a[8:11], v[128:131]
ds_read_b64_tr_b16 a[246:247], v217 offset:8704
v_cvt_pk_bf16_f32 v9, v162, v163
v_mfma_f32_16x16x32_bf16 v[132:135], a[208:211], a[12:15], v[132:135]
buffer_load_dwordx4 v252, s[8:11], s53 offen nt lds
v_mfma_f32_16x16x32_bf16 v[208:211], a[208:211], a[116:119], v[208:211]
s_waitcnt lgkmcnt(8)
ds_read_b64_tr_b16 a[176:177], v218 offset:8192
v_mul_f32 v168, s32, v168
v_mfma_f32_16x16x32_bf16 v[136:139], a[212:215], a[8:11], v[136:139]
ds_read_b64_tr_b16 a[178:179], v218 offset:8704
v_mul_f32 v169, s32, v169
v_mfma_f32_16x16x32_bf16 v[140:143], a[212:215], a[12:15], v[140:143]
s_waitcnt lgkmcnt(8)
ds_read_b64_tr_b16 a[180:181], v219 offset:8192
v_mul_f32 v170, s32, v170
v_mfma_f32_16x16x32_bf16 v[144:147], a[224:227], a[8:11], v[144:147]
ds_read_b64_tr_b16 a[182:183], v219 offset:8704
v_mul_f32 v171, s32, v171
v_mfma_f32_16x16x32_bf16 v[148:151], a[224:227], a[12:15], v[148:151]
s_waitcnt lgkmcnt(8)
ds_read_b64_tr_b16 a[192:193], v216 offset:12288
s_add_u32 m0, s29, 94208
v_mfma_f32_16x16x32_bf16 v[152:155], a[228:231], a[8:11], v[152:155]
ds_read_b64_tr_b16 a[194:195], v216 offset:12800
v_cvt_pk_bf16_f32 v10, v168, v169
v_mfma_f32_16x16x32_bf16 v[156:159], a[228:231], a[12:15], v[156:159]
s_waitcnt lgkmcnt(8)
buffer_load_dwordx4 v252, s[8:11], s54 offen nt lds
v_mfma_f32_16x16x32_bf16 v[128:131], a[240:243], a[16:19], v[128:131]
ds_read_b64_tr_b16 a[196:197], v217 offset:12288
v_cvt_pk_bf16_f32 v11, v170, v171
v_mfma_f32_16x16x32_bf16 v[132:135], a[240:243], a[20:23], v[132:135]
ds_read_b64_tr_b16 a[198:199], v217 offset:12800
v_mul_f32 v176, s32, v176
v_mfma_f32_16x16x32_bf16 v[208:211], a[240:243], a[120:123], v[208:211]
s_waitcnt lgkmcnt(8)
ds_read_b64_tr_b16 a[208:209], v218 offset:12288
s_add_u32 m0, s29, 98304
v_mfma_f32_16x16x32_bf16 v[136:139], a[244:247], a[16:19], v[136:139]
ds_read_b64_tr_b16 a[210:211], v218 offset:12800
v_mul_f32 v177, s32, v177
v_mfma_f32_16x16x32_bf16 v[140:143], a[244:247], a[20:23], v[140:143]
s_waitcnt lgkmcnt(8)
ds_read_b64_tr_b16 a[212:213], v219 offset:12288
v_mul_f32 v178, s32, v178
v_mfma_f32_16x16x32_bf16 v[144:147], a[176:179], a[16:19], v[144:147]
ds_read_b64_tr_b16 a[214:215], v219 offset:12800
v_permlane32_swap_b32 v8, v10
v_mfma_f32_16x16x32_bf16 v[148:151], a[176:179], a[20:23], v[148:151]
s_waitcnt lgkmcnt(8)
ds_read_b64_tr_b16 a[224:225], v216 offset:16384
v_permlane32_swap_b32 v9, v11
v_mfma_f32_16x16x32_bf16 v[152:155], a[180:183], a[16:19], v[152:155]
ds_read_b64_tr_b16 a[226:227], v216 offset:16896
v_mul_f32 v179, s32, v179
v_mfma_f32_16x16x32_bf16 v[156:159], a[180:183], a[20:23], v[156:159]
s_waitcnt lgkmcnt(8)
buffer_load_dwordx4 v252, s[8:11], s55 offen nt lds
v_mfma_f32_16x16x32_bf16 v[128:131], a[192:195], a[24:27], v[128:131]
ds_read_b64_tr_b16 a[228:229], v217 offset:16384
v_permlane16_swap_b32 v8, v10
v_mfma_f32_16x16x32_bf16 v[132:135], a[192:195], a[28:31], v[132:135]
ds_read_b64_tr_b16 a[230:231], v217 offset:16896
v_permlane16_swap_b32 v9, v11
v_mfma_f32_16x16x32_bf16 v[208:211], a[192:195], a[124:127], v[208:211]
s_waitcnt lgkmcnt(8)
ds_read_b64_tr_b16 a[240:241], v218 offset:16384
s_add_u32 m0, s29, 102400
v_mfma_f32_16x16x32_bf16 v[136:139], a[196:199], a[24:27], v[136:139]
ds_read_b64_tr_b16 a[242:243], v218 offset:16896
v_cvt_pk_bf16_f32 v12, v176, v177
v_mfma_f32_16x16x32_bf16 v[140:143], a[196:199], a[28:31], v[140:143]
s_waitcnt lgkmcnt(8)
ds_read_b64_tr_b16 a[244:245], v219 offset:16384
v_cvt_pk_bf16_f32 v13, v178, v179
v_mfma_f32_16x16x32_bf16 v[144:147], a[208:211], a[24:27], v[144:147]
ds_read_b64_tr_b16 a[246:247], v219 offset:16896
v_mul_f32 v184, s32, v184
v_mfma_f32_16x16x32_bf16 v[148:151], a[208:211], a[28:31], v[148:151]
s_waitcnt lgkmcnt(8)
ds_read_b64_tr_b16 a[176:177], v216 offset:20480
buffer_load_dwordx4 v252, s[8:11], s56 offen nt lds
v_mfma_f32_16x16x32_bf16 v[152:155], a[212:215], a[24:27], v[152:155]
ds_read_b64_tr_b16 a[178:179], v216 offset:20992
s_add_u32 m0, s29, 106496
v_mfma_f32_16x16x32_bf16 v[156:159], a[212:215], a[28:31], v[156:159]
s_waitcnt lgkmcnt(8)
ds_read_b64_tr_b16 a[180:181], v217 offset:20480
v_mul_f32 v185, s32, v185
v_mfma_f32_16x16x32_bf16 v[128:131], a[224:227], a[32:35], v[128:131]
ds_read_b64_tr_b16 a[182:183], v217 offset:20992
v_mul_f32 v186, s32, v186
v_mfma_f32_16x16x32_bf16 v[132:135], a[224:227], a[36:39], v[132:135]
buffer_load_dwordx4 v252, s[8:11], s57 offen nt lds
v_mfma_f32_16x16x32_bf16 v[208:211], a[224:227], a[128:131], v[208:211]
s_waitcnt lgkmcnt(8)
ds_read_b64_tr_b16 a[192:193], v218 offset:20480
v_mul_f32 v187, s32, v187
v_mfma_f32_16x16x32_bf16 v[136:139], a[228:231], a[32:35], v[136:139]
ds_read_b64_tr_b16 a[194:195], v218 offset:20992
v_cvt_pk_bf16_f32 v14, v184, v185
v_mfma_f32_16x16x32_bf16 v[140:143], a[228:231], a[36:39], v[140:143]
s_waitcnt lgkmcnt(8)
ds_read_b64_tr_b16 a[212:213], v219 offset:20480
v_cvt_pk_bf16_f32 v15, v186, v187
v_mfma_f32_16x16x32_bf16 v[144:147], a[240:243], a[32:35], v[144:147]
ds_read_b64_tr_b16 a[214:215], v219 offset:20992
s_add_u32 m0, s29, 110592
v_mfma_f32_16x16x32_bf16 v[148:151], a[240:243], a[36:39], v[148:151]
s_waitcnt lgkmcnt(8)
ds_read_b64_tr_b16 a[224:225], v216 offset:24576
v_mfma_f32_16x16x32_bf16 v[152:155], a[244:247], a[32:35], v[152:155]
ds_read_b64_tr_b16 a[226:227], v216 offset:25088
v_mfma_f32_16x16x32_bf16 v[156:159], a[244:247], a[36:39], v[156:159]
s_waitcnt lgkmcnt(8)
buffer_load_dwordx4 v252, s[8:11], s58 offen nt lds
v_mfma_f32_16x16x32_bf16 v[128:131], a[176:179], a[40:43], v[128:131]
ds_read_b64_tr_b16 a[228:229], v217 offset:24576
v_mfma_f32_16x16x32_bf16 v[132:135], a[176:179], a[44:47], v[132:135]
ds_read_b64_tr_b16 a[230:231], v217 offset:25088
v_mfma_f32_16x16x32_bf16 v[208:211], a[176:179], a[132:135], v[208:211]
s_waitcnt lgkmcnt(8)
ds_read_b64_tr_b16 a[240:241], v218 offset:24576
v_permlane32_swap_b32 v12, v14
v_mfma_f32_16x16x32_bf16 v[136:139], a[180:183], a[40:43], v[136:139]
ds_read_b64_tr_b16 a[242:243], v218 offset:25088
v_mfma_f32_16x16x32_bf16 v[140:143], a[180:183], a[44:47], v[140:143]
s_waitcnt lgkmcnt(8)
ds_read_b64_tr_b16 a[244:245], v219 offset:24576
v_permlane32_swap_b32 v13, v15
v_mfma_f32_16x16x32_bf16 v[144:147], a[192:195], a[40:43], v[144:147]
ds_read_b64_tr_b16 a[246:247], v219 offset:25088
v_permlane16_swap_b32 v12, v14
v_mfma_f32_16x16x32_bf16 v[148:151], a[192:195], a[44:47], v[148:151]
s_waitcnt lgkmcnt(8)
ds_read_b64_tr_b16 a[176:177], v216 offset:28672
v_mfma_f32_16x16x32_bf16 v[152:155], a[212:215], a[40:43], v[152:155]
ds_read_b64_tr_b16 a[178:179], v216 offset:29184
v_permlane16_swap_b32 v13, v15
v_mfma_f32_16x16x32_bf16 v[156:159], a[212:215], a[44:47], v[156:159]
s_waitcnt lgkmcnt(8)
ds_read_b64_tr_b16 a[180:181], v217 offset:28672
v_mfma_f32_16x16x32_bf16 v[128:131], a[224:227], a[48:51], v[128:131]
ds_read_b64_tr_b16 a[182:183], v217 offset:29184
v_mfma_f32_16x16x32_bf16 v[132:135], a[224:227], a[52:55], v[132:135]
ds_read_b64_tr_b16 a[192:193], v218 offset:28672
v_mfma_f32_16x16x32_bf16 v[208:211], a[224:227], a[136:139], v[208:211]
s_waitcnt lgkmcnt(9)
ds_read_b64_tr_b16 a[194:195], v218 offset:29184
v_mfma_f32_16x16x32_bf16 v[136:139], a[228:231], a[48:51], v[136:139]
ds_read_b64_tr_b16 a[196:197], v219 offset:28672
v_mfma_f32_16x16x32_bf16 v[140:143], a[228:231], a[52:55], v[140:143]
s_waitcnt lgkmcnt(9)
ds_read_b64_tr_b16 a[198:199], v219 offset:29184
v_mfma_f32_16x16x32_bf16 v[144:147], a[240:243], a[48:51], v[144:147]
ds_read_b64_tr_b16 a[208:209], v216 offset:32768
v_mfma_f32_16x16x32_bf16 v[148:151], a[240:243], a[52:55], v[148:151]
s_waitcnt lgkmcnt(9)
ds_read_b64_tr_b16 a[210:211], v216 offset:33280
v_mfma_f32_16x16x32_bf16 v[152:155], a[244:247], a[48:51], v[152:155]
v_mfma_f32_16x16x32_bf16 v[156:159], a[244:247], a[52:55], v[156:159]
s_waitcnt vmcnt(7) lgkmcnt(10)
s_barrier
s_waitcnt lgkmcnt(8)
v_mfma_f32_16x16x32_bf16 v[128:131], a[176:179], a[56:59], v[128:131]
ds_read_b64_tr_b16 a[212:213], v217 offset:32768
v_add_u32 v252, 512, v253
v_mfma_f32_16x16x32_bf16 v[132:135], a[176:179], a[60:63], v[132:135]
ds_read_b64_tr_b16 a[214:215], v217 offset:33280
s_add_u32 m0, s29, 0
v_mfma_f32_16x16x32_bf16 v[208:211], a[176:179], a[140:143], v[208:211]
s_waitcnt lgkmcnt(8)
ds_read_b64_tr_b16 a[224:225], v218 offset:32768
v_mul_f32 v164, s32, v164
v_mfma_f32_16x16x32_bf16 v[136:139], a[180:183], a[56:59], v[136:139]
ds_read_b64_tr_b16 a[226:227], v218 offset:33280
v_mul_f32 v165, s32, v165
v_mfma_f32_16x16x32_bf16 v[140:143], a[180:183], a[60:63], v[140:143]
s_waitcnt lgkmcnt(8)
ds_read_b64_tr_b16 a[228:229], v219 offset:32768
v_mul_f32 v166, s32, v166
v_mfma_f32_16x16x32_bf16 v[144:147], a[192:195], a[56:59], v[144:147]
ds_read_b64_tr_b16 a[230:231], v219 offset:33280
buffer_load_dwordx4 v252, s[8:11], s52 offen nt lds
v_mfma_f32_16x16x32_bf16 v[148:151], a[192:195], a[60:63], v[148:151]
s_waitcnt lgkmcnt(8)
ds_read_b64_tr_b16 a[240:241], v216 offset:36864
v_mul_f32 v167, s32, v167
v_mfma_f32_16x16x32_bf16 v[152:155], a[196:199], a[56:59], v[152:155]
ds_read_b64_tr_b16 a[242:243], v216 offset:37376
v_cvt_pk_bf16_f32 v40, v164, v165
v_mfma_f32_16x16x32_bf16 v[156:159], a[196:199], a[60:63], v[156:159]
s_waitcnt lgkmcnt(8)
ds_read_b64_tr_b16 a[244:245], v217 offset:36864
v_cvt_pk_bf16_f32 v41, v166, v167
v_mfma_f32_16x16x32_bf16 v[128:131], a[208:211], a[64:67], v[128:131]
ds_read_b64_tr_b16 a[246:247], v217 offset:37376
s_add_u32 m0, s29, 4096
v_mfma_f32_16x16x32_bf16 v[132:135], a[208:211], a[68:71], v[132:135]
buffer_load_dwordx4 v252, s[8:11], s53 offen nt lds
v_mfma_f32_16x16x32_bf16 v[208:211], a[208:211], a[144:147], v[208:211]
s_waitcnt lgkmcnt(8)
ds_read_b64_tr_b16 a[176:177], v218 offset:36864
v_mul_f32 v172, s32, v172
v_mfma_f32_16x16x32_bf16 v[136:139], a[212:215], a[64:67], v[136:139]
ds_read_b64_tr_b16 a[178:179], v218 offset:37376
v_mul_f32 v173, s32, v173
v_mfma_f32_16x16x32_bf16 v[140:143], a[212:215], a[68:71], v[140:143]
s_waitcnt lgkmcnt(8)
ds_read_b64_tr_b16 a[180:181], v219 offset:36864
v_mul_f32 v174, s32, v174
v_mfma_f32_16x16x32_bf16 v[144:147], a[224:227], a[64:67], v[144:147]
ds_read_b64_tr_b16 a[182:183], v219 offset:37376
v_mul_f32 v175, s32, v175
v_mfma_f32_16x16x32_bf16 v[148:151], a[224:227], a[68:71], v[148:151]
s_waitcnt lgkmcnt(8)
ds_read_b64_tr_b16 a[192:193], v216 offset:40960
v_cvt_pk_bf16_f32 v42, v172, v173
v_mfma_f32_16x16x32_bf16 v[152:155], a[228:231], a[64:67], v[152:155]
ds_read_b64_tr_b16 a[194:195], v216 offset:41472
v_cvt_pk_bf16_f32 v43, v174, v175
v_mfma_f32_16x16x32_bf16 v[156:159], a[228:231], a[68:71], v[156:159]
s_waitcnt lgkmcnt(8)
v_permlane32_swap_b32 v40, v42
v_mfma_f32_16x16x32_bf16 v[128:131], a[240:243], a[72:75], v[128:131]
ds_read_b64_tr_b16 a[196:197], v217 offset:40960
s_add_u32 m0, s29, 8192
v_mfma_f32_16x16x32_bf16 v[132:135], a[240:243], a[76:79], v[132:135]
ds_read_b64_tr_b16 a[198:199], v217 offset:41472
buffer_load_dwordx4 v252, s[8:11], s54 offen nt lds
v_mfma_f32_16x16x32_bf16 v[208:211], a[240:243], a[148:151], v[208:211]
s_waitcnt lgkmcnt(8)
ds_read_b64_tr_b16 a[208:209], v218 offset:40960
v_mul_f32 v180, s32, v180
v_mfma_f32_16x16x32_bf16 v[136:139], a[244:247], a[72:75], v[136:139]
ds_read_b64_tr_b16 a[210:211], v218 offset:41472
v_permlane32_swap_b32 v41, v43
v_mfma_f32_16x16x32_bf16 v[140:143], a[244:247], a[76:79], v[140:143]
s_waitcnt lgkmcnt(8)
ds_read_b64_tr_b16 a[212:213], v219 offset:40960
v_permlane16_swap_b32 v40, v42
v_mfma_f32_16x16x32_bf16 v[144:147], a[176:179], a[72:75], v[144:147]
ds_read_b64_tr_b16 a[214:215], v219 offset:41472
v_permlane16_swap_b32 v41, v43
v_mfma_f32_16x16x32_bf16 v[148:151], a[176:179], a[76:79], v[148:151]
s_waitcnt lgkmcnt(8)
ds_read_b64_tr_b16 a[224:225], v216 offset:45056
s_add_u32 m0, s29, 12288
v_mfma_f32_16x16x32_bf16 v[152:155], a[180:183], a[72:75], v[152:155]
ds_read_b64_tr_b16 a[226:227], v216 offset:45568
v_mul_f32 v181, s32, v181
v_mfma_f32_16x16x32_bf16 v[156:159], a[180:183], a[76:79], v[156:159]
s_waitcnt lgkmcnt(8)
buffer_load_dwordx4 v252, s[8:11], s55 offen nt lds
v_mfma_f32_16x16x32_bf16 v[128:131], a[192:195], a[80:83], v[128:131]
ds_read_b64_tr_b16 a[228:229], v217 offset:45056
v_mul_f32 v182, s32, v182
v_mfma_f32_16x16x32_bf16 v[132:135], a[192:195], a[84:87], v[132:135]
ds_read_b64_tr_b16 a[230:231], v217 offset:45568
v_mul_f32 v183, s32, v183
v_mfma_f32_16x16x32_bf16 v[208:211], a[192:195], a[152:155], v[208:211]
s_waitcnt lgkmcnt(8)
ds_read_b64_tr_b16 a[240:241], v218 offset:45056
v_cvt_pk_bf16_f32 v44, v180, v181
v_mfma_f32_16x16x32_bf16 v[136:139], a[196:199], a[80:83], v[136:139]
ds_read_b64_tr_b16 a[242:243], v218 offset:45568
v_cvt_pk_bf16_f32 v45, v182, v183
v_mfma_f32_16x16x32_bf16 v[140:143], a[196:199], a[84:87], v[140:143]
s_waitcnt lgkmcnt(8)
ds_read_b64_tr_b16 a[244:245], v219 offset:45056
v_mul_f32 v188, s32, v188
v_mfma_f32_16x16x32_bf16 v[144:147], a[208:211], a[80:83], v[144:147]
ds_read_b64_tr_b16 a[246:247], v219 offset:45568
s_add_u32 m0, s29, 16384
v_mfma_f32_16x16x32_bf16 v[148:151], a[208:211], a[84:87], v[148:151]
s_waitcnt lgkmcnt(8)
ds_read_b64_tr_b16 a[176:177], v216 offset:49152
buffer_load_dwordx4 v252, s[8:11], s56 offen nt lds
v_mfma_f32_16x16x32_bf16 v[152:155], a[212:215], a[80:83], v[152:155]
ds_read_b64_tr_b16 a[178:179], v216 offset:49664
v_mul_f32 v189, s32, v189
v_mfma_f32_16x16x32_bf16 v[156:159], a[212:215], a[84:87], v[156:159]
s_waitcnt lgkmcnt(8)
ds_read_b64_tr_b16 a[180:181], v217 offset:49152
v_mul_f32 v190, s32, v190
v_mfma_f32_16x16x32_bf16 v[128:131], a[224:227], a[88:91], v[128:131]
ds_read_b64_tr_b16 a[182:183], v217 offset:49664
v_mul_f32 v191, s32, v191
v_mfma_f32_16x16x32_bf16 v[132:135], a[224:227], a[92:95], v[132:135]
ds_read_b64_tr_b16 a[192:193], v218 offset:49152
v_cvt_pk_bf16_f32 v46, v188, v189
v_mfma_f32_16x16x32_bf16 v[208:211], a[224:227], a[156:159], v[208:211]
s_waitcnt lgkmcnt(9)
ds_read_b64_tr_b16 a[194:195], v218 offset:49664
v_cvt_pk_bf16_f32 v47, v190, v191
v_mfma_f32_16x16x32_bf16 v[136:139], a[228:231], a[88:91], v[136:139]
v_permlane32_swap_b32 v44, v46
v_mfma_f32_16x16x32_bf16 v[140:143], a[228:231], a[92:95], v[140:143]
s_waitcnt lgkmcnt(8)
ds_read_b64_tr_b16 a[212:213], v219 offset:49152
s_add_u32 m0, s29, 20480
v_mfma_f32_16x16x32_bf16 v[144:147], a[240:243], a[88:91], v[144:147]
ds_read_b64_tr_b16 a[214:215], v219 offset:49664
buffer_load_dwordx4 v252, s[8:11], s57 offen nt lds
v_mfma_f32_16x16x32_bf16 v[148:151], a[240:243], a[92:95], v[148:151]
s_waitcnt lgkmcnt(8)
ds_read_b64_tr_b16 a[224:225], v216 offset:53248
v_permlane32_swap_b32 v45, v47
v_mfma_f32_16x16x32_bf16 v[152:155], a[244:247], a[88:91], v[152:155]
ds_read_b64_tr_b16 a[226:227], v216 offset:53760
v_permlane16_swap_b32 v44, v46
v_mfma_f32_16x16x32_bf16 v[156:159], a[244:247], a[92:95], v[156:159]
s_waitcnt lgkmcnt(8)
v_permlane16_swap_b32 v45, v47
v_mfma_f32_16x16x32_bf16 v[128:131], a[176:179], a[96:99], v[128:131]
ds_read_b64_tr_b16 a[228:229], v217 offset:53248
v_mul_f32 v212, s32, v212
v_mfma_f32_16x16x32_bf16 v[132:135], a[176:179], a[100:103], v[132:135]
ds_read_b64_tr_b16 a[230:231], v217 offset:53760
v_mul_f32 v213, s32, v213
v_mfma_f32_16x16x32_bf16 v[208:211], a[176:179], a[160:163], v[208:211]
s_waitcnt lgkmcnt(8)
ds_read_b64_tr_b16 a[240:241], v218 offset:53248
s_add_u32 m0, s29, 24576
v_mfma_f32_16x16x32_bf16 v[136:139], a[180:183], a[96:99], v[136:139]
ds_read_b64_tr_b16 a[242:243], v218 offset:53760
buffer_load_dwordx4 v252, s[8:11], s58 offen nt lds
v_mfma_f32_16x16x32_bf16 v[140:143], a[180:183], a[100:103], v[140:143]
s_waitcnt lgkmcnt(8)
ds_read_b64_tr_b16 a[244:245], v219 offset:53248
v_mul_f32 v214, s32, v214
v_mfma_f32_16x16x32_bf16 v[144:147], a[192:195], a[96:99], v[144:147]
ds_read_b64_tr_b16 a[246:247], v219 offset:53760
v_mul_f32 v215, s32, v215
v_mfma_f32_16x16x32_bf16 v[148:151], a[192:195], a[100:103], v[148:151]
s_waitcnt lgkmcnt(8)
ds_read_b64_tr_b16 a[176:177], v248 offset:0
v_cvt_pk_bf16_f32 v212, v212, v213
v_mfma_f32_16x16x32_bf16 v[152:155], a[212:215], a[96:99], v[152:155]
ds_read_b64_tr_b16 a[178:179], v248 offset:512
v_cvt_pk_bf16_f32 v213, v214, v215
v_mfma_f32_16x16x32_bf16 v[156:159], a[212:215], a[100:103], v[156:159]
s_waitcnt lgkmcnt(8)
ds_read_b64_tr_b16 a[180:181], v249 offset:0
ds_write_b64 v254, v[212:213] offset:2048
v_mfma_f32_16x16x32_bf16 v[128:131], a[224:227], a[104:107], v[128:131]
ds_read_b64_tr_b16 a[182:183], v249 offset:512
v_mfma_f32_16x16x32_bf16 v[132:135], a[224:227], a[108:111], v[132:135]
ds_read_b64_tr_b16 a[192:193], v250 offset:0
v_mfma_f32_16x16x32_bf16 v[208:211], a[224:227], a[164:167], v[208:211]
s_waitcnt lgkmcnt(10)
ds_read_b64_tr_b16 a[194:195], v250 offset:512
v_mfma_f32_16x16x32_bf16 v[136:139], a[228:231], a[104:107], v[136:139]
ds_read_b64_tr_b16 a[196:197], v251 offset:0
v_mfma_f32_16x16x32_bf16 v[140:143], a[228:231], a[108:111], v[140:143]
s_waitcnt lgkmcnt(10)
ds_read_b64_tr_b16 a[198:199], v251 offset:512
v_mfma_f32_16x16x32_bf16 v[144:147], a[240:243], a[104:107], v[144:147]
ds_read_b64_tr_b16 a[208:209], v248 offset:4096
v_mfma_f32_16x16x32_bf16 v[148:151], a[240:243], a[108:111], v[148:151]
s_waitcnt lgkmcnt(10)
ds_read_b64_tr_b16 a[210:211], v248 offset:4608
v_mfma_f32_16x16x32_bf16 v[152:155], a[244:247], a[104:107], v[152:155]
v_mfma_f32_16x16x32_bf16 v[156:159], a[244:247], a[108:111], v[156:159]
s_waitcnt vmcnt(7) lgkmcnt(7)
s_barrier
s_waitcnt lgkmcnt(8)
v_mfma_f32_16x16x32_bf16 v[160:163], a[176:179], a[0:3], 0
ds_read_b64_tr_b16 a[212:213], v249 offset:4096
v_add_u32 v252, 1835520, v253
v_mfma_f32_16x16x32_bf16 v[164:167], a[176:179], a[4:7], 0
ds_read_b64_tr_b16 a[214:215], v249 offset:4608
s_add_u32 m0, s29, 28672
v_mfma_f32_16x16x32_bf16 v[212:215], a[176:179], a[112:115], 0
s_waitcnt lgkmcnt(8)
ds_read_b64_tr_b16 a[224:225], v250 offset:4096
v_mul_f32 v128, s32, v128
v_mfma_f32_16x16x32_bf16 v[168:171], a[180:183], a[0:3], 0
ds_read_b64_tr_b16 a[226:227], v250 offset:4608
v_mul_f32 v129, s32, v129
v_mfma_f32_16x16x32_bf16 v[172:175], a[180:183], a[4:7], 0
s_waitcnt lgkmcnt(8)
ds_read_b64_tr_b16 a[228:229], v251 offset:4096
v_mul_f32 v130, s32, v130
v_mfma_f32_16x16x32_bf16 v[176:179], a[192:195], a[0:3], 0
ds_read_b64_tr_b16 a[230:231], v251 offset:4608
buffer_load_dwordx4 v252, s[8:11], s52 offen nt lds
v_mfma_f32_16x16x32_bf16 v[180:183], a[192:195], a[4:7], 0
s_waitcnt lgkmcnt(8)
ds_read_b64_tr_b16 a[240:241], v248 offset:8192
v_mul_f32 v131, s32, v131
v_mfma_f32_16x16x32_bf16 v[184:187], a[196:199], a[0:3], 0
ds_read_b64_tr_b16 a[242:243], v248 offset:8704
v_cvt_pk_bf16_f32 v16, v128, v129
v_mfma_f32_16x16x32_bf16 v[188:191], a[196:199], a[4:7], 0
s_waitcnt lgkmcnt(8)
ds_read_b64_tr_b16 a[244:245], v249 offset:8192
s_add_u32 m0, s29, 32768
v_mfma_f32_16x16x32_bf16 v[160:163], a[208:211], a[8:11], v[160:163]
ds_read_b64_tr_b16 a[246:247], v249 offset:8704
v_cvt_pk_bf16_f32 v17, v130, v131
v_mfma_f32_16x16x32_bf16 v[164:167], a[208:211], a[12:15], v[164:167]
buffer_load_dwordx4 v252, s[8:11], s53 offen nt lds
v_mfma_f32_16x16x32_bf16 v[212:215], a[208:211], a[116:119], v[212:215]
s_waitcnt lgkmcnt(8)
ds_read_b64_tr_b16 a[176:177], v250 offset:8192
v_mul_f32 v136, s32, v136
v_mfma_f32_16x16x32_bf16 v[168:171], a[212:215], a[8:11], v[168:171]
ds_read_b64_tr_b16 a[178:179], v250 offset:8704
v_mul_f32 v137, s32, v137
v_mfma_f32_16x16x32_bf16 v[172:175], a[212:215], a[12:15], v[172:175]
s_waitcnt lgkmcnt(8)
ds_read_b64_tr_b16 a[180:181], v251 offset:8192
v_mul_f32 v138, s32, v138
v_mfma_f32_16x16x32_bf16 v[176:179], a[224:227], a[8:11], v[176:179]
ds_read_b64_tr_b16 a[182:183], v251 offset:8704
v_mul_f32 v139, s32, v139
v_mfma_f32_16x16x32_bf16 v[180:183], a[224:227], a[12:15], v[180:183]
s_waitcnt lgkmcnt(8)
ds_read_b64_tr_b16 a[192:193], v248 offset:12288
s_add_u32 m0, s29, 36864
v_mfma_f32_16x16x32_bf16 v[184:187], a[228:231], a[8:11], v[184:187]
ds_read_b64_tr_b16 a[194:195], v248 offset:12800
v_cvt_pk_bf16_f32 v18, v136, v137
v_mfma_f32_16x16x32_bf16 v[188:191], a[228:231], a[12:15], v[188:191]
s_waitcnt lgkmcnt(8)
buffer_load_dwordx4 v252, s[8:11], s54 offen nt lds
v_mfma_f32_16x16x32_bf16 v[160:163], a[240:243], a[16:19], v[160:163]
ds_read_b64_tr_b16 a[196:197], v249 offset:12288
v_cvt_pk_bf16_f32 v19, v138, v139
v_mfma_f32_16x16x32_bf16 v[164:167], a[240:243], a[20:23], v[164:167]
ds_read_b64_tr_b16 a[198:199], v249 offset:12800
v_mul_f32 v144, s32, v144
v_mfma_f32_16x16x32_bf16 v[212:215], a[240:243], a[120:123], v[212:215]
s_waitcnt lgkmcnt(8)
ds_read_b64_tr_b16 a[208:209], v250 offset:12288
s_add_u32 m0, s29, 40960
v_mfma_f32_16x16x32_bf16 v[168:171], a[244:247], a[16:19], v[168:171]
ds_read_b64_tr_b16 a[210:211], v250 offset:12800
v_mul_f32 v145, s32, v145
v_mfma_f32_16x16x32_bf16 v[172:175], a[244:247], a[20:23], v[172:175]
s_waitcnt lgkmcnt(8)
ds_read_b64_tr_b16 a[212:213], v251 offset:12288
v_mul_f32 v146, s32, v146
v_mfma_f32_16x16x32_bf16 v[176:179], a[176:179], a[16:19], v[176:179]
ds_read_b64_tr_b16 a[214:215], v251 offset:12800
v_permlane32_swap_b32 v16, v18
v_mfma_f32_16x16x32_bf16 v[180:183], a[176:179], a[20:23], v[180:183]
s_waitcnt lgkmcnt(8)
ds_read_b64_tr_b16 a[224:225], v248 offset:16384
v_permlane32_swap_b32 v17, v19
v_mfma_f32_16x16x32_bf16 v[184:187], a[180:183], a[16:19], v[184:187]
ds_read_b64_tr_b16 a[226:227], v248 offset:16896
v_mul_f32 v147, s32, v147
v_mfma_f32_16x16x32_bf16 v[188:191], a[180:183], a[20:23], v[188:191]
s_waitcnt lgkmcnt(8)
buffer_load_dwordx4 v252, s[8:11], s55 offen nt lds
v_mfma_f32_16x16x32_bf16 v[160:163], a[192:195], a[24:27], v[160:163]
ds_read_b64_tr_b16 a[228:229], v249 offset:16384
v_permlane16_swap_b32 v16, v18
v_mfma_f32_16x16x32_bf16 v[164:167], a[192:195], a[28:31], v[164:167]
ds_read_b64_tr_b16 a[230:231], v249 offset:16896
v_permlane16_swap_b32 v17, v19
v_mfma_f32_16x16x32_bf16 v[212:215], a[192:195], a[124:127], v[212:215]
s_waitcnt lgkmcnt(8)
ds_read_b64_tr_b16 a[240:241], v250 offset:16384
s_add_u32 m0, s29, 45056
v_mfma_f32_16x16x32_bf16 v[168:171], a[196:199], a[24:27], v[168:171]
ds_read_b64_tr_b16 a[242:243], v250 offset:16896
v_cvt_pk_bf16_f32 v20, v144, v145
v_mfma_f32_16x16x32_bf16 v[172:175], a[196:199], a[28:31], v[172:175]
s_waitcnt lgkmcnt(8)
ds_read_b64_tr_b16 a[244:245], v251 offset:16384
v_cvt_pk_bf16_f32 v21, v146, v147
v_mfma_f32_16x16x32_bf16 v[176:179], a[208:211], a[24:27], v[176:179]
ds_read_b64_tr_b16 a[246:247], v251 offset:16896
v_mul_f32 v152, s32, v152
v_mfma_f32_16x16x32_bf16 v[180:183], a[208:211], a[28:31], v[180:183]
s_waitcnt lgkmcnt(8)
ds_read_b64_tr_b16 a[176:177], v248 offset:20480
buffer_load_dwordx4 v252, s[8:11], s56 offen nt lds
v_mfma_f32_16x16x32_bf16 v[184:187], a[212:215], a[24:27], v[184:187]
ds_read_b64_tr_b16 a[178:179], v248 offset:20992
s_add_u32 m0, s29, 49152
v_mfma_f32_16x16x32_bf16 v[188:191], a[212:215], a[28:31], v[188:191]
s_waitcnt lgkmcnt(8)
ds_read_b64_tr_b16 a[180:181], v249 offset:20480
v_mul_f32 v153, s32, v153
v_mfma_f32_16x16x32_bf16 v[160:163], a[224:227], a[32:35], v[160:163]
ds_read_b64_tr_b16 a[182:183], v249 offset:20992
v_mul_f32 v154, s32, v154
v_mfma_f32_16x16x32_bf16 v[164:167], a[224:227], a[36:39], v[164:167]
buffer_load_dwordx4 v252, s[8:11], s57 offen nt lds
v_mfma_f32_16x16x32_bf16 v[212:215], a[224:227], a[128:131], v[212:215]
s_waitcnt lgkmcnt(8)
ds_read_b64_tr_b16 a[192:193], v250 offset:20480
v_mul_f32 v155, s32, v155
v_mfma_f32_16x16x32_bf16 v[168:171], a[228:231], a[32:35], v[168:171]
ds_read_b64_tr_b16 a[194:195], v250 offset:20992
v_cvt_pk_bf16_f32 v22, v152, v153
v_mfma_f32_16x16x32_bf16 v[172:175], a[228:231], a[36:39], v[172:175]
s_waitcnt lgkmcnt(8)
ds_read_b64_tr_b16 a[212:213], v251 offset:20480
v_cvt_pk_bf16_f32 v23, v154, v155
v_mfma_f32_16x16x32_bf16 v[176:179], a[240:243], a[32:35], v[176:179]
ds_read_b64_tr_b16 a[214:215], v251 offset:20992
s_add_u32 m0, s29, 53248
v_mfma_f32_16x16x32_bf16 v[180:183], a[240:243], a[36:39], v[180:183]
s_waitcnt lgkmcnt(8)
ds_read_b64_tr_b16 a[224:225], v248 offset:24576
v_mfma_f32_16x16x32_bf16 v[184:187], a[244:247], a[32:35], v[184:187]
ds_read_b64_tr_b16 a[226:227], v248 offset:25088
v_mfma_f32_16x16x32_bf16 v[188:191], a[244:247], a[36:39], v[188:191]
s_waitcnt lgkmcnt(8)
buffer_load_dwordx4 v252, s[8:11], s58 offen nt lds
v_mfma_f32_16x16x32_bf16 v[160:163], a[176:179], a[40:43], v[160:163]
ds_read_b64_tr_b16 a[228:229], v249 offset:24576
v_mfma_f32_16x16x32_bf16 v[164:167], a[176:179], a[44:47], v[164:167]
ds_read_b64_tr_b16 a[230:231], v249 offset:25088
v_mfma_f32_16x16x32_bf16 v[212:215], a[176:179], a[132:135], v[212:215]
s_waitcnt lgkmcnt(8)
ds_read_b64_tr_b16 a[240:241], v250 offset:24576
v_permlane32_swap_b32 v20, v22
v_mfma_f32_16x16x32_bf16 v[168:171], a[180:183], a[40:43], v[168:171]
ds_read_b64_tr_b16 a[242:243], v250 offset:25088
v_mfma_f32_16x16x32_bf16 v[172:175], a[180:183], a[44:47], v[172:175]
s_waitcnt lgkmcnt(8)
ds_read_b64_tr_b16 a[244:245], v251 offset:24576
v_permlane32_swap_b32 v21, v23
v_mfma_f32_16x16x32_bf16 v[176:179], a[192:195], a[40:43], v[176:179]
ds_read_b64_tr_b16 a[246:247], v251 offset:25088
v_permlane16_swap_b32 v20, v22
v_mfma_f32_16x16x32_bf16 v[180:183], a[192:195], a[44:47], v[180:183]
s_waitcnt lgkmcnt(8)
ds_read_b64_tr_b16 a[176:177], v248 offset:28672
v_mfma_f32_16x16x32_bf16 v[184:187], a[212:215], a[40:43], v[184:187]
ds_read_b64_tr_b16 a[178:179], v248 offset:29184
v_permlane16_swap_b32 v21, v23
v_mfma_f32_16x16x32_bf16 v[188:191], a[212:215], a[44:47], v[188:191]
s_waitcnt lgkmcnt(8)
ds_read_b64_tr_b16 a[180:181], v249 offset:28672
v_mfma_f32_16x16x32_bf16 v[160:163], a[224:227], a[48:51], v[160:163]
ds_read_b64_tr_b16 a[182:183], v249 offset:29184
v_mfma_f32_16x16x32_bf16 v[164:167], a[224:227], a[52:55], v[164:167]
ds_read_b64_tr_b16 a[192:193], v250 offset:28672
v_mfma_f32_16x16x32_bf16 v[212:215], a[224:227], a[136:139], v[212:215]
s_waitcnt lgkmcnt(9)
ds_read_b64_tr_b16 a[194:195], v250 offset:29184
v_mfma_f32_16x16x32_bf16 v[168:171], a[228:231], a[48:51], v[168:171]
ds_read_b64_tr_b16 a[196:197], v251 offset:28672
v_mfma_f32_16x16x32_bf16 v[172:175], a[228:231], a[52:55], v[172:175]
s_waitcnt lgkmcnt(9)
ds_read_b64_tr_b16 a[198:199], v251 offset:29184
v_mfma_f32_16x16x32_bf16 v[176:179], a[240:243], a[48:51], v[176:179]
ds_read_b64_tr_b16 a[208:209], v248 offset:32768
v_mfma_f32_16x16x32_bf16 v[180:183], a[240:243], a[52:55], v[180:183]
s_waitcnt lgkmcnt(9)
ds_read_b64_tr_b16 a[210:211], v248 offset:33280
v_mfma_f32_16x16x32_bf16 v[184:187], a[244:247], a[48:51], v[184:187]
v_mfma_f32_16x16x32_bf16 v[188:191], a[244:247], a[52:55], v[188:191]
s_waitcnt vmcnt(7) lgkmcnt(10)
s_barrier
s_waitcnt lgkmcnt(8)
v_mfma_f32_16x16x32_bf16 v[160:163], a[176:179], a[56:59], v[160:163]
ds_read_b64_tr_b16 a[212:213], v249 offset:32768
v_add_u32 v252, 640, v253
v_mfma_f32_16x16x32_bf16 v[164:167], a[176:179], a[60:63], v[164:167]
ds_read_b64_tr_b16 a[214:215], v249 offset:33280
s_add_u32 m0, s29, 57344
v_mfma_f32_16x16x32_bf16 v[212:215], a[176:179], a[140:143], v[212:215]
s_waitcnt lgkmcnt(8)
ds_read_b64_tr_b16 a[224:225], v250 offset:32768
v_mul_f32 v132, s32, v132
v_mfma_f32_16x16x32_bf16 v[168:171], a[180:183], a[56:59], v[168:171]
ds_read_b64_tr_b16 a[226:227], v250 offset:33280
v_mul_f32 v133, s32, v133
v_mfma_f32_16x16x32_bf16 v[172:175], a[180:183], a[60:63], v[172:175]
s_waitcnt lgkmcnt(8)
ds_read_b64_tr_b16 a[228:229], v251 offset:32768
v_mul_f32 v134, s32, v134
v_mfma_f32_16x16x32_bf16 v[176:179], a[192:195], a[56:59], v[176:179]
ds_read_b64_tr_b16 a[230:231], v251 offset:33280
buffer_load_dwordx4 v252, s[8:11], s52 offen nt lds
v_mfma_f32_16x16x32_bf16 v[180:183], a[192:195], a[60:63], v[180:183]
s_waitcnt lgkmcnt(8)
ds_read_b64_tr_b16 a[240:241], v248 offset:36864
v_mul_f32 v135, s32, v135
v_mfma_f32_16x16x32_bf16 v[184:187], a[196:199], a[56:59], v[184:187]
ds_read_b64_tr_b16 a[242:243], v248 offset:37376
v_cvt_pk_bf16_f32 v48, v132, v133
v_mfma_f32_16x16x32_bf16 v[188:191], a[196:199], a[60:63], v[188:191]
s_waitcnt lgkmcnt(8)
ds_read_b64_tr_b16 a[244:245], v249 offset:36864
v_cvt_pk_bf16_f32 v49, v134, v135
v_mfma_f32_16x16x32_bf16 v[160:163], a[208:211], a[64:67], v[160:163]
ds_read_b64_tr_b16 a[246:247], v249 offset:37376
s_add_u32 m0, s29, 61440
v_mfma_f32_16x16x32_bf16 v[164:167], a[208:211], a[68:71], v[164:167]
buffer_load_dwordx4 v252, s[8:11], s53 offen nt lds
v_mfma_f32_16x16x32_bf16 v[212:215], a[208:211], a[144:147], v[212:215]
s_waitcnt lgkmcnt(8)
ds_read_b64_tr_b16 a[176:177], v250 offset:36864
v_mul_f32 v140, s32, v140
v_mfma_f32_16x16x32_bf16 v[168:171], a[212:215], a[64:67], v[168:171]
ds_read_b64_tr_b16 a[178:179], v250 offset:37376
v_mul_f32 v141, s32, v141
v_mfma_f32_16x16x32_bf16 v[172:175], a[212:215], a[68:71], v[172:175]
s_waitcnt lgkmcnt(8)
ds_read_b64_tr_b16 a[180:181], v251 offset:36864
v_mul_f32 v142, s32, v142
v_mfma_f32_16x16x32_bf16 v[176:179], a[224:227], a[64:67], v[176:179]
ds_read_b64_tr_b16 a[182:183], v251 offset:37376
v_mul_f32 v143, s32, v143
v_mfma_f32_16x16x32_bf16 v[180:183], a[224:227], a[68:71], v[180:183]
s_waitcnt lgkmcnt(8)
ds_read_b64_tr_b16 a[192:193], v248 offset:40960
v_cvt_pk_bf16_f32 v50, v140, v141
v_mfma_f32_16x16x32_bf16 v[184:187], a[228:231], a[64:67], v[184:187]
ds_read_b64_tr_b16 a[194:195], v248 offset:41472
v_cvt_pk_bf16_f32 v51, v142, v143
v_mfma_f32_16x16x32_bf16 v[188:191], a[228:231], a[68:71], v[188:191]
s_waitcnt lgkmcnt(8)
v_permlane32_swap_b32 v48, v50
v_mfma_f32_16x16x32_bf16 v[160:163], a[240:243], a[72:75], v[160:163]
ds_read_b64_tr_b16 a[196:197], v249 offset:40960
s_add_u32 m0, s29, 65536
v_mfma_f32_16x16x32_bf16 v[164:167], a[240:243], a[76:79], v[164:167]
ds_read_b64_tr_b16 a[198:199], v249 offset:41472
buffer_load_dwordx4 v252, s[8:11], s54 offen nt lds
v_mfma_f32_16x16x32_bf16 v[212:215], a[240:243], a[148:151], v[212:215]
s_waitcnt lgkmcnt(8)
ds_read_b64_tr_b16 a[208:209], v250 offset:40960
v_mul_f32 v148, s32, v148
v_mfma_f32_16x16x32_bf16 v[168:171], a[244:247], a[72:75], v[168:171]
ds_read_b64_tr_b16 a[210:211], v250 offset:41472
v_permlane32_swap_b32 v49, v51
v_mfma_f32_16x16x32_bf16 v[172:175], a[244:247], a[76:79], v[172:175]
s_waitcnt lgkmcnt(8)
ds_read_b64_tr_b16 a[212:213], v251 offset:40960
v_permlane16_swap_b32 v48, v50
v_mfma_f32_16x16x32_bf16 v[176:179], a[176:179], a[72:75], v[176:179]
ds_read_b64_tr_b16 a[214:215], v251 offset:41472
v_permlane16_swap_b32 v49, v51
v_mfma_f32_16x16x32_bf16 v[180:183], a[176:179], a[76:79], v[180:183]
s_waitcnt lgkmcnt(8)
ds_read_b64_tr_b16 a[224:225], v248 offset:45056
s_add_u32 m0, s29, 69632
v_mfma_f32_16x16x32_bf16 v[184:187], a[180:183], a[72:75], v[184:187]
ds_read_b64_tr_b16 a[226:227], v248 offset:45568
v_mul_f32 v149, s32, v149
v_mfma_f32_16x16x32_bf16 v[188:191], a[180:183], a[76:79], v[188:191]
s_waitcnt lgkmcnt(8)
buffer_load_dwordx4 v252, s[8:11], s55 offen nt lds
v_mfma_f32_16x16x32_bf16 v[160:163], a[192:195], a[80:83], v[160:163]
ds_read_b64_tr_b16 a[228:229], v249 offset:45056
v_mul_f32 v150, s32, v150
v_mfma_f32_16x16x32_bf16 v[164:167], a[192:195], a[84:87], v[164:167]
ds_read_b64_tr_b16 a[230:231], v249 offset:45568
v_mul_f32 v151, s32, v151
v_mfma_f32_16x16x32_bf16 v[212:215], a[192:195], a[152:155], v[212:215]
s_waitcnt lgkmcnt(8)
ds_read_b64_tr_b16 a[240:241], v250 offset:45056
v_cvt_pk_bf16_f32 v52, v148, v149
v_mfma_f32_16x16x32_bf16 v[168:171], a[196:199], a[80:83], v[168:171]
ds_read_b64_tr_b16 a[242:243], v250 offset:45568
v_cvt_pk_bf16_f32 v53, v150, v151
v_mfma_f32_16x16x32_bf16 v[172:175], a[196:199], a[84:87], v[172:175]
s_waitcnt lgkmcnt(8)
ds_read_b64_tr_b16 a[244:245], v251 offset:45056
v_mul_f32 v156, s32, v156
v_mfma_f32_16x16x32_bf16 v[176:179], a[208:211], a[80:83], v[176:179]
ds_read_b64_tr_b16 a[246:247], v251 offset:45568
s_add_u32 m0, s29, 73728
v_mfma_f32_16x16x32_bf16 v[180:183], a[208:211], a[84:87], v[180:183]
s_waitcnt lgkmcnt(8)
ds_read_b64_tr_b16 a[176:177], v248 offset:49152
buffer_load_dwordx4 v252, s[8:11], s56 offen nt lds
v_mfma_f32_16x16x32_bf16 v[184:187], a[212:215], a[80:83], v[184:187]
ds_read_b64_tr_b16 a[178:179], v248 offset:49664
v_mul_f32 v157, s32, v157
v_mfma_f32_16x16x32_bf16 v[188:191], a[212:215], a[84:87], v[188:191]
s_waitcnt lgkmcnt(8)
ds_read_b64_tr_b16 a[180:181], v249 offset:49152
v_mul_f32 v158, s32, v158
v_mfma_f32_16x16x32_bf16 v[160:163], a[224:227], a[88:91], v[160:163]
ds_read_b64_tr_b16 a[182:183], v249 offset:49664
v_mul_f32 v159, s32, v159
v_mfma_f32_16x16x32_bf16 v[164:167], a[224:227], a[92:95], v[164:167]
ds_read_b64_tr_b16 a[192:193], v250 offset:49152
v_cvt_pk_bf16_f32 v54, v156, v157
v_mfma_f32_16x16x32_bf16 v[212:215], a[224:227], a[156:159], v[212:215]
s_waitcnt lgkmcnt(9)
ds_read_b64_tr_b16 a[194:195], v250 offset:49664
v_cvt_pk_bf16_f32 v55, v158, v159
v_mfma_f32_16x16x32_bf16 v[168:171], a[228:231], a[88:91], v[168:171]
v_permlane32_swap_b32 v52, v54
v_mfma_f32_16x16x32_bf16 v[172:175], a[228:231], a[92:95], v[172:175]
s_waitcnt lgkmcnt(8)
ds_read_b64_tr_b16 a[212:213], v251 offset:49152
s_add_u32 m0, s29, 77824
v_mfma_f32_16x16x32_bf16 v[176:179], a[240:243], a[88:91], v[176:179]
ds_read_b64_tr_b16 a[214:215], v251 offset:49664
buffer_load_dwordx4 v252, s[8:11], s57 offen nt lds
v_mfma_f32_16x16x32_bf16 v[180:183], a[240:243], a[92:95], v[180:183]
s_waitcnt lgkmcnt(8)
ds_read_b64_tr_b16 a[224:225], v248 offset:53248
v_permlane32_swap_b32 v53, v55
v_mfma_f32_16x16x32_bf16 v[184:187], a[244:247], a[88:91], v[184:187]
ds_read_b64_tr_b16 a[226:227], v248 offset:53760
v_permlane16_swap_b32 v52, v54
v_mfma_f32_16x16x32_bf16 v[188:191], a[244:247], a[92:95], v[188:191]
s_waitcnt lgkmcnt(8)
v_permlane16_swap_b32 v53, v55
v_mfma_f32_16x16x32_bf16 v[160:163], a[176:179], a[96:99], v[160:163]
ds_read_b64_tr_b16 a[228:229], v249 offset:53248
v_mul_f32 v208, s32, v208
v_mfma_f32_16x16x32_bf16 v[164:167], a[176:179], a[100:103], v[164:167]
ds_read_b64_tr_b16 a[230:231], v249 offset:53760
v_mul_f32 v209, s32, v209
v_mfma_f32_16x16x32_bf16 v[212:215], a[176:179], a[160:163], v[212:215]
s_waitcnt lgkmcnt(8)
ds_read_b64_tr_b16 a[240:241], v250 offset:53248
s_add_u32 m0, s29, 81920
v_mfma_f32_16x16x32_bf16 v[168:171], a[180:183], a[96:99], v[168:171]
ds_read_b64_tr_b16 a[242:243], v250 offset:53760
buffer_load_dwordx4 v252, s[8:11], s58 offen nt lds
v_mfma_f32_16x16x32_bf16 v[172:175], a[180:183], a[100:103], v[172:175]
s_waitcnt lgkmcnt(8)
ds_read_b64_tr_b16 a[244:245], v251 offset:53248
v_mul_f32 v210, s32, v210
v_mfma_f32_16x16x32_bf16 v[176:179], a[192:195], a[96:99], v[176:179]
ds_read_b64_tr_b16 a[246:247], v251 offset:53760
v_mul_f32 v211, s32, v211
v_mfma_f32_16x16x32_bf16 v[180:183], a[192:195], a[100:103], v[180:183]
s_waitcnt lgkmcnt(8)
ds_read_b64_tr_b16 a[176:177], v216 offset:0
v_cvt_pk_bf16_f32 v208, v208, v209
v_mfma_f32_16x16x32_bf16 v[184:187], a[212:215], a[96:99], v[184:187]
ds_read_b64_tr_b16 a[178:179], v216 offset:512
v_cvt_pk_bf16_f32 v209, v210, v211
v_mfma_f32_16x16x32_bf16 v[188:191], a[212:215], a[100:103], v[188:191]
s_waitcnt lgkmcnt(8)
ds_read_b64_tr_b16 a[180:181], v217 offset:0
ds_write_b64 v254, v[208:209] offset:4096
v_mfma_f32_16x16x32_bf16 v[160:163], a[224:227], a[104:107], v[160:163]
ds_read_b64_tr_b16 a[182:183], v217 offset:512
v_mfma_f32_16x16x32_bf16 v[164:167], a[224:227], a[108:111], v[164:167]
ds_read_b64_tr_b16 a[192:193], v218 offset:0
v_mfma_f32_16x16x32_bf16 v[212:215], a[224:227], a[164:167], v[212:215]
s_waitcnt lgkmcnt(10)
ds_read_b64_tr_b16 a[194:195], v218 offset:512
v_mfma_f32_16x16x32_bf16 v[168:171], a[228:231], a[104:107], v[168:171]
ds_read_b64_tr_b16 a[196:197], v219 offset:0
v_mfma_f32_16x16x32_bf16 v[172:175], a[228:231], a[108:111], v[172:175]
s_waitcnt lgkmcnt(10)
ds_read_b64_tr_b16 a[198:199], v219 offset:512
v_mfma_f32_16x16x32_bf16 v[176:179], a[240:243], a[104:107], v[176:179]
ds_read_b64_tr_b16 a[208:209], v216 offset:4096
v_mfma_f32_16x16x32_bf16 v[180:183], a[240:243], a[108:111], v[180:183]
s_waitcnt lgkmcnt(10)
ds_read_b64_tr_b16 a[210:211], v216 offset:4608
v_mfma_f32_16x16x32_bf16 v[184:187], a[244:247], a[104:107], v[184:187]
v_mfma_f32_16x16x32_bf16 v[188:191], a[244:247], a[108:111], v[188:191]
s_waitcnt vmcnt(7) lgkmcnt(7)
s_barrier
s_waitcnt lgkmcnt(8)
v_mfma_f32_16x16x32_bf16 v[128:131], a[176:179], a[0:3], 0
ds_read_b64_tr_b16 a[212:213], v217 offset:4096
v_add_u32 v252, 1835648, v253
v_mfma_f32_16x16x32_bf16 v[132:135], a[176:179], a[4:7], 0
ds_read_b64_tr_b16 a[214:215], v217 offset:4608
s_add_u32 m0, s29, 86016
v_mfma_f32_16x16x32_bf16 v[208:211], a[176:179], a[112:115], 0
s_waitcnt lgkmcnt(8)
ds_read_b64_tr_b16 a[224:225], v218 offset:4096
v_mul_f32 v160, s32, v160
v_mfma_f32_16x16x32_bf16 v[136:139], a[180:183], a[0:3], 0
ds_read_b64_tr_b16 a[226:227], v218 offset:4608
v_mul_f32 v161, s32, v161
v_mfma_f32_16x16x32_bf16 v[140:143], a[180:183], a[4:7], 0
s_waitcnt lgkmcnt(8)
ds_read_b64_tr_b16 a[228:229], v219 offset:4096
v_mul_f32 v162, s32, v162
v_mfma_f32_16x16x32_bf16 v[144:147], a[192:195], a[0:3], 0
ds_read_b64_tr_b16 a[230:231], v219 offset:4608
buffer_load_dwordx4 v252, s[8:11], s52 offen nt lds
v_mfma_f32_16x16x32_bf16 v[148:151], a[192:195], a[4:7], 0
s_waitcnt lgkmcnt(8)
ds_read_b64_tr_b16 a[240:241], v216 offset:8192
v_mul_f32 v163, s32, v163
v_mfma_f32_16x16x32_bf16 v[152:155], a[196:199], a[0:3], 0
ds_read_b64_tr_b16 a[242:243], v216 offset:8704
v_cvt_pk_bf16_f32 v24, v160, v161
v_mfma_f32_16x16x32_bf16 v[156:159], a[196:199], a[4:7], 0
s_waitcnt lgkmcnt(8)
ds_read_b64_tr_b16 a[244:245], v217 offset:8192
s_add_u32 m0, s29, 90112
v_mfma_f32_16x16x32_bf16 v[128:131], a[208:211], a[8:11], v[128:131]
ds_read_b64_tr_b16 a[246:247], v217 offset:8704
v_cvt_pk_bf16_f32 v25, v162, v163
v_mfma_f32_16x16x32_bf16 v[132:135], a[208:211], a[12:15], v[132:135]
buffer_load_dwordx4 v252, s[8:11], s53 offen nt lds
v_mfma_f32_16x16x32_bf16 v[208:211], a[208:211], a[116:119], v[208:211]
s_waitcnt lgkmcnt(8)
ds_read_b64_tr_b16 a[176:177], v218 offset:8192
v_mul_f32 v168, s32, v168
v_mfma_f32_16x16x32_bf16 v[136:139], a[212:215], a[8:11], v[136:139]
ds_read_b64_tr_b16 a[178:179], v218 offset:8704
v_mul_f32 v169, s32, v169
v_mfma_f32_16x16x32_bf16 v[140:143], a[212:215], a[12:15], v[140:143]
s_waitcnt lgkmcnt(8)
ds_read_b64_tr_b16 a[180:181], v219 offset:8192
v_mul_f32 v170, s32, v170
v_mfma_f32_16x16x32_bf16 v[144:147], a[224:227], a[8:11], v[144:147]
ds_read_b64_tr_b16 a[182:183], v219 offset:8704
v_mul_f32 v171, s32, v171
v_mfma_f32_16x16x32_bf16 v[148:151], a[224:227], a[12:15], v[148:151]
s_waitcnt lgkmcnt(8)
ds_read_b64_tr_b16 a[192:193], v216 offset:12288
s_add_u32 m0, s29, 94208
v_mfma_f32_16x16x32_bf16 v[152:155], a[228:231], a[8:11], v[152:155]
ds_read_b64_tr_b16 a[194:195], v216 offset:12800
v_cvt_pk_bf16_f32 v26, v168, v169
v_mfma_f32_16x16x32_bf16 v[156:159], a[228:231], a[12:15], v[156:159]
s_waitcnt lgkmcnt(8)
buffer_load_dwordx4 v252, s[8:11], s54 offen nt lds
v_mfma_f32_16x16x32_bf16 v[128:131], a[240:243], a[16:19], v[128:131]
ds_read_b64_tr_b16 a[196:197], v217 offset:12288
v_cvt_pk_bf16_f32 v27, v170, v171
v_mfma_f32_16x16x32_bf16 v[132:135], a[240:243], a[20:23], v[132:135]
ds_read_b64_tr_b16 a[198:199], v217 offset:12800
v_mul_f32 v176, s32, v176
v_mfma_f32_16x16x32_bf16 v[208:211], a[240:243], a[120:123], v[208:211]
s_waitcnt lgkmcnt(8)
ds_read_b64_tr_b16 a[208:209], v218 offset:12288
s_add_u32 m0, s29, 98304
v_mfma_f32_16x16x32_bf16 v[136:139], a[244:247], a[16:19], v[136:139]
ds_read_b64_tr_b16 a[210:211], v218 offset:12800
v_mul_f32 v177, s32, v177
v_mfma_f32_16x16x32_bf16 v[140:143], a[244:247], a[20:23], v[140:143]
s_waitcnt lgkmcnt(8)
ds_read_b64_tr_b16 a[212:213], v219 offset:12288
v_mul_f32 v178, s32, v178
v_mfma_f32_16x16x32_bf16 v[144:147], a[176:179], a[16:19], v[144:147]
ds_read_b64_tr_b16 a[214:215], v219 offset:12800
v_permlane32_swap_b32 v24, v26
v_mfma_f32_16x16x32_bf16 v[148:151], a[176:179], a[20:23], v[148:151]
s_waitcnt lgkmcnt(8)
ds_read_b64_tr_b16 a[224:225], v216 offset:16384
v_permlane32_swap_b32 v25, v27
v_mfma_f32_16x16x32_bf16 v[152:155], a[180:183], a[16:19], v[152:155]
ds_read_b64_tr_b16 a[226:227], v216 offset:16896
v_mul_f32 v179, s32, v179
v_mfma_f32_16x16x32_bf16 v[156:159], a[180:183], a[20:23], v[156:159]
s_waitcnt lgkmcnt(8)
buffer_load_dwordx4 v252, s[8:11], s55 offen nt lds
v_mfma_f32_16x16x32_bf16 v[128:131], a[192:195], a[24:27], v[128:131]
ds_read_b64_tr_b16 a[228:229], v217 offset:16384
v_permlane16_swap_b32 v24, v26
v_mfma_f32_16x16x32_bf16 v[132:135], a[192:195], a[28:31], v[132:135]
ds_read_b64_tr_b16 a[230:231], v217 offset:16896
v_permlane16_swap_b32 v25, v27
v_mfma_f32_16x16x32_bf16 v[208:211], a[192:195], a[124:127], v[208:211]
s_waitcnt lgkmcnt(8)
ds_read_b64_tr_b16 a[240:241], v218 offset:16384
s_add_u32 m0, s29, 102400
v_mfma_f32_16x16x32_bf16 v[136:139], a[196:199], a[24:27], v[136:139]
ds_read_b64_tr_b16 a[242:243], v218 offset:16896
v_cvt_pk_bf16_f32 v28, v176, v177
v_mfma_f32_16x16x32_bf16 v[140:143], a[196:199], a[28:31], v[140:143]
s_waitcnt lgkmcnt(8)
ds_read_b64_tr_b16 a[244:245], v219 offset:16384
v_cvt_pk_bf16_f32 v29, v178, v179
v_mfma_f32_16x16x32_bf16 v[144:147], a[208:211], a[24:27], v[144:147]
ds_read_b64_tr_b16 a[246:247], v219 offset:16896
v_mul_f32 v184, s32, v184
v_mfma_f32_16x16x32_bf16 v[148:151], a[208:211], a[28:31], v[148:151]
s_waitcnt lgkmcnt(8)
ds_read_b64_tr_b16 a[176:177], v216 offset:20480
buffer_load_dwordx4 v252, s[8:11], s56 offen nt lds
v_mfma_f32_16x16x32_bf16 v[152:155], a[212:215], a[24:27], v[152:155]
ds_read_b64_tr_b16 a[178:179], v216 offset:20992
s_add_u32 m0, s29, 106496
v_mfma_f32_16x16x32_bf16 v[156:159], a[212:215], a[28:31], v[156:159]
s_waitcnt lgkmcnt(8)
ds_read_b64_tr_b16 a[180:181], v217 offset:20480
v_mul_f32 v185, s32, v185
v_mfma_f32_16x16x32_bf16 v[128:131], a[224:227], a[32:35], v[128:131]
ds_read_b64_tr_b16 a[182:183], v217 offset:20992
v_mul_f32 v186, s32, v186
v_mfma_f32_16x16x32_bf16 v[132:135], a[224:227], a[36:39], v[132:135]
buffer_load_dwordx4 v252, s[8:11], s57 offen nt lds
v_mfma_f32_16x16x32_bf16 v[208:211], a[224:227], a[128:131], v[208:211]
s_waitcnt lgkmcnt(8)
ds_read_b64_tr_b16 a[192:193], v218 offset:20480
v_mul_f32 v187, s32, v187
v_mfma_f32_16x16x32_bf16 v[136:139], a[228:231], a[32:35], v[136:139]
ds_read_b64_tr_b16 a[194:195], v218 offset:20992
v_cvt_pk_bf16_f32 v30, v184, v185
v_mfma_f32_16x16x32_bf16 v[140:143], a[228:231], a[36:39], v[140:143]
s_waitcnt lgkmcnt(8)
ds_read_b64_tr_b16 a[212:213], v219 offset:20480
v_cvt_pk_bf16_f32 v31, v186, v187
v_mfma_f32_16x16x32_bf16 v[144:147], a[240:243], a[32:35], v[144:147]
ds_read_b64_tr_b16 a[214:215], v219 offset:20992
s_add_u32 m0, s29, 110592
v_mfma_f32_16x16x32_bf16 v[148:151], a[240:243], a[36:39], v[148:151]
s_waitcnt lgkmcnt(8)
ds_read_b64_tr_b16 a[224:225], v216 offset:24576
v_mfma_f32_16x16x32_bf16 v[152:155], a[244:247], a[32:35], v[152:155]
ds_read_b64_tr_b16 a[226:227], v216 offset:25088
v_mfma_f32_16x16x32_bf16 v[156:159], a[244:247], a[36:39], v[156:159]
s_waitcnt lgkmcnt(8)
buffer_load_dwordx4 v252, s[8:11], s58 offen nt lds
v_mfma_f32_16x16x32_bf16 v[128:131], a[176:179], a[40:43], v[128:131]
ds_read_b64_tr_b16 a[228:229], v217 offset:24576
v_mfma_f32_16x16x32_bf16 v[132:135], a[176:179], a[44:47], v[132:135]
ds_read_b64_tr_b16 a[230:231], v217 offset:25088
v_mfma_f32_16x16x32_bf16 v[208:211], a[176:179], a[132:135], v[208:211]
s_waitcnt lgkmcnt(8)
ds_read_b64_tr_b16 a[240:241], v218 offset:24576
v_permlane32_swap_b32 v28, v30
v_mfma_f32_16x16x32_bf16 v[136:139], a[180:183], a[40:43], v[136:139]
ds_read_b64_tr_b16 a[242:243], v218 offset:25088
v_mfma_f32_16x16x32_bf16 v[140:143], a[180:183], a[44:47], v[140:143]
s_waitcnt lgkmcnt(8)
ds_read_b64_tr_b16 a[244:245], v219 offset:24576
v_permlane32_swap_b32 v29, v31
v_mfma_f32_16x16x32_bf16 v[144:147], a[192:195], a[40:43], v[144:147]
ds_read_b64_tr_b16 a[246:247], v219 offset:25088
v_permlane16_swap_b32 v28, v30
v_mfma_f32_16x16x32_bf16 v[148:151], a[192:195], a[44:47], v[148:151]
s_waitcnt lgkmcnt(8)
ds_read_b64_tr_b16 a[176:177], v216 offset:28672
v_mfma_f32_16x16x32_bf16 v[152:155], a[212:215], a[40:43], v[152:155]
ds_read_b64_tr_b16 a[178:179], v216 offset:29184
v_permlane16_swap_b32 v29, v31
v_mfma_f32_16x16x32_bf16 v[156:159], a[212:215], a[44:47], v[156:159]
s_waitcnt lgkmcnt(8)
ds_read_b64_tr_b16 a[180:181], v217 offset:28672
v_mfma_f32_16x16x32_bf16 v[128:131], a[224:227], a[48:51], v[128:131]
ds_read_b64_tr_b16 a[182:183], v217 offset:29184
v_mfma_f32_16x16x32_bf16 v[132:135], a[224:227], a[52:55], v[132:135]
ds_read_b64_tr_b16 a[192:193], v218 offset:28672
v_mfma_f32_16x16x32_bf16 v[208:211], a[224:227], a[136:139], v[208:211]
s_waitcnt lgkmcnt(9)
ds_read_b64_tr_b16 a[194:195], v218 offset:29184
v_mfma_f32_16x16x32_bf16 v[136:139], a[228:231], a[48:51], v[136:139]
ds_read_b64_tr_b16 a[196:197], v219 offset:28672
v_mfma_f32_16x16x32_bf16 v[140:143], a[228:231], a[52:55], v[140:143]
s_waitcnt lgkmcnt(9)
ds_read_b64_tr_b16 a[198:199], v219 offset:29184
v_mfma_f32_16x16x32_bf16 v[144:147], a[240:243], a[48:51], v[144:147]
ds_read_b64_tr_b16 a[208:209], v216 offset:32768
v_mfma_f32_16x16x32_bf16 v[148:151], a[240:243], a[52:55], v[148:151]
s_waitcnt lgkmcnt(9)
ds_read_b64_tr_b16 a[210:211], v216 offset:33280
v_mfma_f32_16x16x32_bf16 v[152:155], a[244:247], a[48:51], v[152:155]
v_mfma_f32_16x16x32_bf16 v[156:159], a[244:247], a[52:55], v[156:159]
s_waitcnt vmcnt(7) lgkmcnt(10)
s_barrier
s_waitcnt lgkmcnt(8)
v_mfma_f32_16x16x32_bf16 v[128:131], a[176:179], a[56:59], v[128:131]
ds_read_b64_tr_b16 a[212:213], v217 offset:32768
v_add_u32 v252, 768, v253
v_mfma_f32_16x16x32_bf16 v[132:135], a[176:179], a[60:63], v[132:135]
ds_read_b64_tr_b16 a[214:215], v217 offset:33280
s_add_u32 m0, s29, 0
v_mfma_f32_16x16x32_bf16 v[208:211], a[176:179], a[140:143], v[208:211]
s_waitcnt lgkmcnt(8)
ds_read_b64_tr_b16 a[224:225], v218 offset:32768
v_mul_f32 v164, s32, v164
v_mfma_f32_16x16x32_bf16 v[136:139], a[180:183], a[56:59], v[136:139]
ds_read_b64_tr_b16 a[226:227], v218 offset:33280
v_mul_f32 v165, s32, v165
v_mfma_f32_16x16x32_bf16 v[140:143], a[180:183], a[60:63], v[140:143]
s_waitcnt lgkmcnt(8)
ds_read_b64_tr_b16 a[228:229], v219 offset:32768
v_mul_f32 v166, s32, v166
v_mfma_f32_16x16x32_bf16 v[144:147], a[192:195], a[56:59], v[144:147]
ds_read_b64_tr_b16 a[230:231], v219 offset:33280
buffer_load_dwordx4 v252, s[8:11], s52 offen nt lds
v_mfma_f32_16x16x32_bf16 v[148:151], a[192:195], a[60:63], v[148:151]
s_waitcnt lgkmcnt(8)
ds_read_b64_tr_b16 a[240:241], v216 offset:36864
v_mul_f32 v167, s32, v167
v_mfma_f32_16x16x32_bf16 v[152:155], a[196:199], a[56:59], v[152:155]
ds_read_b64_tr_b16 a[242:243], v216 offset:37376
v_cvt_pk_bf16_f32 v56, v164, v165
v_mfma_f32_16x16x32_bf16 v[156:159], a[196:199], a[60:63], v[156:159]
s_waitcnt lgkmcnt(8)
ds_read_b64_tr_b16 a[244:245], v217 offset:36864
v_cvt_pk_bf16_f32 v57, v166, v167
v_mfma_f32_16x16x32_bf16 v[128:131], a[208:211], a[64:67], v[128:131]
ds_read_b64_tr_b16 a[246:247], v217 offset:37376
s_add_u32 m0, s29, 4096
v_mfma_f32_16x16x32_bf16 v[132:135], a[208:211], a[68:71], v[132:135]
buffer_load_dwordx4 v252, s[8:11], s53 offen nt lds
v_mfma_f32_16x16x32_bf16 v[208:211], a[208:211], a[144:147], v[208:211]
s_waitcnt lgkmcnt(8)
ds_read_b64_tr_b16 a[176:177], v218 offset:36864
v_mul_f32 v172, s32, v172
v_mfma_f32_16x16x32_bf16 v[136:139], a[212:215], a[64:67], v[136:139]
ds_read_b64_tr_b16 a[178:179], v218 offset:37376
v_mul_f32 v173, s32, v173
v_mfma_f32_16x16x32_bf16 v[140:143], a[212:215], a[68:71], v[140:143]
s_waitcnt lgkmcnt(8)
ds_read_b64_tr_b16 a[180:181], v219 offset:36864
v_mul_f32 v174, s32, v174
v_mfma_f32_16x16x32_bf16 v[144:147], a[224:227], a[64:67], v[144:147]
ds_read_b64_tr_b16 a[182:183], v219 offset:37376
v_mul_f32 v175, s32, v175
v_mfma_f32_16x16x32_bf16 v[148:151], a[224:227], a[68:71], v[148:151]
s_waitcnt lgkmcnt(8)
ds_read_b64_tr_b16 a[192:193], v216 offset:40960
v_cvt_pk_bf16_f32 v58, v172, v173
v_mfma_f32_16x16x32_bf16 v[152:155], a[228:231], a[64:67], v[152:155]
ds_read_b64_tr_b16 a[194:195], v216 offset:41472
v_cvt_pk_bf16_f32 v59, v174, v175
v_mfma_f32_16x16x32_bf16 v[156:159], a[228:231], a[68:71], v[156:159]
s_waitcnt lgkmcnt(8)
v_permlane32_swap_b32 v56, v58
v_mfma_f32_16x16x32_bf16 v[128:131], a[240:243], a[72:75], v[128:131]
ds_read_b64_tr_b16 a[196:197], v217 offset:40960
s_add_u32 m0, s29, 8192
v_mfma_f32_16x16x32_bf16 v[132:135], a[240:243], a[76:79], v[132:135]
ds_read_b64_tr_b16 a[198:199], v217 offset:41472
buffer_load_dwordx4 v252, s[8:11], s54 offen nt lds
v_mfma_f32_16x16x32_bf16 v[208:211], a[240:243], a[148:151], v[208:211]
s_waitcnt lgkmcnt(8)
ds_read_b64_tr_b16 a[208:209], v218 offset:40960
v_mul_f32 v180, s32, v180
v_mfma_f32_16x16x32_bf16 v[136:139], a[244:247], a[72:75], v[136:139]
ds_read_b64_tr_b16 a[210:211], v218 offset:41472
v_permlane32_swap_b32 v57, v59
v_mfma_f32_16x16x32_bf16 v[140:143], a[244:247], a[76:79], v[140:143]
s_waitcnt lgkmcnt(8)
ds_read_b64_tr_b16 a[212:213], v219 offset:40960
v_permlane16_swap_b32 v56, v58
v_mfma_f32_16x16x32_bf16 v[144:147], a[176:179], a[72:75], v[144:147]
ds_read_b64_tr_b16 a[214:215], v219 offset:41472
v_permlane16_swap_b32 v57, v59
v_mfma_f32_16x16x32_bf16 v[148:151], a[176:179], a[76:79], v[148:151]
s_waitcnt lgkmcnt(8)
ds_read_b64_tr_b16 a[224:225], v216 offset:45056
s_add_u32 m0, s29, 12288
v_mfma_f32_16x16x32_bf16 v[152:155], a[180:183], a[72:75], v[152:155]
ds_read_b64_tr_b16 a[226:227], v216 offset:45568
v_mul_f32 v181, s32, v181
v_mfma_f32_16x16x32_bf16 v[156:159], a[180:183], a[76:79], v[156:159]
s_waitcnt lgkmcnt(8)
buffer_load_dwordx4 v252, s[8:11], s55 offen nt lds
v_mfma_f32_16x16x32_bf16 v[128:131], a[192:195], a[80:83], v[128:131]
ds_read_b64_tr_b16 a[228:229], v217 offset:45056
v_mul_f32 v182, s32, v182
v_mfma_f32_16x16x32_bf16 v[132:135], a[192:195], a[84:87], v[132:135]
ds_read_b64_tr_b16 a[230:231], v217 offset:45568
v_mul_f32 v183, s32, v183
v_mfma_f32_16x16x32_bf16 v[208:211], a[192:195], a[152:155], v[208:211]
s_waitcnt lgkmcnt(8)
ds_read_b64_tr_b16 a[240:241], v218 offset:45056
v_cvt_pk_bf16_f32 v60, v180, v181
v_mfma_f32_16x16x32_bf16 v[136:139], a[196:199], a[80:83], v[136:139]
ds_read_b64_tr_b16 a[242:243], v218 offset:45568
v_cvt_pk_bf16_f32 v61, v182, v183
v_mfma_f32_16x16x32_bf16 v[140:143], a[196:199], a[84:87], v[140:143]
s_waitcnt lgkmcnt(8)
ds_read_b64_tr_b16 a[244:245], v219 offset:45056
v_mul_f32 v188, s32, v188
v_mfma_f32_16x16x32_bf16 v[144:147], a[208:211], a[80:83], v[144:147]
ds_read_b64_tr_b16 a[246:247], v219 offset:45568
s_add_u32 m0, s29, 16384
v_mfma_f32_16x16x32_bf16 v[148:151], a[208:211], a[84:87], v[148:151]
s_waitcnt lgkmcnt(8)
ds_read_b64_tr_b16 a[176:177], v216 offset:49152
buffer_load_dwordx4 v252, s[8:11], s56 offen nt lds
v_mfma_f32_16x16x32_bf16 v[152:155], a[212:215], a[80:83], v[152:155]
ds_read_b64_tr_b16 a[178:179], v216 offset:49664
v_mul_f32 v189, s32, v189
v_mfma_f32_16x16x32_bf16 v[156:159], a[212:215], a[84:87], v[156:159]
s_waitcnt lgkmcnt(8)
ds_read_b64_tr_b16 a[180:181], v217 offset:49152
v_mul_f32 v190, s32, v190
v_mfma_f32_16x16x32_bf16 v[128:131], a[224:227], a[88:91], v[128:131]
ds_read_b64_tr_b16 a[182:183], v217 offset:49664
v_mul_f32 v191, s32, v191
v_mfma_f32_16x16x32_bf16 v[132:135], a[224:227], a[92:95], v[132:135]
ds_read_b64_tr_b16 a[192:193], v218 offset:49152
v_cvt_pk_bf16_f32 v62, v188, v189
v_mfma_f32_16x16x32_bf16 v[208:211], a[224:227], a[156:159], v[208:211]
s_waitcnt lgkmcnt(9)
ds_read_b64_tr_b16 a[194:195], v218 offset:49664
v_cvt_pk_bf16_f32 v63, v190, v191
v_mfma_f32_16x16x32_bf16 v[136:139], a[228:231], a[88:91], v[136:139]
v_permlane32_swap_b32 v60, v62
v_mfma_f32_16x16x32_bf16 v[140:143], a[228:231], a[92:95], v[140:143]
s_waitcnt lgkmcnt(8)
ds_read_b64_tr_b16 a[212:213], v219 offset:49152
s_add_u32 m0, s29, 20480
v_mfma_f32_16x16x32_bf16 v[144:147], a[240:243], a[88:91], v[144:147]
ds_read_b64_tr_b16 a[214:215], v219 offset:49664
buffer_load_dwordx4 v252, s[8:11], s57 offen nt lds
v_mfma_f32_16x16x32_bf16 v[148:151], a[240:243], a[92:95], v[148:151]
s_waitcnt lgkmcnt(8)
ds_read_b64_tr_b16 a[224:225], v216 offset:53248
v_permlane32_swap_b32 v61, v63
v_mfma_f32_16x16x32_bf16 v[152:155], a[244:247], a[88:91], v[152:155]
ds_read_b64_tr_b16 a[226:227], v216 offset:53760
v_permlane16_swap_b32 v60, v62
v_mfma_f32_16x16x32_bf16 v[156:159], a[244:247], a[92:95], v[156:159]
s_waitcnt lgkmcnt(8)
v_permlane16_swap_b32 v61, v63
v_mfma_f32_16x16x32_bf16 v[128:131], a[176:179], a[96:99], v[128:131]
ds_read_b64_tr_b16 a[228:229], v217 offset:53248
v_mul_f32 v212, s32, v212
v_mfma_f32_16x16x32_bf16 v[132:135], a[176:179], a[100:103], v[132:135]
ds_read_b64_tr_b16 a[230:231], v217 offset:53760
v_mul_f32 v213, s32, v213
v_mfma_f32_16x16x32_bf16 v[208:211], a[176:179], a[160:163], v[208:211]
s_waitcnt lgkmcnt(8)
ds_read_b64_tr_b16 a[240:241], v218 offset:53248
s_add_u32 m0, s29, 24576
v_mfma_f32_16x16x32_bf16 v[136:139], a[180:183], a[96:99], v[136:139]
ds_read_b64_tr_b16 a[242:243], v218 offset:53760
buffer_load_dwordx4 v252, s[8:11], s58 offen nt lds
v_mfma_f32_16x16x32_bf16 v[140:143], a[180:183], a[100:103], v[140:143]
s_waitcnt lgkmcnt(8)
ds_read_b64_tr_b16 a[244:245], v219 offset:53248
v_mul_f32 v214, s32, v214
v_mfma_f32_16x16x32_bf16 v[144:147], a[192:195], a[96:99], v[144:147]
ds_read_b64_tr_b16 a[246:247], v219 offset:53760
v_mul_f32 v215, s32, v215
v_mfma_f32_16x16x32_bf16 v[148:151], a[192:195], a[100:103], v[148:151]
s_waitcnt lgkmcnt(8)
ds_read_b64_tr_b16 a[176:177], v248 offset:0
v_cvt_pk_bf16_f32 v212, v212, v213
v_mfma_f32_16x16x32_bf16 v[152:155], a[212:215], a[96:99], v[152:155]
ds_read_b64_tr_b16 a[178:179], v248 offset:512
v_cvt_pk_bf16_f32 v213, v214, v215
v_mfma_f32_16x16x32_bf16 v[156:159], a[212:215], a[100:103], v[156:159]
s_waitcnt lgkmcnt(8)
ds_read_b64_tr_b16 a[180:181], v249 offset:0
ds_write_b64 v254, v[212:213] offset:6144
v_mfma_f32_16x16x32_bf16 v[128:131], a[224:227], a[104:107], v[128:131]
ds_read_b64_tr_b16 a[182:183], v249 offset:512
v_mfma_f32_16x16x32_bf16 v[132:135], a[224:227], a[108:111], v[132:135]
ds_read_b64_tr_b16 a[192:193], v250 offset:0
v_mfma_f32_16x16x32_bf16 v[208:211], a[224:227], a[164:167], v[208:211]
s_waitcnt lgkmcnt(10)
ds_read_b64_tr_b16 a[194:195], v250 offset:512
v_mfma_f32_16x16x32_bf16 v[136:139], a[228:231], a[104:107], v[136:139]
ds_read_b64_tr_b16 a[196:197], v251 offset:0
v_mfma_f32_16x16x32_bf16 v[140:143], a[228:231], a[108:111], v[140:143]
s_waitcnt lgkmcnt(10)
ds_read_b64_tr_b16 a[198:199], v251 offset:512
v_mfma_f32_16x16x32_bf16 v[144:147], a[240:243], a[104:107], v[144:147]
ds_read_b64_tr_b16 a[208:209], v248 offset:4096
v_mfma_f32_16x16x32_bf16 v[148:151], a[240:243], a[108:111], v[148:151]
s_waitcnt lgkmcnt(10)
ds_read_b64_tr_b16 a[210:211], v248 offset:4608
v_mfma_f32_16x16x32_bf16 v[152:155], a[244:247], a[104:107], v[152:155]
v_mfma_f32_16x16x32_bf16 v[156:159], a[244:247], a[108:111], v[156:159]
s_waitcnt vmcnt(7) lgkmcnt(7)
s_barrier
s_waitcnt lgkmcnt(8)
v_mfma_f32_16x16x32_bf16 v[160:163], a[176:179], a[0:3], 0
ds_read_b64_tr_b16 a[212:213], v249 offset:4096
v_add_u32 v252, 1835776, v253
v_mfma_f32_16x16x32_bf16 v[164:167], a[176:179], a[4:7], 0
ds_read_b64_tr_b16 a[214:215], v249 offset:4608
s_add_u32 m0, s29, 28672
v_mfma_f32_16x16x32_bf16 v[212:215], a[176:179], a[112:115], 0
s_waitcnt lgkmcnt(8)
ds_read_b64_tr_b16 a[224:225], v250 offset:4096
v_mul_f32 v128, s32, v128
v_mfma_f32_16x16x32_bf16 v[168:171], a[180:183], a[0:3], 0
ds_read_b64_tr_b16 a[226:227], v250 offset:4608
v_mul_f32 v129, s32, v129
v_mfma_f32_16x16x32_bf16 v[172:175], a[180:183], a[4:7], 0
s_waitcnt lgkmcnt(8)
ds_read_b64_tr_b16 a[228:229], v251 offset:4096
v_mul_f32 v130, s32, v130
v_mfma_f32_16x16x32_bf16 v[176:179], a[192:195], a[0:3], 0
ds_read_b64_tr_b16 a[230:231], v251 offset:4608
buffer_load_dwordx4 v252, s[8:11], s52 offen nt lds
v_mfma_f32_16x16x32_bf16 v[180:183], a[192:195], a[4:7], 0
s_waitcnt lgkmcnt(8)
ds_read_b64_tr_b16 a[240:241], v248 offset:8192
v_mul_f32 v131, s32, v131
v_mfma_f32_16x16x32_bf16 v[184:187], a[196:199], a[0:3], 0
ds_read_b64_tr_b16 a[242:243], v248 offset:8704
v_cvt_pk_bf16_f32 v64, v128, v129
v_mfma_f32_16x16x32_bf16 v[188:191], a[196:199], a[4:7], 0
s_waitcnt lgkmcnt(8)
ds_read_b64_tr_b16 a[244:245], v249 offset:8192
s_add_u32 m0, s29, 32768
v_mfma_f32_16x16x32_bf16 v[160:163], a[208:211], a[8:11], v[160:163]
ds_read_b64_tr_b16 a[246:247], v249 offset:8704
v_cvt_pk_bf16_f32 v65, v130, v131
v_mfma_f32_16x16x32_bf16 v[164:167], a[208:211], a[12:15], v[164:167]
buffer_load_dwordx4 v252, s[8:11], s53 offen nt lds
v_mfma_f32_16x16x32_bf16 v[212:215], a[208:211], a[116:119], v[212:215]
s_waitcnt lgkmcnt(8)
ds_read_b64_tr_b16 a[176:177], v250 offset:8192
v_mul_f32 v136, s32, v136
v_mfma_f32_16x16x32_bf16 v[168:171], a[212:215], a[8:11], v[168:171]
ds_read_b64_tr_b16 a[178:179], v250 offset:8704
v_mul_f32 v137, s32, v137
v_mfma_f32_16x16x32_bf16 v[172:175], a[212:215], a[12:15], v[172:175]
s_waitcnt lgkmcnt(8)
ds_read_b64_tr_b16 a[180:181], v251 offset:8192
v_mul_f32 v138, s32, v138
v_mfma_f32_16x16x32_bf16 v[176:179], a[224:227], a[8:11], v[176:179]
ds_read_b64_tr_b16 a[182:183], v251 offset:8704
v_mul_f32 v139, s32, v139
v_mfma_f32_16x16x32_bf16 v[180:183], a[224:227], a[12:15], v[180:183]
s_waitcnt lgkmcnt(8)
ds_read_b64_tr_b16 a[192:193], v248 offset:12288
s_add_u32 m0, s29, 36864
v_mfma_f32_16x16x32_bf16 v[184:187], a[228:231], a[8:11], v[184:187]
ds_read_b64_tr_b16 a[194:195], v248 offset:12800
v_cvt_pk_bf16_f32 v66, v136, v137
v_mfma_f32_16x16x32_bf16 v[188:191], a[228:231], a[12:15], v[188:191]
s_waitcnt lgkmcnt(8)
buffer_load_dwordx4 v252, s[8:11], s54 offen nt lds
v_mfma_f32_16x16x32_bf16 v[160:163], a[240:243], a[16:19], v[160:163]
ds_read_b64_tr_b16 a[196:197], v249 offset:12288
v_cvt_pk_bf16_f32 v67, v138, v139
v_mfma_f32_16x16x32_bf16 v[164:167], a[240:243], a[20:23], v[164:167]
ds_read_b64_tr_b16 a[198:199], v249 offset:12800
v_mul_f32 v144, s32, v144
v_mfma_f32_16x16x32_bf16 v[212:215], a[240:243], a[120:123], v[212:215]
s_waitcnt lgkmcnt(8)
ds_read_b64_tr_b16 a[208:209], v250 offset:12288
s_add_u32 m0, s29, 40960
v_mfma_f32_16x16x32_bf16 v[168:171], a[244:247], a[16:19], v[168:171]
ds_read_b64_tr_b16 a[210:211], v250 offset:12800
v_mul_f32 v145, s32, v145
v_mfma_f32_16x16x32_bf16 v[172:175], a[244:247], a[20:23], v[172:175]
s_waitcnt lgkmcnt(8)
ds_read_b64_tr_b16 a[212:213], v251 offset:12288
v_mul_f32 v146, s32, v146
v_mfma_f32_16x16x32_bf16 v[176:179], a[176:179], a[16:19], v[176:179]
ds_read_b64_tr_b16 a[214:215], v251 offset:12800
v_permlane32_swap_b32 v64, v66
v_mfma_f32_16x16x32_bf16 v[180:183], a[176:179], a[20:23], v[180:183]
s_waitcnt lgkmcnt(8)
ds_read_b64_tr_b16 a[224:225], v248 offset:16384
v_permlane32_swap_b32 v65, v67
v_mfma_f32_16x16x32_bf16 v[184:187], a[180:183], a[16:19], v[184:187]
ds_read_b64_tr_b16 a[226:227], v248 offset:16896
v_mul_f32 v147, s32, v147
v_mfma_f32_16x16x32_bf16 v[188:191], a[180:183], a[20:23], v[188:191]
s_waitcnt lgkmcnt(8)
buffer_load_dwordx4 v252, s[8:11], s55 offen nt lds
v_mfma_f32_16x16x32_bf16 v[160:163], a[192:195], a[24:27], v[160:163]
ds_read_b64_tr_b16 a[228:229], v249 offset:16384
v_permlane16_swap_b32 v64, v66
v_mfma_f32_16x16x32_bf16 v[164:167], a[192:195], a[28:31], v[164:167]
ds_read_b64_tr_b16 a[230:231], v249 offset:16896
v_permlane16_swap_b32 v65, v67
v_mfma_f32_16x16x32_bf16 v[212:215], a[192:195], a[124:127], v[212:215]
s_waitcnt lgkmcnt(8)
ds_read_b64_tr_b16 a[240:241], v250 offset:16384
s_add_u32 m0, s29, 45056
v_mfma_f32_16x16x32_bf16 v[168:171], a[196:199], a[24:27], v[168:171]
ds_read_b64_tr_b16 a[242:243], v250 offset:16896
v_cvt_pk_bf16_f32 v68, v144, v145
v_mfma_f32_16x16x32_bf16 v[172:175], a[196:199], a[28:31], v[172:175]
s_waitcnt lgkmcnt(8)
ds_read_b64_tr_b16 a[244:245], v251 offset:16384
v_cvt_pk_bf16_f32 v69, v146, v147
v_mfma_f32_16x16x32_bf16 v[176:179], a[208:211], a[24:27], v[176:179]
ds_read_b64_tr_b16 a[246:247], v251 offset:16896
v_mul_f32 v152, s32, v152
v_mfma_f32_16x16x32_bf16 v[180:183], a[208:211], a[28:31], v[180:183]
s_waitcnt lgkmcnt(8)
ds_read_b64_tr_b16 a[176:177], v248 offset:20480
buffer_load_dwordx4 v252, s[8:11], s56 offen nt lds
v_mfma_f32_16x16x32_bf16 v[184:187], a[212:215], a[24:27], v[184:187]
ds_read_b64_tr_b16 a[178:179], v248 offset:20992
s_add_u32 m0, s29, 49152
v_mfma_f32_16x16x32_bf16 v[188:191], a[212:215], a[28:31], v[188:191]
s_waitcnt lgkmcnt(8)
ds_read_b64_tr_b16 a[180:181], v249 offset:20480
v_mul_f32 v153, s32, v153
v_mfma_f32_16x16x32_bf16 v[160:163], a[224:227], a[32:35], v[160:163]
ds_read_b64_tr_b16 a[182:183], v249 offset:20992
v_mul_f32 v154, s32, v154
v_mfma_f32_16x16x32_bf16 v[164:167], a[224:227], a[36:39], v[164:167]
buffer_load_dwordx4 v252, s[8:11], s57 offen nt lds
v_mfma_f32_16x16x32_bf16 v[212:215], a[224:227], a[128:131], v[212:215]
s_waitcnt lgkmcnt(8)
ds_read_b64_tr_b16 a[192:193], v250 offset:20480
v_mul_f32 v155, s32, v155
v_mfma_f32_16x16x32_bf16 v[168:171], a[228:231], a[32:35], v[168:171]
ds_read_b64_tr_b16 a[194:195], v250 offset:20992
v_cvt_pk_bf16_f32 v70, v152, v153
v_mfma_f32_16x16x32_bf16 v[172:175], a[228:231], a[36:39], v[172:175]
s_waitcnt lgkmcnt(8)
ds_read_b64_tr_b16 a[212:213], v251 offset:20480
v_cvt_pk_bf16_f32 v71, v154, v155
v_mfma_f32_16x16x32_bf16 v[176:179], a[240:243], a[32:35], v[176:179]
ds_read_b64_tr_b16 a[214:215], v251 offset:20992
s_add_u32 m0, s29, 53248
v_mfma_f32_16x16x32_bf16 v[180:183], a[240:243], a[36:39], v[180:183]
s_waitcnt lgkmcnt(8)
ds_read_b64_tr_b16 a[224:225], v248 offset:24576
v_mfma_f32_16x16x32_bf16 v[184:187], a[244:247], a[32:35], v[184:187]
ds_read_b64_tr_b16 a[226:227], v248 offset:25088
v_mfma_f32_16x16x32_bf16 v[188:191], a[244:247], a[36:39], v[188:191]
s_waitcnt lgkmcnt(8)
buffer_load_dwordx4 v252, s[8:11], s58 offen nt lds
v_mfma_f32_16x16x32_bf16 v[160:163], a[176:179], a[40:43], v[160:163]
ds_read_b64_tr_b16 a[228:229], v249 offset:24576
v_mfma_f32_16x16x32_bf16 v[164:167], a[176:179], a[44:47], v[164:167]
ds_read_b64_tr_b16 a[230:231], v249 offset:25088
v_mfma_f32_16x16x32_bf16 v[212:215], a[176:179], a[132:135], v[212:215]
s_waitcnt lgkmcnt(8)
ds_read_b64_tr_b16 a[240:241], v250 offset:24576
v_permlane32_swap_b32 v68, v70
v_mfma_f32_16x16x32_bf16 v[168:171], a[180:183], a[40:43], v[168:171]
ds_read_b64_tr_b16 a[242:243], v250 offset:25088
v_mfma_f32_16x16x32_bf16 v[172:175], a[180:183], a[44:47], v[172:175]
s_waitcnt lgkmcnt(8)
ds_read_b64_tr_b16 a[244:245], v251 offset:24576
v_permlane32_swap_b32 v69, v71
v_mfma_f32_16x16x32_bf16 v[176:179], a[192:195], a[40:43], v[176:179]
ds_read_b64_tr_b16 a[246:247], v251 offset:25088
v_permlane16_swap_b32 v68, v70
v_mfma_f32_16x16x32_bf16 v[180:183], a[192:195], a[44:47], v[180:183]
s_waitcnt lgkmcnt(8)
ds_read_b64_tr_b16 a[176:177], v248 offset:28672
v_mfma_f32_16x16x32_bf16 v[184:187], a[212:215], a[40:43], v[184:187]
ds_read_b64_tr_b16 a[178:179], v248 offset:29184
v_permlane16_swap_b32 v69, v71
v_mfma_f32_16x16x32_bf16 v[188:191], a[212:215], a[44:47], v[188:191]
s_waitcnt lgkmcnt(8)
ds_read_b64_tr_b16 a[180:181], v249 offset:28672
v_mfma_f32_16x16x32_bf16 v[160:163], a[224:227], a[48:51], v[160:163]
ds_read_b64_tr_b16 a[182:183], v249 offset:29184
v_mfma_f32_16x16x32_bf16 v[164:167], a[224:227], a[52:55], v[164:167]
ds_read_b64_tr_b16 a[192:193], v250 offset:28672
v_mfma_f32_16x16x32_bf16 v[212:215], a[224:227], a[136:139], v[212:215]
s_waitcnt lgkmcnt(9)
ds_read_b64_tr_b16 a[194:195], v250 offset:29184
v_mfma_f32_16x16x32_bf16 v[168:171], a[228:231], a[48:51], v[168:171]
ds_read_b64_tr_b16 a[196:197], v251 offset:28672
v_mfma_f32_16x16x32_bf16 v[172:175], a[228:231], a[52:55], v[172:175]
s_waitcnt lgkmcnt(9)
ds_read_b64_tr_b16 a[198:199], v251 offset:29184
v_mfma_f32_16x16x32_bf16 v[176:179], a[240:243], a[48:51], v[176:179]
ds_read_b64_tr_b16 a[208:209], v248 offset:32768
v_mfma_f32_16x16x32_bf16 v[180:183], a[240:243], a[52:55], v[180:183]
s_waitcnt lgkmcnt(9)
ds_read_b64_tr_b16 a[210:211], v248 offset:33280
v_mfma_f32_16x16x32_bf16 v[184:187], a[244:247], a[48:51], v[184:187]
v_mfma_f32_16x16x32_bf16 v[188:191], a[244:247], a[52:55], v[188:191]
s_waitcnt vmcnt(7) lgkmcnt(10)
s_barrier
s_waitcnt lgkmcnt(8)
v_mfma_f32_16x16x32_bf16 v[160:163], a[176:179], a[56:59], v[160:163]
ds_read_b64_tr_b16 a[212:213], v249 offset:32768
v_add_u32 v252, 896, v253
v_mfma_f32_16x16x32_bf16 v[164:167], a[176:179], a[60:63], v[164:167]
ds_read_b64_tr_b16 a[214:215], v249 offset:33280
s_add_u32 m0, s29, 57344
v_mfma_f32_16x16x32_bf16 v[212:215], a[176:179], a[140:143], v[212:215]
s_waitcnt lgkmcnt(8)
ds_read_b64_tr_b16 a[224:225], v250 offset:32768
v_mul_f32 v132, s32, v132
v_mfma_f32_16x16x32_bf16 v[168:171], a[180:183], a[56:59], v[168:171]
ds_read_b64_tr_b16 a[226:227], v250 offset:33280
v_mul_f32 v133, s32, v133
v_mfma_f32_16x16x32_bf16 v[172:175], a[180:183], a[60:63], v[172:175]
s_waitcnt lgkmcnt(8)
ds_read_b64_tr_b16 a[228:229], v251 offset:32768
v_mul_f32 v134, s32, v134
v_mfma_f32_16x16x32_bf16 v[176:179], a[192:195], a[56:59], v[176:179]
ds_read_b64_tr_b16 a[230:231], v251 offset:33280
buffer_load_dwordx4 v252, s[8:11], s52 offen nt lds
v_mfma_f32_16x16x32_bf16 v[180:183], a[192:195], a[60:63], v[180:183]
s_waitcnt lgkmcnt(8)
ds_read_b64_tr_b16 a[240:241], v248 offset:36864
v_mul_f32 v135, s32, v135
v_mfma_f32_16x16x32_bf16 v[184:187], a[196:199], a[56:59], v[184:187]
ds_read_b64_tr_b16 a[242:243], v248 offset:37376
v_cvt_pk_bf16_f32 v96, v132, v133
v_mfma_f32_16x16x32_bf16 v[188:191], a[196:199], a[60:63], v[188:191]
s_waitcnt lgkmcnt(8)
ds_read_b64_tr_b16 a[244:245], v249 offset:36864
v_cvt_pk_bf16_f32 v97, v134, v135
v_mfma_f32_16x16x32_bf16 v[160:163], a[208:211], a[64:67], v[160:163]
ds_read_b64_tr_b16 a[246:247], v249 offset:37376
s_add_u32 m0, s29, 61440
v_mfma_f32_16x16x32_bf16 v[164:167], a[208:211], a[68:71], v[164:167]
buffer_load_dwordx4 v252, s[8:11], s53 offen nt lds
v_mfma_f32_16x16x32_bf16 v[212:215], a[208:211], a[144:147], v[212:215]
s_waitcnt lgkmcnt(8)
ds_read_b64_tr_b16 a[176:177], v250 offset:36864
v_mul_f32 v140, s32, v140
v_mfma_f32_16x16x32_bf16 v[168:171], a[212:215], a[64:67], v[168:171]
ds_read_b64_tr_b16 a[178:179], v250 offset:37376
v_mul_f32 v141, s32, v141
v_mfma_f32_16x16x32_bf16 v[172:175], a[212:215], a[68:71], v[172:175]
s_waitcnt lgkmcnt(8)
ds_read_b64_tr_b16 a[180:181], v251 offset:36864
v_mul_f32 v142, s32, v142
v_mfma_f32_16x16x32_bf16 v[176:179], a[224:227], a[64:67], v[176:179]
ds_read_b64_tr_b16 a[182:183], v251 offset:37376
v_mul_f32 v143, s32, v143
v_mfma_f32_16x16x32_bf16 v[180:183], a[224:227], a[68:71], v[180:183]
s_waitcnt lgkmcnt(8)
ds_read_b64_tr_b16 a[192:193], v248 offset:40960
v_cvt_pk_bf16_f32 v98, v140, v141
v_mfma_f32_16x16x32_bf16 v[184:187], a[228:231], a[64:67], v[184:187]
ds_read_b64_tr_b16 a[194:195], v248 offset:41472
v_cvt_pk_bf16_f32 v99, v142, v143
v_mfma_f32_16x16x32_bf16 v[188:191], a[228:231], a[68:71], v[188:191]
s_waitcnt lgkmcnt(8)
v_permlane32_swap_b32 v96, v98
v_mfma_f32_16x16x32_bf16 v[160:163], a[240:243], a[72:75], v[160:163]
ds_read_b64_tr_b16 a[196:197], v249 offset:40960
s_add_u32 m0, s29, 65536
v_mfma_f32_16x16x32_bf16 v[164:167], a[240:243], a[76:79], v[164:167]
ds_read_b64_tr_b16 a[198:199], v249 offset:41472
buffer_load_dwordx4 v252, s[8:11], s54 offen nt lds
v_mfma_f32_16x16x32_bf16 v[212:215], a[240:243], a[148:151], v[212:215]
s_waitcnt lgkmcnt(8)
ds_read_b64_tr_b16 a[208:209], v250 offset:40960
v_mul_f32 v148, s32, v148
v_mfma_f32_16x16x32_bf16 v[168:171], a[244:247], a[72:75], v[168:171]
ds_read_b64_tr_b16 a[210:211], v250 offset:41472
v_permlane32_swap_b32 v97, v99
v_mfma_f32_16x16x32_bf16 v[172:175], a[244:247], a[76:79], v[172:175]
s_waitcnt lgkmcnt(8)
ds_read_b64_tr_b16 a[212:213], v251 offset:40960
v_permlane16_swap_b32 v96, v98
v_mfma_f32_16x16x32_bf16 v[176:179], a[176:179], a[72:75], v[176:179]
ds_read_b64_tr_b16 a[214:215], v251 offset:41472
v_permlane16_swap_b32 v97, v99
v_mfma_f32_16x16x32_bf16 v[180:183], a[176:179], a[76:79], v[180:183]
s_waitcnt lgkmcnt(8)
ds_read_b64_tr_b16 a[224:225], v248 offset:45056
s_add_u32 m0, s29, 69632
v_mfma_f32_16x16x32_bf16 v[184:187], a[180:183], a[72:75], v[184:187]
ds_read_b64_tr_b16 a[226:227], v248 offset:45568
v_mul_f32 v149, s32, v149
v_mfma_f32_16x16x32_bf16 v[188:191], a[180:183], a[76:79], v[188:191]
s_waitcnt lgkmcnt(8)
buffer_load_dwordx4 v252, s[8:11], s55 offen nt lds
v_mfma_f32_16x16x32_bf16 v[160:163], a[192:195], a[80:83], v[160:163]
ds_read_b64_tr_b16 a[228:229], v249 offset:45056
v_mul_f32 v150, s32, v150
v_mfma_f32_16x16x32_bf16 v[164:167], a[192:195], a[84:87], v[164:167]
ds_read_b64_tr_b16 a[230:231], v249 offset:45568
v_mul_f32 v151, s32, v151
v_mfma_f32_16x16x32_bf16 v[212:215], a[192:195], a[152:155], v[212:215]
s_waitcnt lgkmcnt(8)
ds_read_b64_tr_b16 a[240:241], v250 offset:45056
v_cvt_pk_bf16_f32 v100, v148, v149
v_mfma_f32_16x16x32_bf16 v[168:171], a[196:199], a[80:83], v[168:171]
ds_read_b64_tr_b16 a[242:243], v250 offset:45568
v_cvt_pk_bf16_f32 v101, v150, v151
v_mfma_f32_16x16x32_bf16 v[172:175], a[196:199], a[84:87], v[172:175]
s_waitcnt lgkmcnt(8)
ds_read_b64_tr_b16 a[244:245], v251 offset:45056
v_mul_f32 v156, s32, v156
v_mfma_f32_16x16x32_bf16 v[176:179], a[208:211], a[80:83], v[176:179]
ds_read_b64_tr_b16 a[246:247], v251 offset:45568
s_add_u32 m0, s29, 73728
v_mfma_f32_16x16x32_bf16 v[180:183], a[208:211], a[84:87], v[180:183]
s_waitcnt lgkmcnt(8)
ds_read_b64_tr_b16 a[176:177], v248 offset:49152
buffer_load_dwordx4 v252, s[8:11], s56 offen nt lds
v_mfma_f32_16x16x32_bf16 v[184:187], a[212:215], a[80:83], v[184:187]
ds_read_b64_tr_b16 a[178:179], v248 offset:49664
v_mul_f32 v157, s32, v157
v_mfma_f32_16x16x32_bf16 v[188:191], a[212:215], a[84:87], v[188:191]
s_waitcnt lgkmcnt(8)
ds_read_b64_tr_b16 a[180:181], v249 offset:49152
v_mul_f32 v158, s32, v158
v_mfma_f32_16x16x32_bf16 v[160:163], a[224:227], a[88:91], v[160:163]
ds_read_b64_tr_b16 a[182:183], v249 offset:49664
v_mul_f32 v159, s32, v159
v_mfma_f32_16x16x32_bf16 v[164:167], a[224:227], a[92:95], v[164:167]
ds_read_b64_tr_b16 a[192:193], v250 offset:49152
v_cvt_pk_bf16_f32 v102, v156, v157
v_mfma_f32_16x16x32_bf16 v[212:215], a[224:227], a[156:159], v[212:215]
s_waitcnt lgkmcnt(9)
ds_read_b64_tr_b16 a[194:195], v250 offset:49664
v_cvt_pk_bf16_f32 v103, v158, v159
v_mfma_f32_16x16x32_bf16 v[168:171], a[228:231], a[88:91], v[168:171]
v_permlane32_swap_b32 v100, v102
v_mfma_f32_16x16x32_bf16 v[172:175], a[228:231], a[92:95], v[172:175]
s_waitcnt lgkmcnt(8)
ds_read_b64_tr_b16 a[212:213], v251 offset:49152
s_add_u32 m0, s29, 77824
v_mfma_f32_16x16x32_bf16 v[176:179], a[240:243], a[88:91], v[176:179]
ds_read_b64_tr_b16 a[214:215], v251 offset:49664
buffer_load_dwordx4 v252, s[8:11], s57 offen nt lds
v_mfma_f32_16x16x32_bf16 v[180:183], a[240:243], a[92:95], v[180:183]
s_waitcnt lgkmcnt(8)
ds_read_b64_tr_b16 a[224:225], v248 offset:53248
v_permlane32_swap_b32 v101, v103
v_mfma_f32_16x16x32_bf16 v[184:187], a[244:247], a[88:91], v[184:187]
ds_read_b64_tr_b16 a[226:227], v248 offset:53760
v_permlane16_swap_b32 v100, v102
v_mfma_f32_16x16x32_bf16 v[188:191], a[244:247], a[92:95], v[188:191]
s_waitcnt lgkmcnt(8)
v_permlane16_swap_b32 v101, v103
v_mfma_f32_16x16x32_bf16 v[160:163], a[176:179], a[96:99], v[160:163]
ds_read_b64_tr_b16 a[228:229], v249 offset:53248
v_mul_f32 v208, s32, v208
v_mfma_f32_16x16x32_bf16 v[164:167], a[176:179], a[100:103], v[164:167]
ds_read_b64_tr_b16 a[230:231], v249 offset:53760
v_mul_f32 v209, s32, v209
v_mfma_f32_16x16x32_bf16 v[212:215], a[176:179], a[160:163], v[212:215]
s_waitcnt lgkmcnt(8)
ds_read_b64_tr_b16 a[240:241], v250 offset:53248
s_add_u32 m0, s29, 81920
v_mfma_f32_16x16x32_bf16 v[168:171], a[180:183], a[96:99], v[168:171]
ds_read_b64_tr_b16 a[242:243], v250 offset:53760
buffer_load_dwordx4 v252, s[8:11], s58 offen nt lds
v_mfma_f32_16x16x32_bf16 v[172:175], a[180:183], a[100:103], v[172:175]
s_waitcnt lgkmcnt(8)
ds_read_b64_tr_b16 a[244:245], v251 offset:53248
v_mul_f32 v210, s32, v210
v_mfma_f32_16x16x32_bf16 v[176:179], a[192:195], a[96:99], v[176:179]
ds_read_b64_tr_b16 a[246:247], v251 offset:53760
v_mul_f32 v211, s32, v211
v_mfma_f32_16x16x32_bf16 v[180:183], a[192:195], a[100:103], v[180:183]
s_waitcnt lgkmcnt(8)
ds_read_b64_tr_b16 a[176:177], v216 offset:0
v_cvt_pk_bf16_f32 v208, v208, v209
v_mfma_f32_16x16x32_bf16 v[184:187], a[212:215], a[96:99], v[184:187]
ds_read_b64_tr_b16 a[178:179], v216 offset:512
v_cvt_pk_bf16_f32 v209, v210, v211
v_mfma_f32_16x16x32_bf16 v[188:191], a[212:215], a[100:103], v[188:191]
s_waitcnt lgkmcnt(8)
ds_read_b64_tr_b16 a[180:181], v217 offset:0
ds_write_b64 v254, v[208:209] offset:8192
v_mfma_f32_16x16x32_bf16 v[160:163], a[224:227], a[104:107], v[160:163]
ds_read_b64_tr_b16 a[182:183], v217 offset:512
v_mfma_f32_16x16x32_bf16 v[164:167], a[224:227], a[108:111], v[164:167]
ds_read_b64_tr_b16 a[192:193], v218 offset:0
v_mfma_f32_16x16x32_bf16 v[212:215], a[224:227], a[164:167], v[212:215]
s_waitcnt lgkmcnt(10)
ds_read_b64_tr_b16 a[194:195], v218 offset:512
v_mfma_f32_16x16x32_bf16 v[168:171], a[228:231], a[104:107], v[168:171]
ds_read_b64_tr_b16 a[196:197], v219 offset:0
v_mfma_f32_16x16x32_bf16 v[172:175], a[228:231], a[108:111], v[172:175]
s_waitcnt lgkmcnt(10)
ds_read_b64_tr_b16 a[198:199], v219 offset:512
v_mfma_f32_16x16x32_bf16 v[176:179], a[240:243], a[104:107], v[176:179]
ds_read_b64_tr_b16 a[208:209], v216 offset:4096
v_mfma_f32_16x16x32_bf16 v[180:183], a[240:243], a[108:111], v[180:183]
s_waitcnt lgkmcnt(10)
ds_read_b64_tr_b16 a[210:211], v216 offset:4608
v_mfma_f32_16x16x32_bf16 v[184:187], a[244:247], a[104:107], v[184:187]
v_mfma_f32_16x16x32_bf16 v[188:191], a[244:247], a[108:111], v[188:191]
s_waitcnt vmcnt(7) lgkmcnt(7)
s_barrier
s_waitcnt lgkmcnt(8)
v_mfma_f32_16x16x32_bf16 v[128:131], a[176:179], a[0:3], 0
ds_read_b64_tr_b16 a[212:213], v217 offset:4096
v_add_u32 v252, 1835904, v253
v_mfma_f32_16x16x32_bf16 v[132:135], a[176:179], a[4:7], 0
ds_read_b64_tr_b16 a[214:215], v217 offset:4608
s_add_u32 m0, s29, 86016
v_mfma_f32_16x16x32_bf16 v[208:211], a[176:179], a[112:115], 0
s_waitcnt lgkmcnt(8)
ds_read_b64_tr_b16 a[224:225], v218 offset:4096
v_mul_f32 v160, s32, v160
v_mfma_f32_16x16x32_bf16 v[136:139], a[180:183], a[0:3], 0
ds_read_b64_tr_b16 a[226:227], v218 offset:4608
v_mul_f32 v161, s32, v161
v_mfma_f32_16x16x32_bf16 v[140:143], a[180:183], a[4:7], 0
s_waitcnt lgkmcnt(8)
ds_read_b64_tr_b16 a[228:229], v219 offset:4096
v_mul_f32 v162, s32, v162
v_mfma_f32_16x16x32_bf16 v[144:147], a[192:195], a[0:3], 0
ds_read_b64_tr_b16 a[230:231], v219 offset:4608
buffer_load_dwordx4 v252, s[8:11], s52 offen nt lds
v_mfma_f32_16x16x32_bf16 v[148:151], a[192:195], a[4:7], 0
s_waitcnt lgkmcnt(8)
ds_read_b64_tr_b16 a[240:241], v216 offset:8192
v_mul_f32 v163, s32, v163
v_mfma_f32_16x16x32_bf16 v[152:155], a[196:199], a[0:3], 0
ds_read_b64_tr_b16 a[242:243], v216 offset:8704
v_cvt_pk_bf16_f32 v72, v160, v161
v_mfma_f32_16x16x32_bf16 v[156:159], a[196:199], a[4:7], 0
s_waitcnt lgkmcnt(8)
ds_read_b64_tr_b16 a[244:245], v217 offset:8192
s_add_u32 m0, s29, 90112
v_mfma_f32_16x16x32_bf16 v[128:131], a[208:211], a[8:11], v[128:131]
ds_read_b64_tr_b16 a[246:247], v217 offset:8704
v_cvt_pk_bf16_f32 v73, v162, v163
v_mfma_f32_16x16x32_bf16 v[132:135], a[208:211], a[12:15], v[132:135]
buffer_load_dwordx4 v252, s[8:11], s53 offen nt lds
v_mfma_f32_16x16x32_bf16 v[208:211], a[208:211], a[116:119], v[208:211]
s_waitcnt lgkmcnt(8)
ds_read_b64_tr_b16 a[176:177], v218 offset:8192
v_mul_f32 v168, s32, v168
v_mfma_f32_16x16x32_bf16 v[136:139], a[212:215], a[8:11], v[136:139]
ds_read_b64_tr_b16 a[178:179], v218 offset:8704
v_mul_f32 v169, s32, v169
v_mfma_f32_16x16x32_bf16 v[140:143], a[212:215], a[12:15], v[140:143]
s_waitcnt lgkmcnt(8)
ds_read_b64_tr_b16 a[180:181], v219 offset:8192
v_mul_f32 v170, s32, v170
v_mfma_f32_16x16x32_bf16 v[144:147], a[224:227], a[8:11], v[144:147]
ds_read_b64_tr_b16 a[182:183], v219 offset:8704
v_mul_f32 v171, s32, v171
v_mfma_f32_16x16x32_bf16 v[148:151], a[224:227], a[12:15], v[148:151]
s_waitcnt lgkmcnt(8)
ds_read_b64_tr_b16 a[192:193], v216 offset:12288
s_add_u32 m0, s29, 94208
v_mfma_f32_16x16x32_bf16 v[152:155], a[228:231], a[8:11], v[152:155]
ds_read_b64_tr_b16 a[194:195], v216 offset:12800
v_cvt_pk_bf16_f32 v74, v168, v169
v_mfma_f32_16x16x32_bf16 v[156:159], a[228:231], a[12:15], v[156:159]
s_waitcnt lgkmcnt(8)
buffer_load_dwordx4 v252, s[8:11], s54 offen nt lds
v_mfma_f32_16x16x32_bf16 v[128:131], a[240:243], a[16:19], v[128:131]
ds_read_b64_tr_b16 a[196:197], v217 offset:12288
v_cvt_pk_bf16_f32 v75, v170, v171
v_mfma_f32_16x16x32_bf16 v[132:135], a[240:243], a[20:23], v[132:135]
ds_read_b64_tr_b16 a[198:199], v217 offset:12800
v_mul_f32 v176, s32, v176
v_mfma_f32_16x16x32_bf16 v[208:211], a[240:243], a[120:123], v[208:211]
s_waitcnt lgkmcnt(8)
ds_read_b64_tr_b16 a[208:209], v218 offset:12288
s_add_u32 m0, s29, 98304
v_mfma_f32_16x16x32_bf16 v[136:139], a[244:247], a[16:19], v[136:139]
ds_read_b64_tr_b16 a[210:211], v218 offset:12800
v_mul_f32 v177, s32, v177
v_mfma_f32_16x16x32_bf16 v[140:143], a[244:247], a[20:23], v[140:143]
s_waitcnt lgkmcnt(8)
ds_read_b64_tr_b16 a[212:213], v219 offset:12288
v_mul_f32 v178, s32, v178
v_mfma_f32_16x16x32_bf16 v[144:147], a[176:179], a[16:19], v[144:147]
ds_read_b64_tr_b16 a[214:215], v219 offset:12800
v_permlane32_swap_b32 v72, v74
v_mfma_f32_16x16x32_bf16 v[148:151], a[176:179], a[20:23], v[148:151]
s_waitcnt lgkmcnt(8)
ds_read_b64_tr_b16 a[224:225], v216 offset:16384
v_permlane32_swap_b32 v73, v75
v_mfma_f32_16x16x32_bf16 v[152:155], a[180:183], a[16:19], v[152:155]
ds_read_b64_tr_b16 a[226:227], v216 offset:16896
v_mul_f32 v179, s32, v179
v_mfma_f32_16x16x32_bf16 v[156:159], a[180:183], a[20:23], v[156:159]
s_waitcnt lgkmcnt(8)
buffer_load_dwordx4 v252, s[8:11], s55 offen nt lds
v_mfma_f32_16x16x32_bf16 v[128:131], a[192:195], a[24:27], v[128:131]
ds_read_b64_tr_b16 a[228:229], v217 offset:16384
v_permlane16_swap_b32 v72, v74
v_mfma_f32_16x16x32_bf16 v[132:135], a[192:195], a[28:31], v[132:135]
ds_read_b64_tr_b16 a[230:231], v217 offset:16896
v_permlane16_swap_b32 v73, v75
v_mfma_f32_16x16x32_bf16 v[208:211], a[192:195], a[124:127], v[208:211]
s_waitcnt lgkmcnt(8)
ds_read_b64_tr_b16 a[240:241], v218 offset:16384
s_add_u32 m0, s29, 102400
v_mfma_f32_16x16x32_bf16 v[136:139], a[196:199], a[24:27], v[136:139]
ds_read_b64_tr_b16 a[242:243], v218 offset:16896
v_cvt_pk_bf16_f32 v76, v176, v177
v_mfma_f32_16x16x32_bf16 v[140:143], a[196:199], a[28:31], v[140:143]
s_waitcnt lgkmcnt(8)
ds_read_b64_tr_b16 a[244:245], v219 offset:16384
v_cvt_pk_bf16_f32 v77, v178, v179
v_mfma_f32_16x16x32_bf16 v[144:147], a[208:211], a[24:27], v[144:147]
ds_read_b64_tr_b16 a[246:247], v219 offset:16896
v_mul_f32 v184, s32, v184
v_mfma_f32_16x16x32_bf16 v[148:151], a[208:211], a[28:31], v[148:151]
s_waitcnt lgkmcnt(8)
ds_read_b64_tr_b16 a[176:177], v216 offset:20480
buffer_load_dwordx4 v252, s[8:11], s56 offen nt lds
v_mfma_f32_16x16x32_bf16 v[152:155], a[212:215], a[24:27], v[152:155]
ds_read_b64_tr_b16 a[178:179], v216 offset:20992
s_add_u32 m0, s29, 106496
v_mfma_f32_16x16x32_bf16 v[156:159], a[212:215], a[28:31], v[156:159]
s_waitcnt lgkmcnt(8)
ds_read_b64_tr_b16 a[180:181], v217 offset:20480
v_mul_f32 v185, s32, v185
v_mfma_f32_16x16x32_bf16 v[128:131], a[224:227], a[32:35], v[128:131]
ds_read_b64_tr_b16 a[182:183], v217 offset:20992
v_mul_f32 v186, s32, v186
v_mfma_f32_16x16x32_bf16 v[132:135], a[224:227], a[36:39], v[132:135]
buffer_load_dwordx4 v252, s[8:11], s57 offen nt lds
v_mfma_f32_16x16x32_bf16 v[208:211], a[224:227], a[128:131], v[208:211]
s_waitcnt lgkmcnt(8)
ds_read_b64_tr_b16 a[192:193], v218 offset:20480
v_mul_f32 v187, s32, v187
v_mfma_f32_16x16x32_bf16 v[136:139], a[228:231], a[32:35], v[136:139]
ds_read_b64_tr_b16 a[194:195], v218 offset:20992
v_cvt_pk_bf16_f32 v78, v184, v185
v_mfma_f32_16x16x32_bf16 v[140:143], a[228:231], a[36:39], v[140:143]
s_waitcnt lgkmcnt(8)
ds_read_b64_tr_b16 a[212:213], v219 offset:20480
v_cvt_pk_bf16_f32 v79, v186, v187
v_mfma_f32_16x16x32_bf16 v[144:147], a[240:243], a[32:35], v[144:147]
ds_read_b64_tr_b16 a[214:215], v219 offset:20992
s_add_u32 m0, s29, 110592
v_mfma_f32_16x16x32_bf16 v[148:151], a[240:243], a[36:39], v[148:151]
s_waitcnt lgkmcnt(8)
ds_read_b64_tr_b16 a[224:225], v216 offset:24576
v_mfma_f32_16x16x32_bf16 v[152:155], a[244:247], a[32:35], v[152:155]
ds_read_b64_tr_b16 a[226:227], v216 offset:25088
v_mfma_f32_16x16x32_bf16 v[156:159], a[244:247], a[36:39], v[156:159]
s_waitcnt lgkmcnt(8)
buffer_load_dwordx4 v252, s[8:11], s58 offen nt lds
v_mfma_f32_16x16x32_bf16 v[128:131], a[176:179], a[40:43], v[128:131]
ds_read_b64_tr_b16 a[228:229], v217 offset:24576
v_mfma_f32_16x16x32_bf16 v[132:135], a[176:179], a[44:47], v[132:135]
ds_read_b64_tr_b16 a[230:231], v217 offset:25088
v_mfma_f32_16x16x32_bf16 v[208:211], a[176:179], a[132:135], v[208:211]
s_waitcnt lgkmcnt(8)
ds_read_b64_tr_b16 a[240:241], v218 offset:24576
v_permlane32_swap_b32 v76, v78
v_mfma_f32_16x16x32_bf16 v[136:139], a[180:183], a[40:43], v[136:139]
ds_read_b64_tr_b16 a[242:243], v218 offset:25088
v_mfma_f32_16x16x32_bf16 v[140:143], a[180:183], a[44:47], v[140:143]
s_waitcnt lgkmcnt(8)
ds_read_b64_tr_b16 a[244:245], v219 offset:24576
v_permlane32_swap_b32 v77, v79
v_mfma_f32_16x16x32_bf16 v[144:147], a[192:195], a[40:43], v[144:147]
ds_read_b64_tr_b16 a[246:247], v219 offset:25088
v_permlane16_swap_b32 v76, v78
v_mfma_f32_16x16x32_bf16 v[148:151], a[192:195], a[44:47], v[148:151]
s_waitcnt lgkmcnt(8)
ds_read_b64_tr_b16 a[176:177], v216 offset:28672
v_mfma_f32_16x16x32_bf16 v[152:155], a[212:215], a[40:43], v[152:155]
ds_read_b64_tr_b16 a[178:179], v216 offset:29184
v_permlane16_swap_b32 v77, v79
v_mfma_f32_16x16x32_bf16 v[156:159], a[212:215], a[44:47], v[156:159]
s_waitcnt lgkmcnt(8)
ds_read_b64_tr_b16 a[180:181], v217 offset:28672
v_mfma_f32_16x16x32_bf16 v[128:131], a[224:227], a[48:51], v[128:131]
ds_read_b64_tr_b16 a[182:183], v217 offset:29184
v_mfma_f32_16x16x32_bf16 v[132:135], a[224:227], a[52:55], v[132:135]
ds_read_b64_tr_b16 a[192:193], v218 offset:28672
v_mfma_f32_16x16x32_bf16 v[208:211], a[224:227], a[136:139], v[208:211]
s_waitcnt lgkmcnt(9)
ds_read_b64_tr_b16 a[194:195], v218 offset:29184
v_mfma_f32_16x16x32_bf16 v[136:139], a[228:231], a[48:51], v[136:139]
ds_read_b64_tr_b16 a[196:197], v219 offset:28672
v_mfma_f32_16x16x32_bf16 v[140:143], a[228:231], a[52:55], v[140:143]
s_waitcnt lgkmcnt(9)
ds_read_b64_tr_b16 a[198:199], v219 offset:29184
v_mfma_f32_16x16x32_bf16 v[144:147], a[240:243], a[48:51], v[144:147]
ds_read_b64_tr_b16 a[208:209], v216 offset:32768
v_mfma_f32_16x16x32_bf16 v[148:151], a[240:243], a[52:55], v[148:151]
s_waitcnt lgkmcnt(9)
ds_read_b64_tr_b16 a[210:211], v216 offset:33280
v_mfma_f32_16x16x32_bf16 v[152:155], a[244:247], a[48:51], v[152:155]
v_mfma_f32_16x16x32_bf16 v[156:159], a[244:247], a[52:55], v[156:159]
s_waitcnt vmcnt(7) lgkmcnt(10)
s_barrier
s_waitcnt lgkmcnt(8)
v_mfma_f32_16x16x32_bf16 v[128:131], a[176:179], a[56:59], v[128:131]
ds_read_b64_tr_b16 a[212:213], v217 offset:32768
s_mov_b32 s30, 0
v_mfma_f32_16x16x32_bf16 v[132:135], a[176:179], a[60:63], v[132:135]
ds_read_b64_tr_b16 a[214:215], v217 offset:33280
s_add_u32 m0, s29, 0
v_mfma_f32_16x16x32_bf16 v[208:211], a[176:179], a[140:143], v[208:211]
s_waitcnt lgkmcnt(8)
ds_read_b64_tr_b16 a[224:225], v218 offset:32768
v_mul_f32 v164, s32, v164
v_mfma_f32_16x16x32_bf16 v[136:139], a[180:183], a[56:59], v[136:139]
ds_read_b64_tr_b16 a[226:227], v218 offset:33280
v_mul_f32 v165, s32, v165
v_mfma_f32_16x16x32_bf16 v[140:143], a[180:183], a[60:63], v[140:143]
s_waitcnt lgkmcnt(8)
ds_read_b64_tr_b16 a[228:229], v219 offset:32768
v_mul_f32 v166, s32, v166
v_mfma_f32_16x16x32_bf16 v[144:147], a[192:195], a[56:59], v[144:147]
ds_read_b64_tr_b16 a[230:231], v219 offset:33280
buffer_load_dwordx4 v246, s[12:15], s30 offen offset:0 nt lds
v_mfma_f32_16x16x32_bf16 v[148:151], a[192:195], a[60:63], v[148:151]
s_waitcnt lgkmcnt(8)
ds_read_b64_tr_b16 a[240:241], v216 offset:36864
v_mul_f32 v167, s32, v167
v_mfma_f32_16x16x32_bf16 v[152:155], a[196:199], a[56:59], v[152:155]
ds_read_b64_tr_b16 a[242:243], v216 offset:37376
v_cvt_pk_bf16_f32 v104, v164, v165
v_mfma_f32_16x16x32_bf16 v[156:159], a[196:199], a[60:63], v[156:159]
s_waitcnt lgkmcnt(8)
ds_read_b64_tr_b16 a[244:245], v217 offset:36864
v_cvt_pk_bf16_f32 v105, v166, v167
v_mfma_f32_16x16x32_bf16 v[128:131], a[208:211], a[64:67], v[128:131]
ds_read_b64_tr_b16 a[246:247], v217 offset:37376
v_mul_f32 v172, s32, v172
v_mfma_f32_16x16x32_bf16 v[132:135], a[208:211], a[68:71], v[132:135]
ds_read_b64_tr_b16 a[176:177], v218 offset:36864
v_mul_f32 v173, s32, v173
v_mfma_f32_16x16x32_bf16 v[208:211], a[208:211], a[144:147], v[208:211]
s_waitcnt lgkmcnt(9)
ds_read_b64_tr_b16 a[178:179], v218 offset:37376
v_mul_f32 v174, s32, v174
v_mfma_f32_16x16x32_bf16 v[136:139], a[212:215], a[64:67], v[136:139]
ds_read_b64_tr_b16 a[180:181], v219 offset:36864
v_mul_f32 v175, s32, v175
v_mfma_f32_16x16x32_bf16 v[140:143], a[212:215], a[68:71], v[140:143]
s_waitcnt lgkmcnt(9)
ds_read_b64_tr_b16 a[182:183], v219 offset:37376
s_add_u32 m0, s29, 3968
v_mfma_f32_16x16x32_bf16 v[144:147], a[224:227], a[64:67], v[144:147]
buffer_load_dwordx4 v246, s[12:15], s30 offen offset:128 nt lds
v_mfma_f32_16x16x32_bf16 v[148:151], a[224:227], a[68:71], v[148:151]
s_waitcnt lgkmcnt(8)
ds_read_b64_tr_b16 a[192:193], v216 offset:40960
v_cvt_pk_bf16_f32 v106, v172, v173
v_mfma_f32_16x16x32_bf16 v[152:155], a[228:231], a[64:67], v[152:155]
ds_read_b64_tr_b16 a[194:195], v216 offset:41472
v_cvt_pk_bf16_f32 v107, v174, v175
v_mfma_f32_16x16x32_bf16 v[156:159], a[228:231], a[68:71], v[156:159]
s_waitcnt lgkmcnt(8)
v_permlane32_swap_b32 v104, v106
v_mfma_f32_16x16x32_bf16 v[128:131], a[240:243], a[72:75], v[128:131]
ds_read_b64_tr_b16 a[196:197], v217 offset:40960
v_mul_f32 v180, s32, v180
v_mfma_f32_16x16x32_bf16 v[132:135], a[240:243], a[76:79], v[132:135]
ds_read_b64_tr_b16 a[198:199], v217 offset:41472
v_mul_f32 v181, s32, v181
v_mfma_f32_16x16x32_bf16 v[208:211], a[240:243], a[148:151], v[208:211]
s_waitcnt lgkmcnt(8)
ds_read_b64_tr_b16 a[208:209], v218 offset:40960
v_mul_f32 v182, s32, v182
v_mfma_f32_16x16x32_bf16 v[136:139], a[244:247], a[72:75], v[136:139]
ds_read_b64_tr_b16 a[210:211], v218 offset:41472
v_permlane32_swap_b32 v105, v107
v_mfma_f32_16x16x32_bf16 v[140:143], a[244:247], a[76:79], v[140:143]
s_waitcnt lgkmcnt(8)
ds_read_b64_tr_b16 a[212:213], v219 offset:40960
v_permlane16_swap_b32 v104, v106
v_mfma_f32_16x16x32_bf16 v[144:147], a[176:179], a[72:75], v[144:147]
ds_read_b64_tr_b16 a[214:215], v219 offset:41472
v_permlane16_swap_b32 v105, v107
v_mfma_f32_16x16x32_bf16 v[148:151], a[176:179], a[76:79], v[148:151]
s_waitcnt lgkmcnt(8)
ds_read_b64_tr_b16 a[224:225], v216 offset:45056
v_mul_f32 v183, s32, v183
v_mfma_f32_16x16x32_bf16 v[152:155], a[180:183], a[72:75], v[152:155]
ds_read_b64_tr_b16 a[226:227], v216 offset:45568
s_add_u32 m0, s29, 7936
v_mfma_f32_16x16x32_bf16 v[156:159], a[180:183], a[76:79], v[156:159]
s_waitcnt lgkmcnt(8)
buffer_load_dwordx4 v246, s[12:15], s30 offen offset:256 nt lds
v_mfma_f32_16x16x32_bf16 v[128:131], a[192:195], a[80:83], v[128:131]
ds_read_b64_tr_b16 a[228:229], v217 offset:45056
v_cvt_pk_bf16_f32 v108, v180, v181
v_mfma_f32_16x16x32_bf16 v[132:135], a[192:195], a[84:87], v[132:135]
ds_read_b64_tr_b16 a[230:231], v217 offset:45568
v_cvt_pk_bf16_f32 v109, v182, v183
v_mfma_f32_16x16x32_bf16 v[208:211], a[192:195], a[152:155], v[208:211]
s_waitcnt lgkmcnt(8)
ds_read_b64_tr_b16 a[240:241], v218 offset:45056
v_mul_f32 v188, s32, v188
v_mfma_f32_16x16x32_bf16 v[136:139], a[196:199], a[80:83], v[136:139]
ds_read_b64_tr_b16 a[242:243], v218 offset:45568
v_mul_f32 v189, s32, v189
v_mfma_f32_16x16x32_bf16 v[140:143], a[196:199], a[84:87], v[140:143]
s_waitcnt lgkmcnt(8)
ds_read_b64_tr_b16 a[244:245], v219 offset:45056
v_mul_f32 v190, s32, v190
v_mfma_f32_16x16x32_bf16 v[144:147], a[208:211], a[80:83], v[144:147]
ds_read_b64_tr_b16 a[246:247], v219 offset:45568
v_mul_f32 v191, s32, v191
v_mfma_f32_16x16x32_bf16 v[148:151], a[208:211], a[84:87], v[148:151]
s_waitcnt lgkmcnt(8)
ds_read_b64_tr_b16 a[176:177], v216 offset:49152
v_cvt_pk_bf16_f32 v110, v188, v189
v_mfma_f32_16x16x32_bf16 v[152:155], a[212:215], a[80:83], v[152:155]
ds_read_b64_tr_b16 a[178:179], v216 offset:49664
v_cvt_pk_bf16_f32 v111, v190, v191
v_mfma_f32_16x16x32_bf16 v[156:159], a[212:215], a[84:87], v[156:159]
s_waitcnt lgkmcnt(8)
v_permlane32_swap_b32 v108, v110
v_mfma_f32_16x16x32_bf16 v[128:131], a[224:227], a[88:91], v[128:131]
ds_read_b64_tr_b16 a[180:181], v217 offset:49152
s_add_u32 m0, s29, 11904
v_mfma_f32_16x16x32_bf16 v[132:135], a[224:227], a[92:95], v[132:135]
ds_read_b64_tr_b16 a[182:183], v217 offset:49664
v_mul_f32 v212, s32, v212
v_mfma_f32_16x16x32_bf16 v[208:211], a[224:227], a[156:159], v[208:211]
s_waitcnt lgkmcnt(8)
ds_read_b64_tr_b16 a[192:193], v218 offset:49152
v_mul_f32 v213, s32, v213
v_mfma_f32_16x16x32_bf16 v[136:139], a[228:231], a[88:91], v[136:139]
ds_read_b64_tr_b16 a[194:195], v218 offset:49664
v_mul_f32 v214, s32, v214
v_mfma_f32_16x16x32_bf16 v[140:143], a[228:231], a[92:95], v[140:143]
s_waitcnt lgkmcnt(8)
ds_read_b64_tr_b16 a[212:213], v219 offset:49152
v_mul_f32 v215, s32, v215
v_mfma_f32_16x16x32_bf16 v[144:147], a[240:243], a[88:91], v[144:147]
ds_read_b64_tr_b16 a[214:215], v219 offset:49664
v_permlane32_swap_b32 v109, v111
v_mfma_f32_16x16x32_bf16 v[148:151], a[240:243], a[92:95], v[148:151]
s_waitcnt lgkmcnt(8)
ds_read_b64_tr_b16 a[224:225], v216 offset:53248
buffer_load_dwordx4 v246, s[12:15], s30 offen offset:384 nt lds
v_mfma_f32_16x16x32_bf16 v[152:155], a[244:247], a[88:91], v[152:155]
ds_read_b64_tr_b16 a[226:227], v216 offset:53760
v_permlane16_swap_b32 v108, v110
v_mfma_f32_16x16x32_bf16 v[156:159], a[244:247], a[92:95], v[156:159]
s_waitcnt lgkmcnt(8)
v_permlane16_swap_b32 v109, v111
v_mfma_f32_16x16x32_bf16 v[128:131], a[176:179], a[96:99], v[128:131]
ds_read_b64_tr_b16 a[228:229], v217 offset:53248
v_cvt_pk_bf16_f32 v212, v212, v213
v_mfma_f32_16x16x32_bf16 v[132:135], a[176:179], a[100:103], v[132:135]
ds_read_b64_tr_b16 a[230:231], v217 offset:53760
v_cvt_pk_bf16_f32 v213, v214, v215
v_mfma_f32_16x16x32_bf16 v[208:211], a[176:179], a[160:163], v[208:211]
s_waitcnt lgkmcnt(8)
ds_read_b64_tr_b16 a[240:241], v218 offset:53248
v_mfma_f32_16x16x32_bf16 v[136:139], a[180:183], a[96:99], v[136:139]
ds_read_b64_tr_b16 a[242:243], v218 offset:53760
v_mfma_f32_16x16x32_bf16 v[140:143], a[180:183], a[100:103], v[140:143]
s_waitcnt lgkmcnt(8)
ds_read_b64_tr_b16 a[244:245], v219 offset:53248
v_mfma_f32_16x16x32_bf16 v[144:147], a[192:195], a[96:99], v[144:147]
ds_read_b64_tr_b16 a[246:247], v219 offset:53760
v_mfma_f32_16x16x32_bf16 v[148:151], a[192:195], a[100:103], v[148:151]
s_waitcnt lgkmcnt(8)
ds_read_b64_tr_b16 a[176:177], v248 offset:0
v_mfma_f32_16x16x32_bf16 v[152:155], a[212:215], a[96:99], v[152:155]
ds_read_b64_tr_b16 a[178:179], v248 offset:512
ds_write_b64 v254, v[212:213] offset:10240
v_mfma_f32_16x16x32_bf16 v[156:159], a[212:215], a[100:103], v[156:159]
s_waitcnt lgkmcnt(9)
ds_read_b64_tr_b16 a[180:181], v249 offset:0
v_mfma_f32_16x16x32_bf16 v[128:131], a[224:227], a[104:107], v[128:131]
ds_read_b64_tr_b16 a[182:183], v249 offset:512
v_mfma_f32_16x16x32_bf16 v[132:135], a[224:227], a[108:111], v[132:135]
ds_read_b64_tr_b16 a[192:193], v250 offset:0
v_mfma_f32_16x16x32_bf16 v[208:211], a[224:227], a[164:167], v[208:211]
s_waitcnt lgkmcnt(10)
ds_read_b64_tr_b16 a[194:195], v250 offset:512
v_mfma_f32_16x16x32_bf16 v[136:139], a[228:231], a[104:107], v[136:139]
ds_read_b64_tr_b16 a[196:197], v251 offset:0
v_mfma_f32_16x16x32_bf16 v[140:143], a[228:231], a[108:111], v[140:143]
s_waitcnt lgkmcnt(10)
ds_read_b64_tr_b16 a[198:199], v251 offset:512
v_mfma_f32_16x16x32_bf16 v[144:147], a[240:243], a[104:107], v[144:147]
ds_read_b64_tr_b16 a[208:209], v248 offset:4096
v_mfma_f32_16x16x32_bf16 v[148:151], a[240:243], a[108:111], v[148:151]
s_waitcnt lgkmcnt(10)
ds_read_b64_tr_b16 a[210:211], v248 offset:4608
v_mfma_f32_16x16x32_bf16 v[152:155], a[244:247], a[104:107], v[152:155]
v_mfma_f32_16x16x32_bf16 v[156:159], a[244:247], a[108:111], v[156:159]
s_waitcnt vmcnt(4) lgkmcnt(8)
s_barrier
s_waitcnt lgkmcnt(8)
v_mfma_f32_16x16x32_bf16 v[160:163], a[176:179], a[0:3], 0
ds_read_b64_tr_b16 a[212:213], v249 offset:4096
s_mov_b32 s30, 16384
v_mfma_f32_16x16x32_bf16 v[164:167], a[176:179], a[4:7], 0
ds_read_b64_tr_b16 a[214:215], v249 offset:4608
s_add_u32 m0, s29, 16384
v_mfma_f32_16x16x32_bf16 v[212:215], a[176:179], a[112:115], 0
s_waitcnt lgkmcnt(8)
ds_read_b64_tr_b16 a[224:225], v250 offset:4096
v_mul_f32 v128, s32, v128
v_mfma_f32_16x16x32_bf16 v[168:171], a[180:183], a[0:3], 0
ds_read_b64_tr_b16 a[226:227], v250 offset:4608
v_mul_f32 v129, s32, v129
v_mfma_f32_16x16x32_bf16 v[172:175], a[180:183], a[4:7], 0
s_waitcnt lgkmcnt(8)
ds_read_b64_tr_b16 a[228:229], v251 offset:4096
v_mul_f32 v130, s32, v130
v_mfma_f32_16x16x32_bf16 v[176:179], a[192:195], a[0:3], 0
ds_read_b64_tr_b16 a[230:231], v251 offset:4608
buffer_load_dwordx4 v246, s[12:15], s30 offen offset:0 nt lds
v_mfma_f32_16x16x32_bf16 v[180:183], a[192:195], a[4:7], 0
s_waitcnt lgkmcnt(8)
ds_read_b64_tr_b16 a[240:241], v248 offset:8192
v_mul_f32 v131, s32, v131
v_mfma_f32_16x16x32_bf16 v[184:187], a[196:199], a[0:3], 0
ds_read_b64_tr_b16 a[242:243], v248 offset:8704
s_add_u32 m0, s29, 20352
v_mfma_f32_16x16x32_bf16 v[188:191], a[196:199], a[4:7], 0
s_waitcnt lgkmcnt(8)
buffer_load_dwordx4 v246, s[12:15], s30 offen offset:128 nt lds
v_mfma_f32_16x16x32_bf16 v[160:163], a[208:211], a[8:11], v[160:163]
ds_read_b64_tr_b16 a[244:245], v249 offset:8192
v_cvt_pk_bf16_f32 v80, v128, v129
v_mfma_f32_16x16x32_bf16 v[164:167], a[208:211], a[12:15], v[164:167]
ds_read_b64_tr_b16 a[246:247], v249 offset:8704
v_cvt_pk_bf16_f32 v81, v130, v131
v_mfma_f32_16x16x32_bf16 v[212:215], a[208:211], a[116:119], v[212:215]
s_waitcnt lgkmcnt(8)
ds_read_b64_tr_b16 a[176:177], v250 offset:8192
v_mul_f32 v136, s32, v136
v_mfma_f32_16x16x32_bf16 v[168:171], a[212:215], a[8:11], v[168:171]
ds_read_b64_tr_b16 a[178:179], v250 offset:8704
v_mul_f32 v137, s32, v137
v_mfma_f32_16x16x32_bf16 v[172:175], a[212:215], a[12:15], v[172:175]
s_waitcnt lgkmcnt(8)
ds_read_b64_tr_b16 a[180:181], v251 offset:8192
s_add_u32 m0, s29, 24320
v_mfma_f32_16x16x32_bf16 v[176:179], a[224:227], a[8:11], v[176:179]
ds_read_b64_tr_b16 a[182:183], v251 offset:8704
v_mul_f32 v138, s32, v138
v_mfma_f32_16x16x32_bf16 v[180:183], a[224:227], a[12:15], v[180:183]
s_waitcnt lgkmcnt(8)
ds_read_b64_tr_b16 a[192:193], v248 offset:12288
v_mul_f32 v139, s32, v139
v_mfma_f32_16x16x32_bf16 v[184:187], a[228:231], a[8:11], v[184:187]
ds_read_b64_tr_b16 a[194:195], v248 offset:12800
v_cvt_pk_bf16_f32 v82, v136, v137
v_mfma_f32_16x16x32_bf16 v[188:191], a[228:231], a[12:15], v[188:191]
s_waitcnt lgkmcnt(8)
buffer_load_dwordx4 v246, s[12:15], s30 offen offset:256 nt lds
v_mfma_f32_16x16x32_bf16 v[160:163], a[240:243], a[16:19], v[160:163]
ds_read_b64_tr_b16 a[196:197], v249 offset:12288
v_cvt_pk_bf16_f32 v83, v138, v139
v_mfma_f32_16x16x32_bf16 v[164:167], a[240:243], a[20:23], v[164:167]
ds_read_b64_tr_b16 a[198:199], v249 offset:12800
s_add_u32 m0, s29, 28288
v_mfma_f32_16x16x32_bf16 v[212:215], a[240:243], a[120:123], v[212:215]
s_waitcnt lgkmcnt(8)
ds_read_b64_tr_b16 a[208:209], v250 offset:12288
v_mul_f32 v144, s32, v144
v_mfma_f32_16x16x32_bf16 v[168:171], a[244:247], a[16:19], v[168:171]
ds_read_b64_tr_b16 a[210:211], v250 offset:12800
v_mul_f32 v145, s32, v145
v_mfma_f32_16x16x32_bf16 v[172:175], a[244:247], a[20:23], v[172:175]
s_waitcnt lgkmcnt(8)
ds_read_b64_tr_b16 a[212:213], v251 offset:12288
v_mul_f32 v146, s32, v146
v_mfma_f32_16x16x32_bf16 v[176:179], a[176:179], a[16:19], v[176:179]
ds_read_b64_tr_b16 a[214:215], v251 offset:12800
buffer_load_dwordx4 v246, s[12:15], s30 offen offset:384 nt lds
v_mfma_f32_16x16x32_bf16 v[180:183], a[176:179], a[20:23], v[180:183]
s_waitcnt lgkmcnt(8)
ds_read_b64_tr_b16 a[224:225], v248 offset:16384
v_permlane32_swap_b32 v80, v82
v_mfma_f32_16x16x32_bf16 v[184:187], a[180:183], a[16:19], v[184:187]
ds_read_b64_tr_b16 a[226:227], v248 offset:16896
v_permlane32_swap_b32 v81, v83
v_mfma_f32_16x16x32_bf16 v[188:191], a[180:183], a[20:23], v[188:191]
s_waitcnt lgkmcnt(8)
v_permlane16_swap_b32 v80, v82
v_mfma_f32_16x16x32_bf16 v[160:163], a[192:195], a[24:27], v[160:163]
ds_read_b64_tr_b16 a[228:229], v249 offset:16384
v_permlane16_swap_b32 v81, v83
v_mfma_f32_16x16x32_bf16 v[164:167], a[192:195], a[28:31], v[164:167]
ds_read_b64_tr_b16 a[230:231], v249 offset:16896
s_mov_b32 s30, 32768
v_mfma_f32_16x16x32_bf16 v[212:215], a[192:195], a[124:127], v[212:215]
s_waitcnt lgkmcnt(8)
ds_read_b64_tr_b16 a[240:241], v250 offset:16384
s_add_u32 m0, s29, 32768
v_mfma_f32_16x16x32_bf16 v[168:171], a[196:199], a[24:27], v[168:171]
ds_read_b64_tr_b16 a[242:243], v250 offset:16896
buffer_load_dwordx4 v246, s[12:15], s30 offen offset:0 nt lds
v_mfma_f32_16x16x32_bf16 v[172:175], a[196:199], a[28:31], v[172:175]
s_waitcnt lgkmcnt(8)
ds_read_b64_tr_b16 a[244:245], v251 offset:16384
v_mul_f32 v147, s32, v147
v_mfma_f32_16x16x32_bf16 v[176:179], a[208:211], a[24:27], v[176:179]
ds_read_b64_tr_b16 a[246:247], v251 offset:16896
v_cvt_pk_bf16_f32 v84, v144, v145
v_mfma_f32_16x16x32_bf16 v[180:183], a[208:211], a[28:31], v[180:183]
s_waitcnt lgkmcnt(8)
ds_read_b64_tr_b16 a[176:177], v248 offset:20480
s_add_u32 m0, s29, 36736
v_mfma_f32_16x16x32_bf16 v[184:187], a[212:215], a[24:27], v[184:187]
ds_read_b64_tr_b16 a[178:179], v248 offset:20992
v_cvt_pk_bf16_f32 v85, v146, v147
v_mfma_f32_16x16x32_bf16 v[188:191], a[212:215], a[28:31], v[188:191]
s_waitcnt lgkmcnt(8)
buffer_load_dwordx4 v246, s[12:15], s30 offen offset:128 nt lds
v_mfma_f32_16x16x32_bf16 v[160:163], a[224:227], a[32:35], v[160:163]
ds_read_b64_tr_b16 a[180:181], v249 offset:20480
v_mul_f32 v152, s32, v152
v_mfma_f32_16x16x32_bf16 v[164:167], a[224:227], a[36:39], v[164:167]
ds_read_b64_tr_b16 a[182:183], v249 offset:20992
v_mul_f32 v153, s32, v153
v_mfma_f32_16x16x32_bf16 v[212:215], a[224:227], a[128:131], v[212:215]
s_waitcnt lgkmcnt(8)
ds_read_b64_tr_b16 a[192:193], v250 offset:20480
v_mul_f32 v154, s32, v154
v_mfma_f32_16x16x32_bf16 v[168:171], a[228:231], a[32:35], v[168:171]
ds_read_b64_tr_b16 a[194:195], v250 offset:20992
s_add_u32 m0, s29, 40704
v_mfma_f32_16x16x32_bf16 v[172:175], a[228:231], a[36:39], v[172:175]
s_waitcnt lgkmcnt(8)
ds_read_b64_tr_b16 a[212:213], v251 offset:20480
v_mul_f32 v155, s32, v155
v_mfma_f32_16x16x32_bf16 v[176:179], a[240:243], a[32:35], v[176:179]
ds_read_b64_tr_b16 a[214:215], v251 offset:20992
v_cvt_pk_bf16_f32 v86, v152, v153
v_mfma_f32_16x16x32_bf16 v[180:183], a[240:243], a[36:39], v[180:183]
s_waitcnt lgkmcnt(8)
ds_read_b64_tr_b16 a[224:225], v248 offset:24576
buffer_load_dwordx4 v246, s[12:15], s30 offen offset:256 nt lds
v_mfma_f32_16x16x32_bf16 v[184:187], a[244:247], a[32:35], v[184:187]
ds_read_b64_tr_b16 a[226:227], v248 offset:25088
v_cvt_pk_bf16_f32 v87, v154, v155
v_mfma_f32_16x16x32_bf16 v[188:191], a[244:247], a[36:39], v[188:191]
s_waitcnt lgkmcnt(8)
v_permlane32_swap_b32 v84, v86
v_mfma_f32_16x16x32_bf16 v[160:163], a[176:179], a[40:43], v[160:163]
ds_read_b64_tr_b16 a[228:229], v249 offset:24576
s_add_u32 m0, s29, 44672
v_mfma_f32_16x16x32_bf16 v[164:167], a[176:179], a[44:47], v[164:167]
ds_read_b64_tr_b16 a[230:231], v249 offset:25088
v_mfma_f32_16x16x32_bf16 v[212:215], a[176:179], a[132:135], v[212:215]
s_waitcnt lgkmcnt(8)
ds_read_b64_tr_b16 a[240:241], v250 offset:24576
v_mfma_f32_16x16x32_bf16 v[168:171], a[180:183], a[40:43], v[168:171]
ds_read_b64_tr_b16 a[242:243], v250 offset:25088
buffer_load_dwordx4 v246, s[12:15], s30 offen offset:384 nt lds
v_mfma_f32_16x16x32_bf16 v[172:175], a[180:183], a[44:47], v[172:175]
s_waitcnt lgkmcnt(8)
ds_read_b64_tr_b16 a[244:245], v251 offset:24576
v_permlane32_swap_b32 v85, v87
v_mfma_f32_16x16x32_bf16 v[176:179], a[192:195], a[40:43], v[176:179]
ds_read_b64_tr_b16 a[246:247], v251 offset:25088
v_permlane16_swap_b32 v84, v86
v_mfma_f32_16x16x32_bf16 v[180:183], a[192:195], a[44:47], v[180:183]
s_waitcnt lgkmcnt(8)
ds_read_b64_tr_b16 a[176:177], v248 offset:28672
v_mfma_f32_16x16x32_bf16 v[184:187], a[212:215], a[40:43], v[184:187]
ds_read_b64_tr_b16 a[178:179], v248 offset:29184
v_permlane16_swap_b32 v85, v87
v_mfma_f32_16x16x32_bf16 v[188:191], a[212:215], a[44:47], v[188:191]
s_waitcnt lgkmcnt(8)
ds_read_b64_tr_b16 a[180:181], v249 offset:28672
v_mfma_f32_16x16x32_bf16 v[160:163], a[224:227], a[48:51], v[160:163]
ds_read_b64_tr_b16 a[182:183], v249 offset:29184
v_mfma_f32_16x16x32_bf16 v[164:167], a[224:227], a[52:55], v[164:167]
ds_read_b64_tr_b16 a[192:193], v250 offset:28672
v_mfma_f32_16x16x32_bf16 v[212:215], a[224:227], a[136:139], v[212:215]
s_waitcnt lgkmcnt(9)
ds_read_b64_tr_b16 a[194:195], v250 offset:29184
v_mfma_f32_16x16x32_bf16 v[168:171], a[228:231], a[48:51], v[168:171]
ds_read_b64_tr_b16 a[196:197], v251 offset:28672
v_mfma_f32_16x16x32_bf16 v[172:175], a[228:231], a[52:55], v[172:175]
s_waitcnt lgkmcnt(9)
ds_read_b64_tr_b16 a[198:199], v251 offset:29184
v_mfma_f32_16x16x32_bf16 v[176:179], a[240:243], a[48:51], v[176:179]
ds_read_b64_tr_b16 a[208:209], v248 offset:32768
v_mfma_f32_16x16x32_bf16 v[180:183], a[240:243], a[52:55], v[180:183]
s_waitcnt lgkmcnt(9)
ds_read_b64_tr_b16 a[210:211], v248 offset:33280
v_mfma_f32_16x16x32_bf16 v[184:187], a[244:247], a[48:51], v[184:187]
v_mfma_f32_16x16x32_bf16 v[188:191], a[244:247], a[52:55], v[188:191]
s_waitcnt lgkmcnt(10)
s_barrier
s_waitcnt lgkmcnt(8)
v_mfma_f32_16x16x32_bf16 v[160:163], a[176:179], a[56:59], v[160:163]
ds_read_b64_tr_b16 a[212:213], v249 offset:32768
s_mov_b32 s30, 32768
v_mfma_f32_16x16x32_bf16 v[164:167], a[176:179], a[60:63], v[164:167]
ds_read_b64_tr_b16 a[214:215], v249 offset:33280
s_add_u32 m0, s29, 65536
v_mfma_f32_16x16x32_bf16 v[212:215], a[176:179], a[140:143], v[212:215]
s_waitcnt lgkmcnt(8)
ds_read_b64_tr_b16 a[224:225], v250 offset:32768
v_mul_f32 v132, s32, v132
v_mfma_f32_16x16x32_bf16 v[168:171], a[180:183], a[56:59], v[168:171]
ds_read_b64_tr_b16 a[226:227], v250 offset:33280
v_mul_f32 v133, s32, v133
v_mfma_f32_16x16x32_bf16 v[172:175], a[180:183], a[60:63], v[172:175]
s_waitcnt lgkmcnt(8)
ds_read_b64_tr_b16 a[228:229], v251 offset:32768
v_mul_f32 v134, s32, v134
v_mfma_f32_16x16x32_bf16 v[176:179], a[192:195], a[56:59], v[176:179]
ds_read_b64_tr_b16 a[230:231], v251 offset:33280
buffer_load_dwordx4 v247, s[16:19], s30 offen offset:0 nt lds
v_mfma_f32_16x16x32_bf16 v[180:183], a[192:195], a[60:63], v[180:183]
s_waitcnt lgkmcnt(8)
ds_read_b64_tr_b16 a[240:241], v248 offset:36864
v_mul_f32 v135, s32, v135
v_mfma_f32_16x16x32_bf16 v[184:187], a[196:199], a[56:59], v[184:187]
ds_read_b64_tr_b16 a[242:243], v248 offset:37376
v_cvt_pk_bf16_f32 v112, v132, v133
v_mfma_f32_16x16x32_bf16 v[188:191], a[196:199], a[60:63], v[188:191]
s_waitcnt lgkmcnt(8)
ds_read_b64_tr_b16 a[244:245], v249 offset:36864
s_add_u32 m0, s29, 69504
v_mfma_f32_16x16x32_bf16 v[160:163], a[208:211], a[64:67], v[160:163]
ds_read_b64_tr_b16 a[246:247], v249 offset:37376
v_cvt_pk_bf16_f32 v113, v134, v135
v_mfma_f32_16x16x32_bf16 v[164:167], a[208:211], a[68:71], v[164:167]
buffer_load_dwordx4 v247, s[16:19], s30 offen offset:128 nt lds
v_mfma_f32_16x16x32_bf16 v[212:215], a[208:211], a[144:147], v[212:215]
s_waitcnt lgkmcnt(8)
ds_read_b64_tr_b16 a[176:177], v250 offset:36864
v_mul_f32 v140, s32, v140
v_mfma_f32_16x16x32_bf16 v[168:171], a[212:215], a[64:67], v[168:171]
ds_read_b64_tr_b16 a[178:179], v250 offset:37376
v_mul_f32 v141, s32, v141
v_mfma_f32_16x16x32_bf16 v[172:175], a[212:215], a[68:71], v[172:175]
s_waitcnt lgkmcnt(8)
ds_read_b64_tr_b16 a[180:181], v251 offset:36864
v_mul_f32 v142, s32, v142
v_mfma_f32_16x16x32_bf16 v[176:179], a[224:227], a[64:67], v[176:179]
ds_read_b64_tr_b16 a[182:183], v251 offset:37376
v_mul_f32 v143, s32, v143
v_mfma_f32_16x16x32_bf16 v[180:183], a[224:227], a[68:71], v[180:183]
s_waitcnt lgkmcnt(8)
ds_read_b64_tr_b16 a[192:193], v248 offset:40960
s_add_u32 m0, s29, 73472
v_mfma_f32_16x16x32_bf16 v[184:187], a[228:231], a[64:67], v[184:187]
ds_read_b64_tr_b16 a[194:195], v248 offset:41472
v_cvt_pk_bf16_f32 v114, v140, v141
v_mfma_f32_16x16x32_bf16 v[188:191], a[228:231], a[68:71], v[188:191]
s_waitcnt lgkmcnt(8)
buffer_load_dwordx4 v247, s[16:19], s30 offen offset:256 nt lds
v_mfma_f32_16x16x32_bf16 v[160:163], a[240:243], a[72:75], v[160:163]
ds_read_b64_tr_b16 a[196:197], v249 offset:40960
v_cvt_pk_bf16_f32 v115, v142, v143
v_mfma_f32_16x16x32_bf16 v[164:167], a[240:243], a[76:79], v[164:167]
ds_read_b64_tr_b16 a[198:199], v249 offset:41472
s_add_u32 m0, s29, 77440
v_mfma_f32_16x16x32_bf16 v[212:215], a[240:243], a[148:151], v[212:215]
s_waitcnt lgkmcnt(8)
ds_read_b64_tr_b16 a[208:209], v250 offset:40960
v_permlane32_swap_b32 v112, v114
v_mfma_f32_16x16x32_bf16 v[168:171], a[244:247], a[72:75], v[168:171]
ds_read_b64_tr_b16 a[210:211], v250 offset:41472
v_permlane32_swap_b32 v113, v115
v_mfma_f32_16x16x32_bf16 v[172:175], a[244:247], a[76:79], v[172:175]
s_waitcnt lgkmcnt(8)
ds_read_b64_tr_b16 a[212:213], v251 offset:40960
v_permlane16_swap_b32 v112, v114
v_mfma_f32_16x16x32_bf16 v[176:179], a[176:179], a[72:75], v[176:179]
ds_read_b64_tr_b16 a[214:215], v251 offset:41472
buffer_load_dwordx4 v247, s[16:19], s30 offen offset:384 nt lds
v_mfma_f32_16x16x32_bf16 v[180:183], a[176:179], a[76:79], v[180:183]
s_waitcnt lgkmcnt(8)
ds_read_b64_tr_b16 a[224:225], v248 offset:45056
v_permlane16_swap_b32 v113, v115
v_mfma_f32_16x16x32_bf16 v[184:187], a[180:183], a[72:75], v[184:187]
ds_read_b64_tr_b16 a[226:227], v248 offset:45568
v_mul_f32 v148, s32, v148
v_mfma_f32_16x16x32_bf16 v[188:191], a[180:183], a[76:79], v[188:191]
s_waitcnt lgkmcnt(8)
ds_read_b64_tr_b16 a[228:229], v249 offset:45056
v_mul_f32 v149, s32, v149
v_mfma_f32_16x16x32_bf16 v[160:163], a[192:195], a[80:83], v[160:163]
ds_read_b64_tr_b16 a[230:231], v249 offset:45568
v_mul_f32 v150, s32, v150
v_mfma_f32_16x16x32_bf16 v[164:167], a[192:195], a[84:87], v[164:167]
ds_read_b64_tr_b16 a[240:241], v250 offset:45056
v_mul_f32 v151, s32, v151
v_mfma_f32_16x16x32_bf16 v[212:215], a[192:195], a[152:155], v[212:215]
s_waitcnt lgkmcnt(9)
ds_read_b64_tr_b16 a[242:243], v250 offset:45568
s_mov_b32 s30, 49152
v_mfma_f32_16x16x32_bf16 v[168:171], a[196:199], a[80:83], v[168:171]
ds_read_b64_tr_b16 a[244:245], v251 offset:45056
s_add_u32 m0, s29, 49152
v_mfma_f32_16x16x32_bf16 v[172:175], a[196:199], a[84:87], v[172:175]
s_waitcnt lgkmcnt(9)
ds_read_b64_tr_b16 a[246:247], v251 offset:45568
buffer_load_dwordx4 v246, s[12:15], s30 offen offset:0 nt lds
v_mfma_f32_16x16x32_bf16 v[176:179], a[208:211], a[80:83], v[176:179]
ds_read_b64_tr_b16 a[176:177], v248 offset:49152
v_cvt_pk_bf16_f32 v116, v148, v149
v_mfma_f32_16x16x32_bf16 v[180:183], a[208:211], a[84:87], v[180:183]
s_waitcnt lgkmcnt(9)
ds_read_b64_tr_b16 a[178:179], v248 offset:49664
v_cvt_pk_bf16_f32 v117, v150, v151
v_mfma_f32_16x16x32_bf16 v[184:187], a[212:215], a[80:83], v[184:187]
ds_read_b64_tr_b16 a[180:181], v249 offset:49152
v_mul_f32 v156, s32, v156
v_mfma_f32_16x16x32_bf16 v[188:191], a[212:215], a[84:87], v[188:191]
s_waitcnt lgkmcnt(9)
ds_read_b64_tr_b16 a[182:183], v249 offset:49664
v_mul_f32 v157, s32, v157
v_mfma_f32_16x16x32_bf16 v[160:163], a[224:227], a[88:91], v[160:163]
ds_read_b64_tr_b16 a[192:193], v250 offset:49152
v_mul_f32 v158, s32, v158
v_mfma_f32_16x16x32_bf16 v[164:167], a[224:227], a[92:95], v[164:167]
ds_read_b64_tr_b16 a[194:195], v250 offset:49664
s_add_u32 m0, s29, 53120
v_mfma_f32_16x16x32_bf16 v[212:215], a[224:227], a[156:159], v[212:215]
s_waitcnt lgkmcnt(10)
buffer_load_dwordx4 v246, s[12:15], s30 offen offset:128 nt lds
v_mul_f32 v159, s32, v159
v_mfma_f32_16x16x32_bf16 v[168:171], a[228:231], a[88:91], v[168:171]
ds_read_b64_tr_b16 a[196:197], v251 offset:49152
v_cvt_pk_bf16_f32 v118, v156, v157
v_mfma_f32_16x16x32_bf16 v[172:175], a[228:231], a[92:95], v[172:175]
s_waitcnt lgkmcnt(9)
ds_read_b64_tr_b16 a[198:199], v251 offset:49664
v_cvt_pk_bf16_f32 v119, v158, v159
v_mfma_f32_16x16x32_bf16 v[176:179], a[240:243], a[88:91], v[176:179]
v_permlane32_swap_b32 v116, v118
v_mfma_f32_16x16x32_bf16 v[180:183], a[240:243], a[92:95], v[180:183]
s_waitcnt lgkmcnt(8)
ds_read_b64_tr_b16 a[208:209], v248 offset:53248
v_permlane32_swap_b32 v117, v119
v_mfma_f32_16x16x32_bf16 v[184:187], a[244:247], a[88:91], v[184:187]
ds_read_b64_tr_b16 a[210:211], v248 offset:53760
v_permlane16_swap_b32 v116, v118
v_mfma_f32_16x16x32_bf16 v[188:191], a[244:247], a[92:95], v[188:191]
s_waitcnt lgkmcnt(8)
v_permlane16_swap_b32 v117, v119
s_add_u32 m0, s29, 57088
s_nop 0
buffer_load_dwordx4 v246, s[12:15], s30 offen offset:256 nt lds
v_mfma_f32_16x16x32_bf16 v[160:163], a[176:179], a[96:99], v[160:163]
ds_read_b64_tr_b16 a[212:213], v249 offset:53248
v_mul_f32 v208, s32, v208
v_mfma_f32_16x16x32_bf16 v[164:167], a[176:179], a[100:103], v[164:167]
ds_read_b64_tr_b16 a[214:215], v249 offset:53760
v_mul_f32 v209, s32, v209
v_mfma_f32_16x16x32_bf16 v[212:215], a[176:179], a[160:163], v[212:215]
s_waitcnt lgkmcnt(8)
ds_read_b64_tr_b16 a[224:225], v250 offset:53248
v_mul_f32 v210, s32, v210
v_mfma_f32_16x16x32_bf16 v[168:171], a[180:183], a[96:99], v[168:171]
ds_read_b64_tr_b16 a[226:227], v250 offset:53760
s_add_u32 m0, s29, 61056
v_mfma_f32_16x16x32_bf16 v[172:175], a[180:183], a[100:103], v[172:175]
s_waitcnt lgkmcnt(8)
ds_read_b64_tr_b16 a[228:229], v251 offset:53248
buffer_load_dwordx4 v246, s[12:15], s30 offen offset:384 nt lds
v_mfma_f32_16x16x32_bf16 v[176:179], a[192:195], a[96:99], v[176:179]
ds_read_b64_tr_b16 a[230:231], v251 offset:53760
v_mul_f32 v211, s32, v211
v_mfma_f32_16x16x32_bf16 v[180:183], a[192:195], a[100:103], v[180:183]
s_waitcnt lgkmcnt(8)
v_cvt_pk_bf16_f32 v208, v208, v209
v_cvt_pk_bf16_f32 v209, v210, v211
v_mfma_f32_16x16x32_bf16 v[184:187], a[196:199], a[96:99], v[184:187]
ds_write_b64 v254, v[208:209] offset:12288
v_mfma_f32_16x16x32_bf16 v[188:191], a[196:199], a[100:103], v[188:191]
s_waitcnt lgkmcnt(7)
v_mfma_f32_16x16x32_bf16 v[160:163], a[208:211], a[104:107], v[160:163]
v_mfma_f32_16x16x32_bf16 v[164:167], a[208:211], a[108:111], v[164:167]
v_mfma_f32_16x16x32_bf16 v[212:215], a[208:211], a[164:167], v[212:215]
s_waitcnt lgkmcnt(5)
v_mfma_f32_16x16x32_bf16 v[168:171], a[212:215], a[104:107], v[168:171]
v_mfma_f32_16x16x32_bf16 v[172:175], a[212:215], a[108:111], v[172:175]
s_waitcnt lgkmcnt(3)
v_mfma_f32_16x16x32_bf16 v[176:179], a[224:227], a[104:107], v[176:179]
v_mfma_f32_16x16x32_bf16 v[180:183], a[224:227], a[108:111], v[180:183]
s_waitcnt lgkmcnt(1)
v_mfma_f32_16x16x32_bf16 v[184:187], a[228:231], a[104:107], v[184:187]
v_mfma_f32_16x16x32_bf16 v[188:191], a[228:231], a[108:111], v[188:191]
s_waitcnt vmcnt(12) lgkmcnt(0)
s_barrier
s_mov_b32 s30, 49152
s_add_u32 m0, s29, 81920
s_nop 0
buffer_load_dwordx4 v247, s[16:19], s30 offen offset:0 nt lds
s_add_u32 m0, s29, 85888
s_nop 0
buffer_load_dwordx4 v247, s[16:19], s30 offen offset:128 nt lds
s_add_u32 m0, s29, 89856
s_nop 0
buffer_load_dwordx4 v247, s[16:19], s30 offen offset:256 nt lds
s_add_u32 m0, s29, 93824
s_nop 0
buffer_load_dwordx4 v247, s[16:19], s30 offen offset:384 nt lds
s_nop 7
v_mul_f32 v160, s32, v160
v_mul_f32 v161, s32, v161
v_mul_f32 v162, s32, v162
v_mul_f32 v163, s32, v163
v_cvt_pk_bf16_f32 v88, v160, v161
v_cvt_pk_bf16_f32 v89, v162, v163
v_mul_f32 v168, s32, v168
v_mul_f32 v169, s32, v169
v_mul_f32 v170, s32, v170
v_mul_f32 v171, s32, v171
v_cvt_pk_bf16_f32 v90, v168, v169
v_cvt_pk_bf16_f32 v91, v170, v171
s_nop 0
v_permlane32_swap_b32 v88, v90
v_permlane32_swap_b32 v89, v91
s_nop 0
v_permlane16_swap_b32 v88, v90
v_permlane16_swap_b32 v89, v91
v_mul_f32 v176, s32, v176
v_mul_f32 v177, s32, v177
v_mul_f32 v178, s32, v178
v_mul_f32 v179, s32, v179
v_cvt_pk_bf16_f32 v92, v176, v177
v_cvt_pk_bf16_f32 v93, v178, v179
v_mul_f32 v184, s32, v184
v_mul_f32 v185, s32, v185
v_mul_f32 v186, s32, v186
v_mul_f32 v187, s32, v187
v_cvt_pk_bf16_f32 v94, v184, v185
v_cvt_pk_bf16_f32 v95, v186, v187
s_nop 0
v_permlane32_swap_b32 v92, v94
v_permlane32_swap_b32 v93, v95
s_nop 0
v_permlane16_swap_b32 v92, v94
v_permlane16_swap_b32 v93, v95
v_mul_f32 v164, s32, v164
v_mul_f32 v165, s32, v165
v_mul_f32 v166, s32, v166
v_mul_f32 v167, s32, v167
v_cvt_pk_bf16_f32 v120, v164, v165
v_cvt_pk_bf16_f32 v121, v166, v167
v_mul_f32 v172, s32, v172
v_mul_f32 v173, s32, v173
v_mul_f32 v174, s32, v174
v_mul_f32 v175, s32, v175
v_cvt_pk_bf16_f32 v122, v172, v173
v_cvt_pk_bf16_f32 v123, v174, v175
s_nop 0
v_permlane32_swap_b32 v120, v122
v_permlane32_swap_b32 v121, v123
s_nop 0
v_permlane16_swap_b32 v120, v122
v_permlane16_swap_b32 v121, v123
v_mul_f32 v180, s32, v180
v_mul_f32 v181, s32, v181
v_mul_f32 v182, s32, v182
v_mul_f32 v183, s32, v183
v_cvt_pk_bf16_f32 v124, v180, v181
v_cvt_pk_bf16_f32 v125, v182, v183
v_mul_f32 v188, s32, v188
v_mul_f32 v189, s32, v189
v_mul_f32 v190, s32, v190
v_mul_f32 v191, s32, v191
v_cvt_pk_bf16_f32 v126, v188, v189
v_cvt_pk_bf16_f32 v127, v190, v191
s_nop 0
v_permlane32_swap_b32 v124, v126
v_permlane32_swap_b32 v125, v127
s_nop 0
v_permlane16_swap_b32 v124, v126
v_permlane16_swap_b32 v125, v127
v_mul_f32 v212, s32, v212
v_mul_f32 v213, s32, v213
v_mul_f32 v214, s32, v214
v_mul_f32 v215, s32, v215
v_cvt_pk_bf16_f32 v212, v212, v213
v_cvt_pk_bf16_f32 v213, v214, v215
ds_write_b64 v254, v[212:213] offset:14336
s_waitcnt lgkmcnt(0)
s_barrier
s_mov_b32 s30, 65536
v_mov_b32 v248, 0
v_mov_b32 v249, 0
v_mov_b32 v250, 0
v_mov_b32 v251, 0
v_mov_b32 v252, 0
v_mbcnt_lo_u32_b32 v253, -1, 0
v_mbcnt_hi_u32_b32 v253, -1, v253
v_lshlrev_b32 v253, 4, v253
s_mul_i32 s42, s50, 57344
s_mul_i32 s33, s28, 14336
s_add_u32 s42, s42, s33
s_sub_u32 s42, s42, 1024
s_mov_b32 s43, s42
s_mov_b32 s42, 0x40000000
s_cmp_eq_u32 s39, 1
s_cbranch_scc1 L_attn1
ds_read_b128 v[220:223], v236 offset:0
ds_read_b128 v[232:235], v242 offset:0
ds_read_b128 v[224:227], v237 offset:0
ds_read_b128 v[228:231], v243 offset:0
s_waitcnt lgkmcnt(3)
v_mfma_f32_16x16x32_bf16 v[160:163], v[220:223], v[0:3], 0
v_mfma_f32_16x16x32_bf16 v[164:167], v[220:223], v[32:35], 0
v_mfma_f32_16x16x32_bf16 v[168:171], v[220:223], v[64:67], 0
v_mfma_f32_16x16x32_bf16 v[172:175], v[220:223], v[96:99], 0
s_waitcnt lgkmcnt(2)
v_mfma_f32_16x16x32_bf16 v[208:211], v[220:223], v[232:235], 0
s_waitcnt lgkmcnt(1)
v_mfma_f32_16x16x32_bf16 v[160:163], v[224:227], v[4:7], v[160:163]
v_mfma_f32_16x16x32_bf16 v[164:167], v[224:227], v[36:39], v[164:167]
v_mfma_f32_16x16x32_bf16 v[168:171], v[224:227], v[68:71], v[168:171]
v_mfma_f32_16x16x32_bf16 v[172:175], v[224:227], v[100:103], v[172:175]
s_waitcnt lgkmcnt(0)
v_mfma_f32_16x16x32_bf16 v[208:211], v[224:227], v[228:231], v[208:211]
ds_read_b128 v[228:231], v236 offset:4096
s_waitcnt lgkmcnt(0)
ds_read_b128 v[212:215], v242 offset:2048
v_mfma_f32_16x16x32_bf16 v[160:163], v[228:231], v[8:11], v[160:163]
ds_read_b128 v[216:219], v237 offset:4096
v_mfma_f32_16x16x32_bf16 v[164:167], v[228:231], v[40:43], v[164:167]
ds_read_b128 v[220:223], v243 offset:2048
v_mfma_f32_16x16x32_bf16 v[168:171], v[228:231], v[72:75], v[168:171]
ds_read_b128 v[232:235], v236 offset:8192
v_mfma_f32_16x16x32_bf16 v[172:175], v[228:231], v[104:107], v[172:175]
s_waitcnt lgkmcnt(3)
ds_read_b128 v[224:227], v242 offset:4096
v_mfma_f32_16x16x32_bf16 v[208:211], v[228:231], v[212:215], v[208:211]
s_waitcnt lgkmcnt(3)
ds_read_b128 v[228:231], v237 offset:8192
v_mfma_f32_16x16x32_bf16 v[160:163], v[216:219], v[12:15], v[160:163]
ds_read_b128 v[212:215], v243 offset:4096
v_mfma_f32_16x16x32_bf16 v[164:167], v[216:219], v[44:47], v[164:167]
v_mfma_f32_16x16x32_bf16 v[168:171], v[216:219], v[76:79], v[168:171]
v_mfma_f32_16x16x32_bf16 v[172:175], v[216:219], v[108:111], v[172:175]
s_waitcnt lgkmcnt(3)
v_mfma_f32_16x16x32_bf16 v[208:211], v[216:219], v[220:223], v[208:211]
ds_read_b128 v[220:223], v236 offset:12288
v_mfma_f32_16x16x32_bf16 v[160:163], v[232:235], v[16:19], v[160:163]
ds_read_b128 v[216:219], v242 offset:6144
v_mfma_f32_16x16x32_bf16 v[164:167], v[232:235], v[48:51], v[164:167]
v_mfma_f32_16x16x32_bf16 v[168:171], v[232:235], v[80:83], v[168:171]
v_mfma_f32_16x16x32_bf16 v[172:175], v[232:235], v[112:115], v[172:175]
s_waitcnt lgkmcnt(2)
v_mfma_f32_16x16x32_bf16 v[208:211], v[232:235], v[224:227], v[208:211]
ds_read_b128 v[224:227], v237 offset:12288
v_mfma_f32_16x16x32_bf16 v[160:163], v[228:231], v[20:23], v[160:163]
ds_read_b128 v[232:235], v243 offset:6144
v_mfma_f32_16x16x32_bf16 v[164:167], v[228:231], v[52:55], v[164:167]
v_mfma_f32_16x16x32_bf16 v[168:171], v[228:231], v[84:87], v[168:171]
v_mfma_f32_16x16x32_bf16 v[172:175], v[228:231], v[116:119], v[172:175]
v_mfma_f32_16x16x32_bf16 v[208:211], v[228:231], v[212:215], v[208:211]
s_waitcnt lgkmcnt(2)
ds_read_b128 v[228:231], v236 offset:2048
v_mfma_f32_16x16x32_bf16 v[160:163], v[220:223], v[24:27], v[160:163]
ds_read_b128 v[212:215], v237 offset:2048
v_mfma_f32_16x16x32_bf16 v[164:167], v[220:223], v[56:59], v[164:167]
v_mfma_f32_16x16x32_bf16 v[168:171], v[220:223], v[88:91], v[168:171]
v_mfma_f32_16x16x32_bf16 v[172:175], v[220:223], v[120:123], v[172:175]
v_mfma_f32_16x16x32_bf16 v[208:211], v[220:223], v[216:219], v[208:211]
s_waitcnt lgkmcnt(2)
ds_read_b128 v[220:223], v236 offset:6144
v_mfma_f32_16x16x32_bf16 v[160:163], v[224:227], v[28:31], v[160:163]
v_mfma_f32_16x16x32_bf16 v[164:167], v[224:227], v[60:63], v[164:167]
ds_read_b128 v[216:219], v237 offset:6144
v_mfma_f32_16x16x32_bf16 v[168:171], v[224:227], v[92:95], v[168:171]
v_mfma_f32_16x16x32_bf16 v[172:175], v[224:227], v[124:127], v[172:175]
v_mfma_f32_16x16x32_bf16 v[208:211], v[224:227], v[232:235], v[208:211]
s_waitcnt lgkmcnt(2)
v_mfma_f32_16x16x32_bf16 v[192:195], v[228:231], v[0:3], 0
ds_read_b128 v[224:227], v236 offset:10240
v_mfma_f32_16x16x32_bf16 v[196:199], v[228:231], v[32:35], 0
v_mfma_f32_16x16x32_bf16 v[200:203], v[228:231], v[64:67], 0
v_exp_f32 v160, v160
v_mfma_f32_16x16x32_bf16 v[204:207], v[228:231], v[96:99], 0
v_exp_f32 v161, v161
v_mfma_f32_16x16x32_bf16 v[192:195], v[212:215], v[4:7], v[192:195]
v_exp_f32 v162, v162
v_mfma_f32_16x16x32_bf16 v[196:199], v[212:215], v[36:39], v[196:199]
v_exp_f32 v163, v163
v_mfma_f32_16x16x32_bf16 v[200:203], v[212:215], v[68:71], v[200:203]
v_exp_f32 v164, v164
v_mfma_f32_16x16x32_bf16 v[204:207], v[212:215], v[100:103], v[204:207]
s_waitcnt lgkmcnt(0)
v_exp_f32 v165, v165
v_mfma_f32_16x16x32_bf16 v[192:195], v[220:223], v[8:11], v[192:195]
v_exp_f32 v166, v166
v_mfma_f32_16x16x32_bf16 v[196:199], v[220:223], v[40:43], v[196:199]
v_exp_f32 v167, v167
v_mfma_f32_16x16x32_bf16 v[200:203], v[220:223], v[72:75], v[200:203]
ds_read_b128 v[232:235], v237 offset:10240
v_add_f32 v248, v248, v160
v_mfma_f32_16x16x32_bf16 v[204:207], v[220:223], v[104:107], v[204:207]
v_exp_f32 v168, v168
v_mfma_f32_16x16x32_bf16 v[192:195], v[216:219], v[12:15], v[192:195]
v_exp_f32 v169, v169
v_mfma_f32_16x16x32_bf16 v[196:199], v[216:219], v[44:47], v[196:199]
v_exp_f32 v170, v170
v_mfma_f32_16x16x32_bf16 v[200:203], v[216:219], v[76:79], v[200:203]
ds_read_b128 v[228:231], v236 offset:14336
v_add_f32 v248, v248, v161
v_mfma_f32_16x16x32_bf16 v[204:207], v[216:219], v[108:111], v[204:207]
v_exp_f32 v171, v171
v_mfma_f32_16x16x32_bf16 v[192:195], v[224:227], v[16:19], v[192:195]
v_exp_f32 v172, v172
v_mfma_f32_16x16x32_bf16 v[196:199], v[224:227], v[48:51], v[196:199]
v_exp_f32 v173, v173
v_mfma_f32_16x16x32_bf16 v[200:203], v[224:227], v[80:83], v[200:203]
ds_read_b128 v[212:215], v237 offset:14336
v_add_f32 v248, v248, v162
v_mfma_f32_16x16x32_bf16 v[204:207], v[224:227], v[112:115], v[204:207]
s_waitcnt lgkmcnt(2)
v_exp_f32 v174, v174
v_mfma_f32_16x16x32_bf16 v[192:195], v[232:235], v[20:23], v[192:195]
v_exp_f32 v175, v175
v_mfma_f32_16x16x32_bf16 v[196:199], v[232:235], v[52:55], v[196:199]
v_exp_f32 v208, v208
v_mfma_f32_16x16x32_bf16 v[200:203], v[232:235], v[84:87], v[200:203]
v_exp_f32 v209, v209
v_mfma_f32_16x16x32_bf16 v[204:207], v[232:235], v[116:119], v[204:207]
s_waitcnt lgkmcnt(1)
v_exp_f32 v210, v210
v_mfma_f32_16x16x32_bf16 v[192:195], v[228:231], v[24:27], v[192:195]
v_exp_f32 v211, v211
v_mfma_f32_16x16x32_bf16 v[196:199], v[228:231], v[56:59], v[196:199]
v_add_f32 v248, v248, v163
v_cvt_pk_bf16_f32 v160, v160, v161
v_mfma_f32_16x16x32_bf16 v[200:203], v[228:231], v[88:91], v[200:203]
v_cvt_pk_bf16_f32 v161, v162, v163
v_add_f32 v249, v249, v164
v_mfma_f32_16x16x32_bf16 v[204:207], v[228:231], v[120:123], v[204:207]
s_waitcnt lgkmcnt(0)
v_add_f32 v249, v249, v165
v_add_f32 v249, v249, v166
v_mfma_f32_16x16x32_bf16 v[192:195], v[212:215], v[28:31], v[192:195]
v_add_f32 v249, v249, v167
v_cvt_pk_bf16_f32 v164, v164, v165
v_mfma_f32_16x16x32_bf16 v[196:199], v[212:215], v[60:63], v[196:199]
v_cvt_pk_bf16_f32 v165, v166, v167
v_add_f32 v250, v250, v168
v_mfma_f32_16x16x32_bf16 v[200:203], v[212:215], v[92:95], v[200:203]
v_add_f32 v250, v250, v169
v_add_f32 v250, v250, v170
v_mfma_f32_16x16x32_bf16 v[204:207], v[212:215], v[124:127], v[204:207]
v_add_f32 v250, v250, v171
v_cvt_pk_bf16_f32 v168, v168, v169
v_add_f32 v252, v252, v208
v_add_f32 v252, v252, v209
v_add_f32 v252, v252, v210
v_add_f32 v252, v252, v211
v_cvt_pk_bf16_f32 v208, v208, v209
v_cvt_pk_bf16_f32 v209, v210, v211
ds_write_b64 v245, v[208:209] offset:0
v_cvt_pk_bf16_f32 v169, v170, v171
v_add_f32 v251, v251, v172
v_add_f32 v251, v251, v173
v_add_f32 v251, v251, v174
v_add_f32 v251, v251, v175
v_cvt_pk_bf16_f32 v172, v172, v173
v_cvt_pk_bf16_f32 v173, v174, v175
ds_read_b128 v[220:223], v236 offset:16384
ds_read_b128 v[232:235], v242 offset:0
ds_read_b128 v[224:227], v237 offset:16384
ds_read_b128 v[228:231], v236 offset:20480
s_waitcnt vmcnt(14) lgkmcnt(4)
s_barrier
s_mov_b32 s31, 8
s_waitcnt lgkmcnt(3)
v_mfma_f32_16x16x32_bf16 v[176:179], v[220:223], v[0:3], 0
ds_read_b128 v[212:215], v243 offset:0
s_add_u32 m0, s29, 0
v_mfma_f32_16x16x32_bf16 v[180:183], v[220:223], v[32:35], 0
v_exp_f32 v192, v192
v_mfma_f32_16x16x32_bf16 v[184:187], v[220:223], v[64:67], 0
v_exp_f32 v193, v193
v_mfma_f32_16x16x32_bf16 v[188:191], v[220:223], v[96:99], 0
s_waitcnt lgkmcnt(2)
v_exp_f32 v194, v194
v_mfma_f32_16x16x32_bf16 v[208:211], v[220:223], v[232:235], 0
ds_read_b128 v[216:219], v242 offset:2048
v_exp_f32 v195, v195
v_mfma_f32_16x16x32_bf16 v[176:179], v[224:227], v[4:7], v[176:179]
ds_read_b128 v[220:223], v237 offset:20480
v_add_f32 v248, v248, v192
v_mfma_f32_16x16x32_bf16 v[180:183], v[224:227], v[36:39], v[180:183]
buffer_load_dwordx4 v246, s[12:15], s30 offen offset:0 nt lds
v_mfma_f32_16x16x32_bf16 v[184:187], v[224:227], v[68:71], v[184:187]
v_exp_f32 v196, v196
v_add_f32 v248, v248, v193
v_add_f32 v248, v248, v194
v_mfma_f32_16x16x32_bf16 v[188:191], v[224:227], v[100:103], v[188:191]
s_waitcnt lgkmcnt(2)
v_exp_f32 v197, v197
v_add_f32 v248, v248, v195
v_mfma_f32_16x16x32_bf16 v[208:211], v[224:227], v[212:215], v[208:211]
ds_read_b128 v[232:235], v243 offset:2048
v_cvt_pk_bf16_f32 v162, v192, v193
v_mfma_f32_16x16x32_bf16 v[176:179], v[228:231], v[8:11], v[176:179]
ds_read_b128 v[224:227], v236 offset:24576
v_exp_f32 v198, v198
v_cvt_pk_bf16_f32 v163, v194, v195
v_mfma_f32_16x16x32_bf16 v[180:183], v[228:231], v[40:43], v[180:183]
v_exp_f32 v199, v199
v_mfma_f32_16x16x32_bf16 v[184:187], v[228:231], v[72:75], v[184:187]
v_exp_f32 v200, v200
v_mfma_f32_16x16x32_bf16 v[188:191], v[228:231], v[104:107], v[188:191]
s_waitcnt lgkmcnt(2)
v_exp_f32 v201, v201
v_mfma_f32_16x16x32_bf16 v[208:211], v[228:231], v[216:219], v[208:211]
ds_read_b128 v[212:215], v242 offset:4096
v_add_f32 v249, v249, v196
v_mfma_f32_16x16x32_bf16 v[176:179], v[220:223], v[12:15], v[176:179]
ds_read_b128 v[228:231], v237 offset:24576
v_add_f32 v249, v249, v197
v_add_f32 v249, v249, v198
v_mfma_f32_16x16x32_bf16 v[180:183], v[220:223], v[44:47], v[180:183]
v_exp_f32 v202, v202
v_add_f32 v249, v249, v199
v_mfma_f32_16x16x32_bf16 v[184:187], v[220:223], v[76:79], v[184:187]
v_exp_f32 v203, v203
v_cvt_pk_bf16_f32 v166, v196, v197
v_mfma_f32_16x16x32_bf16 v[188:191], v[220:223], v[108:111], v[188:191]
s_waitcnt lgkmcnt(2)
ds_read_b128 v[216:219], v243 offset:4096
v_cvt_pk_bf16_f32 v167, v198, v199
v_mfma_f32_16x16x32_bf16 v[208:211], v[220:223], v[232:235], v[208:211]
v_exp_f32 v204, v204
v_mfma_f32_16x16x32_bf16 v[176:179], v[224:227], v[16:19], v[176:179]
ds_read_b128 v[220:223], v236 offset:28672
v_add_f32 v250, v250, v200
v_mfma_f32_16x16x32_bf16 v[180:183], v[224:227], v[48:51], v[180:183]
v_exp_f32 v205, v205
v_mfma_f32_16x16x32_bf16 v[184:187], v[224:227], v[80:83], v[184:187]
v_exp_f32 v206, v206
v_mfma_f32_16x16x32_bf16 v[188:191], v[224:227], v[112:115], v[188:191]
s_waitcnt lgkmcnt(2)
v_exp_f32 v207, v207
v_add_f32 v250, v250, v201
v_add_f32 v250, v250, v202
v_mfma_f32_16x16x32_bf16 v[208:211], v[224:227], v[212:215], v[208:211]
ds_read_b128 v[232:235], v242 offset:6144
v_add_f32 v250, v250, v203
v_mfma_f32_16x16x32_bf16 v[176:179], v[228:231], v[20:23], v[176:179]
ds_read_b128 v[224:227], v237 offset:28672
s_add_u32 m0, s29, 3968
s_nop 0
buffer_load_dwordx4 v246, s[12:15], s30 offen offset:128 nt lds
v_cvt_pk_bf16_f32 v170, v200, v201
v_mfma_f32_16x16x32_bf16 v[180:183], v[228:231], v[52:55], v[180:183]
ds_read_b128 v[212:215], v243 offset:6144
v_cvt_pk_bf16_f32 v171, v202, v203
v_mfma_f32_16x16x32_bf16 v[184:187], v[228:231], v[84:87], v[184:187]
v_add_f32 v251, v251, v204
v_add_f32 v251, v251, v205
v_mfma_f32_16x16x32_bf16 v[188:191], v[228:231], v[116:119], v[188:191]
s_waitcnt lgkmcnt(3)
v_add_f32 v251, v251, v206
v_add_f32 v251, v251, v207
v_mfma_f32_16x16x32_bf16 v[208:211], v[228:231], v[216:219], v[208:211]
ds_read_b128 v[228:231], v236 offset:18432
v_cvt_pk_bf16_f32 v174, v204, v205
v_mfma_f32_16x16x32_bf16 v[176:179], v[220:223], v[24:27], v[176:179]
ds_read_b128 v[216:219], v237 offset:18432
v_cvt_pk_bf16_f32 v175, v206, v207
v_mfma_f32_16x16x32_bf16 v[180:183], v[220:223], v[56:59], v[180:183]
v_mfma_f32_16x16x32_bf16 v[184:187], v[220:223], v[88:91], v[184:187]
s_add_u32 m0, s29, 7936
v_mfma_f32_16x16x32_bf16 v[188:191], v[220:223], v[120:123], v[188:191]
s_waitcnt lgkmcnt(3)
v_mfma_f32_16x16x32_bf16 v[208:211], v[220:223], v[232:235], v[208:211]
buffer_load_dwordx4 v246, s[12:15], s30 offen offset:256 nt lds
v_mfma_f32_16x16x32_bf16 v[176:179], v[224:227], v[28:31], v[176:179]
ds_read_b128 v[220:223], v236 offset:22528
v_mfma_f32_16x16x32_bf16 v[180:183], v[224:227], v[60:63], v[180:183]
ds_read_b128 v[232:235], v237 offset:22528
v_mfma_f32_16x16x32_bf16 v[184:187], v[224:227], v[92:95], v[184:187]
v_mfma_f32_16x16x32_bf16 v[188:191], v[224:227], v[124:127], v[188:191]
s_waitcnt lgkmcnt(2)
v_mfma_f32_16x16x32_bf16 v[208:211], v[224:227], v[212:215], v[208:211]
v_mfma_f32_16x16x32_bf16 v[192:195], v[228:231], v[0:3], 0
ds_read_b128 v[224:227], v236 offset:26624
v_mfma_f32_16x16x32_bf16 v[196:199], v[228:231], v[32:35], 0
v_mfma_f32_16x16x32_bf16 v[200:203], v[228:231], v[64:67], 0
v_exp_f32 v176, v176
v_mfma_f32_16x16x32_bf16 v[204:207], v[228:231], v[96:99], 0
v_exp_f32 v177, v177
v_mfma_f32_16x16x32_bf16 v[192:195], v[216:219], v[4:7], v[192:195]
v_exp_f32 v178, v178
v_mfma_f32_16x16x32_bf16 v[196:199], v[216:219], v[36:39], v[196:199]
v_exp_f32 v179, v179
v_mfma_f32_16x16x32_bf16 v[200:203], v[216:219], v[68:71], v[200:203]
v_exp_f32 v180, v180
v_mfma_f32_16x16x32_bf16 v[204:207], v[216:219], v[100:103], v[204:207]
s_waitcnt lgkmcnt(1)
v_exp_f32 v181, v181
v_mfma_f32_16x16x32_bf16 v[192:195], v[220:223], v[8:11], v[192:195]
ds_read_b128 v[212:215], v237 offset:26624
s_add_u32 m0, s29, 11904
v_mfma_f32_16x16x32_bf16 v[196:199], v[220:223], v[40:43], v[196:199]
v_exp_f32 v182, v182
v_mfma_f32_16x16x32_bf16 v[200:203], v[220:223], v[72:75], v[200:203]
buffer_load_dwordx4 v246, s[12:15], s30 offen offset:384 nt lds
v_mfma_f32_16x16x32_bf16 v[204:207], v[220:223], v[104:107], v[204:207]
v_exp_f32 v183, v183
v_mfma_f32_16x16x32_bf16 v[192:195], v[232:235], v[12:15], v[192:195]
v_exp_f32 v184, v184
v_mfma_f32_16x16x32_bf16 v[196:199], v[232:235], v[44:47], v[196:199]
v_exp_f32 v185, v185
v_mfma_f32_16x16x32_bf16 v[200:203], v[232:235], v[76:79], v[200:203]
ds_read_b128 v[228:231], v236 offset:30720
v_add_f32 v248, v248, v176
v_mfma_f32_16x16x32_bf16 v[204:207], v[232:235], v[108:111], v[204:207]
s_waitcnt lgkmcnt(2)
v_exp_f32 v186, v186
v_mfma_f32_16x16x32_bf16 v[192:195], v[224:227], v[16:19], v[192:195]
v_exp_f32 v187, v187
v_mfma_f32_16x16x32_bf16 v[196:199], v[224:227], v[48:51], v[196:199]
v_exp_f32 v188, v188
v_mfma_f32_16x16x32_bf16 v[200:203], v[224:227], v[80:83], v[200:203]
ds_read_b128 v[216:219], v237 offset:30720
v_add_f32 v248, v248, v177
v_mfma_f32_16x16x32_bf16 v[204:207], v[224:227], v[112:115], v[204:207]
s_waitcnt lgkmcnt(2)
v_exp_f32 v189, v189
v_mfma_f32_16x16x32_bf16 v[192:195], v[212:215], v[20:23], v[192:195]
v_exp_f32 v190, v190
v_mfma_f32_16x16x32_bf16 v[196:199], v[212:215], v[52:55], v[196:199]
v_exp_f32 v191, v191
v_mfma_f32_16x16x32_bf16 v[200:203], v[212:215], v[84:87], v[200:203]
ds_read_b64_tr_b16 v[220:221], v239 offset:49152
v_add_f32 v248, v248, v178
v_mfma_f32_16x16x32_bf16 v[204:207], v[212:215], v[116:119], v[204:207]
s_waitcnt lgkmcnt(2)
ds_read_b64_tr_b16 v[222:223], v239 offset:51200
v_add_f32 v248, v248, v179
v_mfma_f32_16x16x32_bf16 v[192:195], v[228:231], v[24:27], v[192:195]
ds_read_b64_tr_b16 v[232:233], v239 offset:53248
s_add_u32 m0, s29, 98304
v_mfma_f32_16x16x32_bf16 v[196:199], v[228:231], v[56:59], v[196:199]
ds_read_b64_tr_b16 v[234:235], v239 offset:55296
v_cvt_pk_bf16_f32 v176, v176, v177
v_mfma_f32_16x16x32_bf16 v[200:203], v[228:231], v[88:91], v[200:203]
buffer_load_dwordx4 v247, s[16:19], s30 offen offset:0 nt lds
v_mfma_f32_16x16x32_bf16 v[204:207], v[228:231], v[120:123], v[204:207]
s_waitcnt lgkmcnt(4)
ds_read_b64_tr_b16 v[224:225], v239 offset:57344
v_cvt_pk_bf16_f32 v177, v178, v179
v_mfma_f32_16x16x32_bf16 v[192:195], v[216:219], v[28:31], v[192:195]
ds_read_b64_tr_b16 v[226:227], v239 offset:59392
v_add_f32 v249, v249, v180
v_mfma_f32_16x16x32_bf16 v[196:199], v[216:219], v[60:63], v[196:199]
ds_read_b64_tr_b16 v[228:229], v239 offset:61440
v_add_f32 v249, v249, v181
v_mfma_f32_16x16x32_bf16 v[200:203], v[216:219], v[92:95], v[200:203]
ds_read_b64_tr_b16 v[230:231], v239 offset:63488
v_add_f32 v249, v249, v182
v_mfma_f32_16x16x32_bf16 v[204:207], v[216:219], v[124:127], v[204:207]
s_waitcnt lgkmcnt(6)
v_exp_f32 v208, v208
v_mfma_f32_16x16x32_bf16 a[16:19], v[220:223], v[160:163], 0
ds_read_b128 v[212:215], v244 offset:0
v_add_f32 v249, v249, v183
v_mfma_f32_16x16x32_bf16 a[20:23], v[220:223], v[164:167], 0
ds_read_b128 v[216:219], v244 offset:1024
v_cvt_pk_bf16_f32 v180, v180, v181
v_mfma_f32_16x16x32_bf16 a[24:27], v[220:223], v[168:171], 0
v_exp_f32 v209, v209
v_mfma_f32_16x16x32_bf16 a[28:31], v[220:223], v[172:175], 0
s_waitcnt lgkmcnt(6)
ds_read_b64_tr_b16 v[220:221], v238 offset:49152
v_cvt_pk_bf16_f32 v181, v182, v183
v_mfma_f32_16x16x32_bf16 a[80:83], v[232:235], v[160:163], 0
ds_read_b64_tr_b16 v[222:223], v238 offset:51200
v_add_f32 v250, v250, v184
v_mfma_f32_16x16x32_bf16 a[84:87], v[232:235], v[164:167], 0
v_exp_f32 v210, v210
v_mfma_f32_16x16x32_bf16 a[88:91], v[232:235], v[168:171], 0
v_exp_f32 v211, v211
v_mfma_f32_16x16x32_bf16 a[92:95], v[232:235], v[172:175], 0
s_waitcnt lgkmcnt(4)
ds_read_b64_tr_b16 v[232:233], v238 offset:53248
v_add_f32 v250, v250, v185
v_mfma_f32_16x16x32_bf16 a[144:147], v[224:227], v[160:163], 0
ds_read_b64_tr_b16 v[234:235], v238 offset:55296
s_add_u32 m0, s29, 102272
v_mfma_f32_16x16x32_bf16 a[148:151], v[224:227], v[164:167], 0
v_exp_f32 v192, v192
v_mfma_f32_16x16x32_bf16 a[152:155], v[224:227], v[168:171], 0
buffer_load_dwordx4 v247, s[16:19], s30 offen offset:128 nt lds
v_mfma_f32_16x16x32_bf16 a[156:159], v[224:227], v[172:175], 0
v_exp_f32 v193, v193
v_mfma_f32_16x16x32_bf16 a[208:211], v[228:231], v[160:163], 0
ds_read_b64_tr_b16 v[224:225], v238 offset:57344
v_add_f32 v250, v250, v186
v_mfma_f32_16x16x32_bf16 a[212:215], v[228:231], v[164:167], 0
ds_read_b64_tr_b16 v[226:227], v238 offset:59392
v_add_f32 v250, v250, v187
v_mfma_f32_16x16x32_bf16 a[216:219], v[228:231], v[168:171], 0
v_exp_f32 v194, v194
v_mfma_f32_16x16x32_bf16 a[220:223], v[228:231], v[172:175], 0
s_waitcnt lgkmcnt(4)
v_exp_f32 v195, v195
v_mfma_f32_16x16x32_bf16 a[0:3], v[220:223], v[160:163], 0
v_exp_f32 v196, v196
v_mfma_f32_16x16x32_bf16 a[4:7], v[220:223], v[164:167], 0
v_exp_f32 v197, v197
v_mfma_f32_16x16x32_bf16 v[128:131], v[220:223], v[212:215], 0
ds_read_b64_tr_b16 v[228:229], v238 offset:61440
v_cvt_pk_bf16_f32 v184, v184, v185
v_mfma_f32_16x16x32_bf16 a[8:11], v[220:223], v[168:171], 0
ds_read_b64_tr_b16 v[230:231], v238 offset:63488
v_cvt_pk_bf16_f32 v185, v186, v187
v_mfma_f32_16x16x32_bf16 v[132:135], v[220:223], v[216:219], 0
v_exp_f32 v198, v198
v_mfma_f32_16x16x32_bf16 a[12:15], v[220:223], v[172:175], 0
s_waitcnt lgkmcnt(2)
v_exp_f32 v199, v199
v_mfma_f32_16x16x32_bf16 a[64:67], v[232:235], v[160:163], 0
v_exp_f32 v200, v200
v_mfma_f32_16x16x32_bf16 a[68:71], v[232:235], v[164:167], 0
v_exp_f32 v201, v201
v_mfma_f32_16x16x32_bf16 v[136:139], v[232:235], v[212:215], 0
ds_read_b64_tr_b16 v[220:221], v240 offset:49152
v_add_f32 v251, v251, v188
v_mfma_f32_16x16x32_bf16 a[72:75], v[232:235], v[168:171], 0
ds_read_b64_tr_b16 v[222:223], v240 offset:51200
v_add_f32 v251, v251, v189
v_mfma_f32_16x16x32_bf16 v[140:143], v[232:235], v[216:219], 0
v_exp_f32 v202, v202
v_mfma_f32_16x16x32_bf16 a[76:79], v[232:235], v[172:175], 0
v_exp_f32 v203, v203
v_mfma_f32_16x16x32_bf16 a[128:131], v[224:227], v[160:163], 0
ds_read_b64_tr_b16 v[232:233], v240 offset:53248
v_add_f32 v251, v251, v190
v_mfma_f32_16x16x32_bf16 a[132:135], v[224:227], v[164:167], 0
ds_read_b64_tr_b16 v[234:235], v240 offset:55296
v_add_f32 v251, v251, v191
v_mfma_f32_16x16x32_bf16 v[144:147], v[224:227], v[212:215], 0
v_exp_f32 v204, v204
v_cvt_pk_bf16_f32 v188, v188, v189
v_cvt_pk_bf16_f32 v189, v190, v191
v_mfma_f32_16x16x32_bf16 a[136:139], v[224:227], v[168:171], 0
v_exp_f32 v205, v205
v_mfma_f32_16x16x32_bf16 v[148:151], v[224:227], v[216:219], 0
v_exp_f32 v206, v206
v_mfma_f32_16x16x32_bf16 a[140:143], v[224:227], v[172:175], 0
s_waitcnt lgkmcnt(2)
ds_read_b64_tr_b16 v[224:225], v240 offset:57344
s_add_u32 m0, s29, 106240
s_nop 0
buffer_load_dwordx4 v247, s[16:19], s30 offen offset:256 nt lds
v_mfma_f32_16x16x32_bf16 a[192:195], v[228:231], v[160:163], 0
ds_read_b64_tr_b16 v[226:227], v240 offset:59392
v_add_f32 v252, v252, v208
v_mfma_f32_16x16x32_bf16 a[196:199], v[228:231], v[164:167], 0
v_exp_f32 v207, v207
v_mfma_f32_16x16x32_bf16 v[152:155], v[228:231], v[212:215], 0
v_add_f32 v252, v252, v209
v_add_f32 v252, v252, v210
v_mfma_f32_16x16x32_bf16 a[200:203], v[228:231], v[168:171], 0
v_add_f32 v252, v252, v211
v_cvt_pk_bf16_f32 v208, v208, v209
v_mfma_f32_16x16x32_bf16 v[156:159], v[228:231], v[216:219], 0
v_cvt_pk_bf16_f32 v209, v210, v211
v_add_f32 v248, v248, v192
v_mfma_f32_16x16x32_bf16 a[204:207], v[228:231], v[172:175], 0
ds_write_b64 v245, v[208:209] offset:2048
v_mfma_f32_16x16x32_bf16 a[32:35], v[220:223], v[160:163], 0
ds_read_b64_tr_b16 v[228:229], v240 offset:61440
s_add_u32 m0, s29, 110208
v_mfma_f32_16x16x32_bf16 a[36:39], v[220:223], v[164:167], 0
ds_read_b64_tr_b16 v[230:231], v240 offset:63488
v_add_f32 v248, v248, v193
v_mfma_f32_16x16x32_bf16 a[40:43], v[220:223], v[168:171], 0
buffer_load_dwordx4 v247, s[16:19], s30 offen offset:384 nt lds
v_mfma_f32_16x16x32_bf16 a[44:47], v[220:223], v[172:175], 0
s_waitcnt lgkmcnt(3)
ds_read_b64_tr_b16 v[220:221], v241 offset:49152
v_add_f32 v248, v248, v194
v_mfma_f32_16x16x32_bf16 a[96:99], v[232:235], v[160:163], 0
ds_read_b64_tr_b16 v[222:223], v241 offset:51200
s_add_u32 s30, s30, 16384
v_mfma_f32_16x16x32_bf16 a[100:103], v[232:235], v[164:167], 0
v_add_f32 v248, v248, v195
v_cvt_pk_bf16_f32 v178, v192, v193
v_mfma_f32_16x16x32_bf16 a[104:107], v[232:235], v[168:171], 0
v_cvt_pk_bf16_f32 v179, v194, v195
v_add_f32 v249, v249, v196
v_mfma_f32_16x16x32_bf16 a[108:111], v[232:235], v[172:175], 0
ds_read_b64_tr_b16 v[232:233], v241 offset:53248
v_add_f32 v249, v249, v197
v_mfma_f32_16x16x32_bf16 a[160:163], v[224:227], v[160:163], 0
ds_read_b64_tr_b16 v[234:235], v241 offset:55296
v_add_f32 v249, v249, v198
v_mfma_f32_16x16x32_bf16 a[164:167], v[224:227], v[164:167], 0
v_add_f32 v249, v249, v199
v_cvt_pk_bf16_f32 v182, v196, v197
v_mfma_f32_16x16x32_bf16 a[168:171], v[224:227], v[168:171], 0
v_cvt_pk_bf16_f32 v183, v198, v199
v_add_f32 v250, v250, v200
v_mfma_f32_16x16x32_bf16 a[172:175], v[224:227], v[172:175], 0
s_waitcnt lgkmcnt(4)
ds_read_b64_tr_b16 v[224:225], v241 offset:57344
v_add_f32 v250, v250, v201
v_mfma_f32_16x16x32_bf16 a[224:227], v[228:231], v[160:163], 0
ds_read_b64_tr_b16 v[226:227], v241 offset:59392
v_add_f32 v250, v250, v202
v_mfma_f32_16x16x32_bf16 a[228:231], v[228:231], v[164:167], 0
v_add_f32 v250, v250, v203
v_cvt_pk_bf16_f32 v186, v200, v201
v_mfma_f32_16x16x32_bf16 a[232:235], v[228:231], v[168:171], 0
v_cvt_pk_bf16_f32 v187, v202, v203
v_add_f32 v251, v251, v204
v_mfma_f32_16x16x32_bf16 a[236:239], v[228:231], v[172:175], 0
s_waitcnt lgkmcnt(4)
ds_read_b64_tr_b16 v[228:229], v241 offset:61440
v_add_f32 v251, v251, v205
v_mfma_f32_16x16x32_bf16 a[48:51], v[220:223], v[160:163], 0
ds_read_b64_tr_b16 v[230:231], v241 offset:63488
v_add_f32 v251, v251, v206
v_mfma_f32_16x16x32_bf16 a[52:55], v[220:223], v[164:167], 0
v_add_f32 v251, v251, v207
v_cvt_pk_bf16_f32 v190, v204, v205
v_mfma_f32_16x16x32_bf16 a[56:59], v[220:223], v[168:171], 0
s_add_u32 s42, s42, 1024
s_mov_b32 m0, 161792
v_mfma_f32_16x16x32_bf16 a[60:63], v[220:223], v[172:175], 0
s_waitcnt lgkmcnt(4)
buffer_load_dwordx4 v253, s[20:23], s42 offen lds
v_mfma_f32_16x16x32_bf16 a[112:115], v[232:235], v[160:163], 0
ds_read_b128 v[220:223], v236 offset:32768
v_cvt_pk_bf16_f32 v191, v206, v207
v_mfma_f32_16x16x32_bf16 a[116:119], v[232:235], v[164:167], 0
v_mfma_f32_16x16x32_bf16 a[120:123], v[232:235], v[168:171], 0
v_mfma_f32_16x16x32_bf16 a[124:127], v[232:235], v[172:175], 0
s_waitcnt lgkmcnt(3)
ds_read_b128 v[232:235], v242 offset:0
v_mfma_f32_16x16x32_bf16 a[176:179], v[224:227], v[160:163], 0
v_mfma_f32_16x16x32_bf16 a[180:183], v[224:227], v[164:167], 0
v_mfma_f32_16x16x32_bf16 a[184:187], v[224:227], v[168:171], 0
v_mfma_f32_16x16x32_bf16 a[188:191], v[224:227], v[172:175], 0
s_waitcnt lgkmcnt(2)
ds_read_b128 v[224:227], v237 offset:32768
v_mfma_f32_16x16x32_bf16 a[240:243], v[228:231], v[160:163], 0
v_mfma_f32_16x16x32_bf16 a[244:247], v[228:231], v[164:167], 0
v_mfma_f32_16x16x32_bf16 a[248:251], v[228:231], v[168:171], 0
v_mfma_f32_16x16x32_bf16 a[252:255], v[228:231], v[172:175], 0
ds_read_b128 v[228:231], v236 offset:36864
s_waitcnt vmcnt(15) lgkmcnt(4)
s_barrier
s_branch L_body1_0
.p2align 3
L_loop0:
s_cmp_eq_u32 s31, 4
s_cselect_b32 s42, s43, s42
s_cmp_lg_u32 s31, 2
s_cbranch_scc1 L_nopf0
s_getpc_b64 s[44:45]
L_pc2_0:
s_sub_u32 s44, s44, L_pc2_0-L_pc
s_subb_u32 s45, s45, 0
s_lshr_b32 s46, s2, 3
s_lshl_b32 s46, s46, 12
s_add_u32 s46, s46, s29
s_min_u32 s46, s46, R_end-L_pc-1024
v_add_u32 v254, s46, v253
v_mov_b32 v255, s45
v_add_co_u32 v254, vcc, s44, v254
s_nop 1
v_addc_co_u32 v255, vcc, 0, v255, vcc
s_mov_b32 m0, 161792
s_nop 0
global_load_lds_dwordx4 v[254:255], off
L_nopf0:
s_waitcnt lgkmcnt(3)
v_mfma_f32_16x16x32_bf16 v[176:179], v[220:223], v[0:3], 0
ds_read_b128 v[212:215], v243 offset:0
s_add_u32 m0, s29, 0
v_mfma_f32_16x16x32_bf16 v[180:183], v[220:223], v[32:35], 0
ds_read_b128 v[216:219], v242 offset:2048
v_mfma_f32_16x16x32_bf16 v[184:187], v[220:223], v[64:67], 0
buffer_load_dwordx4 v246, s[12:15], s30 offen offset:0 nt lds
v_mfma_f32_16x16x32_bf16 v[188:191], v[220:223], v[96:99], 0
s_waitcnt lgkmcnt(3)
v_mfma_f32_16x16x32_bf16 v[208:211], v[220:223], v[232:235], 0
ds_read_b128 v[220:223], v237 offset:20480
v_mfma_f32_16x16x32_bf16 v[176:179], v[224:227], v[4:7], v[176:179]
ds_read_b128 v[232:235], v243 offset:2048
v_mfma_f32_16x16x32_bf16 v[180:183], v[224:227], v[36:39], v[180:183]
v_mfma_f32_16x16x32_bf16 v[184:187], v[224:227], v[68:71], v[184:187]
v_mfma_f32_16x16x32_bf16 v[188:191], v[224:227], v[100:103], v[188:191]
s_waitcnt lgkmcnt(3)
v_mfma_f32_16x16x32_bf16 v[208:211], v[224:227], v[212:215], v[208:211]
ds_read_b128 v[224:227], v236 offset:24576
v_mfma_f32_16x16x32_bf16 v[176:179], v[228:231], v[8:11], v[176:179]
ds_read_b128 v[212:215], v242 offset:4096
v_mfma_f32_16x16x32_bf16 v[180:183], v[228:231], v[40:43], v[180:183]
v_mfma_f32_16x16x32_bf16 v[184:187], v[228:231], v[72:75], v[184:187]
v_mfma_f32_16x16x32_bf16 v[188:191], v[228:231], v[104:107], v[188:191]
s_waitcnt lgkmcnt(2)
v_mfma_f32_16x16x32_bf16 v[208:211], v[228:231], v[216:219], v[208:211]
ds_read_b128 v[228:231], v237 offset:24576
v_mfma_f32_16x16x32_bf16 v[176:179], v[220:223], v[12:15], v[176:179]
ds_read_b128 v[216:219], v243 offset:4096
v_mfma_f32_16x16x32_bf16 v[180:183], v[220:223], v[44:47], v[180:183]
s_add_u32 m0, s29, 3968
v_mfma_f32_16x16x32_bf16 v[184:187], v[220:223], v[76:79], v[184:187]
v_mfma_f32_16x16x32_bf16 v[188:191], v[220:223], v[108:111], v[188:191]
buffer_load_dwordx4 v246, s[12:15], s30 offen offset:128 nt lds
v_mfma_f32_16x16x32_bf16 v[208:211], v[220:223], v[232:235], v[208:211]
s_waitcnt lgkmcnt(2)
ds_read_b128 v[220:223], v236 offset:28672
v_mfma_f32_16x16x32_bf16 v[176:179], v[224:227], v[16:19], v[176:179]
ds_read_b128 v[232:235], v242 offset:6144
v_mfma_f32_16x16x32_bf16 v[180:183], v[224:227], v[48:51], v[180:183]
v_mfma_f32_16x16x32_bf16 v[184:187], v[224:227], v[80:83], v[184:187]
v_mfma_f32_16x16x32_bf16 v[188:191], v[224:227], v[112:115], v[188:191]
v_mfma_f32_16x16x32_bf16 v[208:211], v[224:227], v[212:215], v[208:211]
s_waitcnt lgkmcnt(2)
ds_read_b128 v[224:227], v237 offset:28672
v_mfma_f32_16x16x32_bf16 v[176:179], v[228:231], v[20:23], v[176:179]
ds_read_b128 v[212:215], v243 offset:6144
v_mfma_f32_16x16x32_bf16 v[180:183], v[228:231], v[52:55], v[180:183]
v_mfma_f32_16x16x32_bf16 v[184:187], v[228:231], v[84:87], v[184:187]
v_mfma_f32_16x16x32_bf16 v[188:191], v[228:231], v[116:119], v[188:191]
v_mfma_f32_16x16x32_bf16 v[208:211], v[228:231], v[216:219], v[208:211]
s_waitcnt lgkmcnt(2)
ds_read_b128 v[228:231], v236 offset:18432
v_mfma_f32_16x16x32_bf16 v[176:179], v[220:223], v[24:27], v[176:179]
ds_read_b128 v[216:219], v237 offset:18432
v_mfma_f32_16x16x32_bf16 v[180:183], v[220:223], v[56:59], v[180:183]
v_mfma_f32_16x16x32_bf16 v[184:187], v[220:223], v[88:91], v[184:187]
s_add_u32 m0, s29, 7936
v_mfma_f32_16x16x32_bf16 v[188:191], v[220:223], v[120:123], v[188:191]
v_mfma_f32_16x16x32_bf16 v[208:211], v[220:223], v[232:235], v[208:211]
s_waitcnt lgkmcnt(2)
buffer_load_dwordx4 v246, s[12:15], s30 offen offset:256 nt lds
v_mfma_f32_16x16x32_bf16 v[176:179], v[224:227], v[28:31], v[176:179]
ds_read_b128 v[220:223], v236 offset:22528
v_mfma_f32_16x16x32_bf16 v[180:183], v[224:227], v[60:63], v[180:183]
ds_read_b128 v[232:235], v237 offset:22528
v_mfma_f32_16x16x32_bf16 v[184:187], v[224:227], v[92:95], v[184:187]
v_mfma_f32_16x16x32_bf16 v[188:191], v[224:227], v[124:127], v[188:191]
v_mfma_f32_16x16x32_bf16 v[208:211], v[224:227], v[212:215], v[208:211]
s_waitcnt lgkmcnt(2)
v_mfma_f32_16x16x32_bf16 v[192:195], v[228:231], v[0:3], 0
ds_read_b128 v[224:227], v236 offset:26624
v_mfma_f32_16x16x32_bf16 v[196:199], v[228:231], v[32:35], 0
v_mfma_f32_16x16x32_bf16 v[200:203], v[228:231], v[64:67], 0
v_exp_f32 v176, v176
v_mfma_f32_16x16x32_bf16 v[204:207], v[228:231], v[96:99], 0
v_exp_f32 v177, v177
v_mfma_f32_16x16x32_bf16 v[192:195], v[216:219], v[4:7], v[192:195]
v_exp_f32 v178, v178
v_mfma_f32_16x16x32_bf16 v[196:199], v[216:219], v[36:39], v[196:199]
v_exp_f32 v179, v179
v_mfma_f32_16x16x32_bf16 v[200:203], v[216:219], v[68:71], v[200:203]
v_exp_f32 v180, v180
v_mfma_f32_16x16x32_bf16 v[204:207], v[216:219], v[100:103], v[204:207]
s_waitcnt lgkmcnt(1)
v_exp_f32 v181, v181
v_mfma_f32_16x16x32_bf16 v[192:195], v[220:223], v[8:11], v[192:195]
ds_read_b128 v[212:215], v237 offset:26624
s_add_u32 m0, s29, 11904
v_mfma_f32_16x16x32_bf16 v[196:199], v[220:223], v[40:43], v[196:199]
v_exp_f32 v182, v182
v_mfma_f32_16x16x32_bf16 v[200:203], v[220:223], v[72:75], v[200:203]
buffer_load_dwordx4 v246, s[12:15], s30 offen offset:384 nt lds
v_mfma_f32_16x16x32_bf16 v[204:207], v[220:223], v[104:107], v[204:207]
v_exp_f32 v183, v183
v_mfma_f32_16x16x32_bf16 v[192:195], v[232:235], v[12:15], v[192:195]
v_exp_f32 v184, v184
v_mfma_f32_16x16x32_bf16 v[196:199], v[232:235], v[44:47], v[196:199]
v_exp_f32 v185, v185
v_mfma_f32_16x16x32_bf16 v[200:203], v[232:235], v[76:79], v[200:203]
ds_read_b128 v[228:231], v236 offset:30720
v_add_f32 v248, v248, v176
v_mfma_f32_16x16x32_bf16 v[204:207], v[232:235], v[108:111], v[204:207]
s_waitcnt lgkmcnt(2)
v_exp_f32 v186, v186
v_mfma_f32_16x16x32_bf16 v[192:195], v[224:227], v[16:19], v[192:195]
v_exp_f32 v187, v187
v_mfma_f32_16x16x32_bf16 v[196:199], v[224:227], v[48:51], v[196:199]
v_exp_f32 v188, v188
v_mfma_f32_16x16x32_bf16 v[200:203], v[224:227], v[80:83], v[200:203]
ds_read_b128 v[216:219], v237 offset:30720
v_add_f32 v248, v248, v177
v_mfma_f32_16x16x32_bf16 v[204:207], v[224:227], v[112:115], v[204:207]
s_waitcnt lgkmcnt(2)
v_exp_f32 v189, v189
v_mfma_f32_16x16x32_bf16 v[192:195], v[212:215], v[20:23], v[192:195]
v_exp_f32 v190, v190
v_mfma_f32_16x16x32_bf16 v[196:199], v[212:215], v[52:55], v[196:199]
v_exp_f32 v191, v191
v_mfma_f32_16x16x32_bf16 v[200:203], v[212:215], v[84:87], v[200:203]
ds_read_b64_tr_b16 v[220:221], v239 offset:49152
v_add_f32 v248, v248, v178
v_mfma_f32_16x16x32_bf16 v[204:207], v[212:215], v[116:119], v[204:207]
s_waitcnt lgkmcnt(2)
ds_read_b64_tr_b16 v[222:223], v239 offset:51200
v_add_f32 v248, v248, v179
v_mfma_f32_16x16x32_bf16 v[192:195], v[228:231], v[24:27], v[192:195]
ds_read_b64_tr_b16 v[232:233], v239 offset:53248
s_add_u32 m0, s29, 98304
v_mfma_f32_16x16x32_bf16 v[196:199], v[228:231], v[56:59], v[196:199]
ds_read_b64_tr_b16 v[234:235], v239 offset:55296
v_cvt_pk_bf16_f32 v176, v176, v177
v_mfma_f32_16x16x32_bf16 v[200:203], v[228:231], v[88:91], v[200:203]
buffer_load_dwordx4 v247, s[16:19], s30 offen offset:0 nt lds
v_mfma_f32_16x16x32_bf16 v[204:207], v[228:231], v[120:123], v[204:207]
s_waitcnt lgkmcnt(4)
ds_read_b64_tr_b16 v[224:225], v239 offset:57344
v_cvt_pk_bf16_f32 v177, v178, v179
v_mfma_f32_16x16x32_bf16 v[192:195], v[216:219], v[28:31], v[192:195]
ds_read_b64_tr_b16 v[226:227], v239 offset:59392
v_add_f32 v249, v249, v180
v_mfma_f32_16x16x32_bf16 v[196:199], v[216:219], v[60:63], v[196:199]
ds_read_b64_tr_b16 v[228:229], v239 offset:61440
v_add_f32 v249, v249, v181
v_mfma_f32_16x16x32_bf16 v[200:203], v[216:219], v[92:95], v[200:203]
ds_read_b64_tr_b16 v[230:231], v239 offset:63488
v_add_f32 v249, v249, v182
v_mfma_f32_16x16x32_bf16 v[204:207], v[216:219], v[124:127], v[204:207]
s_waitcnt lgkmcnt(6)
v_exp_f32 v208, v208
v_mfma_f32_16x16x32_bf16 a[16:19], v[220:223], v[160:163], a[16:19]
ds_read_b128 v[212:215], v244 offset:0
v_add_f32 v249, v249, v183
v_mfma_f32_16x16x32_bf16 a[20:23], v[220:223], v[164:167], a[20:23]
ds_read_b128 v[216:219], v244 offset:1024
v_cvt_pk_bf16_f32 v180, v180, v181
v_mfma_f32_16x16x32_bf16 a[24:27], v[220:223], v[168:171], a[24:27]
v_exp_f32 v209, v209
v_mfma_f32_16x16x32_bf16 a[28:31], v[220:223], v[172:175], a[28:31]
s_waitcnt lgkmcnt(6)
ds_read_b64_tr_b16 v[220:221], v238 offset:49152
v_cvt_pk_bf16_f32 v181, v182, v183
v_mfma_f32_16x16x32_bf16 a[80:83], v[232:235], v[160:163], a[80:83]
ds_read_b64_tr_b16 v[222:223], v238 offset:51200
v_add_f32 v250, v250, v184
v_mfma_f32_16x16x32_bf16 a[84:87], v[232:235], v[164:167], a[84:87]
v_exp_f32 v210, v210
v_mfma_f32_16x16x32_bf16 a[88:91], v[232:235], v[168:171], a[88:91]
v_exp_f32 v211, v211
v_mfma_f32_16x16x32_bf16 a[92:95], v[232:235], v[172:175], a[92:95]
s_waitcnt lgkmcnt(4)
ds_read_b64_tr_b16 v[232:233], v238 offset:53248
v_add_f32 v250, v250, v185
v_mfma_f32_16x16x32_bf16 a[144:147], v[224:227], v[160:163], a[144:147]
ds_read_b64_tr_b16 v[234:235], v238 offset:55296
s_add_u32 m0, s29, 102272
v_mfma_f32_16x16x32_bf16 a[148:151], v[224:227], v[164:167], a[148:151]
v_exp_f32 v192, v192
v_mfma_f32_16x16x32_bf16 a[152:155], v[224:227], v[168:171], a[152:155]
buffer_load_dwordx4 v247, s[16:19], s30 offen offset:128 nt lds
v_mfma_f32_16x16x32_bf16 a[156:159], v[224:227], v[172:175], a[156:159]
v_exp_f32 v193, v193
v_mfma_f32_16x16x32_bf16 a[208:211], v[228:231], v[160:163], a[208:211]
ds_read_b64_tr_b16 v[224:225], v238 offset:57344
v_add_f32 v250, v250, v186
v_mfma_f32_16x16x32_bf16 a[212:215], v[228:231], v[164:167], a[212:215]
ds_read_b64_tr_b16 v[226:227], v238 offset:59392
v_add_f32 v250, v250, v187
v_mfma_f32_16x16x32_bf16 a[216:219], v[228:231], v[168:171], a[216:219]
v_exp_f32 v194, v194
v_mfma_f32_16x16x32_bf16 a[220:223], v[228:231], v[172:175], a[220:223]
s_waitcnt lgkmcnt(4)
v_exp_f32 v195, v195
v_mfma_f32_16x16x32_bf16 a[0:3], v[220:223], v[160:163], a[0:3]
v_exp_f32 v196, v196
v_mfma_f32_16x16x32_bf16 a[4:7], v[220:223], v[164:167], a[4:7]
v_exp_f32 v197, v197
v_mfma_f32_16x16x32_bf16 v[128:131], v[220:223], v[212:215], v[128:131]
ds_read_b64_tr_b16 v[228:229], v238 offset:61440
v_cvt_pk_bf16_f32 v184, v184, v185
v_mfma_f32_16x16x32_bf16 a[8:11], v[220:223], v[168:171], a[8:11]
ds_read_b64_tr_b16 v[230:231], v238 offset:63488
v_cvt_pk_bf16_f32 v185, v186, v187
v_mfma_f32_16x16x32_bf16 v[132:135], v[220:223], v[216:219], v[132:135]
v_exp_f32 v198, v198
v_mfma_f32_16x16x32_bf16 a[12:15], v[220:223], v[172:175], a[12:15]
s_waitcnt lgkmcnt(2)
v_exp_f32 v199, v199
v_mfma_f32_16x16x32_bf16 a[64:67], v[232:235], v[160:163], a[64:67]
v_exp_f32 v200, v200
v_mfma_f32_16x16x32_bf16 a[68:71], v[232:235], v[164:167], a[68:71]
v_exp_f32 v201, v201
v_mfma_f32_16x16x32_bf16 v[136:139], v[232:235], v[212:215], v[136:139]
ds_read_b64_tr_b16 v[220:221], v240 offset:49152
v_add_f32 v251, v251, v188
v_mfma_f32_16x16x32_bf16 a[72:75], v[232:235], v[168:171], a[72:75]
ds_read_b64_tr_b16 v[222:223], v240 offset:51200
v_add_f32 v251, v251, v189
v_mfma_f32_16x16x32_bf16 v[140:143], v[232:235], v[216:219], v[140:143]
v_exp_f32 v202, v202
v_mfma_f32_16x16x32_bf16 a[76:79], v[232:235], v[172:175], a[76:79]
v_exp_f32 v203, v203
v_mfma_f32_16x16x32_bf16 a[128:131], v[224:227], v[160:163], a[128:131]
ds_read_b64_tr_b16 v[232:233], v240 offset:53248
v_add_f32 v251, v251, v190
v_mfma_f32_16x16x32_bf16 a[132:135], v[224:227], v[164:167], a[132:135]
ds_read_b64_tr_b16 v[234:235], v240 offset:55296
v_add_f32 v251, v251, v191
v_mfma_f32_16x16x32_bf16 v[144:147], v[224:227], v[212:215], v[144:147]
v_exp_f32 v204, v204
v_cvt_pk_bf16_f32 v188, v188, v189
v_cvt_pk_bf16_f32 v189, v190, v191
v_mfma_f32_16x16x32_bf16 a[136:139], v[224:227], v[168:171], a[136:139]
v_exp_f32 v205, v205
v_mfma_f32_16x16x32_bf16 v[148:151], v[224:227], v[216:219], v[148:151]
v_exp_f32 v206, v206
v_mfma_f32_16x16x32_bf16 a[140:143], v[224:227], v[172:175], a[140:143]
s_waitcnt lgkmcnt(2)
ds_read_b64_tr_b16 v[224:225], v240 offset:57344
s_add_u32 m0, s29, 106240
s_nop 0
buffer_load_dwordx4 v247, s[16:19], s30 offen offset:256 nt lds
v_mfma_f32_16x16x32_bf16 a[192:195], v[228:231], v[160:163], a[192:195]
ds_read_b64_tr_b16 v[226:227], v240 offset:59392
v_add_f32 v252, v252, v208
v_mfma_f32_16x16x32_bf16 a[196:199], v[228:231], v[164:167], a[196:199]
v_exp_f32 v207, v207
v_mfma_f32_16x16x32_bf16 v[152:155], v[228:231], v[212:215], v[152:155]
v_add_f32 v252, v252, v209
v_add_f32 v252, v252, v210
v_mfma_f32_16x16x32_bf16 a[200:203], v[228:231], v[168:171], a[200:203]
v_add_f32 v252, v252, v211
v_cvt_pk_bf16_f32 v208, v208, v209
v_mfma_f32_16x16x32_bf16 v[156:159], v[228:231], v[216:219], v[156:159]
v_cvt_pk_bf16_f32 v209, v210, v211
v_add_f32 v248, v248, v192
v_mfma_f32_16x16x32_bf16 a[204:207], v[228:231], v[172:175], a[204:207]
ds_write_b64 v245, v[208:209] offset:2048
v_mfma_f32_16x16x32_bf16 a[32:35], v[220:223], v[160:163], a[32:35]
ds_read_b64_tr_b16 v[228:229], v240 offset:61440
s_add_u32 m0, s29, 110208
v_mfma_f32_16x16x32_bf16 a[36:39], v[220:223], v[164:167], a[36:39]
ds_read_b64_tr_b16 v[230:231], v240 offset:63488
v_add_f32 v248, v248, v193
v_mfma_f32_16x16x32_bf16 a[40:43], v[220:223], v[168:171], a[40:43]
buffer_load_dwordx4 v247, s[16:19], s30 offen offset:384 nt lds
v_mfma_f32_16x16x32_bf16 a[44:47], v[220:223], v[172:175], a[44:47]
s_waitcnt lgkmcnt(3)
ds_read_b64_tr_b16 v[220:221], v241 offset:49152
v_add_f32 v248, v248, v194
v_mfma_f32_16x16x32_bf16 a[96:99], v[232:235], v[160:163], a[96:99]
ds_read_b64_tr_b16 v[222:223], v241 offset:51200
s_add_u32 s30, s30, 16384
v_mfma_f32_16x16x32_bf16 a[100:103], v[232:235], v[164:167], a[100:103]
v_add_f32 v248, v248, v195
v_cvt_pk_bf16_f32 v178, v192, v193
v_mfma_f32_16x16x32_bf16 a[104:107], v[232:235], v[168:171], a[104:107]
v_cvt_pk_bf16_f32 v179, v194, v195
v_add_f32 v249, v249, v196
v_mfma_f32_16x16x32_bf16 a[108:111], v[232:235], v[172:175], a[108:111]
ds_read_b64_tr_b16 v[232:233], v241 offset:53248
v_add_f32 v249, v249, v197
v_mfma_f32_16x16x32_bf16 a[160:163], v[224:227], v[160:163], a[160:163]
ds_read_b64_tr_b16 v[234:235], v241 offset:55296
v_add_f32 v249, v249, v198
v_mfma_f32_16x16x32_bf16 a[164:167], v[224:227], v[164:167], a[164:167]
v_add_f32 v249, v249, v199
v_cvt_pk_bf16_f32 v182, v196, v197
v_mfma_f32_16x16x32_bf16 a[168:171], v[224:227], v[168:171], a[168:171]
v_cvt_pk_bf16_f32 v183, v198, v199
v_add_f32 v250, v250, v200
v_mfma_f32_16x16x32_bf16 a[172:175], v[224:227], v[172:175], a[172:175]
s_waitcnt lgkmcnt(4)
ds_read_b64_tr_b16 v[224:225], v241 offset:57344
v_add_f32 v250, v250, v201
v_mfma_f32_16x16x32_bf16 a[224:227], v[228:231], v[160:163], a[224:227]
ds_read_b64_tr_b16 v[226:227], v241 offset:59392
v_add_f32 v250, v250, v202
v_mfma_f32_16x16x32_bf16 a[228:231], v[228:231], v[164:167], a[228:231]
v_add_f32 v250, v250, v203
v_cvt_pk_bf16_f32 v186, v200, v201
v_mfma_f32_16x16x32_bf16 a[232:235], v[228:231], v[168:171], a[232:235]
v_cvt_pk_bf16_f32 v187, v202, v203
v_add_f32 v251, v251, v204
v_mfma_f32_16x16x32_bf16 a[236:239], v[228:231], v[172:175], a[236:239]
s_waitcnt lgkmcnt(4)
ds_read_b64_tr_b16 v[228:229], v241 offset:61440
v_add_f32 v251, v251, v205
v_mfma_f32_16x16x32_bf16 a[48:51], v[220:223], v[160:163], a[48:51]
ds_read_b64_tr_b16 v[230:231], v241 offset:63488
v_add_f32 v251, v251, v206
v_mfma_f32_16x16x32_bf16 a[52:55], v[220:223], v[164:167], a[52:55]
v_add_f32 v251, v251, v207
v_cvt_pk_bf16_f32 v190, v204, v205
v_mfma_f32_16x16x32_bf16 a[56:59], v[220:223], v[168:171], a[56:59]
s_add_u32 s42, s42, 1024
s_mov_b32 m0, 161792
v_mfma_f32_16x16x32_bf16 a[60:63], v[220:223], v[172:175], a[60:63]
s_waitcnt lgkmcnt(4)
buffer_load_dwordx4 v253, s[20:23], s42 offen lds
v_mfma_f32_16x16x32_bf16 a[112:115], v[232:235], v[160:163], a[112:115]
ds_read_b128 v[220:223], v236 offset:32768
v_cvt_pk_bf16_f32 v191, v206, v207
v_mfma_f32_16x16x32_bf16 a[116:119], v[232:235], v[164:167], a[116:119]
v_mfma_f32_16x16x32_bf16 a[120:123], v[232:235], v[168:171], a[120:123]
v_mfma_f32_16x16x32_bf16 a[124:127], v[232:235], v[172:175], a[124:127]
s_waitcnt lgkmcnt(3)
ds_read_b128 v[232:235], v242 offset:0
v_mfma_f32_16x16x32_bf16 a[176:179], v[224:227], v[160:163], a[176:179]
v_mfma_f32_16x16x32_bf16 a[180:183], v[224:227], v[164:167], a[180:183]
v_mfma_f32_16x16x32_bf16 a[184:187], v[224:227], v[168:171], a[184:187]
v_mfma_f32_16x16x32_bf16 a[188:191], v[224:227], v[172:175], a[188:191]
s_waitcnt lgkmcnt(2)
ds_read_b128 v[224:227], v237 offset:32768
v_mfma_f32_16x16x32_bf16 a[240:243], v[228:231], v[160:163], a[240:243]
v_mfma_f32_16x16x32_bf16 a[244:247], v[228:231], v[164:167], a[244:247]
v_mfma_f32_16x16x32_bf16 a[248:251], v[228:231], v[168:171], a[248:251]
v_mfma_f32_16x16x32_bf16 a[252:255], v[228:231], v[172:175], a[252:255]
ds_read_b128 v[228:231], v236 offset:36864
s_waitcnt vmcnt(16) lgkmcnt(4)
s_barrier
L_body1_0:
s_waitcnt lgkmcnt(3)
v_mfma_f32_16x16x32_bf16 v[160:163], v[220:223], v[0:3], 0
ds_read_b128 v[212:215], v243 offset:0
s_add_u32 m0, s29, 16384
v_mfma_f32_16x16x32_bf16 v[164:167], v[220:223], v[32:35], 0
ds_read_b128 v[216:219], v242 offset:2048
v_mfma_f32_16x16x32_bf16 v[168:171], v[220:223], v[64:67], 0
buffer_load_dwordx4 v246, s[12:15], s30 offen offset:0 nt lds
v_mfma_f32_16x16x32_bf16 v[172:175], v[220:223], v[96:99], 0
s_waitcnt lgkmcnt(3)
v_mfma_f32_16x16x32_bf16 v[208:211], v[220:223], v[232:235], 0
ds_read_b128 v[220:223], v237 offset:36864
v_mfma_f32_16x16x32_bf16 v[160:163], v[224:227], v[4:7], v[160:163]
ds_read_b128 v[232:235], v243 offset:2048
v_mfma_f32_16x16x32_bf16 v[164:167], v[224:227], v[36:39], v[164:167]
v_mfma_f32_16x16x32_bf16 v[168:171], v[224:227], v[68:71], v[168:171]
v_mfma_f32_16x16x32_bf16 v[172:175], v[224:227], v[100:103], v[172:175]
s_waitcnt lgkmcnt(3)
v_mfma_f32_16x16x32_bf16 v[208:211], v[224:227], v[212:215], v[208:211]
ds_read_b128 v[224:227], v236 offset:40960
v_mfma_f32_16x16x32_bf16 v[160:163], v[228:231], v[8:11], v[160:163]
ds_read_b128 v[212:215], v242 offset:4096
v_mfma_f32_16x16x32_bf16 v[164:167], v[228:231], v[40:43], v[164:167]
v_mfma_f32_16x16x32_bf16 v[168:171], v[228:231], v[72:75], v[168:171]
v_mfma_f32_16x16x32_bf16 v[172:175], v[228:231], v[104:107], v[172:175]
s_waitcnt lgkmcnt(2)
v_mfma_f32_16x16x32_bf16 v[208:211], v[228:231], v[216:219], v[208:211]
ds_read_b128 v[228:231], v237 offset:40960
v_mfma_f32_16x16x32_bf16 v[160:163], v[220:223], v[12:15], v[160:163]
ds_read_b128 v[216:219], v243 offset:4096
v_mfma_f32_16x16x32_bf16 v[164:167], v[220:223], v[44:47], v[164:167]
s_add_u32 m0, s29, 20352
v_mfma_f32_16x16x32_bf16 v[168:171], v[220:223], v[76:79], v[168:171]
v_mfma_f32_16x16x32_bf16 v[172:175], v[220:223], v[108:111], v[172:175]
buffer_load_dwordx4 v246, s[12:15], s30 offen offset:128 nt lds
v_mfma_f32_16x16x32_bf16 v[208:211], v[220:223], v[232:235], v[208:211]
s_waitcnt lgkmcnt(2)
ds_read_b128 v[220:223], v236 offset:45056
v_mfma_f32_16x16x32_bf16 v[160:163], v[224:227], v[16:19], v[160:163]
ds_read_b128 v[232:235], v242 offset:6144
v_mfma_f32_16x16x32_bf16 v[164:167], v[224:227], v[48:51], v[164:167]
v_mfma_f32_16x16x32_bf16 v[168:171], v[224:227], v[80:83], v[168:171]
v_mfma_f32_16x16x32_bf16 v[172:175], v[224:227], v[112:115], v[172:175]
v_mfma_f32_16x16x32_bf16 v[208:211], v[224:227], v[212:215], v[208:211]
s_waitcnt lgkmcnt(2)
ds_read_b128 v[224:227], v237 offset:45056
v_mfma_f32_16x16x32_bf16 v[160:163], v[228:231], v[20:23], v[160:163]
ds_read_b128 v[212:215], v243 offset:6144
v_mfma_f32_16x16x32_bf16 v[164:167], v[228:231], v[52:55], v[164:167]
v_mfma_f32_16x16x32_bf16 v[168:171], v[228:231], v[84:87], v[168:171]
v_mfma_f32_16x16x32_bf16 v[172:175], v[228:231], v[116:119], v[172:175]
v_mfma_f32_16x16x32_bf16 v[208:211], v[228:231], v[216:219], v[208:211]
s_waitcnt lgkmcnt(2)
ds_read_b128 v[228:231], v236 offset:34816
v_mfma_f32_16x16x32_bf16 v[160:163], v[220:223], v[24:27], v[160:163]
ds_read_b128 v[216:219], v237 offset:34816
v_mfma_f32_16x16x32_bf16 v[164:167], v[220:223], v[56:59], v[164:167]
v_mfma_f32_16x16x32_bf16 v[168:171], v[220:223], v[88:91], v[168:171]
s_add_u32 m0, s29, 24320
v_mfma_f32_16x16x32_bf16 v[172:175], v[220:223], v[120:123], v[172:175]
v_mfma_f32_16x16x32_bf16 v[208:211], v[220:223], v[232:235], v[208:211]
s_waitcnt lgkmcnt(2)
buffer_load_dwordx4 v246, s[12:15], s30 offen offset:256 nt lds
v_mfma_f32_16x16x32_bf16 v[160:163], v[224:227], v[28:31], v[160:163]
ds_read_b128 v[220:223], v236 offset:38912
v_mfma_f32_16x16x32_bf16 v[164:167], v[224:227], v[60:63], v[164:167]
ds_read_b128 v[232:235], v237 offset:38912
v_mfma_f32_16x16x32_bf16 v[168:171], v[224:227], v[92:95], v[168:171]
v_mfma_f32_16x16x32_bf16 v[172:175], v[224:227], v[124:127], v[172:175]
v_mfma_f32_16x16x32_bf16 v[208:211], v[224:227], v[212:215], v[208:211]
s_waitcnt lgkmcnt(2)
v_mfma_f32_16x16x32_bf16 v[192:195], v[228:231], v[0:3], 0
ds_read_b128 v[224:227], v236 offset:43008
v_mfma_f32_16x16x32_bf16 v[196:199], v[228:231], v[32:35], 0
v_mfma_f32_16x16x32_bf16 v[200:203], v[228:231], v[64:67], 0
v_exp_f32 v160, v160
v_mfma_f32_16x16x32_bf16 v[204:207], v[228:231], v[96:99], 0
v_exp_f32 v161, v161
v_mfma_f32_16x16x32_bf16 v[192:195], v[216:219], v[4:7], v[192:195]
v_exp_f32 v162, v162
v_mfma_f32_16x16x32_bf16 v[196:199], v[216:219], v[36:39], v[196:199]
v_exp_f32 v163, v163
v_mfma_f32_16x16x32_bf16 v[200:203], v[216:219], v[68:71], v[200:203]
v_exp_f32 v164, v164
v_mfma_f32_16x16x32_bf16 v[204:207], v[216:219], v[100:103], v[204:207]
s_waitcnt lgkmcnt(1)
v_exp_f32 v165, v165
v_mfma_f32_16x16x32_bf16 v[192:195], v[220:223], v[8:11], v[192:195]
ds_read_b128 v[212:215], v237 offset:43008
s_add_u32 m0, s29, 28288
v_mfma_f32_16x16x32_bf16 v[196:199], v[220:223], v[40:43], v[196:199]
v_exp_f32 v166, v166
v_mfma_f32_16x16x32_bf16 v[200:203], v[220:223], v[72:75], v[200:203]
buffer_load_dwordx4 v246, s[12:15], s30 offen offset:384 nt lds
v_mfma_f32_16x16x32_bf16 v[204:207], v[220:223], v[104:107], v[204:207]
v_exp_f32 v167, v167
v_mfma_f32_16x16x32_bf16 v[192:195], v[232:235], v[12:15], v[192:195]
v_exp_f32 v168, v168
v_mfma_f32_16x16x32_bf16 v[196:199], v[232:235], v[44:47], v[196:199]
v_exp_f32 v169, v169
v_mfma_f32_16x16x32_bf16 v[200:203], v[232:235], v[76:79], v[200:203]
ds_read_b128 v[228:231], v236 offset:47104
v_add_f32 v248, v248, v160
v_mfma_f32_16x16x32_bf16 v[204:207], v[232:235], v[108:111], v[204:207]
s_waitcnt lgkmcnt(2)
v_exp_f32 v170, v170
v_mfma_f32_16x16x32_bf16 v[192:195], v[224:227], v[16:19], v[192:195]
v_exp_f32 v171, v171
v_mfma_f32_16x16x32_bf16 v[196:199], v[224:227], v[48:51], v[196:199]
v_exp_f32 v172, v172
v_mfma_f32_16x16x32_bf16 v[200:203], v[224:227], v[80:83], v[200:203]
ds_read_b128 v[216:219], v237 offset:47104
v_add_f32 v248, v248, v161
v_mfma_f32_16x16x32_bf16 v[204:207], v[224:227], v[112:115], v[204:207]
s_waitcnt lgkmcnt(2)
v_exp_f32 v173, v173
v_mfma_f32_16x16x32_bf16 v[192:195], v[212:215], v[20:23], v[192:195]
v_exp_f32 v174, v174
v_mfma_f32_16x16x32_bf16 v[196:199], v[212:215], v[52:55], v[196:199]
v_exp_f32 v175, v175
v_mfma_f32_16x16x32_bf16 v[200:203], v[212:215], v[84:87], v[200:203]
ds_read_b64_tr_b16 v[220:221], v239 offset:0
v_add_f32 v248, v248, v162
v_mfma_f32_16x16x32_bf16 v[204:207], v[212:215], v[116:119], v[204:207]
s_waitcnt lgkmcnt(2)
ds_read_b64_tr_b16 v[222:223], v239 offset:2048
v_add_f32 v248, v248, v163
v_mfma_f32_16x16x32_bf16 v[192:195], v[228:231], v[24:27], v[192:195]
ds_read_b64_tr_b16 v[232:233], v239 offset:4096
s_add_u32 m0, s29, 114688
v_mfma_f32_16x16x32_bf16 v[196:199], v[228:231], v[56:59], v[196:199]
ds_read_b64_tr_b16 v[234:235], v239 offset:6144
v_cvt_pk_bf16_f32 v160, v160, v161
v_mfma_f32_16x16x32_bf16 v[200:203], v[228:231], v[88:91], v[200:203]
buffer_load_dwordx4 v247, s[16:19], s30 offen offset:0 nt lds
v_mfma_f32_16x16x32_bf16 v[204:207], v[228:231], v[120:123], v[204:207]
s_waitcnt lgkmcnt(4)
ds_read_b64_tr_b16 v[224:225], v239 offset:8192
v_cvt_pk_bf16_f32 v161, v162, v163
v_mfma_f32_16x16x32_bf16 v[192:195], v[216:219], v[28:31], v[192:195]
ds_read_b64_tr_b16 v[226:227], v239 offset:10240
v_add_f32 v249, v249, v164
v_mfma_f32_16x16x32_bf16 v[196:199], v[216:219], v[60:63], v[196:199]
ds_read_b64_tr_b16 v[228:229], v239 offset:12288
v_add_f32 v249, v249, v165
v_mfma_f32_16x16x32_bf16 v[200:203], v[216:219], v[92:95], v[200:203]
ds_read_b64_tr_b16 v[230:231], v239 offset:14336
v_add_f32 v249, v249, v166
v_mfma_f32_16x16x32_bf16 v[204:207], v[216:219], v[124:127], v[204:207]
s_waitcnt lgkmcnt(6)
v_exp_f32 v208, v208
v_mfma_f32_16x16x32_bf16 a[16:19], v[220:223], v[176:179], a[16:19]
ds_read_b128 v[212:215], v244 offset:2048
v_add_f32 v249, v249, v167
v_mfma_f32_16x16x32_bf16 a[20:23], v[220:223], v[180:183], a[20:23]
ds_read_b128 v[216:219], v244 offset:3072
v_cvt_pk_bf16_f32 v164, v164, v165
v_mfma_f32_16x16x32_bf16 a[24:27], v[220:223], v[184:187], a[24:27]
v_exp_f32 v209, v209
v_mfma_f32_16x16x32_bf16 a[28:31], v[220:223], v[188:191], a[28:31]
s_waitcnt lgkmcnt(6)
ds_read_b64_tr_b16 v[220:221], v238 offset:0
v_cvt_pk_bf16_f32 v165, v166, v167
v_mfma_f32_16x16x32_bf16 a[80:83], v[232:235], v[176:179], a[80:83]
ds_read_b64_tr_b16 v[222:223], v238 offset:2048
v_add_f32 v250, v250, v168
v_mfma_f32_16x16x32_bf16 a[84:87], v[232:235], v[180:183], a[84:87]
v_exp_f32 v210, v210
v_mfma_f32_16x16x32_bf16 a[88:91], v[232:235], v[184:187], a[88:91]
v_exp_f32 v211, v211
v_mfma_f32_16x16x32_bf16 a[92:95], v[232:235], v[188:191], a[92:95]
s_waitcnt lgkmcnt(4)
ds_read_b64_tr_b16 v[232:233], v238 offset:4096
v_add_f32 v250, v250, v169
v_mfma_f32_16x16x32_bf16 a[144:147], v[224:227], v[176:179], a[144:147]
ds_read_b64_tr_b16 v[234:235], v238 offset:6144
s_add_u32 m0, s29, 118656
v_mfma_f32_16x16x32_bf16 a[148:151], v[224:227], v[180:183], a[148:151]
v_exp_f32 v192, v192
v_mfma_f32_16x16x32_bf16 a[152:155], v[224:227], v[184:187], a[152:155]
buffer_load_dwordx4 v247, s[16:19], s30 offen offset:128 nt lds
v_mfma_f32_16x16x32_bf16 a[156:159], v[224:227], v[188:191], a[156:159]
v_exp_f32 v193, v193
v_mfma_f32_16x16x32_bf16 a[208:211], v[228:231], v[176:179], a[208:211]
ds_read_b64_tr_b16 v[224:225], v238 offset:8192
v_add_f32 v250, v250, v170
v_mfma_f32_16x16x32_bf16 a[212:215], v[228:231], v[180:183], a[212:215]
ds_read_b64_tr_b16 v[226:227], v238 offset:10240
v_add_f32 v250, v250, v171
v_mfma_f32_16x16x32_bf16 a[216:219], v[228:231], v[184:187], a[216:219]
v_exp_f32 v194, v194
v_mfma_f32_16x16x32_bf16 a[220:223], v[228:231], v[188:191], a[220:223]
s_waitcnt lgkmcnt(4)
v_exp_f32 v195, v195
v_mfma_f32_16x16x32_bf16 a[0:3], v[220:223], v[176:179], a[0:3]
v_exp_f32 v196, v196
v_mfma_f32_16x16x32_bf16 a[4:7], v[220:223], v[180:183], a[4:7]
v_exp_f32 v197, v197
v_mfma_f32_16x16x32_bf16 v[128:131], v[220:223], v[212:215], v[128:131]
ds_read_b64_tr_b16 v[228:229], v238 offset:12288
v_cvt_pk_bf16_f32 v168, v168, v169
v_mfma_f32_16x16x32_bf16 a[8:11], v[220:223], v[184:187], a[8:11]
ds_read_b64_tr_b16 v[230:231], v238 offset:14336
v_cvt_pk_bf16_f32 v169, v170, v171
v_mfma_f32_16x16x32_bf16 v[132:135], v[220:223], v[216:219], v[132:135]
v_exp_f32 v198, v198
v_mfma_f32_16x16x32_bf16 a[12:15], v[220:223], v[188:191], a[12:15]
s_waitcnt lgkmcnt(2)
v_exp_f32 v199, v199
v_mfma_f32_16x16x32_bf16 a[64:67], v[232:235], v[176:179], a[64:67]
v_exp_f32 v200, v200
v_mfma_f32_16x16x32_bf16 a[68:71], v[232:235], v[180:183], a[68:71]
v_exp_f32 v201, v201
v_mfma_f32_16x16x32_bf16 v[136:139], v[232:235], v[212:215], v[136:139]
ds_read_b64_tr_b16 v[220:221], v240 offset:0
v_add_f32 v251, v251, v172
v_mfma_f32_16x16x32_bf16 a[72:75], v[232:235], v[184:187], a[72:75]
ds_read_b64_tr_b16 v[222:223], v240 offset:2048
v_add_f32 v251, v251, v173
v_mfma_f32_16x16x32_bf16 v[140:143], v[232:235], v[216:219], v[140:143]
v_exp_f32 v202, v202
v_mfma_f32_16x16x32_bf16 a[76:79], v[232:235], v[188:191], a[76:79]
v_exp_f32 v203, v203
v_mfma_f32_16x16x32_bf16 a[128:131], v[224:227], v[176:179], a[128:131]
ds_read_b64_tr_b16 v[232:233], v240 offset:4096
v_add_f32 v251, v251, v174
v_mfma_f32_16x16x32_bf16 a[132:135], v[224:227], v[180:183], a[132:135]
ds_read_b64_tr_b16 v[234:235], v240 offset:6144
v_add_f32 v251, v251, v175
v_mfma_f32_16x16x32_bf16 v[144:147], v[224:227], v[212:215], v[144:147]
v_exp_f32 v204, v204
v_cvt_pk_bf16_f32 v172, v172, v173
v_cvt_pk_bf16_f32 v173, v174, v175
v_mfma_f32_16x16x32_bf16 a[136:139], v[224:227], v[184:187], a[136:139]
v_exp_f32 v205, v205
v_mfma_f32_16x16x32_bf16 v[148:151], v[224:227], v[216:219], v[148:151]
v_exp_f32 v206, v206
v_mfma_f32_16x16x32_bf16 a[140:143], v[224:227], v[188:191], a[140:143]
s_waitcnt lgkmcnt(2)
ds_read_b64_tr_b16 v[224:225], v240 offset:8192
s_add_u32 m0, s29, 122624
s_nop 0
buffer_load_dwordx4 v247, s[16:19], s30 offen offset:256 nt lds
v_mfma_f32_16x16x32_bf16 a[192:195], v[228:231], v[176:179], a[192:195]
ds_read_b64_tr_b16 v[226:227], v240 offset:10240
v_add_f32 v252, v252, v208
v_mfma_f32_16x16x32_bf16 a[196:199], v[228:231], v[180:183], a[196:199]
v_exp_f32 v207, v207
v_mfma_f32_16x16x32_bf16 v[152:155], v[228:231], v[212:215], v[152:155]
v_add_f32 v252, v252, v209
v_add_f32 v252, v252, v210
v_mfma_f32_16x16x32_bf16 a[200:203], v[228:231], v[184:187], a[200:203]
v_add_f32 v252, v252, v211
v_cvt_pk_bf16_f32 v208, v208, v209
v_mfma_f32_16x16x32_bf16 v[156:159], v[228:231], v[216:219], v[156:159]
v_cvt_pk_bf16_f32 v209, v210, v211
v_add_f32 v248, v248, v192
v_mfma_f32_16x16x32_bf16 a[204:207], v[228:231], v[188:191], a[204:207]
ds_write_b64 v245, v[208:209] offset:0
v_mfma_f32_16x16x32_bf16 a[32:35], v[220:223], v[176:179], a[32:35]
ds_read_b64_tr_b16 v[228:229], v240 offset:12288
s_add_u32 m0, s29, 126592
v_mfma_f32_16x16x32_bf16 a[36:39], v[220:223], v[180:183], a[36:39]
ds_read_b64_tr_b16 v[230:231], v240 offset:14336
v_add_f32 v248, v248, v193
v_mfma_f32_16x16x32_bf16 a[40:43], v[220:223], v[184:187], a[40:43]
buffer_load_dwordx4 v247, s[16:19], s30 offen offset:384 nt lds
v_mfma_f32_16x16x32_bf16 a[44:47], v[220:223], v[188:191], a[44:47]
s_waitcnt lgkmcnt(3)
ds_read_b64_tr_b16 v[220:221], v241 offset:0
v_add_f32 v248, v248, v194
v_mfma_f32_16x16x32_bf16 a[96:99], v[232:235], v[176:179], a[96:99]
ds_read_b64_tr_b16 v[222:223], v241 offset:2048
s_add_u32 s30, s30, 16384
v_mfma_f32_16x16x32_bf16 a[100:103], v[232:235], v[180:183], a[100:103]
v_add_f32 v248, v248, v195
v_cvt_pk_bf16_f32 v162, v192, v193
v_mfma_f32_16x16x32_bf16 a[104:107], v[232:235], v[184:187], a[104:107]
v_cvt_pk_bf16_f32 v163, v194, v195
v_add_f32 v249, v249, v196
v_mfma_f32_16x16x32_bf16 a[108:111], v[232:235], v[188:191], a[108:111]
ds_read_b64_tr_b16 v[232:233], v241 offset:4096
v_add_f32 v249, v249, v197
v_mfma_f32_16x16x32_bf16 a[160:163], v[224:227], v[176:179], a[160:163]
ds_read_b64_tr_b16 v[234:235], v241 offset:6144
v_add_f32 v249, v249, v198
v_mfma_f32_16x16x32_bf16 a[164:167], v[224:227], v[180:183], a[164:167]
v_add_f32 v249, v249, v199
v_cvt_pk_bf16_f32 v166, v196, v197
v_mfma_f32_16x16x32_bf16 a[168:171], v[224:227], v[184:187], a[168:171]
v_cvt_pk_bf16_f32 v167, v198, v199
v_add_f32 v250, v250, v200
v_mfma_f32_16x16x32_bf16 a[172:175], v[224:227], v[188:191], a[172:175]
s_waitcnt lgkmcnt(4)
ds_read_b64_tr_b16 v[224:225], v241 offset:8192
v_add_f32 v250, v250, v201
v_mfma_f32_16x16x32_bf16 a[224:227], v[228:231], v[176:179], a[224:227]
ds_read_b64_tr_b16 v[226:227], v241 offset:10240
v_add_f32 v250, v250, v202
v_mfma_f32_16x16x32_bf16 a[228:231], v[228:231], v[180:183], a[228:231]
v_add_f32 v250, v250, v203
v_cvt_pk_bf16_f32 v170, v200, v201
v_mfma_f32_16x16x32_bf16 a[232:235], v[228:231], v[184:187], a[232:235]
v_cvt_pk_bf16_f32 v171, v202, v203
v_add_f32 v251, v251, v204
v_mfma_f32_16x16x32_bf16 a[236:239], v[228:231], v[188:191], a[236:239]
s_waitcnt lgkmcnt(4)
ds_read_b64_tr_b16 v[228:229], v241 offset:12288
v_add_f32 v251, v251, v205
v_mfma_f32_16x16x32_bf16 a[48:51], v[220:223], v[176:179], a[48:51]
ds_read_b64_tr_b16 v[230:231], v241 offset:14336
v_add_f32 v251, v251, v206
v_mfma_f32_16x16x32_bf16 a[52:55], v[220:223], v[180:183], a[52:55]
v_add_f32 v251, v251, v207
v_cvt_pk_bf16_f32 v174, v204, v205
v_mfma_f32_16x16x32_bf16 a[56:59], v[220:223], v[184:187], a[56:59]
s_add_u32 s42, s42, 1024
s_mov_b32 m0, 161792
v_mfma_f32_16x16x32_bf16 a[60:63], v[220:223], v[188:191], a[60:63]
s_waitcnt lgkmcnt(4)
buffer_load_dwordx4 v253, s[20:23], s42 offen lds
v_mfma_f32_16x16x32_bf16 a[112:115], v[232:235], v[176:179], a[112:115]
ds_read_b128 v[220:223], v236 offset:49152
v_cvt_pk_bf16_f32 v175, v206, v207
v_mfma_f32_16x16x32_bf16 a[116:119], v[232:235], v[180:183], a[116:119]
v_mfma_f32_16x16x32_bf16 a[120:123], v[232:235], v[184:187], a[120:123]
v_mfma_f32_16x16x32_bf16 a[124:127], v[232:235], v[188:191], a[124:127]
s_waitcnt lgkmcnt(3)
ds_read_b128 v[232:235], v242 offset:0
v_mfma_f32_16x16x32_bf16 a[176:179], v[224:227], v[176:179], a[176:179]
v_mfma_f32_16x16x32_bf16 a[180:183], v[224:227], v[180:183], a[180:183]
v_mfma_f32_16x16x32_bf16 a[184:187], v[224:227], v[184:187], a[184:187]
v_mfma_f32_16x16x32_bf16 a[188:191], v[224:227], v[188:191], a[188:191]
s_waitcnt lgkmcnt(2)
ds_read_b128 v[224:227], v237 offset:49152
v_mfma_f32_16x16x32_bf16 a[240:243], v[228:231], v[176:179], a[240:243]
v_mfma_f32_16x16x32_bf16 a[244:247], v[228:231], v[180:183], a[244:247]
v_mfma_f32_16x16x32_bf16 a[248:251], v[228:231], v[184:187], a[248:251]
v_mfma_f32_16x16x32_bf16 a[252:255], v[228:231], v[188:191], a[252:255]
ds_read_b128 v[228:231], v236 offset:53248
s_waitcnt vmcnt(16) lgkmcnt(4)
s_barrier
s_waitcnt lgkmcnt(3)
v_mfma_f32_16x16x32_bf16 v[176:179], v[220:223], v[0:3], 0
ds_read_b128 v[212:215], v243 offset:0
s_add_u32 m0, s29, 32768
v_mfma_f32_16x16x32_bf16 v[180:183], v[220:223], v[32:35], 0
ds_read_b128 v[216:219], v242 offset:2048
v_mfma_f32_16x16x32_bf16 v[184:187], v[220:223], v[64:67], 0
buffer_load_dwordx4 v246, s[12:15], s30 offen offset:0 nt lds
v_mfma_f32_16x16x32_bf16 v[188:191], v[220:223], v[96:99], 0
s_waitcnt lgkmcnt(3)
v_mfma_f32_16x16x32_bf16 v[208:211], v[220:223], v[232:235], 0
ds_read_b128 v[220:223], v237 offset:53248
v_mfma_f32_16x16x32_bf16 v[176:179], v[224:227], v[4:7], v[176:179]
ds_read_b128 v[232:235], v243 offset:2048
v_mfma_f32_16x16x32_bf16 v[180:183], v[224:227], v[36:39], v[180:183]
v_mfma_f32_16x16x32_bf16 v[184:187], v[224:227], v[68:71], v[184:187]
v_mfma_f32_16x16x32_bf16 v[188:191], v[224:227], v[100:103], v[188:191]
s_waitcnt lgkmcnt(3)
v_mfma_f32_16x16x32_bf16 v[208:211], v[224:227], v[212:215], v[208:211]
ds_read_b128 v[224:227], v236 offset:57344
v_mfma_f32_16x16x32_bf16 v[176:179], v[228:231], v[8:11], v[176:179]
ds_read_b128 v[212:215], v242 offset:4096
v_mfma_f32_16x16x32_bf16 v[180:183], v[228:231], v[40:43], v[180:183]
v_mfma_f32_16x16x32_bf16 v[184:187], v[228:231], v[72:75], v[184:187]
v_mfma_f32_16x16x32_bf16 v[188:191], v[228:231], v[104:107], v[188:191]
s_waitcnt lgkmcnt(2)
v_mfma_f32_16x16x32_bf16 v[208:211], v[228:231], v[216:219], v[208:211]
ds_read_b128 v[228:231], v237 offset:57344
v_mfma_f32_16x16x32_bf16 v[176:179], v[220:223], v[12:15], v[176:179]
ds_read_b128 v[216:219], v243 offset:4096
v_mfma_f32_16x16x32_bf16 v[180:183], v[220:223], v[44:47], v[180:183]
s_add_u32 m0, s29, 36736
v_mfma_f32_16x16x32_bf16 v[184:187], v[220:223], v[76:79], v[184:187]
v_mfma_f32_16x16x32_bf16 v[188:191], v[220:223], v[108:111], v[188:191]
buffer_load_dwordx4 v246, s[12:15], s30 offen offset:128 nt lds
v_mfma_f32_16x16x32_bf16 v[208:211], v[220:223], v[232:235], v[208:211]
s_waitcnt lgkmcnt(2)
ds_read_b128 v[220:223], v236 offset:61440
v_mfma_f32_16x16x32_bf16 v[176:179], v[224:227], v[16:19], v[176:179]
ds_read_b128 v[232:235], v242 offset:6144
v_mfma_f32_16x16x32_bf16 v[180:183], v[224:227], v[48:51], v[180:183]
v_mfma_f32_16x16x32_bf16 v[184:187], v[224:227], v[80:83], v[184:187]
v_mfma_f32_16x16x32_bf16 v[188:191], v[224:227], v[112:115], v[188:191]
v_mfma_f32_16x16x32_bf16 v[208:211], v[224:227], v[212:215], v[208:211]
s_waitcnt lgkmcnt(2)
ds_read_b128 v[224:227], v237 offset:61440
v_mfma_f32_16x16x32_bf16 v[176:179], v[228:231], v[20:23], v[176:179]
ds_read_b128 v[212:215], v243 offset:6144
v_mfma_f32_16x16x32_bf16 v[180:183], v[228:231], v[52:55], v[180:183]
v_mfma_f32_16x16x32_bf16 v[184:187], v[228:231], v[84:87], v[184:187]
v_mfma_f32_16x16x32_bf16 v[188:191], v[228:231], v[116:119], v[188:191]
v_mfma_f32_16x16x32_bf16 v[208:211], v[228:231], v[216:219], v[208:211]
s_waitcnt lgkmcnt(2)
ds_read_b128 v[228:231], v236 offset:51200
v_mfma_f32_16x16x32_bf16 v[176:179], v[220:223], v[24:27], v[176:179]
ds_read_b128 v[216:219], v237 offset:51200
v_mfma_f32_16x16x32_bf16 v[180:183], v[220:223], v[56:59], v[180:183]
v_mfma_f32_16x16x32_bf16 v[184:187], v[220:223], v[88:91], v[184:187]
s_add_u32 m0, s29, 40704
v_mfma_f32_16x16x32_bf16 v[188:191], v[220:223], v[120:123], v[188:191]
v_mfma_f32_16x16x32_bf16 v[208:211], v[220:223], v[232:235], v[208:211]
s_waitcnt lgkmcnt(2)
buffer_load_dwordx4 v246, s[12:15], s30 offen offset:256 nt lds
v_mfma_f32_16x16x32_bf16 v[176:179], v[224:227], v[28:31], v[176:179]
ds_read_b128 v[220:223], v236 offset:55296
v_mfma_f32_16x16x32_bf16 v[180:183], v[224:227], v[60:63], v[180:183]
ds_read_b128 v[232:235], v237 offset:55296
v_mfma_f32_16x16x32_bf16 v[184:187], v[224:227], v[92:95], v[184:187]
v_mfma_f32_16x16x32_bf16 v[188:191], v[224:227], v[124:127], v[188:191]
v_mfma_f32_16x16x32_bf16 v[208:211], v[224:227], v[212:215], v[208:211]
s_waitcnt lgkmcnt(2)
v_mfma_f32_16x16x32_bf16 v[192:195], v[228:231], v[0:3], 0
ds_read_b128 v[224:227], v236 offset:59392
v_mfma_f32_16x16x32_bf16 v[196:199], v[228:231], v[32:35], 0
v_mfma_f32_16x16x32_bf16 v[200:203], v[228:231], v[64:67], 0
v_exp_f32 v176, v176
v_mfma_f32_16x16x32_bf16 v[204:207], v[228:231], v[96:99], 0
v_exp_f32 v177, v177
v_mfma_f32_16x16x32_bf16 v[192:195], v[216:219], v[4:7], v[192:195]
v_exp_f32 v178, v178
v_mfma_f32_16x16x32_bf16 v[196:199], v[216:219], v[36:39], v[196:199]
v_exp_f32 v179, v179
v_mfma_f32_16x16x32_bf16 v[200:203], v[216:219], v[68:71], v[200:203]
v_exp_f32 v180, v180
v_mfma_f32_16x16x32_bf16 v[204:207], v[216:219], v[100:103], v[204:207]
s_waitcnt lgkmcnt(1)
v_exp_f32 v181, v181
v_mfma_f32_16x16x32_bf16 v[192:195], v[220:223], v[8:11], v[192:195]
ds_read_b128 v[212:215], v237 offset:59392
s_add_u32 m0, s29, 44672
v_mfma_f32_16x16x32_bf16 v[196:199], v[220:223], v[40:43], v[196:199]
v_exp_f32 v182, v182
v_mfma_f32_16x16x32_bf16 v[200:203], v[220:223], v[72:75], v[200:203]
buffer_load_dwordx4 v246, s[12:15], s30 offen offset:384 nt lds
v_mfma_f32_16x16x32_bf16 v[204:207], v[220:223], v[104:107], v[204:207]
v_exp_f32 v183, v183
v_mfma_f32_16x16x32_bf16 v[192:195], v[232:235], v[12:15], v[192:195]
v_exp_f32 v184, v184
v_mfma_f32_16x16x32_bf16 v[196:199], v[232:235], v[44:47], v[196:199]
v_exp_f32 v185, v185
v_mfma_f32_16x16x32_bf16 v[200:203], v[232:235], v[76:79], v[200:203]
ds_read_b128 v[228:231], v236 offset:63488
v_add_f32 v248, v248, v176
v_mfma_f32_16x16x32_bf16 v[204:207], v[232:235], v[108:111], v[204:207]
s_waitcnt lgkmcnt(2)
v_exp_f32 v186, v186
v_mfma_f32_16x16x32_bf16 v[192:195], v[224:227], v[16:19], v[192:195]
v_exp_f32 v187, v187
v_mfma_f32_16x16x32_bf16 v[196:199], v[224:227], v[48:51], v[196:199]
v_exp_f32 v188, v188
v_mfma_f32_16x16x32_bf16 v[200:203], v[224:227], v[80:83], v[200:203]
ds_read_b128 v[216:219], v237 offset:63488
v_add_f32 v248, v248, v177
v_mfma_f32_16x16x32_bf16 v[204:207], v[224:227], v[112:115], v[204:207]
s_waitcnt lgkmcnt(2)
v_exp_f32 v189, v189
v_mfma_f32_16x16x32_bf16 v[192:195], v[212:215], v[20:23], v[192:195]
v_exp_f32 v190, v190
v_mfma_f32_16x16x32_bf16 v[196:199], v[212:215], v[52:55], v[196:199]
v_exp_f32 v191, v191
v_mfma_f32_16x16x32_bf16 v[200:203], v[212:215], v[84:87], v[200:203]
ds_read_b64_tr_b16 v[220:221], v239 offset:16384
v_add_f32 v248, v248, v178
v_mfma_f32_16x16x32_bf16 v[204:207], v[212:215], v[116:119], v[204:207]
s_waitcnt lgkmcnt(2)
ds_read_b64_tr_b16 v[222:223], v239 offset:18432
v_add_f32 v248, v248, v179
v_mfma_f32_16x16x32_bf16 v[192:195], v[228:231], v[24:27], v[192:195]
ds_read_b64_tr_b16 v[232:233], v239 offset:20480
s_add_u32 m0, s29, 65536
v_mfma_f32_16x16x32_bf16 v[196:199], v[228:231], v[56:59], v[196:199]
ds_read_b64_tr_b16 v[234:235], v239 offset:22528
v_cvt_pk_bf16_f32 v176, v176, v177
v_mfma_f32_16x16x32_bf16 v[200:203], v[228:231], v[88:91], v[200:203]
buffer_load_dwordx4 v247, s[16:19], s30 offen offset:0 nt lds
v_mfma_f32_16x16x32_bf16 v[204:207], v[228:231], v[120:123], v[204:207]
s_waitcnt lgkmcnt(4)
ds_read_b64_tr_b16 v[224:225], v239 offset:24576
v_cvt_pk_bf16_f32 v177, v178, v179
v_mfma_f32_16x16x32_bf16 v[192:195], v[216:219], v[28:31], v[192:195]
ds_read_b64_tr_b16 v[226:227], v239 offset:26624
v_add_f32 v249, v249, v180
v_mfma_f32_16x16x32_bf16 v[196:199], v[216:219], v[60:63], v[196:199]
ds_read_b64_tr_b16 v[228:229], v239 offset:28672
v_add_f32 v249, v249, v181
v_mfma_f32_16x16x32_bf16 v[200:203], v[216:219], v[92:95], v[200:203]
ds_read_b64_tr_b16 v[230:231], v239 offset:30720
v_add_f32 v249, v249, v182
v_mfma_f32_16x16x32_bf16 v[204:207], v[216:219], v[124:127], v[204:207]
s_waitcnt lgkmcnt(6)
v_exp_f32 v208, v208
v_mfma_f32_16x16x32_bf16 a[16:19], v[220:223], v[160:163], a[16:19]
ds_read_b128 v[212:215], v244 offset:0
v_add_f32 v249, v249, v183
v_mfma_f32_16x16x32_bf16 a[20:23], v[220:223], v[164:167], a[20:23]
ds_read_b128 v[216:219], v244 offset:1024
v_cvt_pk_bf16_f32 v180, v180, v181
v_mfma_f32_16x16x32_bf16 a[24:27], v[220:223], v[168:171], a[24:27]
v_exp_f32 v209, v209
v_mfma_f32_16x16x32_bf16 a[28:31], v[220:223], v[172:175], a[28:31]
s_waitcnt lgkmcnt(6)
ds_read_b64_tr_b16 v[220:221], v238 offset:16384
v_cvt_pk_bf16_f32 v181, v182, v183
v_mfma_f32_16x16x32_bf16 a[80:83], v[232:235], v[160:163], a[80:83]
ds_read_b64_tr_b16 v[222:223], v238 offset:18432
v_add_f32 v250, v250, v184
v_mfma_f32_16x16x32_bf16 a[84:87], v[232:235], v[164:167], a[84:87]
v_exp_f32 v210, v210
v_mfma_f32_16x16x32_bf16 a[88:91], v[232:235], v[168:171], a[88:91]
v_exp_f32 v211, v211
v_mfma_f32_16x16x32_bf16 a[92:95], v[232:235], v[172:175], a[92:95]
s_waitcnt lgkmcnt(4)
ds_read_b64_tr_b16 v[232:233], v238 offset:20480
v_add_f32 v250, v250, v185
v_mfma_f32_16x16x32_bf16 a[144:147], v[224:227], v[160:163], a[144:147]
ds_read_b64_tr_b16 v[234:235], v238 offset:22528
s_add_u32 m0, s29, 69504
v_mfma_f32_16x16x32_bf16 a[148:151], v[224:227], v[164:167], a[148:151]
v_exp_f32 v192, v192
v_mfma_f32_16x16x32_bf16 a[152:155], v[224:227], v[168:171], a[152:155]
buffer_load_dwordx4 v247, s[16:19], s30 offen offset:128 nt lds
v_mfma_f32_16x16x32_bf16 a[156:159], v[224:227], v[172:175], a[156:159]
v_exp_f32 v193, v193
v_mfma_f32_16x16x32_bf16 a[208:211], v[228:231], v[160:163], a[208:211]
ds_read_b64_tr_b16 v[224:225], v238 offset:24576
v_add_f32 v250, v250, v186
v_mfma_f32_16x16x32_bf16 a[212:215], v[228:231], v[164:167], a[212:215]
ds_read_b64_tr_b16 v[226:227], v238 offset:26624
v_add_f32 v250, v250, v187
v_mfma_f32_16x16x32_bf16 a[216:219], v[228:231], v[168:171], a[216:219]
v_exp_f32 v194, v194
v_mfma_f32_16x16x32_bf16 a[220:223], v[228:231], v[172:175], a[220:223]
s_waitcnt lgkmcnt(4)
v_exp_f32 v195, v195
v_mfma_f32_16x16x32_bf16 a[0:3], v[220:223], v[160:163], a[0:3]
v_exp_f32 v196, v196
v_mfma_f32_16x16x32_bf16 a[4:7], v[220:223], v[164:167], a[4:7]
v_exp_f32 v197, v197
v_mfma_f32_16x16x32_bf16 v[128:131], v[220:223], v[212:215], v[128:131]
ds_read_b64_tr_b16 v[228:229], v238 offset:28672
v_cvt_pk_bf16_f32 v184, v184, v185
v_mfma_f32_16x16x32_bf16 a[8:11], v[220:223], v[168:171], a[8:11]
ds_read_b64_tr_b16 v[230:231], v238 offset:30720
v_cvt_pk_bf16_f32 v185, v186, v187
v_mfma_f32_16x16x32_bf16 v[132:135], v[220:223], v[216:219], v[132:135]
v_exp_f32 v198, v198
v_mfma_f32_16x16x32_bf16 a[12:15], v[220:223], v[172:175], a[12:15]
s_waitcnt lgkmcnt(2)
v_exp_f32 v199, v199
v_mfma_f32_16x16x32_bf16 a[64:67], v[232:235], v[160:163], a[64:67]
v_exp_f32 v200, v200
v_mfma_f32_16x16x32_bf16 a[68:71], v[232:235], v[164:167], a[68:71]
v_exp_f32 v201, v201
v_mfma_f32_16x16x32_bf16 v[136:139], v[232:235], v[212:215], v[136:139]
ds_read_b64_tr_b16 v[220:221], v240 offset:16384
v_add_f32 v251, v251, v188
v_mfma_f32_16x16x32_bf16 a[72:75], v[232:235], v[168:171], a[72:75]
ds_read_b64_tr_b16 v[222:223], v240 offset:18432
v_add_f32 v251, v251, v189
v_mfma_f32_16x16x32_bf16 v[140:143], v[232:235], v[216:219], v[140:143]
v_exp_f32 v202, v202
v_mfma_f32_16x16x32_bf16 a[76:79], v[232:235], v[172:175], a[76:79]
v_exp_f32 v203, v203
v_mfma_f32_16x16x32_bf16 a[128:131], v[224:227], v[160:163], a[128:131]
ds_read_b64_tr_b16 v[232:233], v240 offset:20480
v_add_f32 v251, v251, v190
v_mfma_f32_16x16x32_bf16 a[132:135], v[224:227], v[164:167], a[132:135]
ds_read_b64_tr_b16 v[234:235], v240 offset:22528
v_add_f32 v251, v251, v191
v_mfma_f32_16x16x32_bf16 v[144:147], v[224:227], v[212:215], v[144:147]
v_exp_f32 v204, v204
v_cvt_pk_bf16_f32 v188, v188, v189
v_cvt_pk_bf16_f32 v189, v190, v191
v_mfma_f32_16x16x32_bf16 a[136:139], v[224:227], v[168:171], a[136:139]
v_exp_f32 v205, v205
v_mfma_f32_16x16x32_bf16 v[148:151], v[224:227], v[216:219], v[148:151]
v_exp_f32 v206, v206
v_mfma_f32_16x16x32_bf16 a[140:143], v[224:227], v[172:175], a[140:143]
s_waitcnt lgkmcnt(2)
ds_read_b64_tr_b16 v[224:225], v240 offset:24576
s_add_u32 m0, s29, 73472
s_nop 0
buffer_load_dwordx4 v247, s[16:19], s30 offen offset:256 nt lds
v_mfma_f32_16x16x32_bf16 a[192:195], v[228:231], v[160:163], a[192:195]
ds_read_b64_tr_b16 v[226:227], v240 offset:26624
v_add_f32 v252, v252, v208
v_mfma_f32_16x16x32_bf16 a[196:199], v[228:231], v[164:167], a[196:199]
v_exp_f32 v207, v207
v_mfma_f32_16x16x32_bf16 v[152:155], v[228:231], v[212:215], v[152:155]
v_add_f32 v252, v252, v209
v_add_f32 v252, v252, v210
v_mfma_f32_16x16x32_bf16 a[200:203], v[228:231], v[168:171], a[200:203]
v_add_f32 v252, v252, v211
v_cvt_pk_bf16_f32 v208, v208, v209
v_mfma_f32_16x16x32_bf16 v[156:159], v[228:231], v[216:219], v[156:159]
v_cvt_pk_bf16_f32 v209, v210, v211
v_add_f32 v248, v248, v192
v_mfma_f32_16x16x32_bf16 a[204:207], v[228:231], v[172:175], a[204:207]
ds_write_b64 v245, v[208:209] offset:2048
v_mfma_f32_16x16x32_bf16 a[32:35], v[220:223], v[160:163], a[32:35]
ds_read_b64_tr_b16 v[228:229], v240 offset:28672
s_add_u32 m0, s29, 77440
v_mfma_f32_16x16x32_bf16 a[36:39], v[220:223], v[164:167], a[36:39]
ds_read_b64_tr_b16 v[230:231], v240 offset:30720
v_add_f32 v248, v248, v193
v_mfma_f32_16x16x32_bf16 a[40:43], v[220:223], v[168:171], a[40:43]
buffer_load_dwordx4 v247, s[16:19], s30 offen offset:384 nt lds
v_mfma_f32_16x16x32_bf16 a[44:47], v[220:223], v[172:175], a[44:47]
s_waitcnt lgkmcnt(3)
ds_read_b64_tr_b16 v[220:221], v241 offset:16384
v_add_f32 v248, v248, v194
v_mfma_f32_16x16x32_bf16 a[96:99], v[232:235], v[160:163], a[96:99]
ds_read_b64_tr_b16 v[222:223], v241 offset:18432
s_add_u32 s30, s30, 16384
v_mfma_f32_16x16x32_bf16 a[100:103], v[232:235], v[164:167], a[100:103]
v_add_f32 v248, v248, v195
v_cvt_pk_bf16_f32 v178, v192, v193
v_mfma_f32_16x16x32_bf16 a[104:107], v[232:235], v[168:171], a[104:107]
v_cvt_pk_bf16_f32 v179, v194, v195
v_add_f32 v249, v249, v196
v_mfma_f32_16x16x32_bf16 a[108:111], v[232:235], v[172:175], a[108:111]
ds_read_b64_tr_b16 v[232:233], v241 offset:20480
v_add_f32 v249, v249, v197
v_mfma_f32_16x16x32_bf16 a[160:163], v[224:227], v[160:163], a[160:163]
ds_read_b64_tr_b16 v[234:235], v241 offset:22528
v_add_f32 v249, v249, v198
v_mfma_f32_16x16x32_bf16 a[164:167], v[224:227], v[164:167], a[164:167]
v_add_f32 v249, v249, v199
v_cvt_pk_bf16_f32 v182, v196, v197
v_mfma_f32_16x16x32_bf16 a[168:171], v[224:227], v[168:171], a[168:171]
v_cvt_pk_bf16_f32 v183, v198, v199
v_add_f32 v250, v250, v200
v_mfma_f32_16x16x32_bf16 a[172:175], v[224:227], v[172:175], a[172:175]
s_waitcnt lgkmcnt(4)
ds_read_b64_tr_b16 v[224:225], v241 offset:24576
v_add_f32 v250, v250, v201
v_mfma_f32_16x16x32_bf16 a[224:227], v[228:231], v[160:163], a[224:227]
ds_read_b64_tr_b16 v[226:227], v241 offset:26624
v_add_f32 v250, v250, v202
v_mfma_f32_16x16x32_bf16 a[228:231], v[228:231], v[164:167], a[228:231]
v_add_f32 v250, v250, v203
v_cvt_pk_bf16_f32 v186, v200, v201
v_mfma_f32_16x16x32_bf16 a[232:235], v[228:231], v[168:171], a[232:235]
v_cvt_pk_bf16_f32 v187, v202, v203
v_add_f32 v251, v251, v204
v_mfma_f32_16x16x32_bf16 a[236:239], v[228:231], v[172:175], a[236:239]
s_waitcnt lgkmcnt(4)
ds_read_b64_tr_b16 v[228:229], v241 offset:28672
v_add_f32 v251, v251, v205
v_mfma_f32_16x16x32_bf16 a[48:51], v[220:223], v[160:163], a[48:51]
ds_read_b64_tr_b16 v[230:231], v241 offset:30720
v_add_f32 v251, v251, v206
v_mfma_f32_16x16x32_bf16 a[52:55], v[220:223], v[164:167], a[52:55]
v_add_f32 v251, v251, v207
v_cvt_pk_bf16_f32 v190, v204, v205
v_mfma_f32_16x16x32_bf16 a[56:59], v[220:223], v[168:171], a[56:59]
s_add_u32 s42, s42, 1024
s_mov_b32 m0, 161792
v_mfma_f32_16x16x32_bf16 a[60:63], v[220:223], v[172:175], a[60:63]
s_waitcnt lgkmcnt(4)
buffer_load_dwordx4 v253, s[20:23], s42 offen lds
v_mfma_f32_16x16x32_bf16 a[112:115], v[232:235], v[160:163], a[112:115]
ds_read_b128 v[220:223], v236 offset:0
v_cvt_pk_bf16_f32 v191, v206, v207
v_mfma_f32_16x16x32_bf16 a[116:119], v[232:235], v[164:167], a[116:119]
v_mfma_f32_16x16x32_bf16 a[120:123], v[232:235], v[168:171], a[120:123]
v_mfma_f32_16x16x32_bf16 a[124:127], v[232:235], v[172:175], a[124:127]
s_waitcnt lgkmcnt(3)
ds_read_b128 v[232:235], v242 offset:0
v_mfma_f32_16x16x32_bf16 a[176:179], v[224:227], v[160:163], a[176:179]
v_mfma_f32_16x16x32_bf16 a[180:183], v[224:227], v[164:167], a[180:183]
v_mfma_f32_16x16x32_bf16 a[184:187], v[224:227], v[168:171], a[184:187]
v_mfma_f32_16x16x32_bf16 a[188:191], v[224:227], v[172:175], a[188:191]
s_waitcnt lgkmcnt(2)
ds_read_b128 v[224:227], v237 offset:0
v_mfma_f32_16x16x32_bf16 a[240:243], v[228:231], v[160:163], a[240:243]
v_mfma_f32_16x16x32_bf16 a[244:247], v[228:231], v[164:167], a[244:247]
v_mfma_f32_16x16x32_bf16 a[248:251], v[228:231], v[168:171], a[248:251]
v_mfma_f32_16x16x32_bf16 a[252:255], v[228:231], v[172:175], a[252:255]
ds_read_b128 v[228:231], v236 offset:4096
s_waitcnt vmcnt(16) lgkmcnt(4)
s_barrier
s_sub_u32 s31, s31, 1
s_cmp_eq_u32 s31, 0
s_cbranch_scc1 L_tail
s_waitcnt lgkmcnt(3)
v_mfma_f32_16x16x32_bf16 v[160:163], v[220:223], v[0:3], 0
ds_read_b128 v[212:215], v243 offset:0
s_add_u32 m0, s29, 49152
v_mfma_f32_16x16x32_bf16 v[164:167], v[220:223], v[32:35], 0
ds_read_b128 v[216:219], v242 offset:2048
v_mfma_f32_16x16x32_bf16 v[168:171], v[220:223], v[64:67], 0
buffer_load_dwordx4 v246, s[12:15], s30 offen offset:0 nt lds
v_mfma_f32_16x16x32_bf16 v[172:175], v[220:223], v[96:99], 0
s_waitcnt lgkmcnt(3)
v_mfma_f32_16x16x32_bf16 v[208:211], v[220:223], v[232:235], 0
ds_read_b128 v[220:223], v237 offset:4096
v_mfma_f32_16x16x32_bf16 v[160:163], v[224:227], v[4:7], v[160:163]
ds_read_b128 v[232:235], v243 offset:2048
v_mfma_f32_16x16x32_bf16 v[164:167], v[224:227], v[36:39], v[164:167]
v_mfma_f32_16x16x32_bf16 v[168:171], v[224:227], v[68:71], v[168:171]
v_mfma_f32_16x16x32_bf16 v[172:175], v[224:227], v[100:103], v[172:175]
s_waitcnt lgkmcnt(3)
v_mfma_f32_16x16x32_bf16 v[208:211], v[224:227], v[212:215], v[208:211]
ds_read_b128 v[224:227], v236 offset:8192
v_mfma_f32_16x16x32_bf16 v[160:163], v[228:231], v[8:11], v[160:163]
ds_read_b128 v[212:215], v242 offset:4096
v_mfma_f32_16x16x32_bf16 v[164:167], v[228:231], v[40:43], v[164:167]
v_mfma_f32_16x16x32_bf16 v[168:171], v[228:231], v[72:75], v[168:171]
v_mfma_f32_16x16x32_bf16 v[172:175], v[228:231], v[104:107], v[172:175]
s_waitcnt lgkmcnt(2)
v_mfma_f32_16x16x32_bf16 v[208:211], v[228:231], v[216:219], v[208:211]
ds_read_b128 v[228:231], v237 offset:8192
v_mfma_f32_16x16x32_bf16 v[160:163], v[220:223], v[12:15], v[160:163]
ds_read_b128 v[216:219], v243 offset:4096
v_mfma_f32_16x16x32_bf16 v[164:167], v[220:223], v[44:47], v[164:167]
s_add_u32 m0, s29, 53120
v_mfma_f32_16x16x32_bf16 v[168:171], v[220:223], v[76:79], v[168:171]
v_mfma_f32_16x16x32_bf16 v[172:175], v[220:223], v[108:111], v[172:175]
buffer_load_dwordx4 v246, s[12:15], s30 offen offset:128 nt lds
v_mfma_f32_16x16x32_bf16 v[208:211], v[220:223], v[232:235], v[208:211]
s_waitcnt lgkmcnt(2)
ds_read_b128 v[220:223], v236 offset:12288
v_mfma_f32_16x16x32_bf16 v[160:163], v[224:227], v[16:19], v[160:163]
ds_read_b128 v[232:235], v242 offset:6144
v_mfma_f32_16x16x32_bf16 v[164:167], v[224:227], v[48:51], v[164:167]
v_mfma_f32_16x16x32_bf16 v[168:171], v[224:227], v[80:83], v[168:171]
v_mfma_f32_16x16x32_bf16 v[172:175], v[224:227], v[112:115], v[172:175]
v_mfma_f32_16x16x32_bf16 v[208:211], v[224:227], v[212:215], v[208:211]
s_waitcnt lgkmcnt(2)
ds_read_b128 v[224:227], v237 offset:12288
v_mfma_f32_16x16x32_bf16 v[160:163], v[228:231], v[20:23], v[160:163]
ds_read_b128 v[212:215], v243 offset:6144
v_mfma_f32_16x16x32_bf16 v[164:167], v[228:231], v[52:55], v[164:167]
v_mfma_f32_16x16x32_bf16 v[168:171], v[228:231], v[84:87], v[168:171]
v_mfma_f32_16x16x32_bf16 v[172:175], v[228:231], v[116:119], v[172:175]
v_mfma_f32_16x16x32_bf16 v[208:211], v[228:231], v[216:219], v[208:211]
s_waitcnt lgkmcnt(2)
ds_read_b128 v[228:231], v236 offset:2048
v_mfma_f32_16x16x32_bf16 v[160:163], v[220:223], v[24:27], v[160:163]
ds_read_b128 v[216:219], v237 offset:2048
v_mfma_f32_16x16x32_bf16 v[164:167], v[220:223], v[56:59], v[164:167]
v_mfma_f32_16x16x32_bf16 v[168:171], v[220:223], v[88:91], v[168:171]
s_add_u32 m0, s29, 57088
v_mfma_f32_16x16x32_bf16 v[172:175], v[220:223], v[120:123], v[172:175]
v_mfma_f32_16x16x32_bf16 v[208:211], v[220:223], v[232:235], v[208:211]
s_waitcnt lgkmcnt(2)
buffer_load_dwordx4 v246, s[12:15], s30 offen offset:256 nt lds
v_mfma_f32_16x16x32_bf16 v[160:163], v[224:227], v[28:31], v[160:163]
ds_read_b128 v[220:223], v236 offset:6144
v_mfma_f32_16x16x32_bf16 v[164:167], v[224:227], v[60:63], v[164:167]
ds_read_b128 v[232:235], v237 offset:6144
v_mfma_f32_16x16x32_bf16 v[168:171], v[224:227], v[92:95], v[168:171]
v_mfma_f32_16x16x32_bf16 v[172:175], v[224:227], v[124:127], v[172:175]
v_mfma_f32_16x16x32_bf16 v[208:211], v[224:227], v[212:215], v[208:211]
s_waitcnt lgkmcnt(2)
v_mfma_f32_16x16x32_bf16 v[192:195], v[228:231], v[0:3], 0
ds_read_b128 v[224:227], v236 offset:10240
v_mfma_f32_16x16x32_bf16 v[196:199], v[228:231], v[32:35], 0
v_mfma_f32_16x16x32_bf16 v[200:203], v[228:231], v[64:67], 0
v_exp_f32 v160, v160
v_mfma_f32_16x16x32_bf16 v[204:207], v[228:231], v[96:99], 0
v_exp_f32 v161, v161
v_mfma_f32_16x16x32_bf16 v[192:195], v[216:219], v[4:7], v[192:195]
v_exp_f32 v162, v162
v_mfma_f32_16x16x32_bf16 v[196:199], v[216:219], v[36:39], v[196:199]
v_exp_f32 v163, v163
v_mfma_f32_16x16x32_bf16 v[200:203], v[216:219], v[68:71], v[200:203]
v_exp_f32 v164, v164
v_mfma_f32_16x16x32_bf16 v[204:207], v[216:219], v[100:103], v[204:207]
s_waitcnt lgkmcnt(1)
v_exp_f32 v165, v165
v_mfma_f32_16x16x32_bf16 v[192:195], v[220:223], v[8:11], v[192:195]
ds_read_b128 v[212:215], v237 offset:10240
s_add_u32 m0, s29, 61056
v_mfma_f32_16x16x32_bf16 v[196:199], v[220:223], v[40:43], v[196:199]
v_exp_f32 v166, v166
v_mfma_f32_16x16x32_bf16 v[200:203], v[220:223], v[72:75], v[200:203]
buffer_load_dwordx4 v246, s[12:15], s30 offen offset:384 nt lds
v_mfma_f32_16x16x32_bf16 v[204:207], v[220:223], v[104:107], v[204:207]
v_exp_f32 v167, v167
v_mfma_f32_16x16x32_bf16 v[192:195], v[232:235], v[12:15], v[192:195]
v_exp_f32 v168, v168
v_mfma_f32_16x16x32_bf16 v[196:199], v[232:235], v[44:47], v[196:199]
v_exp_f32 v169, v169
v_mfma_f32_16x16x32_bf16 v[200:203], v[232:235], v[76:79], v[200:203]
ds_read_b128 v[228:231], v236 offset:14336
v_add_f32 v248, v248, v160
v_mfma_f32_16x16x32_bf16 v[204:207], v[232:235], v[108:111], v[204:207]
s_waitcnt lgkmcnt(2)
v_exp_f32 v170, v170
v_mfma_f32_16x16x32_bf16 v[192:195], v[224:227], v[16:19], v[192:195]
v_exp_f32 v171, v171
v_mfma_f32_16x16x32_bf16 v[196:199], v[224:227], v[48:51], v[196:199]
v_exp_f32 v172, v172
v_mfma_f32_16x16x32_bf16 v[200:203], v[224:227], v[80:83], v[200:203]
ds_read_b128 v[216:219], v237 offset:14336
v_add_f32 v248, v248, v161
v_mfma_f32_16x16x32_bf16 v[204:207], v[224:227], v[112:115], v[204:207]
s_waitcnt lgkmcnt(2)
v_exp_f32 v173, v173
v_mfma_f32_16x16x32_bf16 v[192:195], v[212:215], v[20:23], v[192:195]
v_exp_f32 v174, v174
v_mfma_f32_16x16x32_bf16 v[196:199], v[212:215], v[52:55], v[196:199]
v_exp_f32 v175, v175
v_mfma_f32_16x16x32_bf16 v[200:203], v[212:215], v[84:87], v[200:203]
ds_read_b64_tr_b16 v[220:221], v239 offset:32768
v_add_f32 v248, v248, v162
v_mfma_f32_16x16x32_bf16 v[204:207], v[212:215], v[116:119], v[204:207]
s_waitcnt lgkmcnt(2)
ds_read_b64_tr_b16 v[222:223], v239 offset:34816
v_add_f32 v248, v248, v163
v_mfma_f32_16x16x32_bf16 v[192:195], v[228:231], v[24:27], v[192:195]
ds_read_b64_tr_b16 v[232:233], v239 offset:36864
s_add_u32 m0, s29, 81920
v_mfma_f32_16x16x32_bf16 v[196:199], v[228:231], v[56:59], v[196:199]
ds_read_b64_tr_b16 v[234:235], v239 offset:38912
v_cvt_pk_bf16_f32 v160, v160, v161
v_mfma_f32_16x16x32_bf16 v[200:203], v[228:231], v[88:91], v[200:203]
buffer_load_dwordx4 v247, s[16:19], s30 offen offset:0 nt lds
v_mfma_f32_16x16x32_bf16 v[204:207], v[228:231], v[120:123], v[204:207]
s_waitcnt lgkmcnt(4)
ds_read_b64_tr_b16 v[224:225], v239 offset:40960
v_cvt_pk_bf16_f32 v161, v162, v163
v_mfma_f32_16x16x32_bf16 v[192:195], v[216:219], v[28:31], v[192:195]
ds_read_b64_tr_b16 v[226:227], v239 offset:43008
v_add_f32 v249, v249, v164
v_mfma_f32_16x16x32_bf16 v[196:199], v[216:219], v[60:63], v[196:199]
ds_read_b64_tr_b16 v[228:229], v239 offset:45056
v_add_f32 v249, v249, v165
v_mfma_f32_16x16x32_bf16 v[200:203], v[216:219], v[92:95], v[200:203]
ds_read_b64_tr_b16 v[230:231], v239 offset:47104
v_add_f32 v249, v249, v166
v_mfma_f32_16x16x32_bf16 v[204:207], v[216:219], v[124:127], v[204:207]
s_waitcnt lgkmcnt(6)
v_exp_f32 v208, v208
v_mfma_f32_16x16x32_bf16 a[16:19], v[220:223], v[176:179], a[16:19]
ds_read_b128 v[212:215], v244 offset:2048
v_add_f32 v249, v249, v167
v_mfma_f32_16x16x32_bf16 a[20:23], v[220:223], v[180:183], a[20:23]
ds_read_b128 v[216:219], v244 offset:3072
v_cvt_pk_bf16_f32 v164, v164, v165
v_mfma_f32_16x16x32_bf16 a[24:27], v[220:223], v[184:187], a[24:27]
v_exp_f32 v209, v209
v_mfma_f32_16x16x32_bf16 a[28:31], v[220:223], v[188:191], a[28:31]
s_waitcnt lgkmcnt(6)
ds_read_b64_tr_b16 v[220:221], v238 offset:32768
v_cvt_pk_bf16_f32 v165, v166, v167
v_mfma_f32_16x16x32_bf16 a[80:83], v[232:235], v[176:179], a[80:83]
ds_read_b64_tr_b16 v[222:223], v238 offset:34816
v_add_f32 v250, v250, v168
v_mfma_f32_16x16x32_bf16 a[84:87], v[232:235], v[180:183], a[84:87]
v_exp_f32 v210, v210
v_mfma_f32_16x16x32_bf16 a[88:91], v[232:235], v[184:187], a[88:91]
v_exp_f32 v211, v211
v_mfma_f32_16x16x32_bf16 a[92:95], v[232:235], v[188:191], a[92:95]
s_waitcnt lgkmcnt(4)
ds_read_b64_tr_b16 v[232:233], v238 offset:36864
v_add_f32 v250, v250, v169
v_mfma_f32_16x16x32_bf16 a[144:147], v[224:227], v[176:179], a[144:147]
ds_read_b64_tr_b16 v[234:235], v238 offset:38912
s_add_u32 m0, s29, 85888
v_mfma_f32_16x16x32_bf16 a[148:151], v[224:227], v[180:183], a[148:151]
v_exp_f32 v192, v192
v_mfma_f32_16x16x32_bf16 a[152:155], v[224:227], v[184:187], a[152:155]
buffer_load_dwordx4 v247, s[16:19], s30 offen offset:128 nt lds
v_mfma_f32_16x16x32_bf16 a[156:159], v[224:227], v[188:191], a[156:159]
v_exp_f32 v193, v193
v_mfma_f32_16x16x32_bf16 a[208:211], v[228:231], v[176:179], a[208:211]
ds_read_b64_tr_b16 v[224:225], v238 offset:40960
v_add_f32 v250, v250, v170
v_mfma_f32_16x16x32_bf16 a[212:215], v[228:231], v[180:183], a[212:215]
ds_read_b64_tr_b16 v[226:227], v238 offset:43008
v_add_f32 v250, v250, v171
v_mfma_f32_16x16x32_bf16 a[216:219], v[228:231], v[184:187], a[216:219]
v_exp_f32 v194, v194
v_mfma_f32_16x16x32_bf16 a[220:223], v[228:231], v[188:191], a[220:223]
s_waitcnt lgkmcnt(4)
v_exp_f32 v195, v195
v_mfma_f32_16x16x32_bf16 a[0:3], v[220:223], v[176:179], a[0:3]
v_exp_f32 v196, v196
v_mfma_f32_16x16x32_bf16 a[4:7], v[220:223], v[180:183], a[4:7]
v_exp_f32 v197, v197
v_mfma_f32_16x16x32_bf16 v[128:131], v[220:223], v[212:215], v[128:131]
ds_read_b64_tr_b16 v[228:229], v238 offset:45056
v_cvt_pk_bf16_f32 v168, v168, v169
v_mfma_f32_16x16x32_bf16 a[8:11], v[220:223], v[184:187], a[8:11]
ds_read_b64_tr_b16 v[230:231], v238 offset:47104
v_cvt_pk_bf16_f32 v169, v170, v171
v_mfma_f32_16x16x32_bf16 v[132:135], v[220:223], v[216:219], v[132:135]
v_exp_f32 v198, v198
v_mfma_f32_16x16x32_bf16 a[12:15], v[220:223], v[188:191], a[12:15]
s_waitcnt lgkmcnt(2)
v_exp_f32 v199, v199
v_mfma_f32_16x16x32_bf16 a[64:67], v[232:235], v[176:179], a[64:67]
v_exp_f32 v200, v200
v_mfma_f32_16x16x32_bf16 a[68:71], v[232:235], v[180:183], a[68:71]
v_exp_f32 v201, v201
v_mfma_f32_16x16x32_bf16 v[136:139], v[232:235], v[212:215], v[136:139]
ds_read_b64_tr_b16 v[220:221], v240 offset:32768
v_add_f32 v251, v251, v172
v_mfma_f32_16x16x32_bf16 a[72:75], v[232:235], v[184:187], a[72:75]
ds_read_b64_tr_b16 v[222:223], v240 offset:34816
v_add_f32 v251, v251, v173
v_mfma_f32_16x16x32_bf16 v[140:143], v[232:235], v[216:219], v[140:143]
v_exp_f32 v202, v202
v_mfma_f32_16x16x32_bf16 a[76:79], v[232:235], v[188:191], a[76:79]
v_exp_f32 v203, v203
v_mfma_f32_16x16x32_bf16 a[128:131], v[224:227], v[176:179], a[128:131]
ds_read_b64_tr_b16 v[232:233], v240 offset:36864
v_add_f32 v251, v251, v174
v_mfma_f32_16x16x32_bf16 a[132:135], v[224:227], v[180:183], a[132:135]
ds_read_b64_tr_b16 v[234:235], v240 offset:38912
v_add_f32 v251, v251, v175
v_mfma_f32_16x16x32_bf16 v[144:147], v[224:227], v[212:215], v[144:147]
v_exp_f32 v204, v204
v_cvt_pk_bf16_f32 v172, v172, v173
v_cvt_pk_bf16_f32 v173, v174, v175
v_mfma_f32_16x16x32_bf16 a[136:139], v[224:227], v[184:187], a[136:139]
v_exp_f32 v205, v205
v_mfma_f32_16x16x32_bf16 v[148:151], v[224:227], v[216:219], v[148:151]
v_exp_f32 v206, v206
v_mfma_f32_16x16x32_bf16 a[140:143], v[224:227], v[188:191], a[140:143]
s_waitcnt lgkmcnt(2)
ds_read_b64_tr_b16 v[224:225], v240 offset:40960
s_add_u32 m0, s29, 89856
s_nop 0
buffer_load_dwordx4 v247, s[16:19], s30 offen offset:256 nt lds
v_mfma_f32_16x16x32_bf16 a[192:195], v[228:231], v[176:179], a[192:195]
ds_read_b64_tr_b16 v[226:227], v240 offset:43008
v_add_f32 v252, v252, v208
v_mfma_f32_16x16x32_bf16 a[196:199], v[228:231], v[180:183], a[196:199]
v_exp_f32 v207, v207
v_mfma_f32_16x16x32_bf16 v[152:155], v[228:231], v[212:215], v[152:155]
v_add_f32 v252, v252, v209
v_add_f32 v252, v252, v210
v_mfma_f32_16x16x32_bf16 a[200:203], v[228:231], v[184:187], a[200:203]
v_add_f32 v252, v252, v211
v_cvt_pk_bf16_f32 v208, v208, v209
v_mfma_f32_16x16x32_bf16 v[156:159], v[228:231], v[216:219], v[156:159]
v_cvt_pk_bf16_f32 v209, v210, v211
v_add_f32 v248, v248, v192
v_mfma_f32_16x16x32_bf16 a[204:207], v[228:231], v[188:191], a[204:207]
ds_write_b64 v245, v[208:209] offset:0
v_mfma_f32_16x16x32_bf16 a[32:35], v[220:223], v[176:179], a[32:35]
ds_read_b64_tr_b16 v[228:229], v240 offset:45056
s_add_u32 m0, s29, 93824
v_mfma_f32_16x16x32_bf16 a[36:39], v[220:223], v[180:183], a[36:39]
ds_read_b64_tr_b16 v[230:231], v240 offset:47104
v_add_f32 v248, v248, v193
v_mfma_f32_16x16x32_bf16 a[40:43], v[220:223], v[184:187], a[40:43]
buffer_load_dwordx4 v247, s[16:19], s30 offen offset:384 nt lds
v_mfma_f32_16x16x32_bf16 a[44:47], v[220:223], v[188:191], a[44:47]
s_waitcnt lgkmcnt(3)
ds_read_b64_tr_b16 v[220:221], v241 offset:32768
v_add_f32 v248, v248, v194
v_mfma_f32_16x16x32_bf16 a[96:99], v[232:235], v[176:179], a[96:99]
ds_read_b64_tr_b16 v[222:223], v241 offset:34816
s_add_u32 s30, s30, 16384
v_mfma_f32_16x16x32_bf16 a[100:103], v[232:235], v[180:183], a[100:103]
v_add_f32 v248, v248, v195
v_cvt_pk_bf16_f32 v162, v192, v193
v_mfma_f32_16x16x32_bf16 a[104:107], v[232:235], v[184:187], a[104:107]
v_cvt_pk_bf16_f32 v163, v194, v195
v_add_f32 v249, v249, v196
v_mfma_f32_16x16x32_bf16 a[108:111], v[232:235], v[188:191], a[108:111]
ds_read_b64_tr_b16 v[232:233], v241 offset:36864
v_add_f32 v249, v249, v197
v_mfma_f32_16x16x32_bf16 a[160:163], v[224:227], v[176:179], a[160:163]
ds_read_b64_tr_b16 v[234:235], v241 offset:38912
v_add_f32 v249, v249, v198
v_mfma_f32_16x16x32_bf16 a[164:167], v[224:227], v[180:183], a[164:167]
v_add_f32 v249, v249, v199
v_cvt_pk_bf16_f32 v166, v196, v197
v_mfma_f32_16x16x32_bf16 a[168:171], v[224:227], v[184:187], a[168:171]
v_cvt_pk_bf16_f32 v167, v198, v199
v_add_f32 v250, v250, v200
v_mfma_f32_16x16x32_bf16 a[172:175], v[224:227], v[188:191], a[172:175]
s_waitcnt lgkmcnt(4)
ds_read_b64_tr_b16 v[224:225], v241 offset:40960
v_add_f32 v250, v250, v201
v_mfma_f32_16x16x32_bf16 a[224:227], v[228:231], v[176:179], a[224:227]
ds_read_b64_tr_b16 v[226:227], v241 offset:43008
v_add_f32 v250, v250, v202
v_mfma_f32_16x16x32_bf16 a[228:231], v[228:231], v[180:183], a[228:231]
v_add_f32 v250, v250, v203
v_cvt_pk_bf16_f32 v170, v200, v201
v_mfma_f32_16x16x32_bf16 a[232:235], v[228:231], v[184:187], a[232:235]
v_cvt_pk_bf16_f32 v171, v202, v203
v_add_f32 v251, v251, v204
v_mfma_f32_16x16x32_bf16 a[236:239], v[228:231], v[188:191], a[236:239]
s_waitcnt lgkmcnt(4)
ds_read_b64_tr_b16 v[228:229], v241 offset:45056
v_add_f32 v251, v251, v205
v_mfma_f32_16x16x32_bf16 a[48:51], v[220:223], v[176:179], a[48:51]
ds_read_b64_tr_b16 v[230:231], v241 offset:47104
v_add_f32 v251, v251, v206
v_mfma_f32_16x16x32_bf16 a[52:55], v[220:223], v[180:183], a[52:55]
v_add_f32 v251, v251, v207
v_cvt_pk_bf16_f32 v174, v204, v205
v_mfma_f32_16x16x32_bf16 a[56:59], v[220:223], v[184:187], a[56:59]
s_add_u32 s42, s42, 1024
s_mov_b32 m0, 161792
v_mfma_f32_16x16x32_bf16 a[60:63], v[220:223], v[188:191], a[60:63]
s_waitcnt lgkmcnt(4)
buffer_load_dwordx4 v253, s[20:23], s42 offen lds
v_mfma_f32_16x16x32_bf16 a[112:115], v[232:235], v[176:179], a[112:115]
ds_read_b128 v[220:223], v236 offset:16384
v_cvt_pk_bf16_f32 v175, v206, v207
v_mfma_f32_16x16x32_bf16 a[116:119], v[232:235], v[180:183], a[116:119]
v_mfma_f32_16x16x32_bf16 a[120:123], v[232:235], v[184:187], a[120:123]
v_mfma_f32_16x16x32_bf16 a[124:127], v[232:235], v[188:191], a[124:127]
s_waitcnt lgkmcnt(3)
ds_read_b128 v[232:235], v242 offset:0
v_mfma_f32_16x16x32_bf16 a[176:179], v[224:227], v[176:179], a[176:179]
v_mfma_f32_16x16x32_bf16 a[180:183], v[224:227], v[180:183], a[180:183]
v_mfma_f32_16x16x32_bf16 a[184:187], v[224:227], v[184:187], a[184:187]
v_mfma_f32_16x16x32_bf16 a[188:191], v[224:227], v[188:191], a[188:191]
s_waitcnt lgkmcnt(2)
ds_read_b128 v[224:227], v237 offset:16384
v_mfma_f32_16x16x32_bf16 a[240:243], v[228:231], v[176:179], a[240:243]
v_mfma_f32_16x16x32_bf16 a[244:247], v[228:231], v[180:183], a[244:247]
v_mfma_f32_16x16x32_bf16 a[248:251], v[228:231], v[184:187], a[248:251]
v_mfma_f32_16x16x32_bf16 a[252:255], v[228:231], v[188:191], a[252:255]
ds_read_b128 v[228:231], v236 offset:20480
s_waitcnt vmcnt(16) lgkmcnt(4)
s_barrier
s_branch L_loop0
L_attn1:
ds_read_b128 v[220:223], v236 offset:0
ds_read_b128 v[224:227], v237 offset:0
ds_read_b128 v[228:231], v236 offset:4096
ds_read_b128 v[232:235], v237 offset:4096
ds_read_b128 v[212:215], v236 offset:8192
ds_read_b128 v[216:219], v237 offset:8192
s_waitcnt lgkmcnt(5)
v_mfma_f32_16x16x32_bf16 v[160:163], v[220:223], v[0:3], 0
v_mfma_f32_16x16x32_bf16 v[164:167], v[220:223], v[32:35], 0
v_mfma_f32_16x16x32_bf16 v[168:171], v[220:223], v[64:67], 0
v_mfma_f32_16x16x32_bf16 v[172:175], v[220:223], v[96:99], 0
s_waitcnt lgkmcnt(4)
v_mfma_f32_16x16x32_bf16 v[160:163], v[224:227], v[4:7], v[160:163]
v_mfma_f32_16x16x32_bf16 v[164:167], v[224:227], v[36:39], v[164:167]
v_mfma_f32_16x16x32_bf16 v[168:171], v[224:227], v[68:71], v[168:171]
v_mfma_f32_16x16x32_bf16 v[172:175], v[224:227], v[100:103], v[172:175]
s_waitcnt lgkmcnt(0)
v_mfma_f32_16x16x32_bf16 v[160:163], v[228:231], v[8:11], v[160:163]
ds_read_b128 v[220:223], v236 offset:12288
v_mfma_f32_16x16x32_bf16 v[164:167], v[228:231], v[40:43], v[164:167]
v_mfma_f32_16x16x32_bf16 v[168:171], v[228:231], v[72:75], v[168:171]
v_mfma_f32_16x16x32_bf16 v[172:175], v[228:231], v[104:107], v[172:175]
v_mfma_f32_16x16x32_bf16 v[160:163], v[232:235], v[12:15], v[160:163]
ds_read_b128 v[224:227], v237 offset:12288
v_mfma_f32_16x16x32_bf16 v[164:167], v[232:235], v[44:47], v[164:167]
v_mfma_f32_16x16x32_bf16 v[168:171], v[232:235], v[76:79], v[168:171]
v_mfma_f32_16x16x32_bf16 v[172:175], v[232:235], v[108:111], v[172:175]
v_mfma_f32_16x16x32_bf16 v[160:163], v[212:215], v[16:19], v[160:163]
ds_read_b128 v[228:231], v236 offset:2048
v_mfma_f32_16x16x32_bf16 v[164:167], v[212:215], v[48:51], v[164:167]
v_mfma_f32_16x16x32_bf16 v[168:171], v[212:215], v[80:83], v[168:171]
v_mfma_f32_16x16x32_bf16 v[172:175], v[212:215], v[112:115], v[172:175]
v_mfma_f32_16x16x32_bf16 v[160:163], v[216:219], v[20:23], v[160:163]
ds_read_b128 v[232:235], v242 offset:0
v_mfma_f32_16x16x32_bf16 v[164:167], v[216:219], v[52:55], v[164:167]
ds_read_b128 v[212:215], v237 offset:2048
v_mfma_f32_16x16x32_bf16 v[168:171], v[216:219], v[84:87], v[168:171]
v_mfma_f32_16x16x32_bf16 v[172:175], v[216:219], v[116:119], v[172:175]
s_waitcnt lgkmcnt(2)
v_mfma_f32_16x16x32_bf16 v[160:163], v[220:223], v[24:27], v[160:163]
v_mfma_f32_16x16x32_bf16 v[164:167], v[220:223], v[56:59], v[164:167]
ds_read_b128 v[216:219], v243 offset:0
v_mfma_f32_16x16x32_bf16 v[168:171], v[220:223], v[88:91], v[168:171]
v_mfma_f32_16x16x32_bf16 v[172:175], v[220:223], v[120:123], v[172:175]
ds_read_b128 v[220:223], v236 offset:6144
v_mfma_f32_16x16x32_bf16 v[160:163], v[224:227], v[28:31], v[160:163]
v_mfma_f32_16x16x32_bf16 v[164:167], v[224:227], v[60:63], v[164:167]
v_mfma_f32_16x16x32_bf16 v[168:171], v[224:227], v[92:95], v[168:171]
v_mfma_f32_16x16x32_bf16 v[172:175], v[224:227], v[124:127], v[172:175]
ds_read_b128 v[224:227], v242 offset:2048
v_mfma_f32_16x16x32_bf16 v[192:195], v[228:231], v[0:3], 0
v_mfma_f32_16x16x32_bf16 v[196:199], v[228:231], v[32:35], 0
v_mfma_f32_16x16x32_bf16 v[200:203], v[228:231], v[64:67], 0
s_nop 0
v_exp_f32 v160, v160
v_mfma_f32_16x16x32_bf16 v[204:207], v[228:231], v[96:99], 0
s_waitcnt lgkmcnt(1)
v_exp_f32 v161, v161
v_mfma_f32_16x16x32_bf16 v[208:211], v[228:231], v[232:235], 0
v_exp_f32 v162, v162
v_mfma_f32_16x16x32_bf16 v[192:195], v[212:215], v[4:7], v[192:195]
ds_read_b128 v[228:231], v237 offset:6144
v_add_f32 v248, v248, v160
v_mfma_f32_16x16x32_bf16 v[196:199], v[212:215], v[36:39], v[196:199]
v_exp_f32 v163, v163
v_mfma_f32_16x16x32_bf16 v[200:203], v[212:215], v[68:71], v[200:203]
v_exp_f32 v164, v164
v_mfma_f32_16x16x32_bf16 v[204:207], v[212:215], v[100:103], v[204:207]
v_exp_f32 v165, v165
v_mfma_f32_16x16x32_bf16 v[208:211], v[212:215], v[216:219], v[208:211]
ds_read_b128 v[232:235], v243 offset:2048
v_add_f32 v248, v248, v161
v_mfma_f32_16x16x32_bf16 v[192:195], v[220:223], v[8:11], v[192:195]
ds_read_b128 v[212:215], v236 offset:10240
v_add_f32 v248, v248, v162
v_mfma_f32_16x16x32_bf16 v[196:199], v[220:223], v[40:43], v[196:199]
v_exp_f32 v166, v166
v_mfma_f32_16x16x32_bf16 v[200:203], v[220:223], v[72:75], v[200:203]
v_exp_f32 v167, v167
v_mfma_f32_16x16x32_bf16 v[204:207], v[220:223], v[104:107], v[204:207]
s_waitcnt lgkmcnt(2)
v_exp_f32 v168, v168
v_mfma_f32_16x16x32_bf16 v[208:211], v[220:223], v[224:227], v[208:211]
ds_read_b128 v[216:219], v242 offset:4096
v_add_f32 v248, v248, v163
v_mfma_f32_16x16x32_bf16 v[192:195], v[228:231], v[12:15], v[192:195]
ds_read_b128 v[220:223], v237 offset:10240
v_cvt_pk_bf16_f32 v160, v160, v161
v_mfma_f32_16x16x32_bf16 v[196:199], v[228:231], v[44:47], v[196:199]
v_exp_f32 v169, v169
v_mfma_f32_16x16x32_bf16 v[200:203], v[228:231], v[76:79], v[200:203]
v_exp_f32 v170, v170
v_mfma_f32_16x16x32_bf16 v[204:207], v[228:231], v[108:111], v[204:207]
s_waitcnt lgkmcnt(2)
v_exp_f32 v171, v171
v_mfma_f32_16x16x32_bf16 v[208:211], v[228:231], v[232:235], v[208:211]
ds_read_b128 v[224:227], v243 offset:4096
v_cvt_pk_bf16_f32 v161, v162, v163
v_mfma_f32_16x16x32_bf16 v[192:195], v[212:215], v[16:19], v[192:195]
ds_read_b128 v[228:231], v236 offset:14336
v_add_f32 v249, v249, v164
v_mfma_f32_16x16x32_bf16 v[196:199], v[212:215], v[48:51], v[196:199]
v_exp_f32 v172, v172
v_mfma_f32_16x16x32_bf16 v[200:203], v[212:215], v[80:83], v[200:203]
v_exp_f32 v173, v173
v_mfma_f32_16x16x32_bf16 v[204:207], v[212:215], v[112:115], v[204:207]
s_waitcnt lgkmcnt(2)
v_exp_f32 v174, v174
v_mfma_f32_16x16x32_bf16 v[208:211], v[212:215], v[216:219], v[208:211]
ds_read_b128 v[232:235], v242 offset:6144
v_add_f32 v249, v249, v165
v_mfma_f32_16x16x32_bf16 v[192:195], v[220:223], v[20:23], v[192:195]
ds_read_b128 v[212:215], v237 offset:14336
v_add_f32 v249, v249, v166
v_mfma_f32_16x16x32_bf16 v[196:199], v[220:223], v[52:55], v[196:199]
v_exp_f32 v175, v175
v_mfma_f32_16x16x32_bf16 v[200:203], v[220:223], v[84:87], v[200:203]
ds_read_b128 v[216:219], v243 offset:6144
v_add_f32 v249, v249, v167
v_mfma_f32_16x16x32_bf16 v[204:207], v[220:223], v[116:119], v[204:207]
s_waitcnt lgkmcnt(3)
v_cvt_pk_bf16_f32 v164, v164, v165
v_cvt_pk_bf16_f32 v165, v166, v167
v_mfma_f32_16x16x32_bf16 v[208:211], v[220:223], v[224:227], v[208:211]
v_add_f32 v250, v250, v168
v_add_f32 v250, v250, v169
v_mfma_f32_16x16x32_bf16 v[192:195], v[228:231], v[24:27], v[192:195]
v_add_f32 v250, v250, v170
v_add_f32 v250, v250, v171
v_mfma_f32_16x16x32_bf16 v[196:199], v[228:231], v[56:59], v[196:199]
v_cvt_pk_bf16_f32 v168, v168, v169
v_cvt_pk_bf16_f32 v169, v170, v171
v_mfma_f32_16x16x32_bf16 v[200:203], v[228:231], v[88:91], v[200:203]
v_add_f32 v251, v251, v172
v_add_f32 v251, v251, v173
v_mfma_f32_16x16x32_bf16 v[204:207], v[228:231], v[120:123], v[204:207]
s_waitcnt lgkmcnt(0)
v_add_f32 v251, v251, v174
v_add_f32 v251, v251, v175
v_mfma_f32_16x16x32_bf16 v[208:211], v[228:231], v[232:235], v[208:211]
v_cvt_pk_bf16_f32 v172, v172, v173
v_cvt_pk_bf16_f32 v173, v174, v175
v_mfma_f32_16x16x32_bf16 v[192:195], v[212:215], v[28:31], v[192:195]
v_mfma_f32_16x16x32_bf16 v[196:199], v[212:215], v[60:63], v[196:199]
v_mfma_f32_16x16x32_bf16 v[200:203], v[212:215], v[92:95], v[200:203]
v_mfma_f32_16x16x32_bf16 v[204:207], v[212:215], v[124:127], v[204:207]
v_mfma_f32_16x16x32_bf16 v[208:211], v[212:215], v[216:219], v[208:211]
s_nop 7
v_exp_f32 v208, v208
v_exp_f32 v209, v209
v_exp_f32 v210, v210
v_exp_f32 v211, v211
v_add_f32 v252, v252, v208
v_add_f32 v252, v252, v209
v_add_f32 v252, v252, v210
v_add_f32 v252, v252, v211
v_cvt_pk_bf16_f32 v208, v208, v209
v_cvt_pk_bf16_f32 v209, v210, v211
ds_write_b64 v245, v[208:209] offset:0
ds_read_b128 v[220:223], v236 offset:16384
ds_read_b128 v[224:227], v237 offset:16384
ds_read_b128 v[228:231], v236 offset:20480
s_waitcnt vmcnt(14) lgkmcnt(3)
s_barrier
s_mov_b32 s31, 8
s_waitcnt lgkmcnt(2)
v_mfma_f32_16x16x32_bf16 v[176:179], v[220:223], v[0:3], 0
v_exp_f32 v192, v192
v_mfma_f32_16x16x32_bf16 v[180:183], v[220:223], v[32:35], 0
v_exp_f32 v193, v193
v_mfma_f32_16x16x32_bf16 v[184:187], v[220:223], v[64:67], 0
ds_read_b128 v[232:235], v237 offset:20480
v_exp_f32 v194, v194
v_mfma_f32_16x16x32_bf16 v[188:191], v[220:223], v[96:99], 0
s_waitcnt lgkmcnt(2)
v_exp_f32 v195, v195
v_mfma_f32_16x16x32_bf16 v[176:179], v[224:227], v[4:7], v[176:179]
v_exp_f32 v196, v196
v_mfma_f32_16x16x32_bf16 v[180:183], v[224:227], v[36:39], v[180:183]
v_exp_f32 v197, v197
v_add_f32 v248, v248, v192
v_mfma_f32_16x16x32_bf16 v[184:187], v[224:227], v[68:71], v[184:187]
ds_read_b128 v[212:215], v236 offset:24576
v_add_f32 v248, v248, v193
v_add_f32 v248, v248, v194
v_mfma_f32_16x16x32_bf16 v[188:191], v[224:227], v[100:103], v[188:191]
s_waitcnt lgkmcnt(2)
v_exp_f32 v198, v198
v_add_f32 v248, v248, v195
v_cvt_pk_bf16_f32 v162, v192, v193
v_mfma_f32_16x16x32_bf16 v[176:179], v[228:231], v[8:11], v[176:179]
v_exp_f32 v199, v199
v_cvt_pk_bf16_f32 v163, v194, v195
v_mfma_f32_16x16x32_bf16 v[180:183], v[228:231], v[40:43], v[180:183]
v_exp_f32 v200, v200
s_add_u32 m0, s29, 0
s_nop 0
buffer_load_dwordx4 v246, s[12:15], s30 offen offset:0 nt lds
v_mfma_f32_16x16x32_bf16 v[184:187], v[228:231], v[72:75], v[184:187]
ds_read_b128 v[216:219], v237 offset:24576
v_add_f32 v249, v249, v196
v_mfma_f32_16x16x32_bf16 v[188:191], v[228:231], v[104:107], v[188:191]
s_waitcnt lgkmcnt(2)
v_exp_f32 v201, v201
v_mfma_f32_16x16x32_bf16 v[176:179], v[232:235], v[12:15], v[176:179]
v_exp_f32 v202, v202
v_add_f32 v249, v249, v197
v_add_f32 v249, v249, v198
v_mfma_f32_16x16x32_bf16 v[180:183], v[232:235], v[44:47], v[180:183]
v_exp_f32 v203, v203
v_add_f32 v249, v249, v199
v_cvt_pk_bf16_f32 v166, v196, v197
v_mfma_f32_16x16x32_bf16 v[184:187], v[232:235], v[76:79], v[184:187]
ds_read_b128 v[220:223], v236 offset:28672
v_cvt_pk_bf16_f32 v167, v198, v199
v_mfma_f32_16x16x32_bf16 v[188:191], v[232:235], v[108:111], v[188:191]
s_waitcnt lgkmcnt(2)
v_exp_f32 v204, v204
v_mfma_f32_16x16x32_bf16 v[176:179], v[212:215], v[16:19], v[176:179]
v_exp_f32 v205, v205
v_mfma_f32_16x16x32_bf16 v[180:183], v[212:215], v[48:51], v[180:183]
v_exp_f32 v206, v206
v_add_f32 v250, v250, v200
v_mfma_f32_16x16x32_bf16 v[184:187], v[212:215], v[80:83], v[184:187]
ds_read_b128 v[224:227], v237 offset:28672
v_add_f32 v250, v250, v201
v_add_f32 v250, v250, v202
v_mfma_f32_16x16x32_bf16 v[188:191], v[212:215], v[112:115], v[188:191]
s_waitcnt lgkmcnt(2)
v_exp_f32 v207, v207
v_add_f32 v250, v250, v203
v_cvt_pk_bf16_f32 v170, v200, v201
v_mfma_f32_16x16x32_bf16 v[176:179], v[216:219], v[20:23], v[176:179]
ds_read_b128 v[228:231], v236 offset:18432
v_cvt_pk_bf16_f32 v171, v202, v203
v_mfma_f32_16x16x32_bf16 v[180:183], v[216:219], v[52:55], v[180:183]
ds_read_b128 v[232:235], v242 offset:0
v_add_f32 v251, v251, v204
v_mfma_f32_16x16x32_bf16 v[184:187], v[216:219], v[84:87], v[184:187]
ds_read_b128 v[212:215], v237 offset:18432
v_add_f32 v251, v251, v205
v_mfma_f32_16x16x32_bf16 v[188:191], v[216:219], v[116:119], v[188:191]
s_waitcnt lgkmcnt(4)
v_add_f32 v251, v251, v206
s_add_u32 m0, s29, 3968
v_mfma_f32_16x16x32_bf16 v[176:179], v[220:223], v[24:27], v[176:179]
buffer_load_dwordx4 v246, s[12:15], s30 offen offset:128 nt lds
v_mfma_f32_16x16x32_bf16 v[180:183], v[220:223], v[56:59], v[180:183]
ds_read_b128 v[216:219], v243 offset:0
v_add_f32 v251, v251, v207
v_cvt_pk_bf16_f32 v174, v204, v205
v_mfma_f32_16x16x32_bf16 v[184:187], v[220:223], v[88:91], v[184:187]
v_cvt_pk_bf16_f32 v175, v206, v207
v_mfma_f32_16x16x32_bf16 v[188:191], v[220:223], v[120:123], v[188:191]
s_waitcnt lgkmcnt(4)
ds_read_b128 v[220:223], v236 offset:22528
v_mfma_f32_16x16x32_bf16 v[176:179], v[224:227], v[28:31], v[176:179]
v_mfma_f32_16x16x32_bf16 v[180:183], v[224:227], v[60:63], v[180:183]
v_mfma_f32_16x16x32_bf16 v[184:187], v[224:227], v[92:95], v[184:187]
v_mfma_f32_16x16x32_bf16 v[188:191], v[224:227], v[124:127], v[188:191]
s_waitcnt lgkmcnt(2)
ds_read_b128 v[224:227], v242 offset:2048
v_mfma_f32_16x16x32_bf16 v[192:195], v[228:231], v[0:3], 0
s_add_u32 m0, s29, 7936
v_mfma_f32_16x16x32_bf16 v[196:199], v[228:231], v[32:35], 0
v_mfma_f32_16x16x32_bf16 v[200:203], v[228:231], v[64:67], 0
buffer_load_dwordx4 v246, s[12:15], s30 offen offset:256 nt lds
v_mfma_f32_16x16x32_bf16 v[204:207], v[228:231], v[96:99], 0
v_exp_f32 v176, v176
v_mfma_f32_16x16x32_bf16 v[208:211], v[228:231], v[232:235], 0
v_exp_f32 v177, v177
v_mfma_f32_16x16x32_bf16 v[192:195], v[212:215], v[4:7], v[192:195]
ds_read_b128 v[228:231], v237 offset:22528
v_add_f32 v248, v248, v176
v_mfma_f32_16x16x32_bf16 v[196:199], v[212:215], v[36:39], v[196:199]
v_exp_f32 v178, v178
v_mfma_f32_16x16x32_bf16 v[200:203], v[212:215], v[68:71], v[200:203]
v_exp_f32 v179, v179
v_mfma_f32_16x16x32_bf16 v[204:207], v[212:215], v[100:103], v[204:207]
s_waitcnt lgkmcnt(1)
v_exp_f32 v180, v180
v_mfma_f32_16x16x32_bf16 v[208:211], v[212:215], v[216:219], v[208:211]
ds_read_b128 v[232:235], v243 offset:2048
v_add_f32 v248, v248, v177
v_mfma_f32_16x16x32_bf16 v[192:195], v[220:223], v[8:11], v[192:195]
ds_read_b128 v[212:215], v236 offset:26624
v_add_f32 v248, v248, v178
v_mfma_f32_16x16x32_bf16 v[196:199], v[220:223], v[40:43], v[196:199]
v_exp_f32 v181, v181
v_mfma_f32_16x16x32_bf16 v[200:203], v[220:223], v[72:75], v[200:203]
v_exp_f32 v182, v182
v_mfma_f32_16x16x32_bf16 v[204:207], v[220:223], v[104:107], v[204:207]
v_exp_f32 v183, v183
v_mfma_f32_16x16x32_bf16 v[208:211], v[220:223], v[224:227], v[208:211]
s_waitcnt lgkmcnt(2)
ds_read_b128 v[216:219], v242 offset:4096
v_add_f32 v248, v248, v179
v_mfma_f32_16x16x32_bf16 v[192:195], v[228:231], v[12:15], v[192:195]
ds_read_b128 v[220:223], v237 offset:26624
v_cvt_pk_bf16_f32 v176, v176, v177
v_mfma_f32_16x16x32_bf16 v[196:199], v[228:231], v[44:47], v[196:199]
ds_read_b128 v[224:227], v243 offset:4096
s_add_u32 m0, s29, 11904
v_mfma_f32_16x16x32_bf16 v[200:203], v[228:231], v[76:79], v[200:203]
v_exp_f32 v184, v184
v_mfma_f32_16x16x32_bf16 v[204:207], v[228:231], v[108:111], v[204:207]
s_waitcnt lgkmcnt(3)
buffer_load_dwordx4 v246, s[12:15], s30 offen offset:384 nt lds
v_mfma_f32_16x16x32_bf16 v[208:211], v[228:231], v[232:235], v[208:211]
v_exp_f32 v185, v185
v_mfma_f32_16x16x32_bf16 v[192:195], v[212:215], v[16:19], v[192:195]
ds_read_b128 v[228:231], v236 offset:30720
v_cvt_pk_bf16_f32 v177, v178, v179
v_mfma_f32_16x16x32_bf16 v[196:199], v[212:215], v[48:51], v[196:199]
v_exp_f32 v186, v186
v_mfma_f32_16x16x32_bf16 v[200:203], v[212:215], v[80:83], v[200:203]
v_exp_f32 v187, v187
v_mfma_f32_16x16x32_bf16 v[204:207], v[212:215], v[112:115], v[204:207]
s_waitcnt lgkmcnt(2)
v_exp_f32 v188, v188
v_mfma_f32_16x16x32_bf16 v[208:211], v[212:215], v[216:219], v[208:211]
ds_read_b128 v[232:235], v242 offset:6144
v_add_f32 v249, v249, v180
v_mfma_f32_16x16x32_bf16 v[192:195], v[220:223], v[20:23], v[192:195]
ds_read_b128 v[212:215], v237 offset:30720
v_add_f32 v249, v249, v181
v_mfma_f32_16x16x32_bf16 v[196:199], v[220:223], v[52:55], v[196:199]
v_exp_f32 v189, v189
v_mfma_f32_16x16x32_bf16 v[200:203], v[220:223], v[84:87], v[200:203]
v_exp_f32 v190, v190
v_mfma_f32_16x16x32_bf16 v[204:207], v[220:223], v[116:119], v[204:207]
s_waitcnt lgkmcnt(2)
v_exp_f32 v191, v191
v_mfma_f32_16x16x32_bf16 v[208:211], v[220:223], v[224:227], v[208:211]
ds_read_b128 v[216:219], v243 offset:6144
v_add_f32 v249, v249, v182
v_mfma_f32_16x16x32_bf16 v[192:195], v[228:231], v[24:27], v[192:195]
ds_read_b64_tr_b16 v[220:221], v239 offset:49152
v_add_f32 v249, v249, v183
v_mfma_f32_16x16x32_bf16 v[196:199], v[228:231], v[56:59], v[196:199]
ds_read_b64_tr_b16 v[222:223], v239 offset:51200
v_cvt_pk_bf16_f32 v180, v180, v181
v_mfma_f32_16x16x32_bf16 v[200:203], v[228:231], v[88:91], v[200:203]
ds_read_b64_tr_b16 v[224:225], v239 offset:53248
s_add_u32 m0, s29, 98304
v_mfma_f32_16x16x32_bf16 v[204:207], v[228:231], v[120:123], v[204:207]
s_waitcnt lgkmcnt(4)
ds_read_b64_tr_b16 v[226:227], v239 offset:55296
v_cvt_pk_bf16_f32 v181, v182, v183
v_mfma_f32_16x16x32_bf16 v[208:211], v[228:231], v[232:235], v[208:211]
buffer_load_dwordx4 v247, s[16:19], s30 offen offset:0 nt lds
v_mfma_f32_16x16x32_bf16 v[192:195], v[212:215], v[28:31], v[192:195]
ds_read_b64_tr_b16 v[228:229], v239 offset:57344
v_add_f32 v250, v250, v184
v_mfma_f32_16x16x32_bf16 v[196:199], v[212:215], v[60:63], v[196:199]
ds_read_b64_tr_b16 v[230:231], v239 offset:59392
v_add_f32 v250, v250, v185
v_mfma_f32_16x16x32_bf16 v[200:203], v[212:215], v[92:95], v[200:203]
ds_read_b64_tr_b16 v[232:233], v239 offset:61440
v_add_f32 v250, v250, v186
v_mfma_f32_16x16x32_bf16 v[204:207], v[212:215], v[124:127], v[204:207]
s_waitcnt lgkmcnt(7)
ds_read_b64_tr_b16 v[234:235], v239 offset:63488
v_add_f32 v250, v250, v187
v_mfma_f32_16x16x32_bf16 v[208:211], v[212:215], v[216:219], v[208:211]
s_waitcnt lgkmcnt(6)
v_cvt_pk_bf16_f32 v184, v184, v185
v_cvt_pk_bf16_f32 v185, v186, v187
v_mfma_f32_16x16x32_bf16 a[16:19], v[220:223], v[160:163], 0
ds_read_b128 v[212:215], v244 offset:0
v_add_f32 v251, v251, v188
v_mfma_f32_16x16x32_bf16 a[20:23], v[220:223], v[164:167], 0
ds_read_b128 v[216:219], v244 offset:1024
v_add_f32 v251, v251, v189
v_mfma_f32_16x16x32_bf16 a[24:27], v[220:223], v[168:171], 0
v_exp_f32 v208, v208
v_mfma_f32_16x16x32_bf16 a[28:31], v[220:223], v[172:175], 0
s_waitcnt lgkmcnt(6)
ds_read_b64_tr_b16 v[220:221], v238 offset:49152
v_add_f32 v251, v251, v190
v_mfma_f32_16x16x32_bf16 a[80:83], v[224:227], v[160:163], 0
ds_read_b64_tr_b16 v[222:223], v238 offset:51200
v_add_f32 v251, v251, v191
v_mfma_f32_16x16x32_bf16 a[84:87], v[224:227], v[164:167], 0
v_exp_f32 v209, v209
v_mfma_f32_16x16x32_bf16 a[88:91], v[224:227], v[168:171], 0
v_exp_f32 v210, v210
v_mfma_f32_16x16x32_bf16 a[92:95], v[224:227], v[172:175], 0
s_waitcnt lgkmcnt(4)
ds_read_b64_tr_b16 v[224:225], v238 offset:53248
v_cvt_pk_bf16_f32 v188, v188, v189
v_mfma_f32_16x16x32_bf16 a[144:147], v[228:231], v[160:163], 0
ds_read_b64_tr_b16 v[226:227], v238 offset:55296
s_add_u32 m0, s29, 102272
v_mfma_f32_16x16x32_bf16 a[148:151], v[228:231], v[164:167], 0
v_exp_f32 v211, v211
v_mfma_f32_16x16x32_bf16 a[152:155], v[228:231], v[168:171], 0
buffer_load_dwordx4 v247, s[16:19], s30 offen offset:128 nt lds
v_mfma_f32_16x16x32_bf16 a[156:159], v[228:231], v[172:175], 0
v_exp_f32 v192, v192
v_mfma_f32_16x16x32_bf16 a[208:211], v[232:235], v[160:163], 0
ds_read_b64_tr_b16 v[228:229], v238 offset:57344
v_cvt_pk_bf16_f32 v189, v190, v191
v_mfma_f32_16x16x32_bf16 a[212:215], v[232:235], v[164:167], 0
ds_read_b64_tr_b16 v[230:231], v238 offset:59392
v_add_f32 v252, v252, v208
v_mfma_f32_16x16x32_bf16 a[216:219], v[232:235], v[168:171], 0
v_exp_f32 v193, v193
v_mfma_f32_16x16x32_bf16 a[220:223], v[232:235], v[172:175], 0
s_waitcnt lgkmcnt(4)
v_exp_f32 v194, v194
v_mfma_f32_16x16x32_bf16 a[0:3], v[220:223], v[160:163], 0
v_exp_f32 v195, v195
v_mfma_f32_16x16x32_bf16 a[4:7], v[220:223], v[164:167], 0
v_exp_f32 v196, v196
v_mfma_f32_16x16x32_bf16 v[128:131], v[220:223], v[212:215], 0
ds_read_b64_tr_b16 v[232:233], v238 offset:61440
v_add_f32 v252, v252, v209
v_mfma_f32_16x16x32_bf16 a[8:11], v[220:223], v[168:171], 0
ds_read_b64_tr_b16 v[234:235], v238 offset:63488
v_add_f32 v252, v252, v210
v_mfma_f32_16x16x32_bf16 v[132:135], v[220:223], v[216:219], 0
v_exp_f32 v197, v197
v_mfma_f32_16x16x32_bf16 a[12:15], v[220:223], v[172:175], 0
s_waitcnt lgkmcnt(2)
v_exp_f32 v198, v198
v_mfma_f32_16x16x32_bf16 a[64:67], v[224:227], v[160:163], 0
v_exp_f32 v199, v199
v_mfma_f32_16x16x32_bf16 a[68:71], v[224:227], v[164:167], 0
v_exp_f32 v200, v200
v_mfma_f32_16x16x32_bf16 v[136:139], v[224:227], v[212:215], 0
ds_read_b64_tr_b16 v[220:221], v240 offset:49152
s_add_u32 m0, s29, 106240
v_mfma_f32_16x16x32_bf16 a[72:75], v[224:227], v[168:171], 0
ds_read_b64_tr_b16 v[222:223], v240 offset:51200
v_add_f32 v252, v252, v211
v_mfma_f32_16x16x32_bf16 v[140:143], v[224:227], v[216:219], 0
buffer_load_dwordx4 v247, s[16:19], s30 offen offset:256 nt lds
v_mfma_f32_16x16x32_bf16 a[76:79], v[224:227], v[172:175], 0
v_exp_f32 v201, v201
v_mfma_f32_16x16x32_bf16 a[128:131], v[228:231], v[160:163], 0
ds_read_b64_tr_b16 v[224:225], v240 offset:53248
v_cvt_pk_bf16_f32 v208, v208, v209
v_mfma_f32_16x16x32_bf16 a[132:135], v[228:231], v[164:167], 0
ds_read_b64_tr_b16 v[226:227], v240 offset:55296
v_cvt_pk_bf16_f32 v209, v210, v211
v_mfma_f32_16x16x32_bf16 v[144:147], v[228:231], v[212:215], 0
ds_write_b64 v245, v[208:209] offset:2048
v_mfma_f32_16x16x32_bf16 a[136:139], v[228:231], v[168:171], 0
v_exp_f32 v202, v202
v_mfma_f32_16x16x32_bf16 v[148:151], v[228:231], v[216:219], 0
v_exp_f32 v203, v203
v_mfma_f32_16x16x32_bf16 a[140:143], v[228:231], v[172:175], 0
s_waitcnt lgkmcnt(3)
v_exp_f32 v204, v204
v_mfma_f32_16x16x32_bf16 a[192:195], v[232:235], v[160:163], 0
v_exp_f32 v205, v205
v_mfma_f32_16x16x32_bf16 a[196:199], v[232:235], v[164:167], 0
v_exp_f32 v206, v206
v_mfma_f32_16x16x32_bf16 v[152:155], v[232:235], v[212:215], 0
v_exp_f32 v207, v207
v_mfma_f32_16x16x32_bf16 a[200:203], v[232:235], v[168:171], 0
ds_read_b64_tr_b16 v[228:229], v240 offset:57344
v_add_f32 v248, v248, v192
v_mfma_f32_16x16x32_bf16 v[156:159], v[232:235], v[216:219], 0
ds_read_b64_tr_b16 v[230:231], v240 offset:59392
v_add_f32 v248, v248, v193
v_mfma_f32_16x16x32_bf16 a[204:207], v[232:235], v[172:175], 0
ds_read_b64_tr_b16 v[232:233], v240 offset:61440
v_add_f32 v248, v248, v194
v_mfma_f32_16x16x32_bf16 a[32:35], v[220:223], v[160:163], 0
ds_read_b64_tr_b16 v[234:235], v240 offset:63488
s_add_u32 m0, s29, 110208
v_mfma_f32_16x16x32_bf16 a[36:39], v[220:223], v[164:167], 0
v_add_f32 v248, v248, v195
v_cvt_pk_bf16_f32 v178, v192, v193
v_mfma_f32_16x16x32_bf16 a[40:43], v[220:223], v[168:171], 0
buffer_load_dwordx4 v247, s[16:19], s30 offen offset:384 nt lds
v_mfma_f32_16x16x32_bf16 a[44:47], v[220:223], v[172:175], 0
s_waitcnt lgkmcnt(5)
ds_read_b64_tr_b16 v[220:221], v241 offset:49152
v_cvt_pk_bf16_f32 v179, v194, v195
v_mfma_f32_16x16x32_bf16 a[96:99], v[224:227], v[160:163], 0
ds_read_b64_tr_b16 v[222:223], v241 offset:51200
s_add_u32 s30, s30, 16384
v_mfma_f32_16x16x32_bf16 a[100:103], v[224:227], v[164:167], 0
v_add_f32 v249, v249, v196
v_add_f32 v249, v249, v197
v_mfma_f32_16x16x32_bf16 a[104:107], v[224:227], v[168:171], 0
v_add_f32 v249, v249, v198
v_add_f32 v249, v249, v199
v_mfma_f32_16x16x32_bf16 a[108:111], v[224:227], v[172:175], 0
s_waitcnt lgkmcnt(4)
ds_read_b64_tr_b16 v[224:225], v241 offset:53248
v_cvt_pk_bf16_f32 v182, v196, v197
v_mfma_f32_16x16x32_bf16 a[160:163], v[228:231], v[160:163], 0
ds_read_b64_tr_b16 v[226:227], v241 offset:55296
v_cvt_pk_bf16_f32 v183, v198, v199
v_mfma_f32_16x16x32_bf16 a[164:167], v[228:231], v[164:167], 0
v_add_f32 v250, v250, v200
v_add_f32 v250, v250, v201
v_mfma_f32_16x16x32_bf16 a[168:171], v[228:231], v[168:171], 0
v_add_f32 v250, v250, v202
v_add_f32 v250, v250, v203
v_mfma_f32_16x16x32_bf16 a[172:175], v[228:231], v[172:175], 0
s_waitcnt lgkmcnt(4)
ds_read_b64_tr_b16 v[228:229], v241 offset:57344
v_cvt_pk_bf16_f32 v186, v200, v201
v_mfma_f32_16x16x32_bf16 a[224:227], v[232:235], v[160:163], 0
ds_read_b64_tr_b16 v[230:231], v241 offset:59392
v_cvt_pk_bf16_f32 v187, v202, v203
v_mfma_f32_16x16x32_bf16 a[228:231], v[232:235], v[164:167], 0
v_add_f32 v251, v251, v204
v_add_f32 v251, v251, v205
v_mfma_f32_16x16x32_bf16 a[232:235], v[232:235], v[168:171], 0
v_add_f32 v251, v251, v206
v_add_f32 v251, v251, v207
v_mfma_f32_16x16x32_bf16 a[236:239], v[232:235], v[172:175], 0
s_waitcnt lgkmcnt(4)
ds_read_b64_tr_b16 v[232:233], v241 offset:61440
v_cvt_pk_bf16_f32 v190, v204, v205
v_mfma_f32_16x16x32_bf16 a[48:51], v[220:223], v[160:163], 0
ds_read_b64_tr_b16 v[234:235], v241 offset:63488
v_cvt_pk_bf16_f32 v191, v206, v207
v_mfma_f32_16x16x32_bf16 a[52:55], v[220:223], v[164:167], 0
v_mfma_f32_16x16x32_bf16 a[56:59], v[220:223], v[168:171], 0
s_add_u32 s42, s42, 1024
s_mov_b32 m0, 161792
v_mfma_f32_16x16x32_bf16 a[60:63], v[220:223], v[172:175], 0
s_waitcnt lgkmcnt(4)
buffer_load_dwordx4 v253, s[20:23], s42 offen lds
v_mfma_f32_16x16x32_bf16 a[112:115], v[224:227], v[160:163], 0
ds_read_b128 v[220:223], v236 offset:32768
v_mfma_f32_16x16x32_bf16 a[116:119], v[224:227], v[164:167], 0
v_mfma_f32_16x16x32_bf16 a[120:123], v[224:227], v[168:171], 0
v_mfma_f32_16x16x32_bf16 a[124:127], v[224:227], v[172:175], 0
s_waitcnt lgkmcnt(3)
ds_read_b128 v[224:227], v237 offset:32768
v_mfma_f32_16x16x32_bf16 a[176:179], v[228:231], v[160:163], 0
v_mfma_f32_16x16x32_bf16 a[180:183], v[228:231], v[164:167], 0
v_mfma_f32_16x16x32_bf16 a[184:187], v[228:231], v[168:171], 0
v_mfma_f32_16x16x32_bf16 a[188:191], v[228:231], v[172:175], 0
s_waitcnt lgkmcnt(2)
ds_read_b128 v[228:231], v236 offset:36864
v_mfma_f32_16x16x32_bf16 a[240:243], v[232:235], v[160:163], 0
v_mfma_f32_16x16x32_bf16 a[244:247], v[232:235], v[164:167], 0
v_mfma_f32_16x16x32_bf16 a[248:251], v[232:235], v[168:171], 0
v_mfma_f32_16x16x32_bf16 a[252:255], v[232:235], v[172:175], 0
s_waitcnt vmcnt(15) lgkmcnt(3)
s_barrier
s_branch L_body1_1
.p2align 3
L_loop1:
s_cmp_eq_u32 s31, 4
s_cselect_b32 s42, s43, s42
s_cmp_lg_u32 s31, 2
s_cbranch_scc1 L_nopf1
s_getpc_b64 s[44:45]
L_pc2_1:
s_sub_u32 s44, s44, L_pc2_1-L_pc
s_subb_u32 s45, s45, 0
s_lshr_b32 s46, s2, 3
s_lshl_b32 s46, s46, 12
s_add_u32 s46, s46, s29
s_min_u32 s46, s46, R_end-L_pc-1024
v_add_u32 v254, s46, v253
v_mov_b32 v255, s45
v_add_co_u32 v254, vcc, s44, v254
s_nop 1
v_addc_co_u32 v255, vcc, 0, v255, vcc
s_mov_b32 m0, 161792
s_nop 0
global_load_lds_dwordx4 v[254:255], off
L_nopf1:
s_waitcnt lgkmcnt(2)
v_mfma_f32_16x16x32_bf16 v[176:179], v[220:223], v[0:3], 0
ds_read_b128 v[232:235], v237 offset:20480
s_add_u32 m0, s29, 0
v_mfma_f32_16x16x32_bf16 v[180:183], v[220:223], v[32:35], 0
ds_read_b128 v[212:215], v236 offset:24576
v_mfma_f32_16x16x32_bf16 v[184:187], v[220:223], v[64:67], 0
buffer_load_dwordx4 v246, s[12:15], s30 offen offset:0 nt lds
v_mfma_f32_16x16x32_bf16 v[188:191], v[220:223], v[96:99], 0
s_waitcnt lgkmcnt(3)
v_mfma_f32_16x16x32_bf16 v[176:179], v[224:227], v[4:7], v[176:179]
ds_read_b128 v[216:219], v237 offset:24576
v_mfma_f32_16x16x32_bf16 v[180:183], v[224:227], v[36:39], v[180:183]
v_mfma_f32_16x16x32_bf16 v[184:187], v[224:227], v[68:71], v[184:187]
v_mfma_f32_16x16x32_bf16 v[188:191], v[224:227], v[100:103], v[188:191]
s_waitcnt lgkmcnt(3)
v_mfma_f32_16x16x32_bf16 v[176:179], v[228:231], v[8:11], v[176:179]
ds_read_b128 v[220:223], v236 offset:28672
v_mfma_f32_16x16x32_bf16 v[180:183], v[228:231], v[40:43], v[180:183]
v_mfma_f32_16x16x32_bf16 v[184:187], v[228:231], v[72:75], v[184:187]
v_mfma_f32_16x16x32_bf16 v[188:191], v[228:231], v[104:107], v[188:191]
s_waitcnt lgkmcnt(2)
v_mfma_f32_16x16x32_bf16 v[176:179], v[232:235], v[12:15], v[176:179]
ds_read_b128 v[224:227], v237 offset:28672
v_mfma_f32_16x16x32_bf16 v[180:183], v[232:235], v[44:47], v[180:183]
v_mfma_f32_16x16x32_bf16 v[184:187], v[232:235], v[76:79], v[184:187]
v_mfma_f32_16x16x32_bf16 v[188:191], v[232:235], v[108:111], v[188:191]
v_mfma_f32_16x16x32_bf16 v[176:179], v[212:215], v[16:19], v[176:179]
ds_read_b128 v[228:231], v236 offset:18432
s_add_u32 m0, s29, 3968
v_mfma_f32_16x16x32_bf16 v[180:183], v[212:215], v[48:51], v[180:183]
v_mfma_f32_16x16x32_bf16 v[184:187], v[212:215], v[80:83], v[184:187]
buffer_load_dwordx4 v246, s[12:15], s30 offen offset:128 nt lds
v_mfma_f32_16x16x32_bf16 v[188:191], v[212:215], v[112:115], v[188:191]
s_waitcnt lgkmcnt(2)
v_mfma_f32_16x16x32_bf16 v[176:179], v[216:219], v[20:23], v[176:179]
ds_read_b128 v[232:235], v242 offset:0
v_mfma_f32_16x16x32_bf16 v[180:183], v[216:219], v[52:55], v[180:183]
ds_read_b128 v[212:215], v237 offset:18432
v_mfma_f32_16x16x32_bf16 v[184:187], v[216:219], v[84:87], v[184:187]
v_mfma_f32_16x16x32_bf16 v[188:191], v[216:219], v[116:119], v[188:191]
v_mfma_f32_16x16x32_bf16 v[176:179], v[220:223], v[24:27], v[176:179]
v_mfma_f32_16x16x32_bf16 v[180:183], v[220:223], v[56:59], v[180:183]
ds_read_b128 v[216:219], v243 offset:0
v_mfma_f32_16x16x32_bf16 v[184:187], v[220:223], v[88:91], v[184:187]
v_mfma_f32_16x16x32_bf16 v[188:191], v[220:223], v[120:123], v[188:191]
s_waitcnt lgkmcnt(3)
ds_read_b128 v[220:223], v236 offset:22528
v_mfma_f32_16x16x32_bf16 v[176:179], v[224:227], v[28:31], v[176:179]
v_mfma_f32_16x16x32_bf16 v[180:183], v[224:227], v[60:63], v[180:183]
v_mfma_f32_16x16x32_bf16 v[184:187], v[224:227], v[92:95], v[184:187]
v_mfma_f32_16x16x32_bf16 v[188:191], v[224:227], v[124:127], v[188:191]
ds_read_b128 v[224:227], v242 offset:2048
v_mfma_f32_16x16x32_bf16 v[192:195], v[228:231], v[0:3], 0
s_add_u32 m0, s29, 7936
v_mfma_f32_16x16x32_bf16 v[196:199], v[228:231], v[32:35], 0
v_mfma_f32_16x16x32_bf16 v[200:203], v[228:231], v[64:67], 0
buffer_load_dwordx4 v246, s[12:15], s30 offen offset:256 nt lds
v_mfma_f32_16x16x32_bf16 v[204:207], v[228:231], v[96:99], 0
s_waitcnt lgkmcnt(1)
v_exp_f32 v176, v176
v_mfma_f32_16x16x32_bf16 v[208:211], v[228:231], v[232:235], 0
v_exp_f32 v177, v177
v_mfma_f32_16x16x32_bf16 v[192:195], v[212:215], v[4:7], v[192:195]
ds_read_b128 v[228:231], v237 offset:22528
v_add_f32 v248, v248, v176
v_mfma_f32_16x16x32_bf16 v[196:199], v[212:215], v[36:39], v[196:199]
v_exp_f32 v178, v178
v_mfma_f32_16x16x32_bf16 v[200:203], v[212:215], v[68:71], v[200:203]
v_exp_f32 v179, v179
v_mfma_f32_16x16x32_bf16 v[204:207], v[212:215], v[100:103], v[204:207]
v_exp_f32 v180, v180
v_mfma_f32_16x16x32_bf16 v[208:211], v[212:215], v[216:219], v[208:211]
ds_read_b128 v[232:235], v243 offset:2048
v_add_f32 v248, v248, v177
v_mfma_f32_16x16x32_bf16 v[192:195], v[220:223], v[8:11], v[192:195]
ds_read_b128 v[212:215], v236 offset:26624
v_add_f32 v248, v248, v178
v_mfma_f32_16x16x32_bf16 v[196:199], v[220:223], v[40:43], v[196:199]
v_exp_f32 v181, v181
v_mfma_f32_16x16x32_bf16 v[200:203], v[220:223], v[72:75], v[200:203]
v_exp_f32 v182, v182
v_mfma_f32_16x16x32_bf16 v[204:207], v[220:223], v[104:107], v[204:207]
s_waitcnt lgkmcnt(2)
v_exp_f32 v183, v183
v_mfma_f32_16x16x32_bf16 v[208:211], v[220:223], v[224:227], v[208:211]
ds_read_b128 v[216:219], v242 offset:4096
v_add_f32 v248, v248, v179
v_mfma_f32_16x16x32_bf16 v[192:195], v[228:231], v[12:15], v[192:195]
ds_read_b128 v[220:223], v237 offset:26624
v_cvt_pk_bf16_f32 v176, v176, v177
v_mfma_f32_16x16x32_bf16 v[196:199], v[228:231], v[44:47], v[196:199]
ds_read_b128 v[224:227], v243 offset:4096
s_add_u32 m0, s29, 11904
v_mfma_f32_16x16x32_bf16 v[200:203], v[228:231], v[76:79], v[200:203]
v_exp_f32 v184, v184
v_mfma_f32_16x16x32_bf16 v[204:207], v[228:231], v[108:111], v[204:207]
s_waitcnt lgkmcnt(3)
buffer_load_dwordx4 v246, s[12:15], s30 offen offset:384 nt lds
v_mfma_f32_16x16x32_bf16 v[208:211], v[228:231], v[232:235], v[208:211]
v_exp_f32 v185, v185
v_mfma_f32_16x16x32_bf16 v[192:195], v[212:215], v[16:19], v[192:195]
ds_read_b128 v[228:231], v236 offset:30720
v_cvt_pk_bf16_f32 v177, v178, v179
v_mfma_f32_16x16x32_bf16 v[196:199], v[212:215], v[48:51], v[196:199]
v_exp_f32 v186, v186
v_mfma_f32_16x16x32_bf16 v[200:203], v[212:215], v[80:83], v[200:203]
v_exp_f32 v187, v187
v_mfma_f32_16x16x32_bf16 v[204:207], v[212:215], v[112:115], v[204:207]
s_waitcnt lgkmcnt(2)
v_exp_f32 v188, v188
v_mfma_f32_16x16x32_bf16 v[208:211], v[212:215], v[216:219], v[208:211]
ds_read_b128 v[232:235], v242 offset:6144
v_add_f32 v249, v249, v180
v_mfma_f32_16x16x32_bf16 v[192:195], v[220:223], v[20:23], v[192:195]
ds_read_b128 v[212:215], v237 offset:30720
v_add_f32 v249, v249, v181
v_mfma_f32_16x16x32_bf16 v[196:199], v[220:223], v[52:55], v[196:199]
v_exp_f32 v189, v189
v_mfma_f32_16x16x32_bf16 v[200:203], v[220:223], v[84:87], v[200:203]
v_exp_f32 v190, v190
v_mfma_f32_16x16x32_bf16 v[204:207], v[220:223], v[116:119], v[204:207]
s_waitcnt lgkmcnt(2)
v_exp_f32 v191, v191
v_mfma_f32_16x16x32_bf16 v[208:211], v[220:223], v[224:227], v[208:211]
ds_read_b128 v[216:219], v243 offset:6144
v_add_f32 v249, v249, v182
v_mfma_f32_16x16x32_bf16 v[192:195], v[228:231], v[24:27], v[192:195]
ds_read_b64_tr_b16 v[220:221], v239 offset:49152
v_add_f32 v249, v249, v183
v_mfma_f32_16x16x32_bf16 v[196:199], v[228:231], v[56:59], v[196:199]
ds_read_b64_tr_b16 v[222:223], v239 offset:51200
v_cvt_pk_bf16_f32 v180, v180, v181
v_mfma_f32_16x16x32_bf16 v[200:203], v[228:231], v[88:91], v[200:203]
ds_read_b64_tr_b16 v[224:225], v239 offset:53248
s_add_u32 m0, s29, 98304
v_mfma_f32_16x16x32_bf16 v[204:207], v[228:231], v[120:123], v[204:207]
s_waitcnt lgkmcnt(4)
ds_read_b64_tr_b16 v[226:227], v239 offset:55296
v_cvt_pk_bf16_f32 v181, v182, v183
v_mfma_f32_16x16x32_bf16 v[208:211], v[228:231], v[232:235], v[208:211]
buffer_load_dwordx4 v247, s[16:19], s30 offen offset:0 nt lds
v_mfma_f32_16x16x32_bf16 v[192:195], v[212:215], v[28:31], v[192:195]
ds_read_b64_tr_b16 v[228:229], v239 offset:57344
v_add_f32 v250, v250, v184
v_mfma_f32_16x16x32_bf16 v[196:199], v[212:215], v[60:63], v[196:199]
ds_read_b64_tr_b16 v[230:231], v239 offset:59392
v_add_f32 v250, v250, v185
v_mfma_f32_16x16x32_bf16 v[200:203], v[212:215], v[92:95], v[200:203]
ds_read_b64_tr_b16 v[232:233], v239 offset:61440
v_add_f32 v250, v250, v186
v_mfma_f32_16x16x32_bf16 v[204:207], v[212:215], v[124:127], v[204:207]
s_waitcnt lgkmcnt(7)
ds_read_b64_tr_b16 v[234:235], v239 offset:63488
v_add_f32 v250, v250, v187
v_mfma_f32_16x16x32_bf16 v[208:211], v[212:215], v[216:219], v[208:211]
s_waitcnt lgkmcnt(6)
v_cvt_pk_bf16_f32 v184, v184, v185
v_cvt_pk_bf16_f32 v185, v186, v187
v_mfma_f32_16x16x32_bf16 a[16:19], v[220:223], v[160:163], a[16:19]
ds_read_b128 v[212:215], v244 offset:0
v_add_f32 v251, v251, v188
v_mfma_f32_16x16x32_bf16 a[20:23], v[220:223], v[164:167], a[20:23]
ds_read_b128 v[216:219], v244 offset:1024
v_add_f32 v251, v251, v189
v_mfma_f32_16x16x32_bf16 a[24:27], v[220:223], v[168:171], a[24:27]
v_exp_f32 v208, v208
v_mfma_f32_16x16x32_bf16 a[28:31], v[220:223], v[172:175], a[28:31]
s_waitcnt lgkmcnt(6)
ds_read_b64_tr_b16 v[220:221], v238 offset:49152
v_add_f32 v251, v251, v190
v_mfma_f32_16x16x32_bf16 a[80:83], v[224:227], v[160:163], a[80:83]
ds_read_b64_tr_b16 v[222:223], v238 offset:51200
v_add_f32 v251, v251, v191
v_mfma_f32_16x16x32_bf16 a[84:87], v[224:227], v[164:167], a[84:87]
v_exp_f32 v209, v209
v_mfma_f32_16x16x32_bf16 a[88:91], v[224:227], v[168:171], a[88:91]
v_exp_f32 v210, v210
v_mfma_f32_16x16x32_bf16 a[92:95], v[224:227], v[172:175], a[92:95]
s_waitcnt lgkmcnt(4)
ds_read_b64_tr_b16 v[224:225], v238 offset:53248
v_cvt_pk_bf16_f32 v188, v188, v189
v_mfma_f32_16x16x32_bf16 a[144:147], v[228:231], v[160:163], a[144:147]
ds_read_b64_tr_b16 v[226:227], v238 offset:55296
s_add_u32 m0, s29, 102272
v_mfma_f32_16x16x32_bf16 a[148:151], v[228:231], v[164:167], a[148:151]
v_exp_f32 v211, v211
v_mfma_f32_16x16x32_bf16 a[152:155], v[228:231], v[168:171], a[152:155]
buffer_load_dwordx4 v247, s[16:19], s30 offen offset:128 nt lds
v_mfma_f32_16x16x32_bf16 a[156:159], v[228:231], v[172:175], a[156:159]
v_exp_f32 v192, v192
v_mfma_f32_16x16x32_bf16 a[208:211], v[232:235], v[160:163], a[208:211]
ds_read_b64_tr_b16 v[228:229], v238 offset:57344
v_cvt_pk_bf16_f32 v189, v190, v191
v_mfma_f32_16x16x32_bf16 a[212:215], v[232:235], v[164:167], a[212:215]
ds_read_b64_tr_b16 v[230:231], v238 offset:59392
v_add_f32 v252, v252, v208
v_mfma_f32_16x16x32_bf16 a[216:219], v[232:235], v[168:171], a[216:219]
v_exp_f32 v193, v193
v_mfma_f32_16x16x32_bf16 a[220:223], v[232:235], v[172:175], a[220:223]
s_waitcnt lgkmcnt(4)
v_exp_f32 v194, v194
v_mfma_f32_16x16x32_bf16 a[0:3], v[220:223], v[160:163], a[0:3]
v_exp_f32 v195, v195
v_mfma_f32_16x16x32_bf16 a[4:7], v[220:223], v[164:167], a[4:7]
v_exp_f32 v196, v196
v_mfma_f32_16x16x32_bf16 v[128:131], v[220:223], v[212:215], v[128:131]
ds_read_b64_tr_b16 v[232:233], v238 offset:61440
v_add_f32 v252, v252, v209
v_mfma_f32_16x16x32_bf16 a[8:11], v[220:223], v[168:171], a[8:11]
ds_read_b64_tr_b16 v[234:235], v238 offset:63488
v_add_f32 v252, v252, v210
v_mfma_f32_16x16x32_bf16 v[132:135], v[220:223], v[216:219], v[132:135]
v_exp_f32 v197, v197
v_mfma_f32_16x16x32_bf16 a[12:15], v[220:223], v[172:175], a[12:15]
s_waitcnt lgkmcnt(2)
v_exp_f32 v198, v198
v_mfma_f32_16x16x32_bf16 a[64:67], v[224:227], v[160:163], a[64:67]
v_exp_f32 v199, v199
v_mfma_f32_16x16x32_bf16 a[68:71], v[224:227], v[164:167], a[68:71]
v_exp_f32 v200, v200
v_mfma_f32_16x16x32_bf16 v[136:139], v[224:227], v[212:215], v[136:139]
ds_read_b64_tr_b16 v[220:221], v240 offset:49152
s_add_u32 m0, s29, 106240
v_mfma_f32_16x16x32_bf16 a[72:75], v[224:227], v[168:171], a[72:75]
ds_read_b64_tr_b16 v[222:223], v240 offset:51200
v_add_f32 v252, v252, v211
v_mfma_f32_16x16x32_bf16 v[140:143], v[224:227], v[216:219], v[140:143]
buffer_load_dwordx4 v247, s[16:19], s30 offen offset:256 nt lds
v_mfma_f32_16x16x32_bf16 a[76:79], v[224:227], v[172:175], a[76:79]
v_exp_f32 v201, v201
v_mfma_f32_16x16x32_bf16 a[128:131], v[228:231], v[160:163], a[128:131]
ds_read_b64_tr_b16 v[224:225], v240 offset:53248
v_cvt_pk_bf16_f32 v208, v208, v209
v_mfma_f32_16x16x32_bf16 a[132:135], v[228:231], v[164:167], a[132:135]
ds_read_b64_tr_b16 v[226:227], v240 offset:55296
v_cvt_pk_bf16_f32 v209, v210, v211
v_mfma_f32_16x16x32_bf16 v[144:147], v[228:231], v[212:215], v[144:147]
ds_write_b64 v245, v[208:209] offset:2048
v_mfma_f32_16x16x32_bf16 a[136:139], v[228:231], v[168:171], a[136:139]
v_exp_f32 v202, v202
v_mfma_f32_16x16x32_bf16 v[148:151], v[228:231], v[216:219], v[148:151]
v_exp_f32 v203, v203
v_mfma_f32_16x16x32_bf16 a[140:143], v[228:231], v[172:175], a[140:143]
s_waitcnt lgkmcnt(3)
v_exp_f32 v204, v204
v_mfma_f32_16x16x32_bf16 a[192:195], v[232:235], v[160:163], a[192:195]
v_exp_f32 v205, v205
v_mfma_f32_16x16x32_bf16 a[196:199], v[232:235], v[164:167], a[196:199]
v_exp_f32 v206, v206
v_mfma_f32_16x16x32_bf16 v[152:155], v[232:235], v[212:215], v[152:155]
v_exp_f32 v207, v207
v_mfma_f32_16x16x32_bf16 a[200:203], v[232:235], v[168:171], a[200:203]
ds_read_b64_tr_b16 v[228:229], v240 offset:57344
v_add_f32 v248, v248, v192
v_mfma_f32_16x16x32_bf16 v[156:159], v[232:235], v[216:219], v[156:159]
ds_read_b64_tr_b16 v[230:231], v240 offset:59392
v_add_f32 v248, v248, v193
v_mfma_f32_16x16x32_bf16 a[204:207], v[232:235], v[172:175], a[204:207]
ds_read_b64_tr_b16 v[232:233], v240 offset:61440
v_add_f32 v248, v248, v194
v_mfma_f32_16x16x32_bf16 a[32:35], v[220:223], v[160:163], a[32:35]
ds_read_b64_tr_b16 v[234:235], v240 offset:63488
s_add_u32 m0, s29, 110208
v_mfma_f32_16x16x32_bf16 a[36:39], v[220:223], v[164:167], a[36:39]
v_add_f32 v248, v248, v195
v_cvt_pk_bf16_f32 v178, v192, v193
v_mfma_f32_16x16x32_bf16 a[40:43], v[220:223], v[168:171], a[40:43]
buffer_load_dwordx4 v247, s[16:19], s30 offen offset:384 nt lds
v_mfma_f32_16x16x32_bf16 a[44:47], v[220:223], v[172:175], a[44:47]
s_waitcnt lgkmcnt(5)
ds_read_b64_tr_b16 v[220:221], v241 offset:49152
v_cvt_pk_bf16_f32 v179, v194, v195
v_mfma_f32_16x16x32_bf16 a[96:99], v[224:227], v[160:163], a[96:99]
ds_read_b64_tr_b16 v[222:223], v241 offset:51200
s_add_u32 s30, s30, 16384
v_mfma_f32_16x16x32_bf16 a[100:103], v[224:227], v[164:167], a[100:103]
v_add_f32 v249, v249, v196
v_add_f32 v249, v249, v197
v_mfma_f32_16x16x32_bf16 a[104:107], v[224:227], v[168:171], a[104:107]
v_add_f32 v249, v249, v198
v_add_f32 v249, v249, v199
v_mfma_f32_16x16x32_bf16 a[108:111], v[224:227], v[172:175], a[108:111]
s_waitcnt lgkmcnt(4)
ds_read_b64_tr_b16 v[224:225], v241 offset:53248
v_cvt_pk_bf16_f32 v182, v196, v197
v_mfma_f32_16x16x32_bf16 a[160:163], v[228:231], v[160:163], a[160:163]
ds_read_b64_tr_b16 v[226:227], v241 offset:55296
v_cvt_pk_bf16_f32 v183, v198, v199
v_mfma_f32_16x16x32_bf16 a[164:167], v[228:231], v[164:167], a[164:167]
v_add_f32 v250, v250, v200
v_add_f32 v250, v250, v201
v_mfma_f32_16x16x32_bf16 a[168:171], v[228:231], v[168:171], a[168:171]
v_add_f32 v250, v250, v202
v_add_f32 v250, v250, v203
v_mfma_f32_16x16x32_bf16 a[172:175], v[228:231], v[172:175], a[172:175]
s_waitcnt lgkmcnt(4)
ds_read_b64_tr_b16 v[228:229], v241 offset:57344
v_cvt_pk_bf16_f32 v186, v200, v201
v_mfma_f32_16x16x32_bf16 a[224:227], v[232:235], v[160:163], a[224:227]
ds_read_b64_tr_b16 v[230:231], v241 offset:59392
v_cvt_pk_bf16_f32 v187, v202, v203
v_mfma_f32_16x16x32_bf16 a[228:231], v[232:235], v[164:167], a[228:231]
v_add_f32 v251, v251, v204
v_add_f32 v251, v251, v205
v_mfma_f32_16x16x32_bf16 a[232:235], v[232:235], v[168:171], a[232:235]
v_add_f32 v251, v251, v206
v_add_f32 v251, v251, v207
v_mfma_f32_16x16x32_bf16 a[236:239], v[232:235], v[172:175], a[236:239]
s_waitcnt lgkmcnt(4)
ds_read_b64_tr_b16 v[232:233], v241 offset:61440
v_cvt_pk_bf16_f32 v190, v204, v205
v_mfma_f32_16x16x32_bf16 a[48:51], v[220:223], v[160:163], a[48:51]
ds_read_b64_tr_b16 v[234:235], v241 offset:63488
v_cvt_pk_bf16_f32 v191, v206, v207
v_mfma_f32_16x16x32_bf16 a[52:55], v[220:223], v[164:167], a[52:55]
v_mfma_f32_16x16x32_bf16 a[56:59], v[220:223], v[168:171], a[56:59]
s_add_u32 s42, s42, 1024
s_mov_b32 m0, 161792
v_mfma_f32_16x16x32_bf16 a[60:63], v[220:223], v[172:175], a[60:63]
s_waitcnt lgkmcnt(4)
buffer_load_dwordx4 v253, s[20:23], s42 offen lds
v_mfma_f32_16x16x32_bf16 a[112:115], v[224:227], v[160:163], a[112:115]
ds_read_b128 v[220:223], v236 offset:32768
v_mfma_f32_16x16x32_bf16 a[116:119], v[224:227], v[164:167], a[116:119]
v_mfma_f32_16x16x32_bf16 a[120:123], v[224:227], v[168:171], a[120:123]
v_mfma_f32_16x16x32_bf16 a[124:127], v[224:227], v[172:175], a[124:127]
s_waitcnt lgkmcnt(3)
ds_read_b128 v[224:227], v237 offset:32768
v_mfma_f32_16x16x32_bf16 a[176:179], v[228:231], v[160:163], a[176:179]
v_mfma_f32_16x16x32_bf16 a[180:183], v[228:231], v[164:167], a[180:183]
v_mfma_f32_16x16x32_bf16 a[184:187], v[228:231], v[168:171], a[184:187]
v_mfma_f32_16x16x32_bf16 a[188:191], v[228:231], v[172:175], a[188:191]
s_waitcnt lgkmcnt(2)
ds_read_b128 v[228:231], v236 offset:36864
v_mfma_f32_16x16x32_bf16 a[240:243], v[232:235], v[160:163], a[240:243]
v_mfma_f32_16x16x32_bf16 a[244:247], v[232:235], v[164:167], a[244:247]
v_mfma_f32_16x16x32_bf16 a[248:251], v[232:235], v[168:171], a[248:251]
v_mfma_f32_16x16x32_bf16 a[252:255], v[232:235], v[172:175], a[252:255]
s_waitcnt vmcnt(16) lgkmcnt(3)
s_barrier
L_body1_1:
s_waitcnt lgkmcnt(2)
v_mfma_f32_16x16x32_bf16 v[160:163], v[220:223], v[0:3], 0
ds_read_b128 v[232:235], v237 offset:36864
s_add_u32 m0, s29, 16384
v_mfma_f32_16x16x32_bf16 v[164:167], v[220:223], v[32:35], 0
ds_read_b128 v[212:215], v236 offset:40960
v_mfma_f32_16x16x32_bf16 v[168:171], v[220:223], v[64:67], 0
buffer_load_dwordx4 v246, s[12:15], s30 offen offset:0 nt lds
v_mfma_f32_16x16x32_bf16 v[172:175], v[220:223], v[96:99], 0
s_waitcnt lgkmcnt(3)
v_mfma_f32_16x16x32_bf16 v[160:163], v[224:227], v[4:7], v[160:163]
ds_read_b128 v[216:219], v237 offset:40960
v_mfma_f32_16x16x32_bf16 v[164:167], v[224:227], v[36:39], v[164:167]
v_mfma_f32_16x16x32_bf16 v[168:171], v[224:227], v[68:71], v[168:171]
v_mfma_f32_16x16x32_bf16 v[172:175], v[224:227], v[100:103], v[172:175]
s_waitcnt lgkmcnt(3)
v_mfma_f32_16x16x32_bf16 v[160:163], v[228:231], v[8:11], v[160:163]
ds_read_b128 v[220:223], v236 offset:45056
v_mfma_f32_16x16x32_bf16 v[164:167], v[228:231], v[40:43], v[164:167]
v_mfma_f32_16x16x32_bf16 v[168:171], v[228:231], v[72:75], v[168:171]
v_mfma_f32_16x16x32_bf16 v[172:175], v[228:231], v[104:107], v[172:175]
s_waitcnt lgkmcnt(2)
v_mfma_f32_16x16x32_bf16 v[160:163], v[232:235], v[12:15], v[160:163]
ds_read_b128 v[224:227], v237 offset:45056
v_mfma_f32_16x16x32_bf16 v[164:167], v[232:235], v[44:47], v[164:167]
v_mfma_f32_16x16x32_bf16 v[168:171], v[232:235], v[76:79], v[168:171]
v_mfma_f32_16x16x32_bf16 v[172:175], v[232:235], v[108:111], v[172:175]
v_mfma_f32_16x16x32_bf16 v[160:163], v[212:215], v[16:19], v[160:163]
ds_read_b128 v[228:231], v236 offset:34816
s_add_u32 m0, s29, 20352
v_mfma_f32_16x16x32_bf16 v[164:167], v[212:215], v[48:51], v[164:167]
v_mfma_f32_16x16x32_bf16 v[168:171], v[212:215], v[80:83], v[168:171]
buffer_load_dwordx4 v246, s[12:15], s30 offen offset:128 nt lds
v_mfma_f32_16x16x32_bf16 v[172:175], v[212:215], v[112:115], v[172:175]
s_waitcnt lgkmcnt(2)
v_mfma_f32_16x16x32_bf16 v[160:163], v[216:219], v[20:23], v[160:163]
ds_read_b128 v[232:235], v242 offset:0
v_mfma_f32_16x16x32_bf16 v[164:167], v[216:219], v[52:55], v[164:167]
ds_read_b128 v[212:215], v237 offset:34816
v_mfma_f32_16x16x32_bf16 v[168:171], v[216:219], v[84:87], v[168:171]
v_mfma_f32_16x16x32_bf16 v[172:175], v[216:219], v[116:119], v[172:175]
v_mfma_f32_16x16x32_bf16 v[160:163], v[220:223], v[24:27], v[160:163]
v_mfma_f32_16x16x32_bf16 v[164:167], v[220:223], v[56:59], v[164:167]
ds_read_b128 v[216:219], v243 offset:0
v_mfma_f32_16x16x32_bf16 v[168:171], v[220:223], v[88:91], v[168:171]
v_mfma_f32_16x16x32_bf16 v[172:175], v[220:223], v[120:123], v[172:175]
s_waitcnt lgkmcnt(3)
ds_read_b128 v[220:223], v236 offset:38912
v_mfma_f32_16x16x32_bf16 v[160:163], v[224:227], v[28:31], v[160:163]
v_mfma_f32_16x16x32_bf16 v[164:167], v[224:227], v[60:63], v[164:167]
v_mfma_f32_16x16x32_bf16 v[168:171], v[224:227], v[92:95], v[168:171]
v_mfma_f32_16x16x32_bf16 v[172:175], v[224:227], v[124:127], v[172:175]
ds_read_b128 v[224:227], v242 offset:2048
v_mfma_f32_16x16x32_bf16 v[192:195], v[228:231], v[0:3], 0
s_add_u32 m0, s29, 24320
v_mfma_f32_16x16x32_bf16 v[196:199], v[228:231], v[32:35], 0
v_mfma_f32_16x16x32_bf16 v[200:203], v[228:231], v[64:67], 0
buffer_load_dwordx4 v246, s[12:15], s30 offen offset:256 nt lds
v_mfma_f32_16x16x32_bf16 v[204:207], v[228:231], v[96:99], 0
s_waitcnt lgkmcnt(1)
v_exp_f32 v160, v160
v_mfma_f32_16x16x32_bf16 v[208:211], v[228:231], v[232:235], 0
v_exp_f32 v161, v161
v_mfma_f32_16x16x32_bf16 v[192:195], v[212:215], v[4:7], v[192:195]
ds_read_b128 v[228:231], v237 offset:38912
v_add_f32 v248, v248, v160
v_mfma_f32_16x16x32_bf16 v[196:199], v[212:215], v[36:39], v[196:199]
v_exp_f32 v162, v162
v_mfma_f32_16x16x32_bf16 v[200:203], v[212:215], v[68:71], v[200:203]
v_exp_f32 v163, v163
v_mfma_f32_16x16x32_bf16 v[204:207], v[212:215], v[100:103], v[204:207]
v_exp_f32 v164, v164
v_mfma_f32_16x16x32_bf16 v[208:211], v[212:215], v[216:219], v[208:211]
ds_read_b128 v[232:235], v243 offset:2048
v_add_f32 v248, v248, v161
v_mfma_f32_16x16x32_bf16 v[192:195], v[220:223], v[8:11], v[192:195]
ds_read_b128 v[212:215], v236 offset:43008
v_add_f32 v248, v248, v162
v_mfma_f32_16x16x32_bf16 v[196:199], v[220:223], v[40:43], v[196:199]
v_exp_f32 v165, v165
v_mfma_f32_16x16x32_bf16 v[200:203], v[220:223], v[72:75], v[200:203]
v_exp_f32 v166, v166
v_mfma_f32_16x16x32_bf16 v[204:207], v[220:223], v[104:107], v[204:207]
s_waitcnt lgkmcnt(2)
v_exp_f32 v167, v167
v_mfma_f32_16x16x32_bf16 v[208:211], v[220:223], v[224:227], v[208:211]
ds_read_b128 v[216:219], v242 offset:4096
v_add_f32 v248, v248, v163
v_mfma_f32_16x16x32_bf16 v[192:195], v[228:231], v[12:15], v[192:195]
ds_read_b128 v[220:223], v237 offset:43008
v_cvt_pk_bf16_f32 v160, v160, v161
v_mfma_f32_16x16x32_bf16 v[196:199], v[228:231], v[44:47], v[196:199]
ds_read_b128 v[224:227], v243 offset:4096
s_add_u32 m0, s29, 28288
v_mfma_f32_16x16x32_bf16 v[200:203], v[228:231], v[76:79], v[200:203]
v_exp_f32 v168, v168
v_mfma_f32_16x16x32_bf16 v[204:207], v[228:231], v[108:111], v[204:207]
s_waitcnt lgkmcnt(3)
buffer_load_dwordx4 v246, s[12:15], s30 offen offset:384 nt lds
v_mfma_f32_16x16x32_bf16 v[208:211], v[228:231], v[232:235], v[208:211]
v_exp_f32 v169, v169
v_mfma_f32_16x16x32_bf16 v[192:195], v[212:215], v[16:19], v[192:195]
ds_read_b128 v[228:231], v236 offset:47104
v_cvt_pk_bf16_f32 v161, v162, v163
v_mfma_f32_16x16x32_bf16 v[196:199], v[212:215], v[48:51], v[196:199]
v_exp_f32 v170, v170
v_mfma_f32_16x16x32_bf16 v[200:203], v[212:215], v[80:83], v[200:203]
v_exp_f32 v171, v171
v_mfma_f32_16x16x32_bf16 v[204:207], v[212:215], v[112:115], v[204:207]
s_waitcnt lgkmcnt(2)
v_exp_f32 v172, v172
v_mfma_f32_16x16x32_bf16 v[208:211], v[212:215], v[216:219], v[208:211]
ds_read_b128 v[232:235], v242 offset:6144
v_add_f32 v249, v249, v164
v_mfma_f32_16x16x32_bf16 v[192:195], v[220:223], v[20:23], v[192:195]
ds_read_b128 v[212:215], v237 offset:47104
v_add_f32 v249, v249, v165
v_mfma_f32_16x16x32_bf16 v[196:199], v[220:223], v[52:55], v[196:199]
v_exp_f32 v173, v173
v_mfma_f32_16x16x32_bf16 v[200:203], v[220:223], v[84:87], v[200:203]
v_exp_f32 v174, v174
v_mfma_f32_16x16x32_bf16 v[204:207], v[220:223], v[116:119], v[204:207]
s_waitcnt lgkmcnt(2)
v_exp_f32 v175, v175
v_mfma_f32_16x16x32_bf16 v[208:211], v[220:223], v[224:227], v[208:211]
ds_read_b128 v[216:219], v243 offset:6144
v_add_f32 v249, v249, v166
v_mfma_f32_16x16x32_bf16 v[192:195], v[228:231], v[24:27], v[192:195]
ds_read_b64_tr_b16 v[220:221], v239 offset:0
v_add_f32 v249, v249, v167
v_mfma_f32_16x16x32_bf16 v[196:199], v[228:231], v[56:59], v[196:199]
ds_read_b64_tr_b16 v[222:223], v239 offset:2048
v_cvt_pk_bf16_f32 v164, v164, v165
v_mfma_f32_16x16x32_bf16 v[200:203], v[228:231], v[88:91], v[200:203]
ds_read_b64_tr_b16 v[224:225], v239 offset:4096
s_add_u32 m0, s29, 114688
v_mfma_f32_16x16x32_bf16 v[204:207], v[228:231], v[120:123], v[204:207]
s_waitcnt lgkmcnt(4)
ds_read_b64_tr_b16 v[226:227], v239 offset:6144
v_cvt_pk_bf16_f32 v165, v166, v167
v_mfma_f32_16x16x32_bf16 v[208:211], v[228:231], v[232:235], v[208:211]
buffer_load_dwordx4 v247, s[16:19], s30 offen offset:0 nt lds
v_mfma_f32_16x16x32_bf16 v[192:195], v[212:215], v[28:31], v[192:195]
ds_read_b64_tr_b16 v[228:229], v239 offset:8192
v_add_f32 v250, v250, v168
v_mfma_f32_16x16x32_bf16 v[196:199], v[212:215], v[60:63], v[196:199]
ds_read_b64_tr_b16 v[230:231], v239 offset:10240
v_add_f32 v250, v250, v169
v_mfma_f32_16x16x32_bf16 v[200:203], v[212:215], v[92:95], v[200:203]
ds_read_b64_tr_b16 v[232:233], v239 offset:12288
v_add_f32 v250, v250, v170
v_mfma_f32_16x16x32_bf16 v[204:207], v[212:215], v[124:127], v[204:207]
s_waitcnt lgkmcnt(7)
ds_read_b64_tr_b16 v[234:235], v239 offset:14336
v_add_f32 v250, v250, v171
v_mfma_f32_16x16x32_bf16 v[208:211], v[212:215], v[216:219], v[208:211]
s_waitcnt lgkmcnt(6)
v_cvt_pk_bf16_f32 v168, v168, v169
v_cvt_pk_bf16_f32 v169, v170, v171
v_mfma_f32_16x16x32_bf16 a[16:19], v[220:223], v[176:179], a[16:19]
ds_read_b128 v[212:215], v244 offset:2048
v_add_f32 v251, v251, v172
v_mfma_f32_16x16x32_bf16 a[20:23], v[220:223], v[180:183], a[20:23]
ds_read_b128 v[216:219], v244 offset:3072
v_add_f32 v251, v251, v173
v_mfma_f32_16x16x32_bf16 a[24:27], v[220:223], v[184:187], a[24:27]
v_exp_f32 v208, v208
v_mfma_f32_16x16x32_bf16 a[28:31], v[220:223], v[188:191], a[28:31]
s_waitcnt lgkmcnt(6)
ds_read_b64_tr_b16 v[220:221], v238 offset:0
v_add_f32 v251, v251, v174
v_mfma_f32_16x16x32_bf16 a[80:83], v[224:227], v[176:179], a[80:83]
ds_read_b64_tr_b16 v[222:223], v238 offset:2048
v_add_f32 v251, v251, v175
v_mfma_f32_16x16x32_bf16 a[84:87], v[224:227], v[180:183], a[84:87]
v_exp_f32 v209, v209
v_mfma_f32_16x16x32_bf16 a[88:91], v[224:227], v[184:187], a[88:91]
v_exp_f32 v210, v210
v_mfma_f32_16x16x32_bf16 a[92:95], v[224:227], v[188:191], a[92:95]
s_waitcnt lgkmcnt(4)
ds_read_b64_tr_b16 v[224:225], v238 offset:4096
v_cvt_pk_bf16_f32 v172, v172, v173
v_mfma_f32_16x16x32_bf16 a[144:147], v[228:231], v[176:179], a[144:147]
ds_read_b64_tr_b16 v[226:227], v238 offset:6144
s_add_u32 m0, s29, 118656
v_mfma_f32_16x16x32_bf16 a[148:151], v[228:231], v[180:183], a[148:151]
v_exp_f32 v211, v211
v_mfma_f32_16x16x32_bf16 a[152:155], v[228:231], v[184:187], a[152:155]
buffer_load_dwordx4 v247, s[16:19], s30 offen offset:128 nt lds
v_mfma_f32_16x16x32_bf16 a[156:159], v[228:231], v[188:191], a[156:159]
v_exp_f32 v192, v192
v_mfma_f32_16x16x32_bf16 a[208:211], v[232:235], v[176:179], a[208:211]
ds_read_b64_tr_b16 v[228:229], v238 offset:8192
v_cvt_pk_bf16_f32 v173, v174, v175
v_mfma_f32_16x16x32_bf16 a[212:215], v[232:235], v[180:183], a[212:215]
ds_read_b64_tr_b16 v[230:231], v238 offset:10240
v_add_f32 v252, v252, v208
v_mfma_f32_16x16x32_bf16 a[216:219], v[232:235], v[184:187], a[216:219]
v_exp_f32 v193, v193
v_mfma_f32_16x16x32_bf16 a[220:223], v[232:235], v[188:191], a[220:223]
s_waitcnt lgkmcnt(4)
v_exp_f32 v194, v194
v_mfma_f32_16x16x32_bf16 a[0:3], v[220:223], v[176:179], a[0:3]
v_exp_f32 v195, v195
v_mfma_f32_16x16x32_bf16 a[4:7], v[220:223], v[180:183], a[4:7]
v_exp_f32 v196, v196
v_mfma_f32_16x16x32_bf16 v[128:131], v[220:223], v[212:215], v[128:131]
ds_read_b64_tr_b16 v[232:233], v238 offset:12288
v_add_f32 v252, v252, v209
v_mfma_f32_16x16x32_bf16 a[8:11], v[220:223], v[184:187], a[8:11]
ds_read_b64_tr_b16 v[234:235], v238 offset:14336
v_add_f32 v252, v252, v210
v_mfma_f32_16x16x32_bf16 v[132:135], v[220:223], v[216:219], v[132:135]
v_exp_f32 v197, v197
v_mfma_f32_16x16x32_bf16 a[12:15], v[220:223], v[188:191], a[12:15]
s_waitcnt lgkmcnt(2)
v_exp_f32 v198, v198
v_mfma_f32_16x16x32_bf16 a[64:67], v[224:227], v[176:179], a[64:67]
v_exp_f32 v199, v199
v_mfma_f32_16x16x32_bf16 a[68:71], v[224:227], v[180:183], a[68:71]
v_exp_f32 v200, v200
v_mfma_f32_16x16x32_bf16 v[136:139], v[224:227], v[212:215], v[136:139]
ds_read_b64_tr_b16 v[220:221], v240 offset:0
s_add_u32 m0, s29, 122624
v_mfma_f32_16x16x32_bf16 a[72:75], v[224:227], v[184:187], a[72:75]
ds_read_b64_tr_b16 v[222:223], v240 offset:2048
v_add_f32 v252, v252, v211
v_mfma_f32_16x16x32_bf16 v[140:143], v[224:227], v[216:219], v[140:143]
buffer_load_dwordx4 v247, s[16:19], s30 offen offset:256 nt lds
v_mfma_f32_16x16x32_bf16 a[76:79], v[224:227], v[188:191], a[76:79]
v_exp_f32 v201, v201
v_mfma_f32_16x16x32_bf16 a[128:131], v[228:231], v[176:179], a[128:131]
ds_read_b64_tr_b16 v[224:225], v240 offset:4096
v_cvt_pk_bf16_f32 v208, v208, v209
v_mfma_f32_16x16x32_bf16 a[132:135], v[228:231], v[180:183], a[132:135]
ds_read_b64_tr_b16 v[226:227], v240 offset:6144
v_cvt_pk_bf16_f32 v209, v210, v211
v_mfma_f32_16x16x32_bf16 v[144:147], v[228:231], v[212:215], v[144:147]
ds_write_b64 v245, v[208:209] offset:0
v_mfma_f32_16x16x32_bf16 a[136:139], v[228:231], v[184:187], a[136:139]
v_exp_f32 v202, v202
v_mfma_f32_16x16x32_bf16 v[148:151], v[228:231], v[216:219], v[148:151]
v_exp_f32 v203, v203
v_mfma_f32_16x16x32_bf16 a[140:143], v[228:231], v[188:191], a[140:143]
s_waitcnt lgkmcnt(3)
v_exp_f32 v204, v204
v_mfma_f32_16x16x32_bf16 a[192:195], v[232:235], v[176:179], a[192:195]
v_exp_f32 v205, v205
v_mfma_f32_16x16x32_bf16 a[196:199], v[232:235], v[180:183], a[196:199]
v_exp_f32 v206, v206
v_mfma_f32_16x16x32_bf16 v[152:155], v[232:235], v[212:215], v[152:155]
v_exp_f32 v207, v207
v_mfma_f32_16x16x32_bf16 a[200:203], v[232:235], v[184:187], a[200:203]
ds_read_b64_tr_b16 v[228:229], v240 offset:8192
v_add_f32 v248, v248, v192
v_mfma_f32_16x16x32_bf16 v[156:159], v[232:235], v[216:219], v[156:159]
ds_read_b64_tr_b16 v[230:231], v240 offset:10240
v_add_f32 v248, v248, v193
v_mfma_f32_16x16x32_bf16 a[204:207], v[232:235], v[188:191], a[204:207]
ds_read_b64_tr_b16 v[232:233], v240 offset:12288
v_add_f32 v248, v248, v194
v_mfma_f32_16x16x32_bf16 a[32:35], v[220:223], v[176:179], a[32:35]
ds_read_b64_tr_b16 v[234:235], v240 offset:14336
s_add_u32 m0, s29, 126592
v_mfma_f32_16x16x32_bf16 a[36:39], v[220:223], v[180:183], a[36:39]
v_add_f32 v248, v248, v195
v_cvt_pk_bf16_f32 v162, v192, v193
v_mfma_f32_16x16x32_bf16 a[40:43], v[220:223], v[184:187], a[40:43]
buffer_load_dwordx4 v247, s[16:19], s30 offen offset:384 nt lds
v_mfma_f32_16x16x32_bf16 a[44:47], v[220:223], v[188:191], a[44:47]
s_waitcnt lgkmcnt(5)
ds_read_b64_tr_b16 v[220:221], v241 offset:0
v_cvt_pk_bf16_f32 v163, v194, v195
v_mfma_f32_16x16x32_bf16 a[96:99], v[224:227], v[176:179], a[96:99]
ds_read_b64_tr_b16 v[222:223], v241 offset:2048
s_add_u32 s30, s30, 16384
v_mfma_f32_16x16x32_bf16 a[100:103], v[224:227], v[180:183], a[100:103]
v_add_f32 v249, v249, v196
v_add_f32 v249, v249, v197
v_mfma_f32_16x16x32_bf16 a[104:107], v[224:227], v[184:187], a[104:107]
v_add_f32 v249, v249, v198
v_add_f32 v249, v249, v199
v_mfma_f32_16x16x32_bf16 a[108:111], v[224:227], v[188:191], a[108:111]
s_waitcnt lgkmcnt(4)
ds_read_b64_tr_b16 v[224:225], v241 offset:4096
v_cvt_pk_bf16_f32 v166, v196, v197
v_mfma_f32_16x16x32_bf16 a[160:163], v[228:231], v[176:179], a[160:163]
ds_read_b64_tr_b16 v[226:227], v241 offset:6144
v_cvt_pk_bf16_f32 v167, v198, v199
v_mfma_f32_16x16x32_bf16 a[164:167], v[228:231], v[180:183], a[164:167]
v_add_f32 v250, v250, v200
v_add_f32 v250, v250, v201
v_mfma_f32_16x16x32_bf16 a[168:171], v[228:231], v[184:187], a[168:171]
v_add_f32 v250, v250, v202
v_add_f32 v250, v250, v203
v_mfma_f32_16x16x32_bf16 a[172:175], v[228:231], v[188:191], a[172:175]
s_waitcnt lgkmcnt(4)
ds_read_b64_tr_b16 v[228:229], v241 offset:8192
v_cvt_pk_bf16_f32 v170, v200, v201
v_mfma_f32_16x16x32_bf16 a[224:227], v[232:235], v[176:179], a[224:227]
ds_read_b64_tr_b16 v[230:231], v241 offset:10240
v_cvt_pk_bf16_f32 v171, v202, v203
v_mfma_f32_16x16x32_bf16 a[228:231], v[232:235], v[180:183], a[228:231]
v_add_f32 v251, v251, v204
v_add_f32 v251, v251, v205
v_mfma_f32_16x16x32_bf16 a[232:235], v[232:235], v[184:187], a[232:235]
v_add_f32 v251, v251, v206
v_add_f32 v251, v251, v207
v_mfma_f32_16x16x32_bf16 a[236:239], v[232:235], v[188:191], a[236:239]
s_waitcnt lgkmcnt(4)
ds_read_b64_tr_b16 v[232:233], v241 offset:12288
v_cvt_pk_bf16_f32 v174, v204, v205
v_mfma_f32_16x16x32_bf16 a[48:51], v[220:223], v[176:179], a[48:51]
ds_read_b64_tr_b16 v[234:235], v241 offset:14336
v_cvt_pk_bf16_f32 v175, v206, v207
v_mfma_f32_16x16x32_bf16 a[52:55], v[220:223], v[180:183], a[52:55]
v_mfma_f32_16x16x32_bf16 a[56:59], v[220:223], v[184:187], a[56:59]
s_add_u32 s42, s42, 1024
s_mov_b32 m0, 161792
v_mfma_f32_16x16x32_bf16 a[60:63], v[220:223], v[188:191], a[60:63]
s_waitcnt lgkmcnt(4)
buffer_load_dwordx4 v253, s[20:23], s42 offen lds
v_mfma_f32_16x16x32_bf16 a[112:115], v[224:227], v[176:179], a[112:115]
ds_read_b128 v[220:223], v236 offset:49152
v_mfma_f32_16x16x32_bf16 a[116:119], v[224:227], v[180:183], a[116:119]
v_mfma_f32_16x16x32_bf16 a[120:123], v[224:227], v[184:187], a[120:123]
v_mfma_f32_16x16x32_bf16 a[124:127], v[224:227], v[188:191], a[124:127]
s_waitcnt lgkmcnt(3)
ds_read_b128 v[224:227], v237 offset:49152
v_mfma_f32_16x16x32_bf16 a[176:179], v[228:231], v[176:179], a[176:179]
v_mfma_f32_16x16x32_bf16 a[180:183], v[228:231], v[180:183], a[180:183]
v_mfma_f32_16x16x32_bf16 a[184:187], v[228:231], v[184:187], a[184:187]
v_mfma_f32_16x16x32_bf16 a[188:191], v[228:231], v[188:191], a[188:191]
s_waitcnt lgkmcnt(2)
ds_read_b128 v[228:231], v236 offset:53248
v_mfma_f32_16x16x32_bf16 a[240:243], v[232:235], v[176:179], a[240:243]
v_mfma_f32_16x16x32_bf16 a[244:247], v[232:235], v[180:183], a[244:247]
v_mfma_f32_16x16x32_bf16 a[248:251], v[232:235], v[184:187], a[248:251]
v_mfma_f32_16x16x32_bf16 a[252:255], v[232:235], v[188:191], a[252:255]
s_waitcnt vmcnt(16) lgkmcnt(3)
s_barrier
s_waitcnt lgkmcnt(2)
v_mfma_f32_16x16x32_bf16 v[176:179], v[220:223], v[0:3], 0
ds_read_b128 v[232:235], v237 offset:53248
s_add_u32 m0, s29, 32768
v_mfma_f32_16x16x32_bf16 v[180:183], v[220:223], v[32:35], 0
ds_read_b128 v[212:215], v236 offset:57344
v_mfma_f32_16x16x32_bf16 v[184:187], v[220:223], v[64:67], 0
buffer_load_dwordx4 v246, s[12:15], s30 offen offset:0 nt lds
v_mfma_f32_16x16x32_bf16 v[188:191], v[220:223], v[96:99], 0
s_waitcnt lgkmcnt(3)
v_mfma_f32_16x16x32_bf16 v[176:179], v[224:227], v[4:7], v[176:179]
ds_read_b128 v[216:219], v237 offset:57344
v_mfma_f32_16x16x32_bf16 v[180:183], v[224:227], v[36:39], v[180:183]
v_mfma_f32_16x16x32_bf16 v[184:187], v[224:227], v[68:71], v[184:187]
v_mfma_f32_16x16x32_bf16 v[188:191], v[224:227], v[100:103], v[188:191]
s_waitcnt lgkmcnt(3)
v_mfma_f32_16x16x32_bf16 v[176:179], v[228:231], v[8:11], v[176:179]
ds_read_b128 v[220:223], v236 offset:61440
v_mfma_f32_16x16x32_bf16 v[180:183], v[228:231], v[40:43], v[180:183]
v_mfma_f32_16x16x32_bf16 v[184:187], v[228:231], v[72:75], v[184:187]
v_mfma_f32_16x16x32_bf16 v[188:191], v[228:231], v[104:107], v[188:191]
s_waitcnt lgkmcnt(2)
v_mfma_f32_16x16x32_bf16 v[176:179], v[232:235], v[12:15], v[176:179]
ds_read_b128 v[224:227], v237 offset:61440
v_mfma_f32_16x16x32_bf16 v[180:183], v[232:235], v[44:47], v[180:183]
v_mfma_f32_16x16x32_bf16 v[184:187], v[232:235], v[76:79], v[184:187]
v_mfma_f32_16x16x32_bf16 v[188:191], v[232:235], v[108:111], v[188:191]
v_mfma_f32_16x16x32_bf16 v[176:179], v[212:215], v[16:19], v[176:179]
ds_read_b128 v[228:231], v236 offset:51200
s_add_u32 m0, s29, 36736
v_mfma_f32_16x16x32_bf16 v[180:183], v[212:215], v[48:51], v[180:183]
v_mfma_f32_16x16x32_bf16 v[184:187], v[212:215], v[80:83], v[184:187]
buffer_load_dwordx4 v246, s[12:15], s30 offen offset:128 nt lds
v_mfma_f32_16x16x32_bf16 v[188:191], v[212:215], v[112:115], v[188:191]
s_waitcnt lgkmcnt(2)
v_mfma_f32_16x16x32_bf16 v[176:179], v[216:219], v[20:23], v[176:179]
ds_read_b128 v[232:235], v242 offset:0
v_mfma_f32_16x16x32_bf16 v[180:183], v[216:219], v[52:55], v[180:183]
ds_read_b128 v[212:215], v237 offset:51200
v_mfma_f32_16x16x32_bf16 v[184:187], v[216:219], v[84:87], v[184:187]
v_mfma_f32_16x16x32_bf16 v[188:191], v[216:219], v[116:119], v[188:191]
v_mfma_f32_16x16x32_bf16 v[176:179], v[220:223], v[24:27], v[176:179]
v_mfma_f32_16x16x32_bf16 v[180:183], v[220:223], v[56:59], v[180:183]
ds_read_b128 v[216:219], v243 offset:0
v_mfma_f32_16x16x32_bf16 v[184:187], v[220:223], v[88:91], v[184:187]
v_mfma_f32_16x16x32_bf16 v[188:191], v[220:223], v[120:123], v[188:191]
s_waitcnt lgkmcnt(3)
ds_read_b128 v[220:223], v236 offset:55296
v_mfma_f32_16x16x32_bf16 v[176:179], v[224:227], v[28:31], v[176:179]
v_mfma_f32_16x16x32_bf16 v[180:183], v[224:227], v[60:63], v[180:183]
v_mfma_f32_16x16x32_bf16 v[184:187], v[224:227], v[92:95], v[184:187]
v_mfma_f32_16x16x32_bf16 v[188:191], v[224:227], v[124:127], v[188:191]
ds_read_b128 v[224:227], v242 offset:2048
v_mfma_f32_16x16x32_bf16 v[192:195], v[228:231], v[0:3], 0
s_add_u32 m0, s29, 40704
v_mfma_f32_16x16x32_bf16 v[196:199], v[228:231], v[32:35], 0
v_mfma_f32_16x16x32_bf16 v[200:203], v[228:231], v[64:67], 0
buffer_load_dwordx4 v246, s[12:15], s30 offen offset:256 nt lds
v_mfma_f32_16x16x32_bf16 v[204:207], v[228:231], v[96:99], 0
s_waitcnt lgkmcnt(1)
v_exp_f32 v176, v176
v_mfma_f32_16x16x32_bf16 v[208:211], v[228:231], v[232:235], 0
v_exp_f32 v177, v177
v_mfma_f32_16x16x32_bf16 v[192:195], v[212:215], v[4:7], v[192:195]
ds_read_b128 v[228:231], v237 offset:55296
v_add_f32 v248, v248, v176
v_mfma_f32_16x16x32_bf16 v[196:199], v[212:215], v[36:39], v[196:199]
v_exp_f32 v178, v178
v_mfma_f32_16x16x32_bf16 v[200:203], v[212:215], v[68:71], v[200:203]
v_exp_f32 v179, v179
v_mfma_f32_16x16x32_bf16 v[204:207], v[212:215], v[100:103], v[204:207]
v_exp_f32 v180, v180
v_mfma_f32_16x16x32_bf16 v[208:211], v[212:215], v[216:219], v[208:211]
ds_read_b128 v[232:235], v243 offset:2048
v_add_f32 v248, v248, v177
v_mfma_f32_16x16x32_bf16 v[192:195], v[220:223], v[8:11], v[192:195]
ds_read_b128 v[212:215], v236 offset:59392
v_add_f32 v248, v248, v178
v_mfma_f32_16x16x32_bf16 v[196:199], v[220:223], v[40:43], v[196:199]
v_exp_f32 v181, v181
v_mfma_f32_16x16x32_bf16 v[200:203], v[220:223], v[72:75], v[200:203]
v_exp_f32 v182, v182
v_mfma_f32_16x16x32_bf16 v[204:207], v[220:223], v[104:107], v[204:207]
s_waitcnt lgkmcnt(2)
v_exp_f32 v183, v183
v_mfma_f32_16x16x32_bf16 v[208:211], v[220:223], v[224:227], v[208:211]
ds_read_b128 v[216:219], v242 offset:4096
v_add_f32 v248, v248, v179
v_mfma_f32_16x16x32_bf16 v[192:195], v[228:231], v[12:15], v[192:195]
ds_read_b128 v[220:223], v237 offset:59392
v_cvt_pk_bf16_f32 v176, v176, v177
v_mfma_f32_16x16x32_bf16 v[196:199], v[228:231], v[44:47], v[196:199]
ds_read_b128 v[224:227], v243 offset:4096
s_add_u32 m0, s29, 44672
v_mfma_f32_16x16x32_bf16 v[200:203], v[228:231], v[76:79], v[200:203]
v_exp_f32 v184, v184
v_mfma_f32_16x16x32_bf16 v[204:207], v[228:231], v[108:111], v[204:207]
s_waitcnt lgkmcnt(3)
buffer_load_dwordx4 v246, s[12:15], s30 offen offset:384 nt lds
v_mfma_f32_16x16x32_bf16 v[208:211], v[228:231], v[232:235], v[208:211]
v_exp_f32 v185, v185
v_mfma_f32_16x16x32_bf16 v[192:195], v[212:215], v[16:19], v[192:195]
ds_read_b128 v[228:231], v236 offset:63488
v_cvt_pk_bf16_f32 v177, v178, v179
v_mfma_f32_16x16x32_bf16 v[196:199], v[212:215], v[48:51], v[196:199]
v_exp_f32 v186, v186
v_mfma_f32_16x16x32_bf16 v[200:203], v[212:215], v[80:83], v[200:203]
v_exp_f32 v187, v187
v_mfma_f32_16x16x32_bf16 v[204:207], v[212:215], v[112:115], v[204:207]
s_waitcnt lgkmcnt(2)
v_exp_f32 v188, v188
v_mfma_f32_16x16x32_bf16 v[208:211], v[212:215], v[216:219], v[208:211]
ds_read_b128 v[232:235], v242 offset:6144
v_add_f32 v249, v249, v180
v_mfma_f32_16x16x32_bf16 v[192:195], v[220:223], v[20:23], v[192:195]
ds_read_b128 v[212:215], v237 offset:63488
v_add_f32 v249, v249, v181
v_mfma_f32_16x16x32_bf16 v[196:199], v[220:223], v[52:55], v[196:199]
v_exp_f32 v189, v189
v_mfma_f32_16x16x32_bf16 v[200:203], v[220:223], v[84:87], v[200:203]
v_exp_f32 v190, v190
v_mfma_f32_16x16x32_bf16 v[204:207], v[220:223], v[116:119], v[204:207]
s_waitcnt lgkmcnt(2)
v_exp_f32 v191, v191
v_mfma_f32_16x16x32_bf16 v[208:211], v[220:223], v[224:227], v[208:211]
ds_read_b128 v[216:219], v243 offset:6144
v_add_f32 v249, v249, v182
v_mfma_f32_16x16x32_bf16 v[192:195], v[228:231], v[24:27], v[192:195]
ds_read_b64_tr_b16 v[220:221], v239 offset:16384
v_add_f32 v249, v249, v183
v_mfma_f32_16x16x32_bf16 v[196:199], v[228:231], v[56:59], v[196:199]
ds_read_b64_tr_b16 v[222:223], v239 offset:18432
v_cvt_pk_bf16_f32 v180, v180, v181
v_mfma_f32_16x16x32_bf16 v[200:203], v[228:231], v[88:91], v[200:203]
ds_read_b64_tr_b16 v[224:225], v239 offset:20480
s_add_u32 m0, s29, 65536
v_mfma_f32_16x16x32_bf16 v[204:207], v[228:231], v[120:123], v[204:207]
s_waitcnt lgkmcnt(4)
ds_read_b64_tr_b16 v[226:227], v239 offset:22528
v_cvt_pk_bf16_f32 v181, v182, v183
v_mfma_f32_16x16x32_bf16 v[208:211], v[228:231], v[232:235], v[208:211]
buffer_load_dwordx4 v247, s[16:19], s30 offen offset:0 nt lds
v_mfma_f32_16x16x32_bf16 v[192:195], v[212:215], v[28:31], v[192:195]
ds_read_b64_tr_b16 v[228:229], v239 offset:24576
v_add_f32 v250, v250, v184
v_mfma_f32_16x16x32_bf16 v[196:199], v[212:215], v[60:63], v[196:199]
ds_read_b64_tr_b16 v[230:231], v239 offset:26624
v_add_f32 v250, v250, v185
v_mfma_f32_16x16x32_bf16 v[200:203], v[212:215], v[92:95], v[200:203]
ds_read_b64_tr_b16 v[232:233], v239 offset:28672
v_add_f32 v250, v250, v186
v_mfma_f32_16x16x32_bf16 v[204:207], v[212:215], v[124:127], v[204:207]
s_waitcnt lgkmcnt(7)
ds_read_b64_tr_b16 v[234:235], v239 offset:30720
v_add_f32 v250, v250, v187
v_mfma_f32_16x16x32_bf16 v[208:211], v[212:215], v[216:219], v[208:211]
s_waitcnt lgkmcnt(6)
v_cvt_pk_bf16_f32 v184, v184, v185
v_cvt_pk_bf16_f32 v185, v186, v187
v_mfma_f32_16x16x32_bf16 a[16:19], v[220:223], v[160:163], a[16:19]
ds_read_b128 v[212:215], v244 offset:0
v_add_f32 v251, v251, v188
v_mfma_f32_16x16x32_bf16 a[20:23], v[220:223], v[164:167], a[20:23]
ds_read_b128 v[216:219], v244 offset:1024
v_add_f32 v251, v251, v189
v_mfma_f32_16x16x32_bf16 a[24:27], v[220:223], v[168:171], a[24:27]
v_exp_f32 v208, v208
v_mfma_f32_16x16x32_bf16 a[28:31], v[220:223], v[172:175], a[28:31]
s_waitcnt lgkmcnt(6)
ds_read_b64_tr_b16 v[220:221], v238 offset:16384
v_add_f32 v251, v251, v190
v_mfma_f32_16x16x32_bf16 a[80:83], v[224:227], v[160:163], a[80:83]
ds_read_b64_tr_b16 v[222:223], v238 offset:18432
v_add_f32 v251, v251, v191
v_mfma_f32_16x16x32_bf16 a[84:87], v[224:227], v[164:167], a[84:87]
v_exp_f32 v209, v209
v_mfma_f32_16x16x32_bf16 a[88:91], v[224:227], v[168:171], a[88:91]
v_exp_f32 v210, v210
v_mfma_f32_16x16x32_bf16 a[92:95], v[224:227], v[172:175], a[92:95]
s_waitcnt lgkmcnt(4)
ds_read_b64_tr_b16 v[224:225], v238 offset:20480
v_cvt_pk_bf16_f32 v188, v188, v189
v_mfma_f32_16x16x32_bf16 a[144:147], v[228:231], v[160:163], a[144:147]
ds_read_b64_tr_b16 v[226:227], v238 offset:22528
s_add_u32 m0, s29, 69504
v_mfma_f32_16x16x32_bf16 a[148:151], v[228:231], v[164:167], a[148:151]
v_exp_f32 v211, v211
v_mfma_f32_16x16x32_bf16 a[152:155], v[228:231], v[168:171], a[152:155]
buffer_load_dwordx4 v247, s[16:19], s30 offen offset:128 nt lds
v_mfma_f32_16x16x32_bf16 a[156:159], v[228:231], v[172:175], a[156:159]
v_exp_f32 v192, v192
v_mfma_f32_16x16x32_bf16 a[208:211], v[232:235], v[160:163], a[208:211]
ds_read_b64_tr_b16 v[228:229], v238 offset:24576
v_cvt_pk_bf16_f32 v189, v190, v191
v_mfma_f32_16x16x32_bf16 a[212:215], v[232:235], v[164:167], a[212:215]
ds_read_b64_tr_b16 v[230:231], v238 offset:26624
v_add_f32 v252, v252, v208
v_mfma_f32_16x16x32_bf16 a[216:219], v[232:235], v[168:171], a[216:219]
v_exp_f32 v193, v193
v_mfma_f32_16x16x32_bf16 a[220:223], v[232:235], v[172:175], a[220:223]
s_waitcnt lgkmcnt(4)
v_exp_f32 v194, v194
v_mfma_f32_16x16x32_bf16 a[0:3], v[220:223], v[160:163], a[0:3]
v_exp_f32 v195, v195
v_mfma_f32_16x16x32_bf16 a[4:7], v[220:223], v[164:167], a[4:7]
v_exp_f32 v196, v196
v_mfma_f32_16x16x32_bf16 v[128:131], v[220:223], v[212:215], v[128:131]
ds_read_b64_tr_b16 v[232:233], v238 offset:28672
v_add_f32 v252, v252, v209
v_mfma_f32_16x16x32_bf16 a[8:11], v[220:223], v[168:171], a[8:11]
ds_read_b64_tr_b16 v[234:235], v238 offset:30720
v_add_f32 v252, v252, v210
v_mfma_f32_16x16x32_bf16 v[132:135], v[220:223], v[216:219], v[132:135]
v_exp_f32 v197, v197
v_mfma_f32_16x16x32_bf16 a[12:15], v[220:223], v[172:175], a[12:15]
s_waitcnt lgkmcnt(2)
v_exp_f32 v198, v198
v_mfma_f32_16x16x32_bf16 a[64:67], v[224:227], v[160:163], a[64:67]
v_exp_f32 v199, v199
v_mfma_f32_16x16x32_bf16 a[68:71], v[224:227], v[164:167], a[68:71]
v_exp_f32 v200, v200
v_mfma_f32_16x16x32_bf16 v[136:139], v[224:227], v[212:215], v[136:139]
ds_read_b64_tr_b16 v[220:221], v240 offset:16384
s_add_u32 m0, s29, 73472
v_mfma_f32_16x16x32_bf16 a[72:75], v[224:227], v[168:171], a[72:75]
ds_read_b64_tr_b16 v[222:223], v240 offset:18432
v_add_f32 v252, v252, v211
v_mfma_f32_16x16x32_bf16 v[140:143], v[224:227], v[216:219], v[140:143]
buffer_load_dwordx4 v247, s[16:19], s30 offen offset:256 nt lds
v_mfma_f32_16x16x32_bf16 a[76:79], v[224:227], v[172:175], a[76:79]
v_exp_f32 v201, v201
v_mfma_f32_16x16x32_bf16 a[128:131], v[228:231], v[160:163], a[128:131]
ds_read_b64_tr_b16 v[224:225], v240 offset:20480
v_cvt_pk_bf16_f32 v208, v208, v209
v_mfma_f32_16x16x32_bf16 a[132:135], v[228:231], v[164:167], a[132:135]
ds_read_b64_tr_b16 v[226:227], v240 offset:22528
v_cvt_pk_bf16_f32 v209, v210, v211
v_mfma_f32_16x16x32_bf16 v[144:147], v[228:231], v[212:215], v[144:147]
ds_write_b64 v245, v[208:209] offset:2048
v_mfma_f32_16x16x32_bf16 a[136:139], v[228:231], v[168:171], a[136:139]
v_exp_f32 v202, v202
v_mfma_f32_16x16x32_bf16 v[148:151], v[228:231], v[216:219], v[148:151]
v_exp_f32 v203, v203
v_mfma_f32_16x16x32_bf16 a[140:143], v[228:231], v[172:175], a[140:143]
s_waitcnt lgkmcnt(3)
v_exp_f32 v204, v204
v_mfma_f32_16x16x32_bf16 a[192:195], v[232:235], v[160:163], a[192:195]
v_exp_f32 v205, v205
v_mfma_f32_16x16x32_bf16 a[196:199], v[232:235], v[164:167], a[196:199]
v_exp_f32 v206, v206
v_mfma_f32_16x16x32_bf16 v[152:155], v[232:235], v[212:215], v[152:155]
v_exp_f32 v207, v207
v_mfma_f32_16x16x32_bf16 a[200:203], v[232:235], v[168:171], a[200:203]
ds_read_b64_tr_b16 v[228:229], v240 offset:24576
v_add_f32 v248, v248, v192
v_mfma_f32_16x16x32_bf16 v[156:159], v[232:235], v[216:219], v[156:159]
ds_read_b64_tr_b16 v[230:231], v240 offset:26624
v_add_f32 v248, v248, v193
v_mfma_f32_16x16x32_bf16 a[204:207], v[232:235], v[172:175], a[204:207]
ds_read_b64_tr_b16 v[232:233], v240 offset:28672
v_add_f32 v248, v248, v194
v_mfma_f32_16x16x32_bf16 a[32:35], v[220:223], v[160:163], a[32:35]
ds_read_b64_tr_b16 v[234:235], v240 offset:30720
s_add_u32 m0, s29, 77440
v_mfma_f32_16x16x32_bf16 a[36:39], v[220:223], v[164:167], a[36:39]
v_add_f32 v248, v248, v195
v_cvt_pk_bf16_f32 v178, v192, v193
v_mfma_f32_16x16x32_bf16 a[40:43], v[220:223], v[168:171], a[40:43]
buffer_load_dwordx4 v247, s[16:19], s30 offen offset:384 nt lds
v_mfma_f32_16x16x32_bf16 a[44:47], v[220:223], v[172:175], a[44:47]
s_waitcnt lgkmcnt(5)
ds_read_b64_tr_b16 v[220:221], v241 offset:16384
v_cvt_pk_bf16_f32 v179, v194, v195
v_mfma_f32_16x16x32_bf16 a[96:99], v[224:227], v[160:163], a[96:99]
ds_read_b64_tr_b16 v[222:223], v241 offset:18432
s_add_u32 s30, s30, 16384
v_mfma_f32_16x16x32_bf16 a[100:103], v[224:227], v[164:167], a[100:103]
v_add_f32 v249, v249, v196
v_add_f32 v249, v249, v197
v_mfma_f32_16x16x32_bf16 a[104:107], v[224:227], v[168:171], a[104:107]
v_add_f32 v249, v249, v198
v_add_f32 v249, v249, v199
v_mfma_f32_16x16x32_bf16 a[108:111], v[224:227], v[172:175], a[108:111]
s_waitcnt lgkmcnt(4)
ds_read_b64_tr_b16 v[224:225], v241 offset:20480
v_cvt_pk_bf16_f32 v182, v196, v197
v_mfma_f32_16x16x32_bf16 a[160:163], v[228:231], v[160:163], a[160:163]
ds_read_b64_tr_b16 v[226:227], v241 offset:22528
v_cvt_pk_bf16_f32 v183, v198, v199
v_mfma_f32_16x16x32_bf16 a[164:167], v[228:231], v[164:167], a[164:167]
v_add_f32 v250, v250, v200
v_add_f32 v250, v250, v201
v_mfma_f32_16x16x32_bf16 a[168:171], v[228:231], v[168:171], a[168:171]
v_add_f32 v250, v250, v202
v_add_f32 v250, v250, v203
v_mfma_f32_16x16x32_bf16 a[172:175], v[228:231], v[172:175], a[172:175]
s_waitcnt lgkmcnt(4)
ds_read_b64_tr_b16 v[228:229], v241 offset:24576
v_cvt_pk_bf16_f32 v186, v200, v201
v_mfma_f32_16x16x32_bf16 a[224:227], v[232:235], v[160:163], a[224:227]
ds_read_b64_tr_b16 v[230:231], v241 offset:26624
v_cvt_pk_bf16_f32 v187, v202, v203
v_mfma_f32_16x16x32_bf16 a[228:231], v[232:235], v[164:167], a[228:231]
v_add_f32 v251, v251, v204
v_add_f32 v251, v251, v205
v_mfma_f32_16x16x32_bf16 a[232:235], v[232:235], v[168:171], a[232:235]
v_add_f32 v251, v251, v206
v_add_f32 v251, v251, v207
v_mfma_f32_16x16x32_bf16 a[236:239], v[232:235], v[172:175], a[236:239]
s_waitcnt lgkmcnt(4)
ds_read_b64_tr_b16 v[232:233], v241 offset:28672
v_cvt_pk_bf16_f32 v190, v204, v205
v_mfma_f32_16x16x32_bf16 a[48:51], v[220:223], v[160:163], a[48:51]
ds_read_b64_tr_b16 v[234:235], v241 offset:30720
v_cvt_pk_bf16_f32 v191, v206, v207
v_mfma_f32_16x16x32_bf16 a[52:55], v[220:223], v[164:167], a[52:55]
v_mfma_f32_16x16x32_bf16 a[56:59], v[220:223], v[168:171], a[56:59]
s_add_u32 s42, s42, 1024
s_mov_b32 m0, 161792
v_mfma_f32_16x16x32_bf16 a[60:63], v[220:223], v[172:175], a[60:63]
s_waitcnt lgkmcnt(4)
buffer_load_dwordx4 v253, s[20:23], s42 offen lds
v_mfma_f32_16x16x32_bf16 a[112:115], v[224:227], v[160:163], a[112:115]
ds_read_b128 v[220:223], v236 offset:0
v_mfma_f32_16x16x32_bf16 a[116:119], v[224:227], v[164:167], a[116:119]
v_mfma_f32_16x16x32_bf16 a[120:123], v[224:227], v[168:171], a[120:123]
v_mfma_f32_16x16x32_bf16 a[124:127], v[224:227], v[172:175], a[124:127]
s_waitcnt lgkmcnt(3)
ds_read_b128 v[224:227], v237 offset:0
v_mfma_f32_16x16x32_bf16 a[176:179], v[228:231], v[160:163], a[176:179]
v_mfma_f32_16x16x32_bf16 a[180:183], v[228:231], v[164:167], a[180:183]
v_mfma_f32_16x16x32_bf16 a[184:187], v[228:231], v[168:171], a[184:187]
v_mfma_f32_16x16x32_bf16 a[188:191], v[228:231], v[172:175], a[188:191]
s_waitcnt lgkmcnt(2)
ds_read_b128 v[228:231], v236 offset:4096
v_mfma_f32_16x16x32_bf16 a[240:243], v[232:235], v[160:163], a[240:243]
v_mfma_f32_16x16x32_bf16 a[244:247], v[232:235], v[164:167], a[244:247]
v_mfma_f32_16x16x32_bf16 a[248:251], v[232:235], v[168:171], a[248:251]
v_mfma_f32_16x16x32_bf16 a[252:255], v[232:235], v[172:175], a[252:255]
s_waitcnt vmcnt(16) lgkmcnt(3)
s_barrier
s_sub_u32 s31, s31, 1
s_cmp_eq_u32 s31, 0
s_cbranch_scc1 L_tail
s_waitcnt lgkmcnt(2)
v_mfma_f32_16x16x32_bf16 v[160:163], v[220:223], v[0:3], 0
ds_read_b128 v[232:235], v237 offset:4096
s_add_u32 m0, s29, 49152
v_mfma_f32_16x16x32_bf16 v[164:167], v[220:223], v[32:35], 0
ds_read_b128 v[212:215], v236 offset:8192
v_mfma_f32_16x16x32_bf16 v[168:171], v[220:223], v[64:67], 0
buffer_load_dwordx4 v246, s[12:15], s30 offen offset:0 nt lds
v_mfma_f32_16x16x32_bf16 v[172:175], v[220:223], v[96:99], 0
s_waitcnt lgkmcnt(3)
v_mfma_f32_16x16x32_bf16 v[160:163], v[224:227], v[4:7], v[160:163]
ds_read_b128 v[216:219], v237 offset:8192
v_mfma_f32_16x16x32_bf16 v[164:167], v[224:227], v[36:39], v[164:167]
v_mfma_f32_16x16x32_bf16 v[168:171], v[224:227], v[68:71], v[168:171]
v_mfma_f32_16x16x32_bf16 v[172:175], v[224:227], v[100:103], v[172:175]
s_waitcnt lgkmcnt(3)
v_mfma_f32_16x16x32_bf16 v[160:163], v[228:231], v[8:11], v[160:163]
ds_read_b128 v[220:223], v236 offset:12288
v_mfma_f32_16x16x32_bf16 v[164:167], v[228:231], v[40:43], v[164:167]
v_mfma_f32_16x16x32_bf16 v[168:171], v[228:231], v[72:75], v[168:171]
v_mfma_f32_16x16x32_bf16 v[172:175], v[228:231], v[104:107], v[172:175]
s_waitcnt lgkmcnt(2)
v_mfma_f32_16x16x32_bf16 v[160:163], v[232:235], v[12:15], v[160:163]
ds_read_b128 v[224:227], v237 offset:12288
v_mfma_f32_16x16x32_bf16 v[164:167], v[232:235], v[44:47], v[164:167]
v_mfma_f32_16x16x32_bf16 v[168:171], v[232:235], v[76:79], v[168:171]
v_mfma_f32_16x16x32_bf16 v[172:175], v[232:235], v[108:111], v[172:175]
v_mfma_f32_16x16x32_bf16 v[160:163], v[212:215], v[16:19], v[160:163]
ds_read_b128 v[228:231], v236 offset:2048
s_add_u32 m0, s29, 53120
v_mfma_f32_16x16x32_bf16 v[164:167], v[212:215], v[48:51], v[164:167]
v_mfma_f32_16x16x32_bf16 v[168:171], v[212:215], v[80:83], v[168:171]
buffer_load_dwordx4 v246, s[12:15], s30 offen offset:128 nt lds
v_mfma_f32_16x16x32_bf16 v[172:175], v[212:215], v[112:115], v[172:175]
s_waitcnt lgkmcnt(2)
v_mfma_f32_16x16x32_bf16 v[160:163], v[216:219], v[20:23], v[160:163]
ds_read_b128 v[232:235], v242 offset:0
v_mfma_f32_16x16x32_bf16 v[164:167], v[216:219], v[52:55], v[164:167]
ds_read_b128 v[212:215], v237 offset:2048
v_mfma_f32_16x16x32_bf16 v[168:171], v[216:219], v[84:87], v[168:171]
v_mfma_f32_16x16x32_bf16 v[172:175], v[216:219], v[116:119], v[172:175]
v_mfma_f32_16x16x32_bf16 v[160:163], v[220:223], v[24:27], v[160:163]
v_mfma_f32_16x16x32_bf16 v[164:167], v[220:223], v[56:59], v[164:167]
ds_read_b128 v[216:219], v243 offset:0
v_mfma_f32_16x16x32_bf16 v[168:171], v[220:223], v[88:91], v[168:171]
v_mfma_f32_16x16x32_bf16 v[172:175], v[220:223], v[120:123], v[172:175]
s_waitcnt lgkmcnt(3)
ds_read_b128 v[220:223], v236 offset:6144
v_mfma_f32_16x16x32_bf16 v[160:163], v[224:227], v[28:31], v[160:163]
v_mfma_f32_16x16x32_bf16 v[164:167], v[224:227], v[60:63], v[164:167]
v_mfma_f32_16x16x32_bf16 v[168:171], v[224:227], v[92:95], v[168:171]
v_mfma_f32_16x16x32_bf16 v[172:175], v[224:227], v[124:127], v[172:175]
ds_read_b128 v[224:227], v242 offset:2048
v_mfma_f32_16x16x32_bf16 v[192:195], v[228:231], v[0:3], 0
s_add_u32 m0, s29, 57088
v_mfma_f32_16x16x32_bf16 v[196:199], v[228:231], v[32:35], 0
v_mfma_f32_16x16x32_bf16 v[200:203], v[228:231], v[64:67], 0
buffer_load_dwordx4 v246, s[12:15], s30 offen offset:256 nt lds
v_mfma_f32_16x16x32_bf16 v[204:207], v[228:231], v[96:99], 0
s_waitcnt lgkmcnt(1)
v_exp_f32 v160, v160
v_mfma_f32_16x16x32_bf16 v[208:211], v[228:231], v[232:235], 0
v_exp_f32 v161, v161
v_mfma_f32_16x16x32_bf16 v[192:195], v[212:215], v[4:7], v[192:195]
ds_read_b128 v[228:231], v237 offset:6144
v_add_f32 v248, v248, v160
v_mfma_f32_16x16x32_bf16 v[196:199], v[212:215], v[36:39], v[196:199]
v_exp_f32 v162, v162
v_mfma_f32_16x16x32_bf16 v[200:203], v[212:215], v[68:71], v[200:203]
v_exp_f32 v163, v163
v_mfma_f32_16x16x32_bf16 v[204:207], v[212:215], v[100:103], v[204:207]
v_exp_f32 v164, v164
v_mfma_f32_16x16x32_bf16 v[208:211], v[212:215], v[216:219], v[208:211]
ds_read_b128 v[232:235], v243 offset:2048
v_add_f32 v248, v248, v161
v_mfma_f32_16x16x32_bf16 v[192:195], v[220:223], v[8:11], v[192:195]
ds_read_b128 v[212:215], v236 offset:10240
v_add_f32 v248, v248, v162
v_mfma_f32_16x16x32_bf16 v[196:199], v[220:223], v[40:43], v[196:199]
v_exp_f32 v165, v165
v_mfma_f32_16x16x32_bf16 v[200:203], v[220:223], v[72:75], v[200:203]
v_exp_f32 v166, v166
v_mfma_f32_16x16x32_bf16 v[204:207], v[220:223], v[104:107], v[204:207]
s_waitcnt lgkmcnt(2)
v_exp_f32 v167, v167
v_mfma_f32_16x16x32_bf16 v[208:211], v[220:223], v[224:227], v[208:211]
ds_read_b128 v[216:219], v242 offset:4096
v_add_f32 v248, v248, v163
v_mfma_f32_16x16x32_bf16 v[192:195], v[228:231], v[12:15], v[192:195]
ds_read_b128 v[220:223], v237 offset:10240
v_cvt_pk_bf16_f32 v160, v160, v161
v_mfma_f32_16x16x32_bf16 v[196:199], v[228:231], v[44:47], v[196:199]
ds_read_b128 v[224:227], v243 offset:4096
s_add_u32 m0, s29, 61056
v_mfma_f32_16x16x32_bf16 v[200:203], v[228:231], v[76:79], v[200:203]
v_exp_f32 v168, v168
v_mfma_f32_16x16x32_bf16 v[204:207], v[228:231], v[108:111], v[204:207]
s_waitcnt lgkmcnt(3)
buffer_load_dwordx4 v246, s[12:15], s30 offen offset:384 nt lds
v_mfma_f32_16x16x32_bf16 v[208:211], v[228:231], v[232:235], v[208:211]
v_exp_f32 v169, v169
v_mfma_f32_16x16x32_bf16 v[192:195], v[212:215], v[16:19], v[192:195]
ds_read_b128 v[228:231], v236 offset:14336
v_cvt_pk_bf16_f32 v161, v162, v163
v_mfma_f32_16x16x32_bf16 v[196:199], v[212:215], v[48:51], v[196:199]
v_exp_f32 v170, v170
v_mfma_f32_16x16x32_bf16 v[200:203], v[212:215], v[80:83], v[200:203]
v_exp_f32 v171, v171
v_mfma_f32_16x16x32_bf16 v[204:207], v[212:215], v[112:115], v[204:207]
s_waitcnt lgkmcnt(2)
v_exp_f32 v172, v172
v_mfma_f32_16x16x32_bf16 v[208:211], v[212:215], v[216:219], v[208:211]
ds_read_b128 v[232:235], v242 offset:6144
v_add_f32 v249, v249, v164
v_mfma_f32_16x16x32_bf16 v[192:195], v[220:223], v[20:23], v[192:195]
ds_read_b128 v[212:215], v237 offset:14336
v_add_f32 v249, v249, v165
v_mfma_f32_16x16x32_bf16 v[196:199], v[220:223], v[52:55], v[196:199]
v_exp_f32 v173, v173
v_mfma_f32_16x16x32_bf16 v[200:203], v[220:223], v[84:87], v[200:203]
v_exp_f32 v174, v174
v_mfma_f32_16x16x32_bf16 v[204:207], v[220:223], v[116:119], v[204:207]
s_waitcnt lgkmcnt(2)
v_exp_f32 v175, v175
v_mfma_f32_16x16x32_bf16 v[208:211], v[220:223], v[224:227], v[208:211]
ds_read_b128 v[216:219], v243 offset:6144
v_add_f32 v249, v249, v166
v_mfma_f32_16x16x32_bf16 v[192:195], v[228:231], v[24:27], v[192:195]
ds_read_b64_tr_b16 v[220:221], v239 offset:32768
v_add_f32 v249, v249, v167
v_mfma_f32_16x16x32_bf16 v[196:199], v[228:231], v[56:59], v[196:199]
ds_read_b64_tr_b16 v[222:223], v239 offset:34816
v_cvt_pk_bf16_f32 v164, v164, v165
v_mfma_f32_16x16x32_bf16 v[200:203], v[228:231], v[88:91], v[200:203]
ds_read_b64_tr_b16 v[224:225], v239 offset:36864
s_add_u32 m0, s29, 81920
v_mfma_f32_16x16x32_bf16 v[204:207], v[228:231], v[120:123], v[204:207]
s_waitcnt lgkmcnt(4)
ds_read_b64_tr_b16 v[226:227], v239 offset:38912
v_cvt_pk_bf16_f32 v165, v166, v167
v_mfma_f32_16x16x32_bf16 v[208:211], v[228:231], v[232:235], v[208:211]
buffer_load_dwordx4 v247, s[16:19], s30 offen offset:0 nt lds
v_mfma_f32_16x16x32_bf16 v[192:195], v[212:215], v[28:31], v[192:195]
ds_read_b64_tr_b16 v[228:229], v239 offset:40960
v_add_f32 v250, v250, v168
v_mfma_f32_16x16x32_bf16 v[196:199], v[212:215], v[60:63], v[196:199]
ds_read_b64_tr_b16 v[230:231], v239 offset:43008
v_add_f32 v250, v250, v169
v_mfma_f32_16x16x32_bf16 v[200:203], v[212:215], v[92:95], v[200:203]
ds_read_b64_tr_b16 v[232:233], v239 offset:45056
v_add_f32 v250, v250, v170
v_mfma_f32_16x16x32_bf16 v[204:207], v[212:215], v[124:127], v[204:207]
s_waitcnt lgkmcnt(7)
ds_read_b64_tr_b16 v[234:235], v239 offset:47104
v_add_f32 v250, v250, v171
v_mfma_f32_16x16x32_bf16 v[208:211], v[212:215], v[216:219], v[208:211]
s_waitcnt lgkmcnt(6)
v_cvt_pk_bf16_f32 v168, v168, v169
v_cvt_pk_bf16_f32 v169, v170, v171
v_mfma_f32_16x16x32_bf16 a[16:19], v[220:223], v[176:179], a[16:19]
ds_read_b128 v[212:215], v244 offset:2048
v_add_f32 v251, v251, v172
v_mfma_f32_16x16x32_bf16 a[20:23], v[220:223], v[180:183], a[20:23]
ds_read_b128 v[216:219], v244 offset:3072
v_add_f32 v251, v251, v173
v_mfma_f32_16x16x32_bf16 a[24:27], v[220:223], v[184:187], a[24:27]
v_exp_f32 v208, v208
v_mfma_f32_16x16x32_bf16 a[28:31], v[220:223], v[188:191], a[28:31]
s_waitcnt lgkmcnt(6)
ds_read_b64_tr_b16 v[220:221], v238 offset:32768
v_add_f32 v251, v251, v174
v_mfma_f32_16x16x32_bf16 a[80:83], v[224:227], v[176:179], a[80:83]
ds_read_b64_tr_b16 v[222:223], v238 offset:34816
v_add_f32 v251, v251, v175
v_mfma_f32_16x16x32_bf16 a[84:87], v[224:227], v[180:183], a[84:87]
v_exp_f32 v209, v209
v_mfma_f32_16x16x32_bf16 a[88:91], v[224:227], v[184:187], a[88:91]
v_exp_f32 v210, v210
v_mfma_f32_16x16x32_bf16 a[92:95], v[224:227], v[188:191], a[92:95]
s_waitcnt lgkmcnt(4)
ds_read_b64_tr_b16 v[224:225], v238 offset:36864
v_cvt_pk_bf16_f32 v172, v172, v173
v_mfma_f32_16x16x32_bf16 a[144:147], v[228:231], v[176:179], a[144:147]
ds_read_b64_tr_b16 v[226:227], v238 offset:38912
s_add_u32 m0, s29, 85888
v_mfma_f32_16x16x32_bf16 a[148:151], v[228:231], v[180:183], a[148:151]
v_exp_f32 v211, v211
v_mfma_f32_16x16x32_bf16 a[152:155], v[228:231], v[184:187], a[152:155]
buffer_load_dwordx4 v247, s[16:19], s30 offen offset:128 nt lds
v_mfma_f32_16x16x32_bf16 a[156:159], v[228:231], v[188:191], a[156:159]
v_exp_f32 v192, v192
v_mfma_f32_16x16x32_bf16 a[208:211], v[232:235], v[176:179], a[208:211]
ds_read_b64_tr_b16 v[228:229], v238 offset:40960
v_cvt_pk_bf16_f32 v173, v174, v175
v_mfma_f32_16x16x32_bf16 a[212:215], v[232:235], v[180:183], a[212:215]
ds_read_b64_tr_b16 v[230:231], v238 offset:43008
v_add_f32 v252, v252, v208
v_mfma_f32_16x16x32_bf16 a[216:219], v[232:235], v[184:187], a[216:219]
v_exp_f32 v193, v193
v_mfma_f32_16x16x32_bf16 a[220:223], v[232:235], v[188:191], a[220:223]
s_waitcnt lgkmcnt(4)
v_exp_f32 v194, v194
v_mfma_f32_16x16x32_bf16 a[0:3], v[220:223], v[176:179], a[0:3]
v_exp_f32 v195, v195
v_mfma_f32_16x16x32_bf16 a[4:7], v[220:223], v[180:183], a[4:7]
v_exp_f32 v196, v196
v_mfma_f32_16x16x32_bf16 v[128:131], v[220:223], v[212:215], v[128:131]
ds_read_b64_tr_b16 v[232:233], v238 offset:45056
v_add_f32 v252, v252, v209
v_mfma_f32_16x16x32_bf16 a[8:11], v[220:223], v[184:187], a[8:11]
ds_read_b64_tr_b16 v[234:235], v238 offset:47104
v_add_f32 v252, v252, v210
v_mfma_f32_16x16x32_bf16 v[132:135], v[220:223], v[216:219], v[132:135]
v_exp_f32 v197, v197
v_mfma_f32_16x16x32_bf16 a[12:15], v[220:223], v[188:191], a[12:15]
s_waitcnt lgkmcnt(2)
v_exp_f32 v198, v198
v_mfma_f32_16x16x32_bf16 a[64:67], v[224:227], v[176:179], a[64:67]
v_exp_f32 v199, v199
v_mfma_f32_16x16x32_bf16 a[68:71], v[224:227], v[180:183], a[68:71]
v_exp_f32 v200, v200
v_mfma_f32_16x16x32_bf16 v[136:139], v[224:227], v[212:215], v[136:139]
ds_read_b64_tr_b16 v[220:221], v240 offset:32768
s_add_u32 m0, s29, 89856
v_mfma_f32_16x16x32_bf16 a[72:75], v[224:227], v[184:187], a[72:75]
ds_read_b64_tr_b16 v[222:223], v240 offset:34816
v_add_f32 v252, v252, v211
v_mfma_f32_16x16x32_bf16 v[140:143], v[224:227], v[216:219], v[140:143]
buffer_load_dwordx4 v247, s[16:19], s30 offen offset:256 nt lds
v_mfma_f32_16x16x32_bf16 a[76:79], v[224:227], v[188:191], a[76:79]
v_exp_f32 v201, v201
v_mfma_f32_16x16x32_bf16 a[128:131], v[228:231], v[176:179], a[128:131]
ds_read_b64_tr_b16 v[224:225], v240 offset:36864
v_cvt_pk_bf16_f32 v208, v208, v209
v_mfma_f32_16x16x32_bf16 a[132:135], v[228:231], v[180:183], a[132:135]
ds_read_b64_tr_b16 v[226:227], v240 offset:38912
v_cvt_pk_bf16_f32 v209, v210, v211
v_mfma_f32_16x16x32_bf16 v[144:147], v[228:231], v[212:215], v[144:147]
ds_write_b64 v245, v[208:209] offset:0
v_mfma_f32_16x16x32_bf16 a[136:139], v[228:231], v[184:187], a[136:139]
v_exp_f32 v202, v202
v_mfma_f32_16x16x32_bf16 v[148:151], v[228:231], v[216:219], v[148:151]
v_exp_f32 v203, v203
v_mfma_f32_16x16x32_bf16 a[140:143], v[228:231], v[188:191], a[140:143]
s_waitcnt lgkmcnt(3)
v_exp_f32 v204, v204
v_mfma_f32_16x16x32_bf16 a[192:195], v[232:235], v[176:179], a[192:195]
v_exp_f32 v205, v205
v_mfma_f32_16x16x32_bf16 a[196:199], v[232:235], v[180:183], a[196:199]
v_exp_f32 v206, v206
v_mfma_f32_16x16x32_bf16 v[152:155], v[232:235], v[212:215], v[152:155]
v_exp_f32 v207, v207
v_mfma_f32_16x16x32_bf16 a[200:203], v[232:235], v[184:187], a[200:203]
ds_read_b64_tr_b16 v[228:229], v240 offset:40960
v_add_f32 v248, v248, v192
v_mfma_f32_16x16x32_bf16 v[156:159], v[232:235], v[216:219], v[156:159]
ds_read_b64_tr_b16 v[230:231], v240 offset:43008
v_add_f32 v248, v248, v193
v_mfma_f32_16x16x32_bf16 a[204:207], v[232:235], v[188:191], a[204:207]
ds_read_b64_tr_b16 v[232:233], v240 offset:45056
v_add_f32 v248, v248, v194
v_mfma_f32_16x16x32_bf16 a[32:35], v[220:223], v[176:179], a[32:35]
ds_read_b64_tr_b16 v[234:235], v240 offset:47104
s_add_u32 m0, s29, 93824
v_mfma_f32_16x16x32_bf16 a[36:39], v[220:223], v[180:183], a[36:39]
v_add_f32 v248, v248, v195
v_cvt_pk_bf16_f32 v162, v192, v193
v_mfma_f32_16x16x32_bf16 a[40:43], v[220:223], v[184:187], a[40:43]
buffer_load_dwordx4 v247, s[16:19], s30 offen offset:384 nt lds
v_mfma_f32_16x16x32_bf16 a[44:47], v[220:223], v[188:191], a[44:47]
s_waitcnt lgkmcnt(5)
ds_read_b64_tr_b16 v[220:221], v241 offset:32768
v_cvt_pk_bf16_f32 v163, v194, v195
v_mfma_f32_16x16x32_bf16 a[96:99], v[224:227], v[176:179], a[96:99]
ds_read_b64_tr_b16 v[222:223], v241 offset:34816
s_add_u32 s30, s30, 16384
v_mfma_f32_16x16x32_bf16 a[100:103], v[224:227], v[180:183], a[100:103]
v_add_f32 v249, v249, v196
v_add_f32 v249, v249, v197
v_mfma_f32_16x16x32_bf16 a[104:107], v[224:227], v[184:187], a[104:107]
v_add_f32 v249, v249, v198
v_add_f32 v249, v249, v199
v_mfma_f32_16x16x32_bf16 a[108:111], v[224:227], v[188:191], a[108:111]
s_waitcnt lgkmcnt(4)
ds_read_b64_tr_b16 v[224:225], v241 offset:36864
v_cvt_pk_bf16_f32 v166, v196, v197
v_mfma_f32_16x16x32_bf16 a[160:163], v[228:231], v[176:179], a[160:163]
ds_read_b64_tr_b16 v[226:227], v241 offset:38912
v_cvt_pk_bf16_f32 v167, v198, v199
v_mfma_f32_16x16x32_bf16 a[164:167], v[228:231], v[180:183], a[164:167]
v_add_f32 v250, v250, v200
v_add_f32 v250, v250, v201
v_mfma_f32_16x16x32_bf16 a[168:171], v[228:231], v[184:187], a[168:171]
v_add_f32 v250, v250, v202
v_add_f32 v250, v250, v203
v_mfma_f32_16x16x32_bf16 a[172:175], v[228:231], v[188:191], a[172:175]
s_waitcnt lgkmcnt(4)
ds_read_b64_tr_b16 v[228:229], v241 offset:40960
v_cvt_pk_bf16_f32 v170, v200, v201
v_mfma_f32_16x16x32_bf16 a[224:227], v[232:235], v[176:179], a[224:227]
ds_read_b64_tr_b16 v[230:231], v241 offset:43008
v_cvt_pk_bf16_f32 v171, v202, v203
v_mfma_f32_16x16x32_bf16 a[228:231], v[232:235], v[180:183], a[228:231]
v_add_f32 v251, v251, v204
v_add_f32 v251, v251, v205
v_mfma_f32_16x16x32_bf16 a[232:235], v[232:235], v[184:187], a[232:235]
v_add_f32 v251, v251, v206
v_add_f32 v251, v251, v207
v_mfma_f32_16x16x32_bf16 a[236:239], v[232:235], v[188:191], a[236:239]
s_waitcnt lgkmcnt(4)
ds_read_b64_tr_b16 v[232:233], v241 offset:45056
v_cvt_pk_bf16_f32 v174, v204, v205
v_mfma_f32_16x16x32_bf16 a[48:51], v[220:223], v[176:179], a[48:51]
ds_read_b64_tr_b16 v[234:235], v241 offset:47104
v_cvt_pk_bf16_f32 v175, v206, v207
v_mfma_f32_16x16x32_bf16 a[52:55], v[220:223], v[180:183], a[52:55]
v_mfma_f32_16x16x32_bf16 a[56:59], v[220:223], v[184:187], a[56:59]
s_add_u32 s42, s42, 1024
s_mov_b32 m0, 161792
v_mfma_f32_16x16x32_bf16 a[60:63], v[220:223], v[188:191], a[60:63]
s_waitcnt lgkmcnt(4)
buffer_load_dwordx4 v253, s[20:23], s42 offen lds
v_mfma_f32_16x16x32_bf16 a[112:115], v[224:227], v[176:179], a[112:115]
ds_read_b128 v[220:223], v236 offset:16384
v_mfma_f32_16x16x32_bf16 a[116:119], v[224:227], v[180:183], a[116:119]
v_mfma_f32_16x16x32_bf16 a[120:123], v[224:227], v[184:187], a[120:123]
v_mfma_f32_16x16x32_bf16 a[124:127], v[224:227], v[188:191], a[124:127]
s_waitcnt lgkmcnt(3)
ds_read_b128 v[224:227], v237 offset:16384
v_mfma_f32_16x16x32_bf16 a[176:179], v[228:231], v[176:179], a[176:179]
v_mfma_f32_16x16x32_bf16 a[180:183], v[228:231], v[180:183], a[180:183]
v_mfma_f32_16x16x32_bf16 a[184:187], v[228:231], v[184:187], a[184:187]
v_mfma_f32_16x16x32_bf16 a[188:191], v[228:231], v[188:191], a[188:191]
s_waitcnt lgkmcnt(2)
ds_read_b128 v[228:231], v236 offset:20480
v_mfma_f32_16x16x32_bf16 a[240:243], v[232:235], v[176:179], a[240:243]
v_mfma_f32_16x16x32_bf16 a[244:247], v[232:235], v[180:183], a[244:247]
v_mfma_f32_16x16x32_bf16 a[248:251], v[232:235], v[184:187], a[248:251]
v_mfma_f32_16x16x32_bf16 a[252:255], v[232:235], v[188:191], a[252:255]
s_waitcnt vmcnt(16) lgkmcnt(3)
s_barrier
s_branch L_loop1
L_tail:
s_waitcnt lgkmcnt(0)
v_mbcnt_lo_u32_b32 v200, -1, 0
v_mbcnt_hi_u32_b32 v200, -1, v200
v_and_b32 v201, 15, v200
v_lshrrev_b32 v202, 4, v200
s_mov_b32 s33, 813694976
s_mov_b32 s34, 1400897536
s_mov_b64 s[44:45], -1
v_cmp_le_f32 s[46:47], s33, v248
v_cmp_ge_f32 vcc, s34, v248
s_nop 1
s_and_b64 s[44:45], s[44:45], s[46:47]
s_and_b64 s[44:45], s[44:45], vcc
v_cmp_le_f32 s[46:47], s33, v249
v_cmp_ge_f32 vcc, s34, v249
s_nop 1
s_and_b64 s[44:45], s[44:45], s[46:47]
s_and_b64 s[44:45], s[44:45], vcc
v_cmp_le_f32 s[46:47], s33, v250
v_cmp_ge_f32 vcc, s34, v250
s_nop 1
s_and_b64 s[44:45], s[44:45], s[46:47]
s_and_b64 s[44:45], s[44:45], vcc
v_cmp_le_f32 s[46:47], s33, v251
v_cmp_ge_f32 vcc, s34, v251
s_nop 1
s_and_b64 s[44:45], s[44:45], s[46:47]
s_and_b64 s[44:45], s[44:45], vcc
v_cmp_le_f32 s[46:47], s33, v252
v_cmp_ge_f32 vcc, s34, v252
s_nop 1
s_and_b64 s[44:45], s[44:45], s[46:47]
s_and_b64 s[44:45], s[44:45], vcc
s_cmp_eq_u64 s[44:45], -1
s_cselect_b32 s35, 0, 1
v_mov_b32 v203, v252
s_nop 1
v_permlane32_swap_b32 v203, v252
s_nop 1
v_add_f32 v252, v252, v203
v_mov_b32 v203, v252
s_nop 1
v_permlane16_swap_b32 v203, v252
s_nop 1
v_add_f32 v252, v252, v203
v_lshlrev_b32 v203, 2, v200
s_lshl_b32 s33, s28, 8
s_add_u32 s33, s33, 151552
v_add_u32 v203, s33, v203
v_mov_b32 v204, s35
ds_write_b32 v203, v252
ds_write_b32 v203, v204 offset:1024
v_lshrrev_b32 v203, 3, v200
v_and_b32 v204, 7, v200
v_and_b32 v205, 6, v203
v_xor_b32 v204, v204, v205
v_lshlrev_b32 v204, 4, v204
v_mul_u32_u24 v203, 896, v203
v_add_u32 v203, v203, v204
s_mul_i32 s33, s28, 7168
v_add_u32 v253, s33, v203
s_mov_b32 s52, 0
s_mov_b32 s53, 28672
s_mov_b32 s54, 57344
s_mov_b32 s55, 86016
s_mov_b32 s56, 114688
s_mov_b32 s57, 143360
s_mov_b32 s58, 172032
s_mov_b32 s59, 200704
s_mov_b32 s44, 0
s_mov_b32 s45, 0
s_waitcnt vmcnt(0) lgkmcnt(0)
s_barrier
v_lshlrev_b32 v203, 2, v201
v_add_u32 v203, 151552, v203
ds_read_b32 v192, v203 offset:0
ds_read_b32 v193, v203 offset:256
ds_read_b32 v194, v203 offset:512
ds_read_b32 v195, v203 offset:768
ds_read_b32 v196, v203 offset:1024
ds_read_b32 v197, v203 offset:1280
ds_read_b32 v198, v203 offset:1536
ds_read_b32 v199, v203 offset:1792
s_waitcnt lgkmcnt(0)
v_or_b32 v196, v196, v197
v_or_b32 v198, v198, v199
v_or_b32 v196, v196, v198
s_nop 0
v_readfirstlane_b32 s43, v196
v_add_f32 v206, v192, v193
v_add_f32 v207, v194, v195
s_cmp_eq_u32 s43, 0
s_cbranch_scc1 L_fast_ok
s_cmp_lg_u32 s49, 0
s_cbranch_scc1 L_fast_ok
s_branch L_slow
L_fast_ok:
v_rcp_f32 v206, v206
v_rcp_f32 v207, v207
v_mov_b32 v192, v248
v_mov_b32 v193, v249
v_mov_b32 v194, v250
v_mov_b32 v195, v251
v_permlane32_swap_b32 v192, v248
v_permlane32_swap_b32 v193, v249
v_permlane32_swap_b32 v194, v250
v_permlane32_swap_b32 v195, v251
v_add_f32 v248, v248, v192
v_add_f32 v249, v249, v193
v_add_f32 v250, v250, v194
v_add_f32 v251, v251, v195
v_mov_b32 v192, v248
v_mov_b32 v193, v249
v_mov_b32 v194, v250
v_mov_b32 v195, v251
v_permlane16_swap_b32 v192, v248
v_permlane16_swap_b32 v193, v249
v_permlane16_swap_b32 v194, v250
v_permlane16_swap_b32 v195, v251
v_add_f32 v248, v248, v192
v_add_f32 v249, v249, v193
v_add_f32 v250, v250, v194
v_add_f32 v251, v251, v195
v_rcp_f32 v248, v248
v_rcp_f32 v249, v249
v_rcp_f32 v250, v250
v_rcp_f32 v251, v251
v_subrev_u32 v236, 65536, v238
v_subrev_u32 v237, 65536, v239
v_subrev_u32 v242, 65536, v240
v_subrev_u32 v243, 65536, v241
v_lshlrev_b32 v203, 4, v200
s_lshl_b32 s33, s28, 12
v_add_u32 v254, s33, v203
v_lshlrev_b32 v203, 3, v200
s_lshl_b32 s33, s28, 9
s_add_u32 s34, s33, 114688
v_add_u32 v255, s34, v203
s_add_u32 s33, s33, 131072
v_add_u32 v246, s33, v203
v_add_u32 v247, 131072, v203
s_cmp_lg_u32 s28, 0
s_cbranch_scc1 L_tw1
ds_read_b64_tr_b16 v[220:221], v239 offset:32768
ds_read_b64_tr_b16 v[222:223], v239 offset:34816
ds_read_b64_tr_b16 v[224:225], v239 offset:36864
ds_read_b64_tr_b16 v[226:227], v239 offset:38912
ds_read_b64_tr_b16 v[228:229], v239 offset:40960
ds_read_b64_tr_b16 v[230:231], v239 offset:43008
s_waitcnt lgkmcnt(4)
v_mfma_f32_16x16x32_bf16 a[16:19], v[220:223], v[176:179], a[16:19]
ds_read_b64_tr_b16 v[232:233], v239 offset:45056
v_add_u32 v252, 0, v253
v_mfma_f32_16x16x32_bf16 a[20:23], v[220:223], v[180:183], a[20:23]
ds_read_b64_tr_b16 v[234:235], v239 offset:47104
s_add_u32 m0, s29, 0
v_mfma_f32_16x16x32_bf16 a[24:27], v[220:223], v[184:187], a[24:27]
buffer_load_dwordx4 v252, s[20:23], s52 offen  lds
v_mfma_f32_16x16x32_bf16 a[28:31], v[220:223], v[188:191], a[28:31]
s_waitcnt lgkmcnt(4)
ds_read_b128 v[212:215], v244 offset:2048
s_add_u32 m0, s29, 4096
v_mfma_f32_16x16x32_bf16 a[80:83], v[224:227], v[176:179], a[80:83]
buffer_load_dwordx4 v252, s[20:23], s53 offen  lds
v_mfma_f32_16x16x32_bf16 a[84:87], v[224:227], v[180:183], a[84:87]
ds_read_b128 v[216:219], v244 offset:3072
v_mfma_f32_16x16x32_bf16 a[88:91], v[224:227], v[184:187], a[88:91]
ds_read_b64_tr_b16 v[220:221], v238 offset:32768
s_add_u32 m0, s29, 8192
v_mfma_f32_16x16x32_bf16 a[92:95], v[224:227], v[188:191], a[92:95]
s_waitcnt lgkmcnt(5)
ds_read_b64_tr_b16 v[222:223], v238 offset:34816
v_accvgpr_read_b32 v160, a16
v_mfma_f32_16x16x32_bf16 a[144:147], v[228:231], v[176:179], a[144:147]
buffer_load_dwordx4 v252, s[20:23], s54 offen  lds
v_mfma_f32_16x16x32_bf16 a[148:151], v[228:231], v[180:183], a[148:151]
ds_read_b64_tr_b16 v[224:225], v238 offset:36864
v_accvgpr_read_b32 v161, a17
v_mfma_f32_16x16x32_bf16 a[152:155], v[228:231], v[184:187], a[152:155]
ds_read_b64_tr_b16 v[226:227], v238 offset:38912
s_add_u32 m0, s29, 12288
v_mfma_f32_16x16x32_bf16 a[156:159], v[228:231], v[188:191], a[156:159]
s_waitcnt lgkmcnt(6)
v_accvgpr_read_b32 v162, a18
v_accvgpr_read_b32 v163, a19
v_mfma_f32_16x16x32_bf16 a[208:211], v[232:235], v[176:179], a[208:211]
buffer_load_dwordx4 v252, s[20:23], s55 offen  lds
v_mfma_f32_16x16x32_bf16 a[212:215], v[232:235], v[180:183], a[212:215]
ds_read_b64_tr_b16 v[228:229], v238 offset:40960
v_mul_f32 v160, v160, v248
v_mfma_f32_16x16x32_bf16 a[216:219], v[232:235], v[184:187], a[216:219]
ds_read_b64_tr_b16 v[230:231], v238 offset:43008
s_add_u32 m0, s29, 16384
v_mfma_f32_16x16x32_bf16 a[220:223], v[232:235], v[188:191], a[220:223]
s_waitcnt lgkmcnt(4)
v_mul_f32 v161, v161, v248
v_mul_f32 v162, v162, v248
v_mfma_f32_16x16x32_bf16 a[0:3], v[220:223], v[176:179], a[0:3]
buffer_load_dwordx4 v252, s[20:23], s56 offen  lds
v_mfma_f32_16x16x32_bf16 a[4:7], v[220:223], v[180:183], a[4:7]
v_mul_f32 v163, v163, v248
v_cvt_pk_bf16_f32 v2, v160, v161
v_mfma_f32_16x16x32_bf16 v[128:131], v[220:223], v[212:215], v[128:131]
ds_read_b64_tr_b16 v[232:233], v238 offset:45056
s_add_u32 m0, s29, 20480
v_mfma_f32_16x16x32_bf16 a[8:11], v[220:223], v[184:187], a[8:11]
ds_read_b64_tr_b16 v[234:235], v238 offset:47104
v_cvt_pk_bf16_f32 v3, v162, v163
v_mfma_f32_16x16x32_bf16 v[132:135], v[220:223], v[216:219], v[132:135]
buffer_load_dwordx4 v252, s[20:23], s57 offen  lds
v_mfma_f32_16x16x32_bf16 a[12:15], v[220:223], v[188:191], a[12:15]
s_waitcnt lgkmcnt(4)
v_accvgpr_read_b32 v164, a20
v_accvgpr_read_b32 v165, a21
v_mfma_f32_16x16x32_bf16 a[64:67], v[224:227], v[176:179], a[64:67]
s_add_u32 m0, s29, 24576
v_accvgpr_read_b32 v166, a22
v_mfma_f32_16x16x32_bf16 a[68:71], v[224:227], v[180:183], a[68:71]
v_accvgpr_read_b32 v167, a23
v_mul_f32 v164, v164, v249
v_mfma_f32_16x16x32_bf16 v[136:139], v[224:227], v[212:215], v[136:139]
buffer_load_dwordx4 v252, s[20:23], s58 offen  lds
v_mfma_f32_16x16x32_bf16 a[72:75], v[224:227], v[184:187], a[72:75]
ds_read_b64_tr_b16 v[220:221], v240 offset:32768
v_mul_f32 v165, v165, v249
v_mfma_f32_16x16x32_bf16 v[140:143], v[224:227], v[216:219], v[140:143]
ds_read_b64_tr_b16 v[222:223], v240 offset:34816
s_add_u32 m0, s29, 28672
v_mfma_f32_16x16x32_bf16 a[76:79], v[224:227], v[188:191], a[76:79]
s_waitcnt lgkmcnt(2)
v_mul_f32 v166, v166, v249
v_mul_f32 v167, v167, v249
v_mfma_f32_16x16x32_bf16 a[128:131], v[228:231], v[176:179], a[128:131]
buffer_load_dwordx4 v252, s[20:23], s59 offen  lds
v_mfma_f32_16x16x32_bf16 a[132:135], v[228:231], v[180:183], a[132:135]
ds_read_b64_tr_b16 v[224:225], v240 offset:36864
v_cvt_pk_bf16_f32 v34, v164, v165
v_mfma_f32_16x16x32_bf16 v[144:147], v[228:231], v[212:215], v[144:147]
ds_read_b64_tr_b16 v[226:227], v240 offset:38912
v_add_u32 v252, 229376, v253
v_mfma_f32_16x16x32_bf16 a[136:139], v[228:231], v[184:187], a[136:139]
s_add_u32 m0, s29, 32768
v_cvt_pk_bf16_f32 v35, v166, v167
v_mfma_f32_16x16x32_bf16 v[148:151], v[228:231], v[216:219], v[148:151]
buffer_load_dwordx4 v252, s[20:23], s52 offen  lds
v_mfma_f32_16x16x32_bf16 a[140:143], v[228:231], v[188:191], a[140:143]
ds_read_b64_tr_b16 v[228:229], v240 offset:40960
v_accvgpr_read_b32 v168, a80
v_mfma_f32_16x16x32_bf16 a[192:195], v[232:235], v[176:179], a[192:195]
ds_read_b64_tr_b16 v[230:231], v240 offset:43008
s_add_u32 m0, s29, 36864
v_mfma_f32_16x16x32_bf16 a[196:199], v[232:235], v[180:183], a[196:199]
v_accvgpr_read_b32 v169, a81
v_accvgpr_read_b32 v170, a82
v_mfma_f32_16x16x32_bf16 v[152:155], v[232:235], v[212:215], v[152:155]
buffer_load_dwordx4 v252, s[20:23], s53 offen  lds
v_mfma_f32_16x16x32_bf16 a[200:203], v[232:235], v[184:187], a[200:203]
v_accvgpr_read_b32 v171, a83
v_mul_f32 v168, v168, v248
v_mfma_f32_16x16x32_bf16 v[156:159], v[232:235], v[216:219], v[156:159]
s_add_u32 m0, s29, 40960
v_mul_f32 v169, v169, v248
v_mfma_f32_16x16x32_bf16 a[204:207], v[232:235], v[188:191], a[204:207]
s_waitcnt lgkmcnt(2)
ds_read_b64_tr_b16 v[232:233], v240 offset:45056
v_mul_f32 v170, v170, v248
v_mfma_f32_16x16x32_bf16 a[32:35], v[220:223], v[176:179], a[32:35]
buffer_load_dwordx4 v252, s[20:23], s54 offen  lds
v_mfma_f32_16x16x32_bf16 a[36:39], v[220:223], v[180:183], a[36:39]
ds_read_b64_tr_b16 v[234:235], v240 offset:47104
v_mul_f32 v171, v171, v248
v_mfma_f32_16x16x32_bf16 a[40:43], v[220:223], v[184:187], a[40:43]
s_add_u32 m0, s29, 45056
v_cvt_pk_bf16_f32 v10, v168, v169
v_mfma_f32_16x16x32_bf16 a[44:47], v[220:223], v[188:191], a[44:47]
ds_read_b64_tr_b16 v[220:221], v241 offset:32768
v_mul_f32 v128, v128, v206
v_mfma_f32_16x16x32_bf16 a[96:99], v[224:227], v[176:179], a[96:99]
buffer_load_dwordx4 v252, s[20:23], s55 offen  lds
v_mfma_f32_16x16x32_bf16 a[100:103], v[224:227], v[180:183], a[100:103]
ds_read_b64_tr_b16 v[222:223], v241 offset:34816
v_mul_f32 v129, v129, v206
v_mfma_f32_16x16x32_bf16 a[104:107], v[224:227], v[184:187], a[104:107]
s_add_u32 m0, s29, 49152
v_mul_f32 v130, v130, v206
v_mfma_f32_16x16x32_bf16 a[108:111], v[224:227], v[188:191], a[108:111]
s_waitcnt lgkmcnt(4)
ds_read_b64_tr_b16 v[224:225], v241 offset:36864
v_mul_f32 v131, v131, v206
v_mfma_f32_16x16x32_bf16 a[160:163], v[228:231], v[176:179], a[160:163]
buffer_load_dwordx4 v252, s[20:23], s56 offen  lds
v_mfma_f32_16x16x32_bf16 a[164:167], v[228:231], v[180:183], a[164:167]
ds_read_b64_tr_b16 v[226:227], v241 offset:38912
v_cvt_pk_bf16_f32 v128, v128, v129
v_mfma_f32_16x16x32_bf16 a[168:171], v[228:231], v[184:187], a[168:171]
s_add_u32 m0, s29, 53248
v_cvt_pk_bf16_f32 v129, v130, v131
v_mfma_f32_16x16x32_bf16 a[172:175], v[228:231], v[188:191], a[172:175]
s_waitcnt lgkmcnt(4)
ds_write_b64 v246, v[128:129] offset:0
v_mfma_f32_16x16x32_bf16 a[224:227], v[232:235], v[176:179], a[224:227]
buffer_load_dwordx4 v252, s[20:23], s57 offen  lds
v_mfma_f32_16x16x32_bf16 a[228:231], v[232:235], v[180:183], a[228:231]
ds_read_b64_tr_b16 v[228:229], v241 offset:40960
v_mul_f32 v132, v132, v207
v_mfma_f32_16x16x32_bf16 a[232:235], v[232:235], v[184:187], a[232:235]
ds_read_b64_tr_b16 v[230:231], v241 offset:43008
s_add_u32 m0, s29, 57344
v_mfma_f32_16x16x32_bf16 a[236:239], v[232:235], v[188:191], a[236:239]
s_waitcnt lgkmcnt(5)
ds_read_b64_tr_b16 v[232:233], v241 offset:45056
v_mul_f32 v133, v133, v207
v_mfma_f32_16x16x32_bf16 a[48:51], v[220:223], v[176:179], a[48:51]
buffer_load_dwordx4 v252, s[20:23], s58 offen  lds
v_mfma_f32_16x16x32_bf16 a[52:55], v[220:223], v[180:183], a[52:55]
ds_read_b64_tr_b16 v[234:235], v241 offset:47104
v_mul_f32 v134, v134, v207
v_mfma_f32_16x16x32_bf16 a[56:59], v[220:223], v[184:187], a[56:59]
s_add_u32 m0, s29, 61440
v_mul_f32 v135, v135, v207
v_mfma_f32_16x16x32_bf16 a[60:63], v[220:223], v[188:191], a[60:63]
s_waitcnt lgkmcnt(5)
v_cvt_pk_bf16_f32 v132, v132, v133
v_cvt_pk_bf16_f32 v133, v134, v135
v_mfma_f32_16x16x32_bf16 a[112:115], v[224:227], v[176:179], a[112:115]
buffer_load_dwordx4 v252, s[20:23], s59 offen  lds
v_mfma_f32_16x16x32_bf16 a[116:119], v[224:227], v[180:183], a[116:119]
ds_write_b64 v246, v[132:133] offset:8192
v_mfma_f32_16x16x32_bf16 a[120:123], v[224:227], v[184:187], a[120:123]
v_mul_f32 v136, v136, v206
v_mul_f32 v137, v137, v206
v_mfma_f32_16x16x32_bf16 a[124:127], v[224:227], v[188:191], a[124:127]
s_waitcnt lgkmcnt(3)
v_mul_f32 v138, v138, v206
v_mul_f32 v139, v139, v206
v_mfma_f32_16x16x32_bf16 a[176:179], v[228:231], v[176:179], a[176:179]
v_cvt_pk_bf16_f32 v136, v136, v137
v_cvt_pk_bf16_f32 v137, v138, v139
v_mfma_f32_16x16x32_bf16 a[180:183], v[228:231], v[180:183], a[180:183]
ds_write_b64 v246, v[136:137] offset:2048
v_mfma_f32_16x16x32_bf16 a[184:187], v[228:231], v[184:187], a[184:187]
v_mul_f32 v140, v140, v207
v_mul_f32 v141, v141, v207
v_mfma_f32_16x16x32_bf16 a[188:191], v[228:231], v[188:191], a[188:191]
s_waitcnt lgkmcnt(2)
v_mul_f32 v142, v142, v207
v_mul_f32 v143, v143, v207
v_mfma_f32_16x16x32_bf16 a[240:243], v[232:235], v[176:179], a[240:243]
v_cvt_pk_bf16_f32 v140, v140, v141
v_cvt_pk_bf16_f32 v141, v142, v143
v_mfma_f32_16x16x32_bf16 a[244:247], v[232:235], v[180:183], a[244:247]
ds_write_b64 v246, v[140:141] offset:10240
v_mfma_f32_16x16x32_bf16 a[248:251], v[232:235], v[184:187], a[248:251]
v_mul_f32 v144, v144, v206
v_mul_f32 v145, v145, v206
v_mfma_f32_16x16x32_bf16 a[252:255], v[232:235], v[188:191], a[252:255]
v_mul_f32 v146, v146, v206
v_mul_f32 v147, v147, v206
v_cvt_pk_bf16_f32 v11, v170, v171
v_accvgpr_read_b32 v172, a84
v_accvgpr_read_b32 v173, a85
v_accvgpr_read_b32 v174, a86
v_accvgpr_read_b32 v175, a87
v_mul_f32 v172, v172, v249
v_mul_f32 v173, v173, v249
v_mul_f32 v174, v174, v249
v_mul_f32 v175, v175, v249
v_cvt_pk_bf16_f32 v42, v172, v173
v_cvt_pk_bf16_f32 v43, v174, v175
v_accvgpr_read_b32 v192, a144
v_accvgpr_read_b32 v193, a145
v_accvgpr_read_b32 v194, a146
v_accvgpr_read_b32 v195, a147
v_mul_f32 v192, v192, v248
v_mul_f32 v193, v193, v248
v_mul_f32 v194, v194, v248
v_mul_f32 v195, v195, v248
v_cvt_pk_bf16_f32 v18, v192, v193
v_cvt_pk_bf16_f32 v19, v194, v195
v_accvgpr_read_b32 v196, a148
v_accvgpr_read_b32 v197, a149
v_accvgpr_read_b32 v198, a150
v_accvgpr_read_b32 v199, a151
v_mul_f32 v196, v196, v249
v_mul_f32 v197, v197, v249
v_mul_f32 v198, v198, v249
v_mul_f32 v199, v199, v249
v_cvt_pk_bf16_f32 v50, v196, v197
v_cvt_pk_bf16_f32 v51, v198, v199
v_accvgpr_read_b32 v160, a208
v_accvgpr_read_b32 v161, a209
v_accvgpr_read_b32 v162, a210
v_accvgpr_read_b32 v163, a211
v_mul_f32 v160, v160, v248
v_mul_f32 v161, v161, v248
v_mul_f32 v162, v162, v248
v_mul_f32 v163, v163, v248
v_cvt_pk_bf16_f32 v26, v160, v161
v_cvt_pk_bf16_f32 v27, v162, v163
v_accvgpr_read_b32 v164, a212
v_accvgpr_read_b32 v165, a213
v_accvgpr_read_b32 v166, a214
v_accvgpr_read_b32 v167, a215
v_mul_f32 v164, v164, v249
v_mul_f32 v165, v165, v249
v_mul_f32 v166, v166, v249
v_mul_f32 v167, v167, v249
v_cvt_pk_bf16_f32 v58, v164, v165
v_cvt_pk_bf16_f32 v59, v166, v167
v_accvgpr_read_b32 v168, a0
v_accvgpr_read_b32 v169, a1
v_accvgpr_read_b32 v170, a2
v_accvgpr_read_b32 v171, a3
v_mul_f32 v168, v168, v248
v_mul_f32 v169, v169, v248
v_mul_f32 v170, v170, v248
v_mul_f32 v171, v171, v248
v_cvt_pk_bf16_f32 v0, v168, v169
v_cvt_pk_bf16_f32 v1, v170, v171
v_accvgpr_read_b32 v172, a4
v_accvgpr_read_b32 v173, a5
v_accvgpr_read_b32 v174, a6
v_accvgpr_read_b32 v175, a7
v_mul_f32 v172, v172, v249
v_mul_f32 v173, v173, v249
v_mul_f32 v174, v174, v249
v_mul_f32 v175, v175, v249
v_cvt_pk_bf16_f32 v32, v172, v173
v_cvt_pk_bf16_f32 v33, v174, v175
v_accvgpr_read_b32 v192, a64
v_accvgpr_read_b32 v193, a65
v_accvgpr_read_b32 v194, a66
v_accvgpr_read_b32 v195, a67
v_mul_f32 v192, v192, v248
v_mul_f32 v193, v193, v248
v_mul_f32 v194, v194, v248
v_mul_f32 v195, v195, v248
v_cvt_pk_bf16_f32 v8, v192, v193
v_cvt_pk_bf16_f32 v9, v194, v195
v_accvgpr_read_b32 v196, a68
v_accvgpr_read_b32 v197, a69
v_accvgpr_read_b32 v198, a70
v_accvgpr_read_b32 v199, a71
v_mul_f32 v196, v196, v249
v_mul_f32 v197, v197, v249
v_mul_f32 v198, v198, v249
v_mul_f32 v199, v199, v249
v_cvt_pk_bf16_f32 v40, v196, v197
v_cvt_pk_bf16_f32 v41, v198, v199
v_accvgpr_read_b32 v160, a128
v_accvgpr_read_b32 v161, a129
v_accvgpr_read_b32 v162, a130
v_accvgpr_read_b32 v163, a131
v_mul_f32 v160, v160, v248
v_mul_f32 v161, v161, v248
v_mul_f32 v162, v162, v248
v_mul_f32 v163, v163, v248
v_cvt_pk_bf16_f32 v16, v160, v161
v_cvt_pk_bf16_f32 v17, v162, v163
v_accvgpr_read_b32 v164, a132
v_accvgpr_read_b32 v165, a133
v_accvgpr_read_b32 v166, a134
v_accvgpr_read_b32 v167, a135
v_mul_f32 v164, v164, v249
v_mul_f32 v165, v165, v249
v_mul_f32 v166, v166, v249
v_mul_f32 v167, v167, v249
v_cvt_pk_bf16_f32 v48, v164, v165
v_cvt_pk_bf16_f32 v49, v166, v167
v_cvt_pk_bf16_f32 v144, v144, v145
v_cvt_pk_bf16_f32 v145, v146, v147
ds_write_b64 v246, v[144:145] offset:4096
v_mul_f32 v148, v148, v207
v_mul_f32 v149, v149, v207
v_mul_f32 v150, v150, v207
v_mul_f32 v151, v151, v207
v_cvt_pk_bf16_f32 v148, v148, v149
v_cvt_pk_bf16_f32 v149, v150, v151
ds_write_b64 v246, v[148:149] offset:12288
v_mul_f32 v152, v152, v206
v_mul_f32 v153, v153, v206
v_mul_f32 v154, v154, v206
v_mul_f32 v155, v155, v206
v_cvt_pk_bf16_f32 v152, v152, v153
v_cvt_pk_bf16_f32 v153, v154, v155
ds_write_b64 v246, v[152:153] offset:6144
v_mul_f32 v156, v156, v207
v_mul_f32 v157, v157, v207
v_mul_f32 v158, v158, v207
v_mul_f32 v159, v159, v207
v_cvt_pk_bf16_f32 v156, v156, v157
v_cvt_pk_bf16_f32 v157, v158, v159
ds_write_b64 v246, v[156:157] offset:14336
v_accvgpr_read_b32 v168, a192
v_accvgpr_read_b32 v169, a193
v_accvgpr_read_b32 v170, a194
v_accvgpr_read_b32 v171, a195
v_mul_f32 v168, v168, v248
v_mul_f32 v169, v169, v248
v_mul_f32 v170, v170, v248
v_mul_f32 v171, v171, v248
v_cvt_pk_bf16_f32 v24, v168, v169
v_cvt_pk_bf16_f32 v25, v170, v171
v_accvgpr_read_b32 v172, a196
v_accvgpr_read_b32 v173, a197
v_accvgpr_read_b32 v174, a198
v_accvgpr_read_b32 v175, a199
v_mul_f32 v172, v172, v249
v_mul_f32 v173, v173, v249
v_mul_f32 v174, v174, v249
v_mul_f32 v175, v175, v249
v_cvt_pk_bf16_f32 v56, v172, v173
v_cvt_pk_bf16_f32 v57, v174, v175
v_accvgpr_read_b32 v192, a32
v_accvgpr_read_b32 v193, a33
v_accvgpr_read_b32 v194, a34
v_accvgpr_read_b32 v195, a35
v_mul_f32 v192, v192, v248
v_mul_f32 v193, v193, v248
v_mul_f32 v194, v194, v248
v_mul_f32 v195, v195, v248
v_cvt_pk_bf16_f32 v4, v192, v193
v_cvt_pk_bf16_f32 v5, v194, v195
v_accvgpr_read_b32 v196, a36
v_accvgpr_read_b32 v197, a37
v_accvgpr_read_b32 v198, a38
v_accvgpr_read_b32 v199, a39
v_mul_f32 v196, v196, v249
v_mul_f32 v197, v197, v249
v_mul_f32 v198, v198, v249
v_mul_f32 v199, v199, v249
v_cvt_pk_bf16_f32 v36, v196, v197
v_cvt_pk_bf16_f32 v37, v198, v199
v_accvgpr_read_b32 v160, a96
v_accvgpr_read_b32 v161, a97
v_accvgpr_read_b32 v162, a98
v_accvgpr_read_b32 v163, a99
v_mul_f32 v160, v160, v248
v_mul_f32 v161, v161, v248
v_mul_f32 v162, v162, v248
v_mul_f32 v163, v163, v248
v_cvt_pk_bf16_f32 v12, v160, v161
v_cvt_pk_bf16_f32 v13, v162, v163
v_accvgpr_read_b32 v164, a100
v_accvgpr_read_b32 v165, a101
v_accvgpr_read_b32 v166, a102
v_accvgpr_read_b32 v167, a103
v_mul_f32 v164, v164, v249
v_mul_f32 v165, v165, v249
v_mul_f32 v166, v166, v249
v_mul_f32 v167, v167, v249
v_cvt_pk_bf16_f32 v44, v164, v165
v_cvt_pk_bf16_f32 v45, v166, v167
v_accvgpr_read_b32 v168, a160
v_accvgpr_read_b32 v169, a161
v_accvgpr_read_b32 v170, a162
v_accvgpr_read_b32 v171, a163
v_mul_f32 v168, v168, v248
v_mul_f32 v169, v169, v248
v_mul_f32 v170, v170, v248
v_mul_f32 v171, v171, v248
v_cvt_pk_bf16_f32 v20, v168, v169
v_cvt_pk_bf16_f32 v21, v170, v171
v_accvgpr_read_b32 v172, a164
v_accvgpr_read_b32 v173, a165
v_accvgpr_read_b32 v174, a166
v_accvgpr_read_b32 v175, a167
v_mul_f32 v172, v172, v249
v_mul_f32 v173, v173, v249
v_mul_f32 v174, v174, v249
v_mul_f32 v175, v175, v249
v_cvt_pk_bf16_f32 v52, v172, v173
v_cvt_pk_bf16_f32 v53, v174, v175
v_accvgpr_read_b32 v192, a224
v_accvgpr_read_b32 v193, a225
v_accvgpr_read_b32 v194, a226
v_accvgpr_read_b32 v195, a227
v_mul_f32 v192, v192, v248
v_mul_f32 v193, v193, v248
v_mul_f32 v194, v194, v248
v_mul_f32 v195, v195, v248
v_cvt_pk_bf16_f32 v28, v192, v193
v_cvt_pk_bf16_f32 v29, v194, v195
v_accvgpr_read_b32 v196, a228
v_accvgpr_read_b32 v197, a229
v_accvgpr_read_b32 v198, a230
v_accvgpr_read_b32 v199, a231
v_mul_f32 v196, v196, v249
v_mul_f32 v197, v197, v249
v_mul_f32 v198, v198, v249
v_mul_f32 v199, v199, v249
v_cvt_pk_bf16_f32 v60, v196, v197
v_cvt_pk_bf16_f32 v61, v198, v199
v_accvgpr_read_b32 v160, a48
v_accvgpr_read_b32 v161, a49
v_accvgpr_read_b32 v162, a50
v_accvgpr_read_b32 v163, a51
v_mul_f32 v160, v160, v248
v_mul_f32 v161, v161, v248
v_mul_f32 v162, v162, v248
v_mul_f32 v163, v163, v248
v_cvt_pk_bf16_f32 v6, v160, v161
v_cvt_pk_bf16_f32 v7, v162, v163
v_accvgpr_read_b32 v164, a52
v_accvgpr_read_b32 v165, a53
v_accvgpr_read_b32 v166, a54
v_accvgpr_read_b32 v167, a55
v_mul_f32 v164, v164, v249
v_mul_f32 v165, v165, v249
v_mul_f32 v166, v166, v249
v_mul_f32 v167, v167, v249
v_cvt_pk_bf16_f32 v38, v164, v165
v_cvt_pk_bf16_f32 v39, v166, v167
v_accvgpr_read_b32 v168, a112
v_accvgpr_read_b32 v169, a113
v_accvgpr_read_b32 v170, a114
v_accvgpr_read_b32 v171, a115
v_mul_f32 v168, v168, v248
v_mul_f32 v169, v169, v248
v_mul_f32 v170, v170, v248
v_mul_f32 v171, v171, v248
v_cvt_pk_bf16_f32 v14, v168, v169
v_cvt_pk_bf16_f32 v15, v170, v171
v_accvgpr_read_b32 v172, a116
v_accvgpr_read_b32 v173, a117
v_accvgpr_read_b32 v174, a118
v_accvgpr_read_b32 v175, a119
v_mul_f32 v172, v172, v249
v_mul_f32 v173, v173, v249
v_mul_f32 v174, v174, v249
v_mul_f32 v175, v175, v249
v_cvt_pk_bf16_f32 v46, v172, v173
v_cvt_pk_bf16_f32 v47, v174, v175
v_accvgpr_read_b32 v192, a176
v_accvgpr_read_b32 v193, a177
v_accvgpr_read_b32 v194, a178
v_accvgpr_read_b32 v195, a179
v_mul_f32 v192, v192, v248
v_mul_f32 v193, v193, v248
v_mul_f32 v194, v194, v248
v_mul_f32 v195, v195, v248
v_cvt_pk_bf16_f32 v22, v192, v193
v_cvt_pk_bf16_f32 v23, v194, v195
v_accvgpr_read_b32 v196, a180
v_accvgpr_read_b32 v197, a181
v_accvgpr_read_b32 v198, a182
v_accvgpr_read_b32 v199, a183
v_mul_f32 v196, v196, v249
v_mul_f32 v197, v197, v249
v_mul_f32 v198, v198, v249
v_mul_f32 v199, v199, v249
v_cvt_pk_bf16_f32 v54, v196, v197
v_cvt_pk_bf16_f32 v55, v198, v199
v_accvgpr_read_b32 v160, a240
v_accvgpr_read_b32 v161, a241
v_accvgpr_read_b32 v162, a242
v_accvgpr_read_b32 v163, a243
v_mul_f32 v160, v160, v248
v_mul_f32 v161, v161, v248
v_mul_f32 v162, v162, v248
v_mul_f32 v163, v163, v248
v_cvt_pk_bf16_f32 v30, v160, v161
v_cvt_pk_bf16_f32 v31, v162, v163
v_accvgpr_read_b32 v164, a244
v_accvgpr_read_b32 v165, a245
v_accvgpr_read_b32 v166, a246
v_accvgpr_read_b32 v167, a247
v_mul_f32 v164, v164, v249
v_mul_f32 v165, v165, v249
v_mul_f32 v166, v166, v249
v_mul_f32 v167, v167, v249
v_cvt_pk_bf16_f32 v62, v164, v165
v_cvt_pk_bf16_f32 v63, v166, v167
s_waitcnt vmcnt(0) lgkmcnt(0)
s_barrier
ds_read_b64_tr_b16 a[176:177], v236 offset:0
ds_read_b64_tr_b16 a[178:179], v236 offset:2048
ds_read_b64 a[0:1], v247 offset:0
ds_read_b64 a[2:3], v247 offset:512
ds_read_b64_tr_b16 a[180:181], v237 offset:0
ds_read_b64_tr_b16 a[182:183], v237 offset:2048
ds_read_b64_tr_b16 a[192:193], v242 offset:0
ds_read_b64_tr_b16 a[194:195], v242 offset:2048
ds_read_b64_tr_b16 a[196:197], v243 offset:0
ds_read_b64_tr_b16 a[198:199], v243 offset:2048
s_waitcnt lgkmcnt(8)
v_mfma_f32_16x16x32_bf16 v[128:131], a[176:179], v[0:3], 0
ds_read_b64_tr_b16 a[208:209], v236 offset:4096
v_add_u32 v252, 128, v253
v_mfma_f32_16x16x32_bf16 v[132:135], a[176:179], v[32:35], 0
s_waitcnt lgkmcnt(7)
ds_read_b64_tr_b16 a[210:211], v236 offset:6144
s_add_u32 m0, s29, 65536
v_mfma_f32_16x16x32_bf16 v[208:211], a[176:179], a[0:3], 0
s_waitcnt lgkmcnt(6)
ds_read_b64 a[4:5], v247 offset:1024
v_accvgpr_read_b32 v160, a8
v_mfma_f32_16x16x32_bf16 v[136:139], a[180:183], v[0:3], 0
ds_read_b64 a[6:7], v247 offset:1536
v_accvgpr_read_b32 v161, a9
v_mfma_f32_16x16x32_bf16 v[140:143], a[180:183], v[32:35], 0
s_waitcnt lgkmcnt(6)
ds_read_b64_tr_b16 a[212:213], v237 offset:4096
v_accvgpr_read_b32 v162, a10
v_mfma_f32_16x16x32_bf16 v[144:147], a[192:195], v[0:3], 0
ds_read_b64_tr_b16 a[214:215], v237 offset:6144
buffer_load_dwordx4 v252, s[20:23], s52 offen  lds
v_mfma_f32_16x16x32_bf16 v[148:151], a[192:195], v[32:35], 0
s_waitcnt lgkmcnt(6)
ds_read_b64_tr_b16 a[224:225], v242 offset:4096
s_add_u32 m0, s29, 69632
v_mfma_f32_16x16x32_bf16 v[152:155], a[196:199], v[0:3], 0
ds_read_b64_tr_b16 a[226:227], v242 offset:6144
v_accvgpr_read_b32 v163, a11
v_mfma_f32_16x16x32_bf16 v[156:159], a[196:199], v[32:35], 0
s_waitcnt lgkmcnt(6)
ds_read_b64_tr_b16 a[228:229], v243 offset:4096
buffer_load_dwordx4 v252, s[20:23], s53 offen  lds
v_mfma_f32_16x16x32_bf16 v[128:131], a[208:211], v[4:7], v[128:131]
ds_read_b64_tr_b16 a[230:231], v243 offset:6144
s_add_u32 m0, s29, 73728
v_mfma_f32_16x16x32_bf16 v[132:135], a[208:211], v[36:39], v[132:135]
s_waitcnt lgkmcnt(6)
ds_read_b64_tr_b16 a[240:241], v236 offset:8192
v_mul_f32 v160, v160, v250
v_mfma_f32_16x16x32_bf16 v[208:211], a[208:211], a[4:7], v[208:211]
s_waitcnt lgkmcnt(5)
ds_read_b64_tr_b16 a[242:243], v236 offset:10240
v_mul_f32 v161, v161, v250
v_mfma_f32_16x16x32_bf16 v[136:139], a[212:215], v[4:7], v[136:139]
ds_read_b64 a[16:17], v247 offset:2048
buffer_load_dwordx4 v252, s[20:23], s54 offen  lds
v_mfma_f32_16x16x32_bf16 v[140:143], a[212:215], v[36:39], v[140:143]
s_waitcnt lgkmcnt(5)
ds_read_b64 a[18:19], v247 offset:2560
s_add_u32 m0, s29, 77824
v_mfma_f32_16x16x32_bf16 v[144:147], a[224:227], v[4:7], v[144:147]
ds_read_b64_tr_b16 a[244:245], v237 offset:8192
v_mul_f32 v162, v162, v250
v_mfma_f32_16x16x32_bf16 v[148:151], a[224:227], v[36:39], v[148:151]
s_waitcnt lgkmcnt(5)
ds_read_b64_tr_b16 a[246:247], v237 offset:10240
v_mul_f32 v163, v163, v250
v_mfma_f32_16x16x32_bf16 v[152:155], a[228:231], v[4:7], v[152:155]
ds_read_b64_tr_b16 a[176:177], v242 offset:8192
buffer_load_dwordx4 v252, s[20:23], s55 offen  lds
v_mfma_f32_16x16x32_bf16 v[156:159], a[228:231], v[36:39], v[156:159]
s_waitcnt lgkmcnt(5)
ds_read_b64_tr_b16 a[178:179], v242 offset:10240
s_add_u32 m0, s29, 81920
v_mfma_f32_16x16x32_bf16 v[128:131], a[240:243], v[8:11], v[128:131]
ds_read_b64_tr_b16 a[180:181], v243 offset:8192
v_cvt_pk_bf16_f32 v64, v160, v161
v_mfma_f32_16x16x32_bf16 v[132:135], a[240:243], v[40:43], v[132:135]
s_waitcnt lgkmcnt(5)
ds_read_b64_tr_b16 a[182:183], v243 offset:10240
v_cvt_pk_bf16_f32 v65, v162, v163
v_mfma_f32_16x16x32_bf16 v[208:211], a[240:243], a[16:19], v[208:211]
s_waitcnt lgkmcnt(4)
ds_read_b64_tr_b16 a[192:193], v236 offset:12288
buffer_load_dwordx4 v252, s[20:23], s56 offen  lds
v_mfma_f32_16x16x32_bf16 v[136:139], a[244:247], v[8:11], v[136:139]
ds_read_b64_tr_b16 a[194:195], v236 offset:14336
s_add_u32 m0, s29, 86016
v_mfma_f32_16x16x32_bf16 v[140:143], a[244:247], v[40:43], v[140:143]
s_waitcnt lgkmcnt(4)
ds_read_b64 a[20:21], v247 offset:3072
v_accvgpr_read_b32 v164, a12
v_mfma_f32_16x16x32_bf16 v[144:147], a[176:179], v[8:11], v[144:147]
ds_read_b64 a[22:23], v247 offset:3584
v_accvgpr_read_b32 v165, a13
v_mfma_f32_16x16x32_bf16 v[148:151], a[176:179], v[40:43], v[148:151]
s_waitcnt lgkmcnt(4)
ds_read_b64_tr_b16 a[196:197], v237 offset:12288
buffer_load_dwordx4 v252, s[20:23], s57 offen  lds
v_mfma_f32_16x16x32_bf16 v[152:155], a[180:183], v[8:11], v[152:155]
ds_read_b64_tr_b16 a[198:199], v237 offset:14336
s_add_u32 m0, s29, 90112
v_mfma_f32_16x16x32_bf16 v[156:159], a[180:183], v[40:43], v[156:159]
s_waitcnt lgkmcnt(4)
ds_read_b64_tr_b16 a[208:209], v242 offset:12288
v_accvgpr_read_b32 v166, a14
v_mfma_f32_16x16x32_bf16 v[128:131], a[192:195], v[12:15], v[128:131]
ds_read_b64_tr_b16 a[210:211], v242 offset:14336
v_accvgpr_read_b32 v167, a15
v_mfma_f32_16x16x32_bf16 v[132:135], a[192:195], v[44:47], v[132:135]
s_waitcnt lgkmcnt(4)
ds_read_b64_tr_b16 a[212:213], v243 offset:12288
buffer_load_dwordx4 v252, s[20:23], s58 offen  lds
v_mfma_f32_16x16x32_bf16 v[208:211], a[192:195], a[20:23], v[208:211]
s_waitcnt lgkmcnt(3)
ds_read_b64_tr_b16 a[214:215], v243 offset:14336
s_add_u32 m0, s29, 94208
v_mfma_f32_16x16x32_bf16 v[136:139], a[196:199], v[12:15], v[136:139]
ds_read_b64_tr_b16 a[224:225], v236 offset:16384
v_mul_f32 v164, v164, v251
v_mfma_f32_16x16x32_bf16 v[140:143], a[196:199], v[44:47], v[140:143]
s_waitcnt lgkmcnt(3)
ds_read_b64_tr_b16 a[226:227], v236 offset:18432
v_mul_f32 v165, v165, v251
v_mfma_f32_16x16x32_bf16 v[144:147], a[208:211], v[12:15], v[144:147]
ds_read_b64 a[32:33], v247 offset:4096
buffer_load_dwordx4 v252, s[20:23], s59 offen  lds
v_mfma_f32_16x16x32_bf16 v[148:151], a[208:211], v[44:47], v[148:151]
s_waitcnt lgkmcnt(3)
ds_read_b64 a[34:35], v247 offset:4608
v_mul_f32 v166, v166, v251
v_mfma_f32_16x16x32_bf16 v[152:155], a[212:215], v[12:15], v[152:155]
ds_read_b64_tr_b16 a[228:229], v237 offset:16384
v_add_u32 v252, 229504, v253
v_mfma_f32_16x16x32_bf16 v[156:159], a[212:215], v[44:47], v[156:159]
s_waitcnt lgkmcnt(3)
ds_read_b64_tr_b16 a[230:231], v237 offset:18432
s_add_u32 m0, s29, 98304
v_mfma_f32_16x16x32_bf16 v[128:131], a[224:227], v[16:19], v[128:131]
ds_read_b64_tr_b16 a[240:241], v242 offset:16384
v_mul_f32 v167, v167, v251
v_mfma_f32_16x16x32_bf16 v[132:135], a[224:227], v[48:51], v[132:135]
s_waitcnt lgkmcnt(3)
ds_read_b64_tr_b16 a[242:243], v242 offset:18432
v_cvt_pk_bf16_f32 v96, v164, v165
v_mfma_f32_16x16x32_bf16 v[208:211], a[224:227], a[32:35], v[208:211]
s_waitcnt lgkmcnt(2)
ds_read_b64_tr_b16 a[244:245], v243 offset:16384
v_cvt_pk_bf16_f32 v97, v166, v167
v_mfma_f32_16x16x32_bf16 v[136:139], a[228:231], v[16:19], v[136:139]
ds_read_b64_tr_b16 a[246:247], v243 offset:18432
v_accvgpr_read_b32 v168, a24
v_mfma_f32_16x16x32_bf16 v[140:143], a[228:231], v[48:51], v[140:143]
s_waitcnt lgkmcnt(2)
ds_read_b64_tr_b16 a[176:177], v236 offset:20480
buffer_load_dwordx4 v252, s[20:23], s52 offen  lds
v_mfma_f32_16x16x32_bf16 v[144:147], a[240:243], v[16:19], v[144:147]
ds_read_b64_tr_b16 a[178:179], v236 offset:22528
s_add_u32 m0, s29, 102400
v_mfma_f32_16x16x32_bf16 v[148:151], a[240:243], v[48:51], v[148:151]
s_waitcnt lgkmcnt(2)
ds_read_b64 a[36:37], v247 offset:5120
v_accvgpr_read_b32 v169, a25
v_mfma_f32_16x16x32_bf16 v[152:155], a[244:247], v[16:19], v[152:155]
ds_read_b64 a[38:39], v247 offset:5632
buffer_load_dwordx4 v252, s[20:23], s53 offen  lds
v_mfma_f32_16x16x32_bf16 v[156:159], a[244:247], v[48:51], v[156:159]
s_waitcnt lgkmcnt(2)
ds_read_b64_tr_b16 a[180:181], v237 offset:20480
s_add_u32 m0, s29, 106496
v_mfma_f32_16x16x32_bf16 v[128:131], a[176:179], v[20:23], v[128:131]
ds_read_b64_tr_b16 a[182:183], v237 offset:22528
v_accvgpr_read_b32 v170, a26
v_mfma_f32_16x16x32_bf16 v[132:135], a[176:179], v[52:55], v[132:135]
s_waitcnt lgkmcnt(2)
ds_read_b64_tr_b16 a[192:193], v242 offset:20480
v_accvgpr_read_b32 v171, a27
v_mfma_f32_16x16x32_bf16 v[208:211], a[176:179], a[36:39], v[208:211]
s_waitcnt lgkmcnt(1)
ds_read_b64_tr_b16 a[194:195], v242 offset:22528
buffer_load_dwordx4 v252, s[20:23], s54 offen  lds
v_mfma_f32_16x16x32_bf16 v[136:139], a[180:183], v[20:23], v[136:139]
ds_read_b64_tr_b16 a[196:197], v243 offset:20480
s_add_u32 m0, s29, 110592
v_mfma_f32_16x16x32_bf16 v[140:143], a[180:183], v[52:55], v[140:143]
s_waitcnt lgkmcnt(1)
ds_read_b64_tr_b16 a[198:199], v243 offset:22528
v_mul_f32 v168, v168, v250
v_mfma_f32_16x16x32_bf16 v[144:147], a[192:195], v[20:23], v[144:147]
ds_read_b64_tr_b16 a[208:209], v236 offset:24576
buffer_load_dwordx4 v252, s[20:23], s55 offen  lds
v_mfma_f32_16x16x32_bf16 v[148:151], a[192:195], v[52:55], v[148:151]
s_waitcnt lgkmcnt(1)
ds_read_b64_tr_b16 a[210:211], v236 offset:26624
s_add_u32 m0, s29, 114688
v_mfma_f32_16x16x32_bf16 v[152:155], a[196:199], v[20:23], v[152:155]
ds_read_b64 a[48:49], v247 offset:6144
v_mul_f32 v169, v169, v250
v_mfma_f32_16x16x32_bf16 v[156:159], a[196:199], v[52:55], v[156:159]
s_waitcnt lgkmcnt(1)
ds_read_b64 a[50:51], v247 offset:6656
v_mul_f32 v170, v170, v250
v_mfma_f32_16x16x32_bf16 v[128:131], a[208:211], v[24:27], v[128:131]
ds_read_b64_tr_b16 a[212:213], v237 offset:24576
buffer_load_dwordx4 v252, s[20:23], s56 offen  lds
v_mfma_f32_16x16x32_bf16 v[132:135], a[208:211], v[56:59], v[132:135]
s_waitcnt lgkmcnt(1)
ds_read_b64_tr_b16 a[214:215], v237 offset:26624
s_add_u32 m0, s29, 118784
v_mfma_f32_16x16x32_bf16 v[208:211], a[208:211], a[48:51], v[208:211]
s_waitcnt lgkmcnt(0)
ds_read_b64_tr_b16 a[224:225], v242 offset:24576
v_mul_f32 v171, v171, v250
v_mfma_f32_16x16x32_bf16 v[136:139], a[212:215], v[24:27], v[136:139]
ds_read_b64_tr_b16 a[226:227], v242 offset:26624
buffer_load_dwordx4 v252, s[20:23], s57 offen  lds
v_mfma_f32_16x16x32_bf16 v[140:143], a[212:215], v[56:59], v[140:143]
s_waitcnt lgkmcnt(0)
ds_read_b64_tr_b16 a[228:229], v243 offset:24576
s_add_u32 m0, s29, 122880
v_mfma_f32_16x16x32_bf16 v[144:147], a[224:227], v[24:27], v[144:147]
ds_read_b64_tr_b16 a[230:231], v243 offset:26624
v_cvt_pk_bf16_f32 v66, v168, v169
v_mfma_f32_16x16x32_bf16 v[148:151], a[224:227], v[56:59], v[148:151]
s_waitcnt lgkmcnt(0)
ds_read_b64_tr_b16 a[240:241], v236 offset:28672
v_cvt_pk_bf16_f32 v67, v170, v171
v_mfma_f32_16x16x32_bf16 v[152:155], a[228:231], v[24:27], v[152:155]
ds_read_b64_tr_b16 a[242:243], v236 offset:30720
buffer_load_dwordx4 v252, s[20:23], s58 offen  lds
v_mfma_f32_16x16x32_bf16 v[156:159], a[228:231], v[56:59], v[156:159]
s_waitcnt lgkmcnt(0)
ds_read_b64 a[52:53], v247 offset:7168
s_add_u32 m0, s29, 126976
v_mfma_f32_16x16x32_bf16 v[128:131], a[240:243], v[28:31], v[128:131]
ds_read_b64 a[54:55], v247 offset:7680
v_accvgpr_read_b32 v172, a28
v_mfma_f32_16x16x32_bf16 v[132:135], a[240:243], v[60:63], v[132:135]
s_waitcnt lgkmcnt(0)
ds_read_b64_tr_b16 a[244:245], v237 offset:28672
buffer_load_dwordx4 v252, s[20:23], s59 offen  lds
v_mfma_f32_16x16x32_bf16 v[208:211], a[240:243], a[52:55], v[208:211]
ds_read_b64_tr_b16 a[246:247], v237 offset:30720
s_waitcnt lgkmcnt(0)
ds_read_b64_tr_b16 a[212:213], v242 offset:28672
v_accvgpr_read_b32 v173, a29
v_mfma_f32_16x16x32_bf16 v[136:139], a[244:247], v[28:31], v[136:139]
ds_read_b64_tr_b16 a[214:215], v242 offset:30720
v_accvgpr_read_b32 v174, a30
v_mfma_f32_16x16x32_bf16 v[140:143], a[244:247], v[60:63], v[140:143]
s_waitcnt lgkmcnt(0)
ds_read_b64_tr_b16 a[224:225], v243 offset:28672
v_accvgpr_read_b32 v175, a31
v_mfma_f32_16x16x32_bf16 v[144:147], a[212:215], v[28:31], v[144:147]
ds_read_b64_tr_b16 a[226:227], v243 offset:30720
v_mul_f32 v172, v172, v251
v_mfma_f32_16x16x32_bf16 v[148:151], a[212:215], v[60:63], v[148:151]
s_waitcnt lgkmcnt(0)
ds_read_b64_tr_b16 a[176:177], v236 offset:32768
v_mul_f32 v173, v173, v251
v_mfma_f32_16x16x32_bf16 v[152:155], a[224:227], v[28:31], v[152:155]
ds_read_b64_tr_b16 a[178:179], v236 offset:34816
v_mul_f32 v174, v174, v251
v_mfma_f32_16x16x32_bf16 v[156:159], a[224:227], v[60:63], v[156:159]
ds_read_b64_tr_b16 a[180:181], v237 offset:32768
v_mul_f32 v175, v175, v251
v_cvt_pk_bf16_f32 v98, v172, v173
ds_read_b64_tr_b16 a[182:183], v237 offset:34816
v_cvt_pk_bf16_f32 v99, v174, v175
ds_read_b64_tr_b16 a[192:193], v242 offset:32768
v_accvgpr_read_b32 v176, a40
ds_read_b64_tr_b16 a[194:195], v242 offset:34816
v_accvgpr_read_b32 v177, a41
ds_read_b64_tr_b16 a[196:197], v243 offset:32768
v_accvgpr_read_b32 v178, a42
ds_read_b64_tr_b16 a[198:199], v243 offset:34816
v_accvgpr_read_b32 v179, a43
ds_read_b64_tr_b16 a[208:209], v236 offset:36864
v_mul_f32 v176, v176, v250
ds_read_b64_tr_b16 a[210:211], v236 offset:38912
v_mul_f32 v177, v177, v250
v_mul_f32 v178, v178, v250
v_mul_f32 v179, v179, v250
v_cvt_pk_bf16_f32 v68, v176, v177
v_cvt_pk_bf16_f32 v69, v178, v179
v_accvgpr_read_b32 v180, a44
v_accvgpr_read_b32 v181, a45
v_accvgpr_read_b32 v182, a46
v_accvgpr_read_b32 v183, a47
v_mul_f32 v180, v180, v251
v_mul_f32 v181, v181, v251
v_mul_f32 v182, v182, v251
v_mul_f32 v183, v183, v251
v_cvt_pk_bf16_f32 v100, v180, v181
v_cvt_pk_bf16_f32 v101, v182, v183
v_accvgpr_read_b32 v184, a56
v_accvgpr_read_b32 v185, a57
v_accvgpr_read_b32 v186, a58
v_accvgpr_read_b32 v187, a59
v_mul_f32 v184, v184, v250
v_mul_f32 v185, v185, v250
v_mul_f32 v186, v186, v250
v_mul_f32 v187, v187, v250
v_cvt_pk_bf16_f32 v70, v184, v185
v_cvt_pk_bf16_f32 v71, v186, v187
v_accvgpr_read_b32 v188, a60
v_accvgpr_read_b32 v189, a61
v_accvgpr_read_b32 v190, a62
v_accvgpr_read_b32 v191, a63
v_mul_f32 v188, v188, v251
v_mul_f32 v189, v189, v251
v_mul_f32 v190, v190, v251
v_mul_f32 v191, v191, v251
v_cvt_pk_bf16_f32 v102, v188, v189
v_cvt_pk_bf16_f32 v103, v190, v191
v_accvgpr_read_b32 v160, a72
v_accvgpr_read_b32 v161, a73
v_accvgpr_read_b32 v162, a74
v_accvgpr_read_b32 v163, a75
v_mul_f32 v160, v160, v250
v_mul_f32 v161, v161, v250
v_mul_f32 v162, v162, v250
v_mul_f32 v163, v163, v250
v_cvt_pk_bf16_f32 v72, v160, v161
v_cvt_pk_bf16_f32 v73, v162, v163
v_accvgpr_read_b32 v164, a76
v_accvgpr_read_b32 v165, a77
v_accvgpr_read_b32 v166, a78
v_accvgpr_read_b32 v167, a79
v_mul_f32 v164, v164, v251
v_mul_f32 v165, v165, v251
v_mul_f32 v166, v166, v251
v_mul_f32 v167, v167, v251
v_cvt_pk_bf16_f32 v104, v164, v165
v_cvt_pk_bf16_f32 v105, v166, v167
v_accvgpr_read_b32 v168, a88
v_accvgpr_read_b32 v169, a89
v_accvgpr_read_b32 v170, a90
v_accvgpr_read_b32 v171, a91
v_mul_f32 v168, v168, v250
v_mul_f32 v169, v169, v250
v_mul_f32 v170, v170, v250
v_mul_f32 v171, v171, v250
v_cvt_pk_bf16_f32 v74, v168, v169
v_cvt_pk_bf16_f32 v75, v170, v171
v_accvgpr_read_b32 v172, a92
v_accvgpr_read_b32 v173, a93
v_accvgpr_read_b32 v174, a94
v_accvgpr_read_b32 v175, a95
v_mul_f32 v172, v172, v251
v_mul_f32 v173, v173, v251
v_mul_f32 v174, v174, v251
v_mul_f32 v175, v175, v251
v_cvt_pk_bf16_f32 v106, v172, v173
v_cvt_pk_bf16_f32 v107, v174, v175
v_accvgpr_read_b32 v176, a104
v_accvgpr_read_b32 v177, a105
v_accvgpr_read_b32 v178, a106
v_accvgpr_read_b32 v179, a107
v_mul_f32 v176, v176, v250
v_mul_f32 v177, v177, v250
v_mul_f32 v178, v178, v250
v_mul_f32 v179, v179, v250
v_cvt_pk_bf16_f32 v76, v176, v177
v_cvt_pk_bf16_f32 v77, v178, v179
v_accvgpr_read_b32 v180, a108
v_accvgpr_read_b32 v181, a109
v_accvgpr_read_b32 v182, a110
v_accvgpr_read_b32 v183, a111
v_mul_f32 v180, v180, v251
v_mul_f32 v181, v181, v251
v_mul_f32 v182, v182, v251
v_mul_f32 v183, v183, v251
v_cvt_pk_bf16_f32 v108, v180, v181
v_cvt_pk_bf16_f32 v109, v182, v183
v_accvgpr_read_b32 v184, a120
v_accvgpr_read_b32 v185, a121
v_accvgpr_read_b32 v186, a122
v_accvgpr_read_b32 v187, a123
v_mul_f32 v184, v184, v250
v_mul_f32 v185, v185, v250
v_mul_f32 v186, v186, v250
v_mul_f32 v187, v187, v250
v_cvt_pk_bf16_f32 v78, v184, v185
v_cvt_pk_bf16_f32 v79, v186, v187
v_accvgpr_read_b32 v188, a124
v_accvgpr_read_b32 v189, a125
v_accvgpr_read_b32 v190, a126
v_accvgpr_read_b32 v191, a127
v_mul_f32 v188, v188, v251
v_mul_f32 v189, v189, v251
v_mul_f32 v190, v190, v251
v_mul_f32 v191, v191, v251
v_cvt_pk_bf16_f32 v110, v188, v189
v_cvt_pk_bf16_f32 v111, v190, v191
v_accvgpr_read_b32 v160, a136
v_accvgpr_read_b32 v161, a137
v_accvgpr_read_b32 v162, a138
v_accvgpr_read_b32 v163, a139
v_mul_f32 v160, v160, v250
v_mul_f32 v161, v161, v250
v_mul_f32 v162, v162, v250
v_mul_f32 v163, v163, v250
v_cvt_pk_bf16_f32 v80, v160, v161
v_cvt_pk_bf16_f32 v81, v162, v163
v_accvgpr_read_b32 v164, a140
v_accvgpr_read_b32 v165, a141
v_accvgpr_read_b32 v166, a142
v_accvgpr_read_b32 v167, a143
v_mul_f32 v164, v164, v251
v_mul_f32 v165, v165, v251
v_mul_f32 v166, v166, v251
v_mul_f32 v167, v167, v251
v_cvt_pk_bf16_f32 v112, v164, v165
v_cvt_pk_bf16_f32 v113, v166, v167
v_accvgpr_read_b32 v168, a152
v_accvgpr_read_b32 v169, a153
v_accvgpr_read_b32 v170, a154
v_accvgpr_read_b32 v171, a155
v_mul_f32 v168, v168, v250
v_mul_f32 v169, v169, v250
v_mul_f32 v170, v170, v250
v_mul_f32 v171, v171, v250
v_cvt_pk_bf16_f32 v82, v168, v169
v_cvt_pk_bf16_f32 v83, v170, v171
v_accvgpr_read_b32 v172, a156
v_accvgpr_read_b32 v173, a157
v_accvgpr_read_b32 v174, a158
v_accvgpr_read_b32 v175, a159
v_mul_f32 v172, v172, v251
v_mul_f32 v173, v173, v251
v_mul_f32 v174, v174, v251
v_mul_f32 v175, v175, v251
v_cvt_pk_bf16_f32 v114, v172, v173
v_cvt_pk_bf16_f32 v115, v174, v175
v_accvgpr_read_b32 v176, a168
v_accvgpr_read_b32 v177, a169
v_accvgpr_read_b32 v178, a170
v_accvgpr_read_b32 v179, a171
v_mul_f32 v176, v176, v250
v_mul_f32 v177, v177, v250
v_mul_f32 v178, v178, v250
v_mul_f32 v179, v179, v250
v_cvt_pk_bf16_f32 v84, v176, v177
v_cvt_pk_bf16_f32 v85, v178, v179
v_accvgpr_read_b32 v180, a172
v_accvgpr_read_b32 v181, a173
v_accvgpr_read_b32 v182, a174
v_accvgpr_read_b32 v183, a175
v_mul_f32 v180, v180, v251
v_mul_f32 v181, v181, v251
v_mul_f32 v182, v182, v251
v_mul_f32 v183, v183, v251
v_cvt_pk_bf16_f32 v116, v180, v181
v_cvt_pk_bf16_f32 v117, v182, v183
v_accvgpr_read_b32 v184, a184
v_accvgpr_read_b32 v185, a185
v_accvgpr_read_b32 v186, a186
v_accvgpr_read_b32 v187, a187
v_mul_f32 v184, v184, v250
v_mul_f32 v185, v185, v250
v_mul_f32 v186, v186, v250
v_mul_f32 v187, v187, v250
v_cvt_pk_bf16_f32 v86, v184, v185
v_cvt_pk_bf16_f32 v87, v186, v187
v_accvgpr_read_b32 v188, a188
v_accvgpr_read_b32 v189, a189
v_accvgpr_read_b32 v190, a190
v_accvgpr_read_b32 v191, a191
v_mul_f32 v188, v188, v251
v_mul_f32 v189, v189, v251
v_mul_f32 v190, v190, v251
v_mul_f32 v191, v191, v251
v_cvt_pk_bf16_f32 v118, v188, v189
v_cvt_pk_bf16_f32 v119, v190, v191
v_accvgpr_read_b32 v160, a200
v_accvgpr_read_b32 v161, a201
v_accvgpr_read_b32 v162, a202
v_accvgpr_read_b32 v163, a203
v_mul_f32 v160, v160, v250
v_mul_f32 v161, v161, v250
v_mul_f32 v162, v162, v250
v_mul_f32 v163, v163, v250
v_cvt_pk_bf16_f32 v88, v160, v161
v_cvt_pk_bf16_f32 v89, v162, v163
v_accvgpr_read_b32 v164, a204
v_accvgpr_read_b32 v165, a205
v_accvgpr_read_b32 v166, a206
v_accvgpr_read_b32 v167, a207
v_mul_f32 v164, v164, v251
v_mul_f32 v165, v165, v251
v_mul_f32 v166, v166, v251
v_mul_f32 v167, v167, v251
v_cvt_pk_bf16_f32 v120, v164, v165
v_cvt_pk_bf16_f32 v121, v166, v167
v_accvgpr_read_b32 v168, a216
v_accvgpr_read_b32 v169, a217
v_accvgpr_read_b32 v170, a218
v_accvgpr_read_b32 v171, a219
v_mul_f32 v168, v168, v250
v_mul_f32 v169, v169, v250
v_mul_f32 v170, v170, v250
v_mul_f32 v171, v171, v250
v_cvt_pk_bf16_f32 v90, v168, v169
v_cvt_pk_bf16_f32 v91, v170, v171
v_accvgpr_read_b32 v172, a220
v_accvgpr_read_b32 v173, a221
v_accvgpr_read_b32 v174, a222
v_accvgpr_read_b32 v175, a223
v_mul_f32 v172, v172, v251
v_mul_f32 v173, v173, v251
v_mul_f32 v174, v174, v251
v_mul_f32 v175, v175, v251
v_cvt_pk_bf16_f32 v122, v172, v173
v_cvt_pk_bf16_f32 v123, v174, v175
v_accvgpr_read_b32 v176, a232
v_accvgpr_read_b32 v177, a233
v_accvgpr_read_b32 v178, a234
v_accvgpr_read_b32 v179, a235
v_mul_f32 v176, v176, v250
v_mul_f32 v177, v177, v250
v_mul_f32 v178, v178, v250
v_mul_f32 v179, v179, v250
v_cvt_pk_bf16_f32 v92, v176, v177
v_cvt_pk_bf16_f32 v93, v178, v179
v_accvgpr_read_b32 v180, a236
v_accvgpr_read_b32 v181, a237
v_accvgpr_read_b32 v182, a238
v_accvgpr_read_b32 v183, a239
v_mul_f32 v180, v180, v251
v_mul_f32 v181, v181, v251
v_mul_f32 v182, v182, v251
v_mul_f32 v183, v183, v251
v_cvt_pk_bf16_f32 v124, v180, v181
v_cvt_pk_bf16_f32 v125, v182, v183
v_accvgpr_read_b32 v184, a248
v_accvgpr_read_b32 v185, a249
v_accvgpr_read_b32 v186, a250
v_accvgpr_read_b32 v187, a251
v_mul_f32 v184, v184, v250
v_mul_f32 v185, v185, v250
v_mul_f32 v186, v186, v250
v_mul_f32 v187, v187, v250
v_cvt_pk_bf16_f32 v94, v184, v185
v_cvt_pk_bf16_f32 v95, v186, v187
v_accvgpr_read_b32 v188, a252
v_accvgpr_read_b32 v189, a253
v_accvgpr_read_b32 v190, a254
v_accvgpr_read_b32 v191, a255
v_mul_f32 v188, v188, v251
v_mul_f32 v189, v189, v251
v_mul_f32 v190, v190, v251
v_mul_f32 v191, v191, v251
v_cvt_pk_bf16_f32 v126, v188, v189
v_cvt_pk_bf16_f32 v127, v190, v191
s_waitcnt vmcnt(8) lgkmcnt(10)
s_barrier
s_branch L_out1
L_tw1:
s_cmp_lg_u32 s28, 1
s_cbranch_scc1 L_tw2
ds_read_b64_tr_b16 v[220:221], v239 offset:32768
ds_read_b64_tr_b16 v[222:223], v239 offset:34816
ds_read_b64_tr_b16 v[224:225], v239 offset:36864
ds_read_b64_tr_b16 v[226:227], v239 offset:38912
ds_read_b64_tr_b16 v[228:229], v239 offset:40960
ds_read_b64_tr_b16 v[230:231], v239 offset:43008
s_waitcnt lgkmcnt(4)
v_mfma_f32_16x16x32_bf16 a[16:19], v[220:223], v[176:179], a[16:19]
ds_read_b64_tr_b16 v[232:233], v239 offset:45056
v_add_u32 v252, 0, v253
v_mfma_f32_16x16x32_bf16 a[20:23], v[220:223], v[180:183], a[20:23]
ds_read_b64_tr_b16 v[234:235], v239 offset:47104
s_add_u32 m0, s29, 0
v_mfma_f32_16x16x32_bf16 a[24:27], v[220:223], v[184:187], a[24:27]
buffer_load_dwordx4 v252, s[20:23], s52 offen  lds
v_mfma_f32_16x16x32_bf16 a[28:31], v[220:223], v[188:191], a[28:31]
s_waitcnt lgkmcnt(4)
ds_read_b128 v[212:215], v244 offset:2048
s_add_u32 m0, s29, 4096
v_mfma_f32_16x16x32_bf16 a[80:83], v[224:227], v[176:179], a[80:83]
buffer_load_dwordx4 v252, s[20:23], s53 offen  lds
v_mfma_f32_16x16x32_bf16 a[84:87], v[224:227], v[180:183], a[84:87]
ds_read_b128 v[216:219], v244 offset:3072
v_mfma_f32_16x16x32_bf16 a[88:91], v[224:227], v[184:187], a[88:91]
ds_read_b64_tr_b16 v[220:221], v238 offset:32768
s_add_u32 m0, s29, 8192
v_mfma_f32_16x16x32_bf16 a[92:95], v[224:227], v[188:191], a[92:95]
s_waitcnt lgkmcnt(5)
ds_read_b64_tr_b16 v[222:223], v238 offset:34816
v_accvgpr_read_b32 v160, a16
v_mfma_f32_16x16x32_bf16 a[144:147], v[228:231], v[176:179], a[144:147]
buffer_load_dwordx4 v252, s[20:23], s54 offen  lds
v_mfma_f32_16x16x32_bf16 a[148:151], v[228:231], v[180:183], a[148:151]
ds_read_b64_tr_b16 v[224:225], v238 offset:36864
v_accvgpr_read_b32 v161, a17
v_mfma_f32_16x16x32_bf16 a[152:155], v[228:231], v[184:187], a[152:155]
ds_read_b64_tr_b16 v[226:227], v238 offset:38912
s_add_u32 m0, s29, 12288
v_mfma_f32_16x16x32_bf16 a[156:159], v[228:231], v[188:191], a[156:159]
s_waitcnt lgkmcnt(6)
v_accvgpr_read_b32 v162, a18
v_accvgpr_read_b32 v163, a19
v_mfma_f32_16x16x32_bf16 a[208:211], v[232:235], v[176:179], a[208:211]
buffer_load_dwordx4 v252, s[20:23], s55 offen  lds
v_mfma_f32_16x16x32_bf16 a[212:215], v[232:235], v[180:183], a[212:215]
ds_read_b64_tr_b16 v[228:229], v238 offset:40960
v_mul_f32 v160, v160, v248
v_mfma_f32_16x16x32_bf16 a[216:219], v[232:235], v[184:187], a[216:219]
ds_read_b64_tr_b16 v[230:231], v238 offset:43008
s_add_u32 m0, s29, 16384
v_mfma_f32_16x16x32_bf16 a[220:223], v[232:235], v[188:191], a[220:223]
s_waitcnt lgkmcnt(4)
v_mul_f32 v161, v161, v248
v_mul_f32 v162, v162, v248
v_mfma_f32_16x16x32_bf16 a[0:3], v[220:223], v[176:179], a[0:3]
buffer_load_dwordx4 v252, s[20:23], s56 offen  lds
v_mfma_f32_16x16x32_bf16 a[4:7], v[220:223], v[180:183], a[4:7]
v_mul_f32 v163, v163, v248
v_cvt_pk_bf16_f32 v0, v160, v161
v_mfma_f32_16x16x32_bf16 v[128:131], v[220:223], v[212:215], v[128:131]
ds_read_b64_tr_b16 v[232:233], v238 offset:45056
s_add_u32 m0, s29, 20480
v_mfma_f32_16x16x32_bf16 a[8:11], v[220:223], v[184:187], a[8:11]
ds_read_b64_tr_b16 v[234:235], v238 offset:47104
v_cvt_pk_bf16_f32 v1, v162, v163
v_mfma_f32_16x16x32_bf16 v[132:135], v[220:223], v[216:219], v[132:135]
buffer_load_dwordx4 v252, s[20:23], s57 offen  lds
v_mfma_f32_16x16x32_bf16 a[12:15], v[220:223], v[188:191], a[12:15]
s_waitcnt lgkmcnt(4)
v_accvgpr_read_b32 v164, a20
v_accvgpr_read_b32 v165, a21
v_mfma_f32_16x16x32_bf16 a[64:67], v[224:227], v[176:179], a[64:67]
s_add_u32 m0, s29, 24576
v_accvgpr_read_b32 v166, a22
v_mfma_f32_16x16x32_bf16 a[68:71], v[224:227], v[180:183], a[68:71]
v_accvgpr_read_b32 v167, a23
v_mul_f32 v164, v164, v249
v_mfma_f32_16x16x32_bf16 v[136:139], v[224:227], v[212:215], v[136:139]
buffer_load_dwordx4 v252, s[20:23], s58 offen  lds
v_mfma_f32_16x16x32_bf16 a[72:75], v[224:227], v[184:187], a[72:75]
ds_read_b64_tr_b16 v[220:221], v240 offset:32768
v_mul_f32 v165, v165, v249
v_mfma_f32_16x16x32_bf16 v[140:143], v[224:227], v[216:219], v[140:143]
ds_read_b64_tr_b16 v[222:223], v240 offset:34816
s_add_u32 m0, s29, 28672
v_mfma_f32_16x16x32_bf16 a[76:79], v[224:227], v[188:191], a[76:79]
s_waitcnt lgkmcnt(2)
v_mul_f32 v166, v166, v249
v_mul_f32 v167, v167, v249
v_mfma_f32_16x16x32_bf16 a[128:131], v[228:231], v[176:179], a[128:131]
buffer_load_dwordx4 v252, s[20:23], s59 offen  lds
v_mfma_f32_16x16x32_bf16 a[132:135], v[228:231], v[180:183], a[132:135]
ds_read_b64_tr_b16 v[224:225], v240 offset:36864
v_cvt_pk_bf16_f32 v32, v164, v165
v_mfma_f32_16x16x32_bf16 v[144:147], v[228:231], v[212:215], v[144:147]
ds_read_b64_tr_b16 v[226:227], v240 offset:38912
v_add_u32 v252, 229376, v253
v_mfma_f32_16x16x32_bf16 a[136:139], v[228:231], v[184:187], a[136:139]
s_add_u32 m0, s29, 32768
v_cvt_pk_bf16_f32 v33, v166, v167
v_mfma_f32_16x16x32_bf16 v[148:151], v[228:231], v[216:219], v[148:151]
buffer_load_dwordx4 v252, s[20:23], s52 offen  lds
v_mfma_f32_16x16x32_bf16 a[140:143], v[228:231], v[188:191], a[140:143]
ds_read_b64_tr_b16 v[228:229], v240 offset:40960
v_accvgpr_read_b32 v168, a80
v_mfma_f32_16x16x32_bf16 a[192:195], v[232:235], v[176:179], a[192:195]
ds_read_b64_tr_b16 v[230:231], v240 offset:43008
s_add_u32 m0, s29, 36864
v_mfma_f32_16x16x32_bf16 a[196:199], v[232:235], v[180:183], a[196:199]
v_accvgpr_read_b32 v169, a81
v_accvgpr_read_b32 v170, a82
v_mfma_f32_16x16x32_bf16 v[152:155], v[232:235], v[212:215], v[152:155]
buffer_load_dwordx4 v252, s[20:23], s53 offen  lds
v_mfma_f32_16x16x32_bf16 a[200:203], v[232:235], v[184:187], a[200:203]
v_accvgpr_read_b32 v171, a83
v_mul_f32 v168, v168, v248
v_mfma_f32_16x16x32_bf16 v[156:159], v[232:235], v[216:219], v[156:159]
s_add_u32 m0, s29, 40960
v_mul_f32 v169, v169, v248
v_mfma_f32_16x16x32_bf16 a[204:207], v[232:235], v[188:191], a[204:207]
s_waitcnt lgkmcnt(2)
ds_read_b64_tr_b16 v[232:233], v240 offset:45056
v_mul_f32 v170, v170, v248
v_mfma_f32_16x16x32_bf16 a[32:35], v[220:223], v[176:179], a[32:35]
buffer_load_dwordx4 v252, s[20:23], s54 offen  lds
v_mfma_f32_16x16x32_bf16 a[36:39], v[220:223], v[180:183], a[36:39]
ds_read_b64_tr_b16 v[234:235], v240 offset:47104
v_mul_f32 v171, v171, v248
v_mfma_f32_16x16x32_bf16 a[40:43], v[220:223], v[184:187], a[40:43]
s_add_u32 m0, s29, 45056
v_cvt_pk_bf16_f32 v8, v168, v169
v_mfma_f32_16x16x32_bf16 a[44:47], v[220:223], v[188:191], a[44:47]
ds_read_b64_tr_b16 v[220:221], v241 offset:32768
v_mul_f32 v128, v128, v206
v_mfma_f32_16x16x32_bf16 a[96:99], v[224:227], v[176:179], a[96:99]
buffer_load_dwordx4 v252, s[20:23], s55 offen  lds
v_mfma_f32_16x16x32_bf16 a[100:103], v[224:227], v[180:183], a[100:103]
ds_read_b64_tr_b16 v[222:223], v241 offset:34816
v_mul_f32 v129, v129, v206
v_mfma_f32_16x16x32_bf16 a[104:107], v[224:227], v[184:187], a[104:107]
s_add_u32 m0, s29, 49152
v_mul_f32 v130, v130, v206
v_mfma_f32_16x16x32_bf16 a[108:111], v[224:227], v[188:191], a[108:111]
s_waitcnt lgkmcnt(4)
ds_read_b64_tr_b16 v[224:225], v241 offset:36864
v_mul_f32 v131, v131, v206
v_mfma_f32_16x16x32_bf16 a[160:163], v[228:231], v[176:179], a[160:163]
buffer_load_dwordx4 v252, s[20:23], s56 offen  lds
v_mfma_f32_16x16x32_bf16 a[164:167], v[228:231], v[180:183], a[164:167]
ds_read_b64_tr_b16 v[226:227], v241 offset:38912
v_cvt_pk_bf16_f32 v128, v128, v129
v_mfma_f32_16x16x32_bf16 a[168:171], v[228:231], v[184:187], a[168:171]
s_add_u32 m0, s29, 53248
v_cvt_pk_bf16_f32 v129, v130, v131
v_mfma_f32_16x16x32_bf16 a[172:175], v[228:231], v[188:191], a[172:175]
s_waitcnt lgkmcnt(4)
ds_write_b64 v246, v[128:129] offset:0
v_mfma_f32_16x16x32_bf16 a[224:227], v[232:235], v[176:179], a[224:227]
buffer_load_dwordx4 v252, s[20:23], s57 offen  lds
v_mfma_f32_16x16x32_bf16 a[228:231], v[232:235], v[180:183], a[228:231]
ds_read_b64_tr_b16 v[228:229], v241 offset:40960
v_mul_f32 v132, v132, v207
v_mfma_f32_16x16x32_bf16 a[232:235], v[232:235], v[184:187], a[232:235]
ds_read_b64_tr_b16 v[230:231], v241 offset:43008
s_add_u32 m0, s29, 57344
v_mfma_f32_16x16x32_bf16 a[236:239], v[232:235], v[188:191], a[236:239]
s_waitcnt lgkmcnt(5)
ds_read_b64_tr_b16 v[232:233], v241 offset:45056
v_mul_f32 v133, v133, v207
v_mfma_f32_16x16x32_bf16 a[48:51], v[220:223], v[176:179], a[48:51]
buffer_load_dwordx4 v252, s[20:23], s58 offen  lds
v_mfma_f32_16x16x32_bf16 a[52:55], v[220:223], v[180:183], a[52:55]
ds_read_b64_tr_b16 v[234:235], v241 offset:47104
v_mul_f32 v134, v134, v207
v_mfma_f32_16x16x32_bf16 a[56:59], v[220:223], v[184:187], a[56:59]
s_add_u32 m0, s29, 61440
v_mul_f32 v135, v135, v207
v_mfma_f32_16x16x32_bf16 a[60:63], v[220:223], v[188:191], a[60:63]
s_waitcnt lgkmcnt(5)
v_cvt_pk_bf16_f32 v132, v132, v133
v_cvt_pk_bf16_f32 v133, v134, v135
v_mfma_f32_16x16x32_bf16 a[112:115], v[224:227], v[176:179], a[112:115]
buffer_load_dwordx4 v252, s[20:23], s59 offen  lds
v_mfma_f32_16x16x32_bf16 a[116:119], v[224:227], v[180:183], a[116:119]
ds_write_b64 v246, v[132:133] offset:8192
v_mfma_f32_16x16x32_bf16 a[120:123], v[224:227], v[184:187], a[120:123]
v_mul_f32 v136, v136, v206
v_mul_f32 v137, v137, v206
v_mfma_f32_16x16x32_bf16 a[124:127], v[224:227], v[188:191], a[124:127]
s_waitcnt lgkmcnt(3)
v_mul_f32 v138, v138, v206
v_mul_f32 v139, v139, v206
v_mfma_f32_16x16x32_bf16 a[176:179], v[228:231], v[176:179], a[176:179]
v_cvt_pk_bf16_f32 v136, v136, v137
v_cvt_pk_bf16_f32 v137, v138, v139
v_mfma_f32_16x16x32_bf16 a[180:183], v[228:231], v[180:183], a[180:183]
ds_write_b64 v246, v[136:137] offset:2048
v_mfma_f32_16x16x32_bf16 a[184:187], v[228:231], v[184:187], a[184:187]
v_mul_f32 v140, v140, v207
v_mul_f32 v141, v141, v207
v_mfma_f32_16x16x32_bf16 a[188:191], v[228:231], v[188:191], a[188:191]
s_waitcnt lgkmcnt(2)
v_mul_f32 v142, v142, v207
v_mul_f32 v143, v143, v207
v_mfma_f32_16x16x32_bf16 a[240:243], v[232:235], v[176:179], a[240:243]
v_cvt_pk_bf16_f32 v140, v140, v141
v_cvt_pk_bf16_f32 v141, v142, v143
v_mfma_f32_16x16x32_bf16 a[244:247], v[232:235], v[180:183], a[244:247]
ds_write_b64 v246, v[140:141] offset:10240
v_mfma_f32_16x16x32_bf16 a[248:251], v[232:235], v[184:187], a[248:251]
v_mul_f32 v144, v144, v206
v_mul_f32 v145, v145, v206
v_mfma_f32_16x16x32_bf16 a[252:255], v[232:235], v[188:191], a[252:255]
v_mul_f32 v146, v146, v206
v_mul_f32 v147, v147, v206
v_cvt_pk_bf16_f32 v9, v170, v171
v_accvgpr_read_b32 v172, a84
v_accvgpr_read_b32 v173, a85
v_accvgpr_read_b32 v174, a86
v_accvgpr_read_b32 v175, a87
v_mul_f32 v172, v172, v249
v_mul_f32 v173, v173, v249
v_mul_f32 v174, v174, v249
v_mul_f32 v175, v175, v249
v_cvt_pk_bf16_f32 v40, v172, v173
v_cvt_pk_bf16_f32 v41, v174, v175
v_accvgpr_read_b32 v192, a144
v_accvgpr_read_b32 v193, a145
v_accvgpr_read_b32 v194, a146
v_accvgpr_read_b32 v195, a147
v_mul_f32 v192, v192, v248
v_mul_f32 v193, v193, v248
v_mul_f32 v194, v194, v248
v_mul_f32 v195, v195, v248
v_cvt_pk_bf16_f32 v16, v192, v193
v_cvt_pk_bf16_f32 v17, v194, v195
v_accvgpr_read_b32 v196, a148
v_accvgpr_read_b32 v197, a149
v_accvgpr_read_b32 v198, a150
v_accvgpr_read_b32 v199, a151
v_mul_f32 v196, v196, v249
v_mul_f32 v197, v197, v249
v_mul_f32 v198, v198, v249
v_mul_f32 v199, v199, v249
v_cvt_pk_bf16_f32 v48, v196, v197
v_cvt_pk_bf16_f32 v49, v198, v199
v_accvgpr_read_b32 v160, a208
v_accvgpr_read_b32 v161, a209
v_accvgpr_read_b32 v162, a210
v_accvgpr_read_b32 v163, a211
v_mul_f32 v160, v160, v248
v_mul_f32 v161, v161, v248
v_mul_f32 v162, v162, v248
v_mul_f32 v163, v163, v248
v_cvt_pk_bf16_f32 v24, v160, v161
v_cvt_pk_bf16_f32 v25, v162, v163
v_accvgpr_read_b32 v164, a212
v_accvgpr_read_b32 v165, a213
v_accvgpr_read_b32 v166, a214
v_accvgpr_read_b32 v167, a215
v_mul_f32 v164, v164, v249
v_mul_f32 v165, v165, v249
v_mul_f32 v166, v166, v249
v_mul_f32 v167, v167, v249
v_cvt_pk_bf16_f32 v56, v164, v165
v_cvt_pk_bf16_f32 v57, v166, v167
v_accvgpr_read_b32 v168, a0
v_accvgpr_read_b32 v169, a1
v_accvgpr_read_b32 v170, a2
v_accvgpr_read_b32 v171, a3
v_mul_f32 v168, v168, v248
v_mul_f32 v169, v169, v248
v_mul_f32 v170, v170, v248
v_mul_f32 v171, v171, v248
v_cvt_pk_bf16_f32 v2, v168, v169
v_cvt_pk_bf16_f32 v3, v170, v171
v_accvgpr_read_b32 v172, a4
v_accvgpr_read_b32 v173, a5
v_accvgpr_read_b32 v174, a6
v_accvgpr_read_b32 v175, a7
v_mul_f32 v172, v172, v249
v_mul_f32 v173, v173, v249
v_mul_f32 v174, v174, v249
v_mul_f32 v175, v175, v249
v_cvt_pk_bf16_f32 v34, v172, v173
v_cvt_pk_bf16_f32 v35, v174, v175
v_accvgpr_read_b32 v192, a64
v_accvgpr_read_b32 v193, a65
v_accvgpr_read_b32 v194, a66
v_accvgpr_read_b32 v195, a67
v_mul_f32 v192, v192, v248
v_mul_f32 v193, v193, v248
v_mul_f32 v194, v194, v248
v_mul_f32 v195, v195, v248
v_cvt_pk_bf16_f32 v10, v192, v193
v_cvt_pk_bf16_f32 v11, v194, v195
v_accvgpr_read_b32 v196, a68
v_accvgpr_read_b32 v197, a69
v_accvgpr_read_b32 v198, a70
v_accvgpr_read_b32 v199, a71
v_mul_f32 v196, v196, v249
v_mul_f32 v197, v197, v249
v_mul_f32 v198, v198, v249
v_mul_f32 v199, v199, v249
v_cvt_pk_bf16_f32 v42, v196, v197
v_cvt_pk_bf16_f32 v43, v198, v199
v_accvgpr_read_b32 v160, a128
v_accvgpr_read_b32 v161, a129
v_accvgpr_read_b32 v162, a130
v_accvgpr_read_b32 v163, a131
v_mul_f32 v160, v160, v248
v_mul_f32 v161, v161, v248
v_mul_f32 v162, v162, v248
v_mul_f32 v163, v163, v248
v_cvt_pk_bf16_f32 v18, v160, v161
v_cvt_pk_bf16_f32 v19, v162, v163
v_accvgpr_read_b32 v164, a132
v_accvgpr_read_b32 v165, a133
v_accvgpr_read_b32 v166, a134
v_accvgpr_read_b32 v167, a135
v_mul_f32 v164, v164, v249
v_mul_f32 v165, v165, v249
v_mul_f32 v166, v166, v249
v_mul_f32 v167, v167, v249
v_cvt_pk_bf16_f32 v50, v164, v165
v_cvt_pk_bf16_f32 v51, v166, v167
v_cvt_pk_bf16_f32 v144, v144, v145
v_cvt_pk_bf16_f32 v145, v146, v147
ds_write_b64 v246, v[144:145] offset:4096
v_mul_f32 v148, v148, v207
v_mul_f32 v149, v149, v207
v_mul_f32 v150, v150, v207
v_mul_f32 v151, v151, v207
v_cvt_pk_bf16_f32 v148, v148, v149
v_cvt_pk_bf16_f32 v149, v150, v151
ds_write_b64 v246, v[148:149] offset:12288
v_mul_f32 v152, v152, v206
v_mul_f32 v153, v153, v206
v_mul_f32 v154, v154, v206
v_mul_f32 v155, v155, v206
v_cvt_pk_bf16_f32 v152, v152, v153
v_cvt_pk_bf16_f32 v153, v154, v155
ds_write_b64 v246, v[152:153] offset:6144
v_mul_f32 v156, v156, v207
v_mul_f32 v157, v157, v207
v_mul_f32 v158, v158, v207
v_mul_f32 v159, v159, v207
v_cvt_pk_bf16_f32 v156, v156, v157
v_cvt_pk_bf16_f32 v157, v158, v159
ds_write_b64 v246, v[156:157] offset:14336
v_accvgpr_read_b32 v168, a192
v_accvgpr_read_b32 v169, a193
v_accvgpr_read_b32 v170, a194
v_accvgpr_read_b32 v171, a195
v_mul_f32 v168, v168, v248
v_mul_f32 v169, v169, v248
v_mul_f32 v170, v170, v248
v_mul_f32 v171, v171, v248
v_cvt_pk_bf16_f32 v26, v168, v169
v_cvt_pk_bf16_f32 v27, v170, v171
v_accvgpr_read_b32 v172, a196
v_accvgpr_read_b32 v173, a197
v_accvgpr_read_b32 v174, a198
v_accvgpr_read_b32 v175, a199
v_mul_f32 v172, v172, v249
v_mul_f32 v173, v173, v249
v_mul_f32 v174, v174, v249
v_mul_f32 v175, v175, v249
v_cvt_pk_bf16_f32 v58, v172, v173
v_cvt_pk_bf16_f32 v59, v174, v175
v_accvgpr_read_b32 v192, a32
v_accvgpr_read_b32 v193, a33
v_accvgpr_read_b32 v194, a34
v_accvgpr_read_b32 v195, a35
v_mul_f32 v192, v192, v248
v_mul_f32 v193, v193, v248
v_mul_f32 v194, v194, v248
v_mul_f32 v195, v195, v248
v_cvt_pk_bf16_f32 v6, v192, v193
v_cvt_pk_bf16_f32 v7, v194, v195
v_accvgpr_read_b32 v196, a36
v_accvgpr_read_b32 v197, a37
v_accvgpr_read_b32 v198, a38
v_accvgpr_read_b32 v199, a39
v_mul_f32 v196, v196, v249
v_mul_f32 v197, v197, v249
v_mul_f32 v198, v198, v249
v_mul_f32 v199, v199, v249
v_cvt_pk_bf16_f32 v38, v196, v197
v_cvt_pk_bf16_f32 v39, v198, v199
v_accvgpr_read_b32 v160, a96
v_accvgpr_read_b32 v161, a97
v_accvgpr_read_b32 v162, a98
v_accvgpr_read_b32 v163, a99
v_mul_f32 v160, v160, v248
v_mul_f32 v161, v161, v248
v_mul_f32 v162, v162, v248
v_mul_f32 v163, v163, v248
v_cvt_pk_bf16_f32 v14, v160, v161
v_cvt_pk_bf16_f32 v15, v162, v163
v_accvgpr_read_b32 v164, a100
v_accvgpr_read_b32 v165, a101
v_accvgpr_read_b32 v166, a102
v_accvgpr_read_b32 v167, a103
v_mul_f32 v164, v164, v249
v_mul_f32 v165, v165, v249
v_mul_f32 v166, v166, v249
v_mul_f32 v167, v167, v249
v_cvt_pk_bf16_f32 v46, v164, v165
v_cvt_pk_bf16_f32 v47, v166, v167
v_accvgpr_read_b32 v168, a160
v_accvgpr_read_b32 v169, a161
v_accvgpr_read_b32 v170, a162
v_accvgpr_read_b32 v171, a163
v_mul_f32 v168, v168, v248
v_mul_f32 v169, v169, v248
v_mul_f32 v170, v170, v248
v_mul_f32 v171, v171, v248
v_cvt_pk_bf16_f32 v22, v168, v169
v_cvt_pk_bf16_f32 v23, v170, v171
v_accvgpr_read_b32 v172, a164
v_accvgpr_read_b32 v173, a165
v_accvgpr_read_b32 v174, a166
v_accvgpr_read_b32 v175, a167
v_mul_f32 v172, v172, v249
v_mul_f32 v173, v173, v249
v_mul_f32 v174, v174, v249
v_mul_f32 v175, v175, v249
v_cvt_pk_bf16_f32 v54, v172, v173
v_cvt_pk_bf16_f32 v55, v174, v175
v_accvgpr_read_b32 v192, a224
v_accvgpr_read_b32 v193, a225
v_accvgpr_read_b32 v194, a226
v_accvgpr_read_b32 v195, a227
v_mul_f32 v192, v192, v248
v_mul_f32 v193, v193, v248
v_mul_f32 v194, v194, v248
v_mul_f32 v195, v195, v248
v_cvt_pk_bf16_f32 v30, v192, v193
v_cvt_pk_bf16_f32 v31, v194, v195
v_accvgpr_read_b32 v196, a228
v_accvgpr_read_b32 v197, a229
v_accvgpr_read_b32 v198, a230
v_accvgpr_read_b32 v199, a231
v_mul_f32 v196, v196, v249
v_mul_f32 v197, v197, v249
v_mul_f32 v198, v198, v249
v_mul_f32 v199, v199, v249
v_cvt_pk_bf16_f32 v62, v196, v197
v_cvt_pk_bf16_f32 v63, v198, v199
v_accvgpr_read_b32 v160, a48
v_accvgpr_read_b32 v161, a49
v_accvgpr_read_b32 v162, a50
v_accvgpr_read_b32 v163, a51
v_mul_f32 v160, v160, v248
v_mul_f32 v161, v161, v248
v_mul_f32 v162, v162, v248
v_mul_f32 v163, v163, v248
v_cvt_pk_bf16_f32 v4, v160, v161
v_cvt_pk_bf16_f32 v5, v162, v163
v_accvgpr_read_b32 v164, a52
v_accvgpr_read_b32 v165, a53
v_accvgpr_read_b32 v166, a54
v_accvgpr_read_b32 v167, a55
v_mul_f32 v164, v164, v249
v_mul_f32 v165, v165, v249
v_mul_f32 v166, v166, v249
v_mul_f32 v167, v167, v249
v_cvt_pk_bf16_f32 v36, v164, v165
v_cvt_pk_bf16_f32 v37, v166, v167
v_accvgpr_read_b32 v168, a112
v_accvgpr_read_b32 v169, a113
v_accvgpr_read_b32 v170, a114
v_accvgpr_read_b32 v171, a115
v_mul_f32 v168, v168, v248
v_mul_f32 v169, v169, v248
v_mul_f32 v170, v170, v248
v_mul_f32 v171, v171, v248
v_cvt_pk_bf16_f32 v12, v168, v169
v_cvt_pk_bf16_f32 v13, v170, v171
v_accvgpr_read_b32 v172, a116
v_accvgpr_read_b32 v173, a117
v_accvgpr_read_b32 v174, a118
v_accvgpr_read_b32 v175, a119
v_mul_f32 v172, v172, v249
v_mul_f32 v173, v173, v249
v_mul_f32 v174, v174, v249
v_mul_f32 v175, v175, v249
v_cvt_pk_bf16_f32 v44, v172, v173
v_cvt_pk_bf16_f32 v45, v174, v175
v_accvgpr_read_b32 v192, a176
v_accvgpr_read_b32 v193, a177
v_accvgpr_read_b32 v194, a178
v_accvgpr_read_b32 v195, a179
v_mul_f32 v192, v192, v248
v_mul_f32 v193, v193, v248
v_mul_f32 v194, v194, v248
v_mul_f32 v195, v195, v248
v_cvt_pk_bf16_f32 v20, v192, v193
v_cvt_pk_bf16_f32 v21, v194, v195
v_accvgpr_read_b32 v196, a180
v_accvgpr_read_b32 v197, a181
v_accvgpr_read_b32 v198, a182
v_accvgpr_read_b32 v199, a183
v_mul_f32 v196, v196, v249
v_mul_f32 v197, v197, v249
v_mul_f32 v198, v198, v249
v_mul_f32 v199, v199, v249
v_cvt_pk_bf16_f32 v52, v196, v197
v_cvt_pk_bf16_f32 v53, v198, v199
v_accvgpr_read_b32 v160, a240
v_accvgpr_read_b32 v161, a241
v_accvgpr_read_b32 v162, a242
v_accvgpr_read_b32 v163, a243
v_mul_f32 v160, v160, v248
v_mul_f32 v161, v161, v248
v_mul_f32 v162, v162, v248
v_mul_f32 v163, v163, v248
v_cvt_pk_bf16_f32 v28, v160, v161
v_cvt_pk_bf16_f32 v29, v162, v163
v_accvgpr_read_b32 v164, a244
v_accvgpr_read_b32 v165, a245
v_accvgpr_read_b32 v166, a246
v_accvgpr_read_b32 v167, a247
v_mul_f32 v164, v164, v249
v_mul_f32 v165, v165, v249
v_mul_f32 v166, v166, v249
v_mul_f32 v167, v167, v249
v_cvt_pk_bf16_f32 v60, v164, v165
v_cvt_pk_bf16_f32 v61, v166, v167
s_waitcnt vmcnt(0) lgkmcnt(0)
s_barrier
ds_read_b64_tr_b16 a[176:177], v236 offset:0
ds_read_b64_tr_b16 a[178:179], v236 offset:2048
ds_read_b64 a[0:1], v247 offset:0
ds_read_b64 a[2:3], v247 offset:512
ds_read_b64_tr_b16 a[180:181], v237 offset:0
ds_read_b64_tr_b16 a[182:183], v237 offset:2048
ds_read_b64_tr_b16 a[192:193], v242 offset:0
ds_read_b64_tr_b16 a[194:195], v242 offset:2048
ds_read_b64_tr_b16 a[196:197], v243 offset:0
ds_read_b64_tr_b16 a[198:199], v243 offset:2048
s_waitcnt lgkmcnt(8)
v_mfma_f32_16x16x32_bf16 v[128:131], a[176:179], v[0:3], 0
ds_read_b64_tr_b16 a[208:209], v236 offset:4096
v_add_u32 v252, 128, v253
v_mfma_f32_16x16x32_bf16 v[132:135], a[176:179], v[32:35], 0
s_waitcnt lgkmcnt(7)
ds_read_b64_tr_b16 a[210:211], v236 offset:6144
s_add_u32 m0, s29, 65536
v_mfma_f32_16x16x32_bf16 v[208:211], a[176:179], a[0:3], 0
s_waitcnt lgkmcnt(6)
ds_read_b64 a[4:5], v247 offset:1024
v_accvgpr_read_b32 v160, a8
v_mfma_f32_16x16x32_bf16 v[136:139], a[180:183], v[0:3], 0
ds_read_b64 a[6:7], v247 offset:1536
v_accvgpr_read_b32 v161, a9
v_mfma_f32_16x16x32_bf16 v[140:143], a[180:183], v[32:35], 0
s_waitcnt lgkmcnt(6)
ds_read_b64_tr_b16 a[212:213], v237 offset:4096
v_accvgpr_read_b32 v162, a10
v_mfma_f32_16x16x32_bf16 v[144:147], a[192:195], v[0:3], 0
ds_read_b64_tr_b16 a[214:215], v237 offset:6144
buffer_load_dwordx4 v252, s[20:23], s52 offen  lds
v_mfma_f32_16x16x32_bf16 v[148:151], a[192:195], v[32:35], 0
s_waitcnt lgkmcnt(6)
ds_read_b64_tr_b16 a[224:225], v242 offset:4096
s_add_u32 m0, s29, 69632
v_mfma_f32_16x16x32_bf16 v[152:155], a[196:199], v[0:3], 0
ds_read_b64_tr_b16 a[226:227], v242 offset:6144
v_accvgpr_read_b32 v163, a11
v_mfma_f32_16x16x32_bf16 v[156:159], a[196:199], v[32:35], 0
s_waitcnt lgkmcnt(6)
ds_read_b64_tr_b16 a[228:229], v243 offset:4096
buffer_load_dwordx4 v252, s[20:23], s53 offen  lds
v_mfma_f32_16x16x32_bf16 v[128:131], a[208:211], v[4:7], v[128:131]
ds_read_b64_tr_b16 a[230:231], v243 offset:6144
s_add_u32 m0, s29, 73728
v_mfma_f32_16x16x32_bf16 v[132:135], a[208:211], v[36:39], v[132:135]
s_waitcnt lgkmcnt(6)
ds_read_b64_tr_b16 a[240:241], v236 offset:8192
v_mul_f32 v160, v160, v250
v_mfma_f32_16x16x32_bf16 v[208:211], a[208:211], a[4:7], v[208:211]
s_waitcnt lgkmcnt(5)
ds_read_b64_tr_b16 a[242:243], v236 offset:10240
v_mul_f32 v161, v161, v250
v_mfma_f32_16x16x32_bf16 v[136:139], a[212:215], v[4:7], v[136:139]
ds_read_b64 a[16:17], v247 offset:2048
buffer_load_dwordx4 v252, s[20:23], s54 offen  lds
v_mfma_f32_16x16x32_bf16 v[140:143], a[212:215], v[36:39], v[140:143]
s_waitcnt lgkmcnt(5)
ds_read_b64 a[18:19], v247 offset:2560
s_add_u32 m0, s29, 77824
v_mfma_f32_16x16x32_bf16 v[144:147], a[224:227], v[4:7], v[144:147]
ds_read_b64_tr_b16 a[244:245], v237 offset:8192
v_mul_f32 v162, v162, v250
v_mfma_f32_16x16x32_bf16 v[148:151], a[224:227], v[36:39], v[148:151]
s_waitcnt lgkmcnt(5)
ds_read_b64_tr_b16 a[246:247], v237 offset:10240
v_mul_f32 v163, v163, v250
v_mfma_f32_16x16x32_bf16 v[152:155], a[228:231], v[4:7], v[152:155]
ds_read_b64_tr_b16 a[176:177], v242 offset:8192
buffer_load_dwordx4 v252, s[20:23], s55 offen  lds
v_mfma_f32_16x16x32_bf16 v[156:159], a[228:231], v[36:39], v[156:159]
s_waitcnt lgkmcnt(5)
ds_read_b64_tr_b16 a[178:179], v242 offset:10240
s_add_u32 m0, s29, 81920
v_mfma_f32_16x16x32_bf16 v[128:131], a[240:243], v[8:11], v[128:131]
ds_read_b64_tr_b16 a[180:181], v243 offset:8192
v_cvt_pk_bf16_f32 v66, v160, v161
v_mfma_f32_16x16x32_bf16 v[132:135], a[240:243], v[40:43], v[132:135]
s_waitcnt lgkmcnt(5)
ds_read_b64_tr_b16 a[182:183], v243 offset:10240
v_cvt_pk_bf16_f32 v67, v162, v163
v_mfma_f32_16x16x32_bf16 v[208:211], a[240:243], a[16:19], v[208:211]
s_waitcnt lgkmcnt(4)
ds_read_b64_tr_b16 a[192:193], v236 offset:12288
buffer_load_dwordx4 v252, s[20:23], s56 offen  lds
v_mfma_f32_16x16x32_bf16 v[136:139], a[244:247], v[8:11], v[136:139]
ds_read_b64_tr_b16 a[194:195], v236 offset:14336
s_add_u32 m0, s29, 86016
v_mfma_f32_16x16x32_bf16 v[140:143], a[244:247], v[40:43], v[140:143]
s_waitcnt lgkmcnt(4)
ds_read_b64 a[20:21], v247 offset:3072
v_accvgpr_read_b32 v164, a12
v_mfma_f32_16x16x32_bf16 v[144:147], a[176:179], v[8:11], v[144:147]
ds_read_b64 a[22:23], v247 offset:3584
v_accvgpr_read_b32 v165, a13
v_mfma_f32_16x16x32_bf16 v[148:151], a[176:179], v[40:43], v[148:151]
s_waitcnt lgkmcnt(4)
ds_read_b64_tr_b16 a[196:197], v237 offset:12288
buffer_load_dwordx4 v252, s[20:23], s57 offen  lds
v_mfma_f32_16x16x32_bf16 v[152:155], a[180:183], v[8:11], v[152:155]
ds_read_b64_tr_b16 a[198:199], v237 offset:14336
s_add_u32 m0, s29, 90112
v_mfma_f32_16x16x32_bf16 v[156:159], a[180:183], v[40:43], v[156:159]
s_waitcnt lgkmcnt(4)
ds_read_b64_tr_b16 a[208:209], v242 offset:12288
v_accvgpr_read_b32 v166, a14
v_mfma_f32_16x16x32_bf16 v[128:131], a[192:195], v[12:15], v[128:131]
ds_read_b64_tr_b16 a[210:211], v242 offset:14336
v_accvgpr_read_b32 v167, a15
v_mfma_f32_16x16x32_bf16 v[132:135], a[192:195], v[44:47], v[132:135]
s_waitcnt lgkmcnt(4)
ds_read_b64_tr_b16 a[212:213], v243 offset:12288
buffer_load_dwordx4 v252, s[20:23], s58 offen  lds
v_mfma_f32_16x16x32_bf16 v[208:211], a[192:195], a[20:23], v[208:211]
s_waitcnt lgkmcnt(3)
ds_read_b64_tr_b16 a[214:215], v243 offset:14336
s_add_u32 m0, s29, 94208
v_mfma_f32_16x16x32_bf16 v[136:139], a[196:199], v[12:15], v[136:139]
ds_read_b64_tr_b16 a[224:225], v236 offset:16384
v_mul_f32 v164, v164, v251
v_mfma_f32_16x16x32_bf16 v[140:143], a[196:199], v[44:47], v[140:143]
s_waitcnt lgkmcnt(3)
ds_read_b64_tr_b16 a[226:227], v236 offset:18432
v_mul_f32 v165, v165, v251
v_mfma_f32_16x16x32_bf16 v[144:147], a[208:211], v[12:15], v[144:147]
ds_read_b64 a[32:33], v247 offset:4096
buffer_load_dwordx4 v252, s[20:23], s59 offen  lds
v_mfma_f32_16x16x32_bf16 v[148:151], a[208:211], v[44:47], v[148:151]
s_waitcnt lgkmcnt(3)
ds_read_b64 a[34:35], v247 offset:4608
v_mul_f32 v166, v166, v251
v_mfma_f32_16x16x32_bf16 v[152:155], a[212:215], v[12:15], v[152:155]
ds_read_b64_tr_b16 a[228:229], v237 offset:16384
v_add_u32 v252, 229504, v253
v_mfma_f32_16x16x32_bf16 v[156:159], a[212:215], v[44:47], v[156:159]
s_waitcnt lgkmcnt(3)
ds_read_b64_tr_b16 a[230:231], v237 offset:18432
s_add_u32 m0, s29, 98304
v_mfma_f32_16x16x32_bf16 v[128:131], a[224:227], v[16:19], v[128:131]
ds_read_b64_tr_b16 a[240:241], v242 offset:16384
v_mul_f32 v167, v167, v251
v_mfma_f32_16x16x32_bf16 v[132:135], a[224:227], v[48:51], v[132:135]
s_waitcnt lgkmcnt(3)
ds_read_b64_tr_b16 a[242:243], v242 offset:18432
v_cvt_pk_bf16_f32 v98, v164, v165
v_mfma_f32_16x16x32_bf16 v[208:211], a[224:227], a[32:35], v[208:211]
s_waitcnt lgkmcnt(2)
ds_read_b64_tr_b16 a[244:245], v243 offset:16384
v_cvt_pk_bf16_f32 v99, v166, v167
v_mfma_f32_16x16x32_bf16 v[136:139], a[228:231], v[16:19], v[136:139]
ds_read_b64_tr_b16 a[246:247], v243 offset:18432
v_accvgpr_read_b32 v168, a24
v_mfma_f32_16x16x32_bf16 v[140:143], a[228:231], v[48:51], v[140:143]
s_waitcnt lgkmcnt(2)
ds_read_b64_tr_b16 a[176:177], v236 offset:20480
buffer_load_dwordx4 v252, s[20:23], s52 offen  lds
v_mfma_f32_16x16x32_bf16 v[144:147], a[240:243], v[16:19], v[144:147]
ds_read_b64_tr_b16 a[178:179], v236 offset:22528
s_add_u32 m0, s29, 102400
v_mfma_f32_16x16x32_bf16 v[148:151], a[240:243], v[48:51], v[148:151]
s_waitcnt lgkmcnt(2)
ds_read_b64 a[36:37], v247 offset:5120
v_accvgpr_read_b32 v169, a25
v_mfma_f32_16x16x32_bf16 v[152:155], a[244:247], v[16:19], v[152:155]
ds_read_b64 a[38:39], v247 offset:5632
buffer_load_dwordx4 v252, s[20:23], s53 offen  lds
v_mfma_f32_16x16x32_bf16 v[156:159], a[244:247], v[48:51], v[156:159]
s_waitcnt lgkmcnt(2)
ds_read_b64_tr_b16 a[180:181], v237 offset:20480
s_add_u32 m0, s29, 106496
v_mfma_f32_16x16x32_bf16 v[128:131], a[176:179], v[20:23], v[128:131]
ds_read_b64_tr_b16 a[182:183], v237 offset:22528
v_accvgpr_read_b32 v170, a26
v_mfma_f32_16x16x32_bf16 v[132:135], a[176:179], v[52:55], v[132:135]
s_waitcnt lgkmcnt(2)
ds_read_b64_tr_b16 a[192:193], v242 offset:20480
v_accvgpr_read_b32 v171, a27
v_mfma_f32_16x16x32_bf16 v[208:211], a[176:179], a[36:39], v[208:211]
s_waitcnt lgkmcnt(1)
ds_read_b64_tr_b16 a[194:195], v242 offset:22528
buffer_load_dwordx4 v252, s[20:23], s54 offen  lds
v_mfma_f32_16x16x32_bf16 v[136:139], a[180:183], v[20:23], v[136:139]
ds_read_b64_tr_b16 a[196:197], v243 offset:20480
s_add_u32 m0, s29, 110592
v_mfma_f32_16x16x32_bf16 v[140:143], a[180:183], v[52:55], v[140:143]
s_waitcnt lgkmcnt(1)
ds_read_b64_tr_b16 a[198:199], v243 offset:22528
v_mul_f32 v168, v168, v250
v_mfma_f32_16x16x32_bf16 v[144:147], a[192:195], v[20:23], v[144:147]
ds_read_b64_tr_b16 a[208:209], v236 offset:24576
buffer_load_dwordx4 v252, s[20:23], s55 offen  lds
v_mfma_f32_16x16x32_bf16 v[148:151], a[192:195], v[52:55], v[148:151]
s_waitcnt lgkmcnt(1)
ds_read_b64_tr_b16 a[210:211], v236 offset:26624
s_add_u32 m0, s29, 114688
v_mfma_f32_16x16x32_bf16 v[152:155], a[196:199], v[20:23], v[152:155]
ds_read_b64 a[48:49], v247 offset:6144
v_mul_f32 v169, v169, v250
v_mfma_f32_16x16x32_bf16 v[156:159], a[196:199], v[52:55], v[156:159]
s_waitcnt lgkmcnt(1)
ds_read_b64 a[50:51], v247 offset:6656
v_mul_f32 v170, v170, v250
v_mfma_f32_16x16x32_bf16 v[128:131], a[208:211], v[24:27], v[128:131]
ds_read_b64_tr_b16 a[212:213], v237 offset:24576
buffer_load_dwordx4 v252, s[20:23], s56 offen  lds
v_mfma_f32_16x16x32_bf16 v[132:135], a[208:211], v[56:59], v[132:135]
s_waitcnt lgkmcnt(1)
ds_read_b64_tr_b16 a[214:215], v237 offset:26624
s_add_u32 m0, s29, 118784
v_mfma_f32_16x16x32_bf16 v[208:211], a[208:211], a[48:51], v[208:211]
s_waitcnt lgkmcnt(0)
ds_read_b64_tr_b16 a[224:225], v242 offset:24576
v_mul_f32 v171, v171, v250
v_mfma_f32_16x16x32_bf16 v[136:139], a[212:215], v[24:27], v[136:139]
ds_read_b64_tr_b16 a[226:227], v242 offset:26624
buffer_load_dwordx4 v252, s[20:23], s57 offen  lds
v_mfma_f32_16x16x32_bf16 v[140:143], a[212:215], v[56:59], v[140:143]
s_waitcnt lgkmcnt(0)
ds_read_b64_tr_b16 a[228:229], v243 offset:24576
s_add_u32 m0, s29, 122880
v_mfma_f32_16x16x32_bf16 v[144:147], a[224:227], v[24:27], v[144:147]
ds_read_b64_tr_b16 a[230:231], v243 offset:26624
v_cvt_pk_bf16_f32 v64, v168, v169
v_mfma_f32_16x16x32_bf16 v[148:151], a[224:227], v[56:59], v[148:151]
s_waitcnt lgkmcnt(0)
ds_read_b64_tr_b16 a[240:241], v236 offset:28672
v_cvt_pk_bf16_f32 v65, v170, v171
v_mfma_f32_16x16x32_bf16 v[152:155], a[228:231], v[24:27], v[152:155]
ds_read_b64_tr_b16 a[242:243], v236 offset:30720
buffer_load_dwordx4 v252, s[20:23], s58 offen  lds
v_mfma_f32_16x16x32_bf16 v[156:159], a[228:231], v[56:59], v[156:159]
s_waitcnt lgkmcnt(0)
ds_read_b64 a[52:53], v247 offset:7168
s_add_u32 m0, s29, 126976
v_mfma_f32_16x16x32_bf16 v[128:131], a[240:243], v[28:31], v[128:131]
ds_read_b64 a[54:55], v247 offset:7680
v_accvgpr_read_b32 v172, a28
v_mfma_f32_16x16x32_bf16 v[132:135], a[240:243], v[60:63], v[132:135]
s_waitcnt lgkmcnt(0)
ds_read_b64_tr_b16 a[244:245], v237 offset:28672
buffer_load_dwordx4 v252, s[20:23], s59 offen  lds
v_mfma_f32_16x16x32_bf16 v[208:211], a[240:243], a[52:55], v[208:211]
ds_read_b64_tr_b16 a[246:247], v237 offset:30720
s_waitcnt lgkmcnt(0)
ds_read_b64_tr_b16 a[212:213], v242 offset:28672
v_accvgpr_read_b32 v173, a29
v_mfma_f32_16x16x32_bf16 v[136:139], a[244:247], v[28:31], v[136:139]
ds_read_b64_tr_b16 a[214:215], v242 offset:30720
v_accvgpr_read_b32 v174, a30
v_mfma_f32_16x16x32_bf16 v[140:143], a[244:247], v[60:63], v[140:143]
s_waitcnt lgkmcnt(0)
ds_read_b64_tr_b16 a[224:225], v243 offset:28672
v_accvgpr_read_b32 v175, a31
v_mfma_f32_16x16x32_bf16 v[144:147], a[212:215], v[28:31], v[144:147]
ds_read_b64_tr_b16 a[226:227], v243 offset:30720
v_mul_f32 v172, v172, v251
v_mfma_f32_16x16x32_bf16 v[148:151], a[212:215], v[60:63], v[148:151]
s_waitcnt lgkmcnt(0)
ds_read_b64_tr_b16 a[176:177], v236 offset:32768
v_mul_f32 v173, v173, v251
v_mfma_f32_16x16x32_bf16 v[152:155], a[224:227], v[28:31], v[152:155]
ds_read_b64_tr_b16 a[178:179], v236 offset:34816
v_mul_f32 v174, v174, v251
v_mfma_f32_16x16x32_bf16 v[156:159], a[224:227], v[60:63], v[156:159]
ds_read_b64_tr_b16 a[180:181], v237 offset:32768
v_mul_f32 v175, v175, v251
v_cvt_pk_bf16_f32 v96, v172, v173
ds_read_b64_tr_b16 a[182:183], v237 offset:34816
v_cvt_pk_bf16_f32 v97, v174, v175
ds_read_b64_tr_b16 a[192:193], v242 offset:32768
v_accvgpr_read_b32 v176, a40
ds_read_b64_tr_b16 a[194:195], v242 offset:34816
v_accvgpr_read_b32 v177, a41
ds_read_b64_tr_b16 a[196:197], v243 offset:32768
v_accvgpr_read_b32 v178, a42
ds_read_b64_tr_b16 a[198:199], v243 offset:34816
v_accvgpr_read_b32 v179, a43
ds_read_b64_tr_b16 a[208:209], v236 offset:36864
v_mul_f32 v176, v176, v250
ds_read_b64_tr_b16 a[210:211], v236 offset:38912
v_mul_f32 v177, v177, v250
v_mul_f32 v178, v178, v250
v_mul_f32 v179, v179, v250
v_cvt_pk_bf16_f32 v70, v176, v177
v_cvt_pk_bf16_f32 v71, v178, v179
v_accvgpr_read_b32 v180, a44
v_accvgpr_read_b32 v181, a45
v_accvgpr_read_b32 v182, a46
v_accvgpr_read_b32 v183, a47
v_mul_f32 v180, v180, v251
v_mul_f32 v181, v181, v251
v_mul_f32 v182, v182, v251
v_mul_f32 v183, v183, v251
v_cvt_pk_bf16_f32 v102, v180, v181
v_cvt_pk_bf16_f32 v103, v182, v183
v_accvgpr_read_b32 v184, a56
v_accvgpr_read_b32 v185, a57
v_accvgpr_read_b32 v186, a58
v_accvgpr_read_b32 v187, a59
v_mul_f32 v184, v184, v250
v_mul_f32 v185, v185, v250
v_mul_f32 v186, v186, v250
v_mul_f32 v187, v187, v250
v_cvt_pk_bf16_f32 v68, v184, v185
v_cvt_pk_bf16_f32 v69, v186, v187
v_accvgpr_read_b32 v188, a60
v_accvgpr_read_b32 v189, a61
v_accvgpr_read_b32 v190, a62
v_accvgpr_read_b32 v191, a63
v_mul_f32 v188, v188, v251
v_mul_f32 v189, v189, v251
v_mul_f32 v190, v190, v251
v_mul_f32 v191, v191, v251
v_cvt_pk_bf16_f32 v100, v188, v189
v_cvt_pk_bf16_f32 v101, v190, v191
v_accvgpr_read_b32 v160, a72
v_accvgpr_read_b32 v161, a73
v_accvgpr_read_b32 v162, a74
v_accvgpr_read_b32 v163, a75
v_mul_f32 v160, v160, v250
v_mul_f32 v161, v161, v250
v_mul_f32 v162, v162, v250
v_mul_f32 v163, v163, v250
v_cvt_pk_bf16_f32 v74, v160, v161
v_cvt_pk_bf16_f32 v75, v162, v163
v_accvgpr_read_b32 v164, a76
v_accvgpr_read_b32 v165, a77
v_accvgpr_read_b32 v166, a78
v_accvgpr_read_b32 v167, a79
v_mul_f32 v164, v164, v251
v_mul_f32 v165, v165, v251
v_mul_f32 v166, v166, v251
v_mul_f32 v167, v167, v251
v_cvt_pk_bf16_f32 v106, v164, v165
v_cvt_pk_bf16_f32 v107, v166, v167
v_accvgpr_read_b32 v168, a88
v_accvgpr_read_b32 v169, a89
v_accvgpr_read_b32 v170, a90
v_accvgpr_read_b32 v171, a91
v_mul_f32 v168, v168, v250
v_mul_f32 v169, v169, v250
v_mul_f32 v170, v170, v250
v_mul_f32 v171, v171, v250
v_cvt_pk_bf16_f32 v72, v168, v169
v_cvt_pk_bf16_f32 v73, v170, v171
v_accvgpr_read_b32 v172, a92
v_accvgpr_read_b32 v173, a93
v_accvgpr_read_b32 v174, a94
v_accvgpr_read_b32 v175, a95
v_mul_f32 v172, v172, v251
v_mul_f32 v173, v173, v251
v_mul_f32 v174, v174, v251
v_mul_f32 v175, v175, v251
v_cvt_pk_bf16_f32 v104, v172, v173
v_cvt_pk_bf16_f32 v105, v174, v175
v_accvgpr_read_b32 v176, a104
v_accvgpr_read_b32 v177, a105
v_accvgpr_read_b32 v178, a106
v_accvgpr_read_b32 v179, a107
v_mul_f32 v176, v176, v250
v_mul_f32 v177, v177, v250
v_mul_f32 v178, v178, v250
v_mul_f32 v179, v179, v250
v_cvt_pk_bf16_f32 v78, v176, v177
v_cvt_pk_bf16_f32 v79, v178, v179
v_accvgpr_read_b32 v180, a108
v_accvgpr_read_b32 v181, a109
v_accvgpr_read_b32 v182, a110
v_accvgpr_read_b32 v183, a111
v_mul_f32 v180, v180, v251
v_mul_f32 v181, v181, v251
v_mul_f32 v182, v182, v251
v_mul_f32 v183, v183, v251
v_cvt_pk_bf16_f32 v110, v180, v181
v_cvt_pk_bf16_f32 v111, v182, v183
v_accvgpr_read_b32 v184, a120
v_accvgpr_read_b32 v185, a121
v_accvgpr_read_b32 v186, a122
v_accvgpr_read_b32 v187, a123
v_mul_f32 v184, v184, v250
v_mul_f32 v185, v185, v250
v_mul_f32 v186, v186, v250
v_mul_f32 v187, v187, v250
v_cvt_pk_bf16_f32 v76, v184, v185
v_cvt_pk_bf16_f32 v77, v186, v187
v_accvgpr_read_b32 v188, a124
v_accvgpr_read_b32 v189, a125
v_accvgpr_read_b32 v190, a126
v_accvgpr_read_b32 v191, a127
v_mul_f32 v188, v188, v251
v_mul_f32 v189, v189, v251
v_mul_f32 v190, v190, v251
v_mul_f32 v191, v191, v251
v_cvt_pk_bf16_f32 v108, v188, v189
v_cvt_pk_bf16_f32 v109, v190, v191
v_accvgpr_read_b32 v160, a136
v_accvgpr_read_b32 v161, a137
v_accvgpr_read_b32 v162, a138
v_accvgpr_read_b32 v163, a139
v_mul_f32 v160, v160, v250
v_mul_f32 v161, v161, v250
v_mul_f32 v162, v162, v250
v_mul_f32 v163, v163, v250
v_cvt_pk_bf16_f32 v82, v160, v161
v_cvt_pk_bf16_f32 v83, v162, v163
v_accvgpr_read_b32 v164, a140
v_accvgpr_read_b32 v165, a141
v_accvgpr_read_b32 v166, a142
v_accvgpr_read_b32 v167, a143
v_mul_f32 v164, v164, v251
v_mul_f32 v165, v165, v251
v_mul_f32 v166, v166, v251
v_mul_f32 v167, v167, v251
v_cvt_pk_bf16_f32 v114, v164, v165
v_cvt_pk_bf16_f32 v115, v166, v167
v_accvgpr_read_b32 v168, a152
v_accvgpr_read_b32 v169, a153
v_accvgpr_read_b32 v170, a154
v_accvgpr_read_b32 v171, a155
v_mul_f32 v168, v168, v250
v_mul_f32 v169, v169, v250
v_mul_f32 v170, v170, v250
v_mul_f32 v171, v171, v250
v_cvt_pk_bf16_f32 v80, v168, v169
v_cvt_pk_bf16_f32 v81, v170, v171
v_accvgpr_read_b32 v172, a156
v_accvgpr_read_b32 v173, a157
v_accvgpr_read_b32 v174, a158
v_accvgpr_read_b32 v175, a159
v_mul_f32 v172, v172, v251
v_mul_f32 v173, v173, v251
v_mul_f32 v174, v174, v251
v_mul_f32 v175, v175, v251
v_cvt_pk_bf16_f32 v112, v172, v173
v_cvt_pk_bf16_f32 v113, v174, v175
v_accvgpr_read_b32 v176, a168
v_accvgpr_read_b32 v177, a169
v_accvgpr_read_b32 v178, a170
v_accvgpr_read_b32 v179, a171
v_mul_f32 v176, v176, v250
v_mul_f32 v177, v177, v250
v_mul_f32 v178, v178, v250
v_mul_f32 v179, v179, v250
v_cvt_pk_bf16_f32 v86, v176, v177
v_cvt_pk_bf16_f32 v87, v178, v179
v_accvgpr_read_b32 v180, a172
v_accvgpr_read_b32 v181, a173
v_accvgpr_read_b32 v182, a174
v_accvgpr_read_b32 v183, a175
v_mul_f32 v180, v180, v251
v_mul_f32 v181, v181, v251
v_mul_f32 v182, v182, v251
v_mul_f32 v183, v183, v251
v_cvt_pk_bf16_f32 v118, v180, v181
v_cvt_pk_bf16_f32 v119, v182, v183
v_accvgpr_read_b32 v184, a184
v_accvgpr_read_b32 v185, a185
v_accvgpr_read_b32 v186, a186
v_accvgpr_read_b32 v187, a187
v_mul_f32 v184, v184, v250
v_mul_f32 v185, v185, v250
v_mul_f32 v186, v186, v250
v_mul_f32 v187, v187, v250
v_cvt_pk_bf16_f32 v84, v184, v185
v_cvt_pk_bf16_f32 v85, v186, v187
v_accvgpr_read_b32 v188, a188
v_accvgpr_read_b32 v189, a189
v_accvgpr_read_b32 v190, a190
v_accvgpr_read_b32 v191, a191
v_mul_f32 v188, v188, v251
v_mul_f32 v189, v189, v251
v_mul_f32 v190, v190, v251
v_mul_f32 v191, v191, v251
v_cvt_pk_bf16_f32 v116, v188, v189
v_cvt_pk_bf16_f32 v117, v190, v191
v_accvgpr_read_b32 v160, a200
v_accvgpr_read_b32 v161, a201
v_accvgpr_read_b32 v162, a202
v_accvgpr_read_b32 v163, a203
v_mul_f32 v160, v160, v250
v_mul_f32 v161, v161, v250
v_mul_f32 v162, v162, v250
v_mul_f32 v163, v163, v250
v_cvt_pk_bf16_f32 v90, v160, v161
v_cvt_pk_bf16_f32 v91, v162, v163
v_accvgpr_read_b32 v164, a204
v_accvgpr_read_b32 v165, a205
v_accvgpr_read_b32 v166, a206
v_accvgpr_read_b32 v167, a207
v_mul_f32 v164, v164, v251
v_mul_f32 v165, v165, v251
v_mul_f32 v166, v166, v251
v_mul_f32 v167, v167, v251
v_cvt_pk_bf16_f32 v122, v164, v165
v_cvt_pk_bf16_f32 v123, v166, v167
v_accvgpr_read_b32 v168, a216
v_accvgpr_read_b32 v169, a217
v_accvgpr_read_b32 v170, a218
v_accvgpr_read_b32 v171, a219
v_mul_f32 v168, v168, v250
v_mul_f32 v169, v169, v250
v_mul_f32 v170, v170, v250
v_mul_f32 v171, v171, v250
v_cvt_pk_bf16_f32 v88, v168, v169
v_cvt_pk_bf16_f32 v89, v170, v171
v_accvgpr_read_b32 v172, a220
v_accvgpr_read_b32 v173, a221
v_accvgpr_read_b32 v174, a222
v_accvgpr_read_b32 v175, a223
v_mul_f32 v172, v172, v251
v_mul_f32 v173, v173, v251
v_mul_f32 v174, v174, v251
v_mul_f32 v175, v175, v251
v_cvt_pk_bf16_f32 v120, v172, v173
v_cvt_pk_bf16_f32 v121, v174, v175
v_accvgpr_read_b32 v176, a232
v_accvgpr_read_b32 v177, a233
v_accvgpr_read_b32 v178, a234
v_accvgpr_read_b32 v179, a235
v_mul_f32 v176, v176, v250
v_mul_f32 v177, v177, v250
v_mul_f32 v178, v178, v250
v_mul_f32 v179, v179, v250
v_cvt_pk_bf16_f32 v94, v176, v177
v_cvt_pk_bf16_f32 v95, v178, v179
v_accvgpr_read_b32 v180, a236
v_accvgpr_read_b32 v181, a237
v_accvgpr_read_b32 v182, a238
v_accvgpr_read_b32 v183, a239
v_mul_f32 v180, v180, v251
v_mul_f32 v181, v181, v251
v_mul_f32 v182, v182, v251
v_mul_f32 v183, v183, v251
v_cvt_pk_bf16_f32 v126, v180, v181
v_cvt_pk_bf16_f32 v127, v182, v183
v_accvgpr_read_b32 v184, a248
v_accvgpr_read_b32 v185, a249
v_accvgpr_read_b32 v186, a250
v_accvgpr_read_b32 v187, a251
v_mul_f32 v184, v184, v250
v_mul_f32 v185, v185, v250
v_mul_f32 v186, v186, v250
v_mul_f32 v187, v187, v250
v_cvt_pk_bf16_f32 v92, v184, v185
v_cvt_pk_bf16_f32 v93, v186, v187
v_accvgpr_read_b32 v188, a252
v_accvgpr_read_b32 v189, a253
v_accvgpr_read_b32 v190, a254
v_accvgpr_read_b32 v191, a255
v_mul_f32 v188, v188, v251
v_mul_f32 v189, v189, v251
v_mul_f32 v190, v190, v251
v_mul_f32 v191, v191, v251
v_cvt_pk_bf16_f32 v124, v188, v189
v_cvt_pk_bf16_f32 v125, v190, v191
s_waitcnt vmcnt(8) lgkmcnt(10)
s_barrier
s_branch L_out1
L_tw2:
s_cmp_lg_u32 s28, 2
s_cbranch_scc1 L_tw3
ds_read_b64_tr_b16 v[220:221], v239 offset:32768
ds_read_b64_tr_b16 v[222:223], v239 offset:34816
ds_read_b64_tr_b16 v[224:225], v239 offset:36864
ds_read_b64_tr_b16 v[226:227], v239 offset:38912
ds_read_b64_tr_b16 v[228:229], v239 offset:40960
ds_read_b64_tr_b16 v[230:231], v239 offset:43008
s_waitcnt lgkmcnt(4)
v_mfma_f32_16x16x32_bf16 a[16:19], v[220:223], v[176:179], a[16:19]
ds_read_b64_tr_b16 v[232:233], v239 offset:45056
v_add_u32 v252, 0, v253
v_mfma_f32_16x16x32_bf16 a[20:23], v[220:223], v[180:183], a[20:23]
ds_read_b64_tr_b16 v[234:235], v239 offset:47104
s_add_u32 m0, s29, 0
v_mfma_f32_16x16x32_bf16 a[24:27], v[220:223], v[184:187], a[24:27]
buffer_load_dwordx4 v252, s[20:23], s52 offen  lds
v_mfma_f32_16x16x32_bf16 a[28:31], v[220:223], v[188:191], a[28:31]
s_waitcnt lgkmcnt(4)
ds_read_b128 v[212:215], v244 offset:2048
s_add_u32 m0, s29, 4096
v_mfma_f32_16x16x32_bf16 a[80:83], v[224:227], v[176:179], a[80:83]
buffer_load_dwordx4 v252, s[20:23], s53 offen  lds
v_mfma_f32_16x16x32_bf16 a[84:87], v[224:227], v[180:183], a[84:87]
ds_read_b128 v[216:219], v244 offset:3072
v_mfma_f32_16x16x32_bf16 a[88:91], v[224:227], v[184:187], a[88:91]
ds_read_b64_tr_b16 v[220:221], v238 offset:32768
s_add_u32 m0, s29, 8192
v_mfma_f32_16x16x32_bf16 a[92:95], v[224:227], v[188:191], a[92:95]
s_waitcnt lgkmcnt(5)
ds_read_b64_tr_b16 v[222:223], v238 offset:34816
v_accvgpr_read_b32 v160, a16
v_mfma_f32_16x16x32_bf16 a[144:147], v[228:231], v[176:179], a[144:147]
buffer_load_dwordx4 v252, s[20:23], s54 offen  lds
v_mfma_f32_16x16x32_bf16 a[148:151], v[228:231], v[180:183], a[148:151]
ds_read_b64_tr_b16 v[224:225], v238 offset:36864
v_accvgpr_read_b32 v161, a17
v_mfma_f32_16x16x32_bf16 a[152:155], v[228:231], v[184:187], a[152:155]
ds_read_b64_tr_b16 v[226:227], v238 offset:38912
s_add_u32 m0, s29, 12288
v_mfma_f32_16x16x32_bf16 a[156:159], v[228:231], v[188:191], a[156:159]
s_waitcnt lgkmcnt(6)
v_accvgpr_read_b32 v162, a18
v_accvgpr_read_b32 v163, a19
v_mfma_f32_16x16x32_bf16 a[208:211], v[232:235], v[176:179], a[208:211]
buffer_load_dwordx4 v252, s[20:23], s55 offen  lds
v_mfma_f32_16x16x32_bf16 a[212:215], v[232:235], v[180:183], a[212:215]
ds_read_b64_tr_b16 v[228:229], v238 offset:40960
v_mul_f32 v160, v160, v248
v_mfma_f32_16x16x32_bf16 a[216:219], v[232:235], v[184:187], a[216:219]
ds_read_b64_tr_b16 v[230:231], v238 offset:43008
s_add_u32 m0, s29, 16384
v_mfma_f32_16x16x32_bf16 a[220:223], v[232:235], v[188:191], a[220:223]
s_waitcnt lgkmcnt(4)
v_mul_f32 v161, v161, v248
v_mul_f32 v162, v162, v248
v_mfma_f32_16x16x32_bf16 a[0:3], v[220:223], v[176:179], a[0:3]
buffer_load_dwordx4 v252, s[20:23], s56 offen  lds
v_mfma_f32_16x16x32_bf16 a[4:7], v[220:223], v[180:183], a[4:7]
v_mul_f32 v163, v163, v248
v_cvt_pk_bf16_f32 v6, v160, v161
v_mfma_f32_16x16x32_bf16 v[128:131], v[220:223], v[212:215], v[128:131]
ds_read_b64_tr_b16 v[232:233], v238 offset:45056
s_add_u32 m0, s29, 20480
v_mfma_f32_16x16x32_bf16 a[8:11], v[220:223], v[184:187], a[8:11]
ds_read_b64_tr_b16 v[234:235], v238 offset:47104
v_cvt_pk_bf16_f32 v7, v162, v163
v_mfma_f32_16x16x32_bf16 v[132:135], v[220:223], v[216:219], v[132:135]
buffer_load_dwordx4 v252, s[20:23], s57 offen  lds
v_mfma_f32_16x16x32_bf16 a[12:15], v[220:223], v[188:191], a[12:15]
s_waitcnt lgkmcnt(4)
v_accvgpr_read_b32 v164, a20
v_accvgpr_read_b32 v165, a21
v_mfma_f32_16x16x32_bf16 a[64:67], v[224:227], v[176:179], a[64:67]
s_add_u32 m0, s29, 24576
v_accvgpr_read_b32 v166, a22
v_mfma_f32_16x16x32_bf16 a[68:71], v[224:227], v[180:183], a[68:71]
v_accvgpr_read_b32 v167, a23
v_mul_f32 v164, v164, v249
v_mfma_f32_16x16x32_bf16 v[136:139], v[224:227], v[212:215], v[136:139]
buffer_load_dwordx4 v252, s[20:23], s58 offen  lds
v_mfma_f32_16x16x32_bf16 a[72:75], v[224:227], v[184:187], a[72:75]
ds_read_b64_tr_b16 v[220:221], v240 offset:32768
v_mul_f32 v165, v165, v249
v_mfma_f32_16x16x32_bf16 v[140:143], v[224:227], v[216:219], v[140:143]
ds_read_b64_tr_b16 v[222:223], v240 offset:34816
s_add_u32 m0, s29, 28672
v_mfma_f32_16x16x32_bf16 a[76:79], v[224:227], v[188:191], a[76:79]
s_waitcnt lgkmcnt(2)
v_mul_f32 v166, v166, v249
v_mul_f32 v167, v167, v249
v_mfma_f32_16x16x32_bf16 a[128:131], v[228:231], v[176:179], a[128:131]
buffer_load_dwordx4 v252, s[20:23], s59 offen  lds
v_mfma_f32_16x16x32_bf16 a[132:135], v[228:231], v[180:183], a[132:135]
ds_read_b64_tr_b16 v[224:225], v240 offset:36864
v_cvt_pk_bf16_f32 v38, v164, v165
v_mfma_f32_16x16x32_bf16 v[144:147], v[228:231], v[212:215], v[144:147]
ds_read_b64_tr_b16 v[226:227], v240 offset:38912
v_add_u32 v252, 229376, v253
v_mfma_f32_16x16x32_bf16 a[136:139], v[228:231], v[184:187], a[136:139]
s_add_u32 m0, s29, 32768
v_cvt_pk_bf16_f32 v39, v166, v167
v_mfma_f32_16x16x32_bf16 v[148:151], v[228:231], v[216:219], v[148:151]
buffer_load_dwordx4 v252, s[20:23], s52 offen  lds
v_mfma_f32_16x16x32_bf16 a[140:143], v[228:231], v[188:191], a[140:143]
ds_read_b64_tr_b16 v[228:229], v240 offset:40960
v_accvgpr_read_b32 v168, a80
v_mfma_f32_16x16x32_bf16 a[192:195], v[232:235], v[176:179], a[192:195]
ds_read_b64_tr_b16 v[230:231], v240 offset:43008
s_add_u32 m0, s29, 36864
v_mfma_f32_16x16x32_bf16 a[196:199], v[232:235], v[180:183], a[196:199]
v_accvgpr_read_b32 v169, a81
v_accvgpr_read_b32 v170, a82
v_mfma_f32_16x16x32_bf16 v[152:155], v[232:235], v[212:215], v[152:155]
buffer_load_dwordx4 v252, s[20:23], s53 offen  lds
v_mfma_f32_16x16x32_bf16 a[200:203], v[232:235], v[184:187], a[200:203]
v_accvgpr_read_b32 v171, a83
v_mul_f32 v168, v168, v248
v_mfma_f32_16x16x32_bf16 v[156:159], v[232:235], v[216:219], v[156:159]
s_add_u32 m0, s29, 40960
v_mul_f32 v169, v169, v248
v_mfma_f32_16x16x32_bf16 a[204:207], v[232:235], v[188:191], a[204:207]
s_waitcnt lgkmcnt(2)
ds_read_b64_tr_b16 v[232:233], v240 offset:45056
v_mul_f32 v170, v170, v248
v_mfma_f32_16x16x32_bf16 a[32:35], v[220:223], v[176:179], a[32:35]
buffer_load_dwordx4 v252, s[20:23], s54 offen  lds
v_mfma_f32_16x16x32_bf16 a[36:39], v[220:223], v[180:183], a[36:39]
ds_read_b64_tr_b16 v[234:235], v240 offset:47104
v_mul_f32 v171, v171, v248
v_mfma_f32_16x16x32_bf16 a[40:43], v[220:223], v[184:187], a[40:43]
s_add_u32 m0, s29, 45056
v_cvt_pk_bf16_f32 v14, v168, v169
v_mfma_f32_16x16x32_bf16 a[44:47], v[220:223], v[188:191], a[44:47]
ds_read_b64_tr_b16 v[220:221], v241 offset:32768
v_mul_f32 v128, v128, v206
v_mfma_f32_16x16x32_bf16 a[96:99], v[224:227], v[176:179], a[96:99]
buffer_load_dwordx4 v252, s[20:23], s55 offen  lds
v_mfma_f32_16x16x32_bf16 a[100:103], v[224:227], v[180:183], a[100:103]
ds_read_b64_tr_b16 v[222:223], v241 offset:34816
v_mul_f32 v129, v129, v206
v_mfma_f32_16x16x32_bf16 a[104:107], v[224:227], v[184:187], a[104:107]
s_add_u32 m0, s29, 49152
v_mul_f32 v130, v130, v206
v_mfma_f32_16x16x32_bf16 a[108:111], v[224:227], v[188:191], a[108:111]
s_waitcnt lgkmcnt(4)
ds_read_b64_tr_b16 v[224:225], v241 offset:36864
v_mul_f32 v131, v131, v206
v_mfma_f32_16x16x32_bf16 a[160:163], v[228:231], v[176:179], a[160:163]
buffer_load_dwordx4 v252, s[20:23], s56 offen  lds
v_mfma_f32_16x16x32_bf16 a[164:167], v[228:231], v[180:183], a[164:167]
ds_read_b64_tr_b16 v[226:227], v241 offset:38912
v_cvt_pk_bf16_f32 v128, v128, v129
v_mfma_f32_16x16x32_bf16 a[168:171], v[228:231], v[184:187], a[168:171]
s_add_u32 m0, s29, 53248
v_cvt_pk_bf16_f32 v129, v130, v131
v_mfma_f32_16x16x32_bf16 a[172:175], v[228:231], v[188:191], a[172:175]
s_waitcnt lgkmcnt(4)
ds_write_b64 v246, v[128:129] offset:0
v_mfma_f32_16x16x32_bf16 a[224:227], v[232:235], v[176:179], a[224:227]
buffer_load_dwordx4 v252, s[20:23], s57 offen  lds
v_mfma_f32_16x16x32_bf16 a[228:231], v[232:235], v[180:183], a[228:231]
ds_read_b64_tr_b16 v[228:229], v241 offset:40960
v_mul_f32 v132, v132, v207
v_mfma_f32_16x16x32_bf16 a[232:235], v[232:235], v[184:187], a[232:235]
ds_read_b64_tr_b16 v[230:231], v241 offset:43008
s_add_u32 m0, s29, 57344
v_mfma_f32_16x16x32_bf16 a[236:239], v[232:235], v[188:191], a[236:239]
s_waitcnt lgkmcnt(5)
ds_read_b64_tr_b16 v[232:233], v241 offset:45056
v_mul_f32 v133, v133, v207
v_mfma_f32_16x16x32_bf16 a[48:51], v[220:223], v[176:179], a[48:51]
buffer_load_dwordx4 v252, s[20:23], s58 offen  lds
v_mfma_f32_16x16x32_bf16 a[52:55], v[220:223], v[180:183], a[52:55]
ds_read_b64_tr_b16 v[234:235], v241 offset:47104
v_mul_f32 v134, v134, v207
v_mfma_f32_16x16x32_bf16 a[56:59], v[220:223], v[184:187], a[56:59]
s_add_u32 m0, s29, 61440
v_mul_f32 v135, v135, v207
v_mfma_f32_16x16x32_bf16 a[60:63], v[220:223], v[188:191], a[60:63]
s_waitcnt lgkmcnt(5)
v_cvt_pk_bf16_f32 v132, v132, v133
v_cvt_pk_bf16_f32 v133, v134, v135
v_mfma_f32_16x16x32_bf16 a[112:115], v[224:227], v[176:179], a[112:115]
buffer_load_dwordx4 v252, s[20:23], s59 offen  lds
v_mfma_f32_16x16x32_bf16 a[116:119], v[224:227], v[180:183], a[116:119]
ds_write_b64 v246, v[132:133] offset:8192
v_mfma_f32_16x16x32_bf16 a[120:123], v[224:227], v[184:187], a[120:123]
v_mul_f32 v136, v136, v206
v_mul_f32 v137, v137, v206
v_mfma_f32_16x16x32_bf16 a[124:127], v[224:227], v[188:191], a[124:127]
s_waitcnt lgkmcnt(3)
v_mul_f32 v138, v138, v206
v_mul_f32 v139, v139, v206
v_mfma_f32_16x16x32_bf16 a[176:179], v[228:231], v[176:179], a[176:179]
v_cvt_pk_bf16_f32 v136, v136, v137
v_cvt_pk_bf16_f32 v137, v138, v139
v_mfma_f32_16x16x32_bf16 a[180:183], v[228:231], v[180:183], a[180:183]
ds_write_b64 v246, v[136:137] offset:2048
v_mfma_f32_16x16x32_bf16 a[184:187], v[228:231], v[184:187], a[184:187]
v_mul_f32 v140, v140, v207
v_mul_f32 v141, v141, v207
v_mfma_f32_16x16x32_bf16 a[188:191], v[228:231], v[188:191], a[188:191]
s_waitcnt lgkmcnt(2)
v_mul_f32 v142, v142, v207
v_mul_f32 v143, v143, v207
v_mfma_f32_16x16x32_bf16 a[240:243], v[232:235], v[176:179], a[240:243]
v_cvt_pk_bf16_f32 v140, v140, v141
v_cvt_pk_bf16_f32 v141, v142, v143
v_mfma_f32_16x16x32_bf16 a[244:247], v[232:235], v[180:183], a[244:247]
ds_write_b64 v246, v[140:141] offset:10240
v_mfma_f32_16x16x32_bf16 a[248:251], v[232:235], v[184:187], a[248:251]
v_mul_f32 v144, v144, v206
v_mul_f32 v145, v145, v206
v_mfma_f32_16x16x32_bf16 a[252:255], v[232:235], v[188:191], a[252:255]
v_mul_f32 v146, v146, v206
v_mul_f32 v147, v147, v206
v_cvt_pk_bf16_f32 v15, v170, v171
v_accvgpr_read_b32 v172, a84
v_accvgpr_read_b32 v173, a85
v_accvgpr_read_b32 v174, a86
v_accvgpr_read_b32 v175, a87
v_mul_f32 v172, v172, v249
v_mul_f32 v173, v173, v249
v_mul_f32 v174, v174, v249
v_mul_f32 v175, v175, v249
v_cvt_pk_bf16_f32 v46, v172, v173
v_cvt_pk_bf16_f32 v47, v174, v175
v_accvgpr_read_b32 v192, a144
v_accvgpr_read_b32 v193, a145
v_accvgpr_read_b32 v194, a146
v_accvgpr_read_b32 v195, a147
v_mul_f32 v192, v192, v248
v_mul_f32 v193, v193, v248
v_mul_f32 v194, v194, v248
v_mul_f32 v195, v195, v248
v_cvt_pk_bf16_f32 v22, v192, v193
v_cvt_pk_bf16_f32 v23, v194, v195
v_accvgpr_read_b32 v196, a148
v_accvgpr_read_b32 v197, a149
v_accvgpr_read_b32 v198, a150
v_accvgpr_read_b32 v199, a151
v_mul_f32 v196, v196, v249
v_mul_f32 v197, v197, v249
v_mul_f32 v198, v198, v249
v_mul_f32 v199, v199, v249
v_cvt_pk_bf16_f32 v54, v196, v197
v_cvt_pk_bf16_f32 v55, v198, v199
v_accvgpr_read_b32 v160, a208
v_accvgpr_read_b32 v161, a209
v_accvgpr_read_b32 v162, a210
v_accvgpr_read_b32 v163, a211
v_mul_f32 v160, v160, v248
v_mul_f32 v161, v161, v248
v_mul_f32 v162, v162, v248
v_mul_f32 v163, v163, v248
v_cvt_pk_bf16_f32 v30, v160, v161
v_cvt_pk_bf16_f32 v31, v162, v163
v_accvgpr_read_b32 v164, a212
v_accvgpr_read_b32 v165, a213
v_accvgpr_read_b32 v166, a214
v_accvgpr_read_b32 v167, a215
v_mul_f32 v164, v164, v249
v_mul_f32 v165, v165, v249
v_mul_f32 v166, v166, v249
v_mul_f32 v167, v167, v249
v_cvt_pk_bf16_f32 v62, v164, v165
v_cvt_pk_bf16_f32 v63, v166, v167
v_accvgpr_read_b32 v168, a0
v_accvgpr_read_b32 v169, a1
v_accvgpr_read_b32 v170, a2
v_accvgpr_read_b32 v171, a3
v_mul_f32 v168, v168, v248
v_mul_f32 v169, v169, v248
v_mul_f32 v170, v170, v248
v_mul_f32 v171, v171, v248
v_cvt_pk_bf16_f32 v4, v168, v169
v_cvt_pk_bf16_f32 v5, v170, v171
v_accvgpr_read_b32 v172, a4
v_accvgpr_read_b32 v173, a5
v_accvgpr_read_b32 v174, a6
v_accvgpr_read_b32 v175, a7
v_mul_f32 v172, v172, v249
v_mul_f32 v173, v173, v249
v_mul_f32 v174, v174, v249
v_mul_f32 v175, v175, v249
v_cvt_pk_bf16_f32 v36, v172, v173
v_cvt_pk_bf16_f32 v37, v174, v175
v_accvgpr_read_b32 v192, a64
v_accvgpr_read_b32 v193, a65
v_accvgpr_read_b32 v194, a66
v_accvgpr_read_b32 v195, a67
v_mul_f32 v192, v192, v248
v_mul_f32 v193, v193, v248
v_mul_f32 v194, v194, v248
v_mul_f32 v195, v195, v248
v_cvt_pk_bf16_f32 v12, v192, v193
v_cvt_pk_bf16_f32 v13, v194, v195
v_accvgpr_read_b32 v196, a68
v_accvgpr_read_b32 v197, a69
v_accvgpr_read_b32 v198, a70
v_accvgpr_read_b32 v199, a71
v_mul_f32 v196, v196, v249
v_mul_f32 v197, v197, v249
v_mul_f32 v198, v198, v249
v_mul_f32 v199, v199, v249
v_cvt_pk_bf16_f32 v44, v196, v197
v_cvt_pk_bf16_f32 v45, v198, v199
v_accvgpr_read_b32 v160, a128
v_accvgpr_read_b32 v161, a129
v_accvgpr_read_b32 v162, a130
v_accvgpr_read_b32 v163, a131
v_mul_f32 v160, v160, v248
v_mul_f32 v161, v161, v248
v_mul_f32 v162, v162, v248
v_mul_f32 v163, v163, v248
v_cvt_pk_bf16_f32 v20, v160, v161
v_cvt_pk_bf16_f32 v21, v162, v163
v_accvgpr_read_b32 v164, a132
v_accvgpr_read_b32 v165, a133
v_accvgpr_read_b32 v166, a134
v_accvgpr_read_b32 v167, a135
v_mul_f32 v164, v164, v249
v_mul_f32 v165, v165, v249
v_mul_f32 v166, v166, v249
v_mul_f32 v167, v167, v249
v_cvt_pk_bf16_f32 v52, v164, v165
v_cvt_pk_bf16_f32 v53, v166, v167
v_cvt_pk_bf16_f32 v144, v144, v145
v_cvt_pk_bf16_f32 v145, v146, v147
ds_write_b64 v246, v[144:145] offset:4096
v_mul_f32 v148, v148, v207
v_mul_f32 v149, v149, v207
v_mul_f32 v150, v150, v207
v_mul_f32 v151, v151, v207
v_cvt_pk_bf16_f32 v148, v148, v149
v_cvt_pk_bf16_f32 v149, v150, v151
ds_write_b64 v246, v[148:149] offset:12288
v_mul_f32 v152, v152, v206
v_mul_f32 v153, v153, v206
v_mul_f32 v154, v154, v206
v_mul_f32 v155, v155, v206
v_cvt_pk_bf16_f32 v152, v152, v153
v_cvt_pk_bf16_f32 v153, v154, v155
ds_write_b64 v246, v[152:153] offset:6144
v_mul_f32 v156, v156, v207
v_mul_f32 v157, v157, v207
v_mul_f32 v158, v158, v207
v_mul_f32 v159, v159, v207
v_cvt_pk_bf16_f32 v156, v156, v157
v_cvt_pk_bf16_f32 v157, v158, v159
ds_write_b64 v246, v[156:157] offset:14336
v_accvgpr_read_b32 v168, a192
v_accvgpr_read_b32 v169, a193
v_accvgpr_read_b32 v170, a194
v_accvgpr_read_b32 v171, a195
v_mul_f32 v168, v168, v248
v_mul_f32 v169, v169, v248
v_mul_f32 v170, v170, v248
v_mul_f32 v171, v171, v248
v_cvt_pk_bf16_f32 v28, v168, v169
v_cvt_pk_bf16_f32 v29, v170, v171
v_accvgpr_read_b32 v172, a196
v_accvgpr_read_b32 v173, a197
v_accvgpr_read_b32 v174, a198
v_accvgpr_read_b32 v175, a199
v_mul_f32 v172, v172, v249
v_mul_f32 v173, v173, v249
v_mul_f32 v174, v174, v249
v_mul_f32 v175, v175, v249
v_cvt_pk_bf16_f32 v60, v172, v173
v_cvt_pk_bf16_f32 v61, v174, v175
v_accvgpr_read_b32 v192, a32
v_accvgpr_read_b32 v193, a33
v_accvgpr_read_b32 v194, a34
v_accvgpr_read_b32 v195, a35
v_mul_f32 v192, v192, v248
v_mul_f32 v193, v193, v248
v_mul_f32 v194, v194, v248
v_mul_f32 v195, v195, v248
v_cvt_pk_bf16_f32 v0, v192, v193
v_cvt_pk_bf16_f32 v1, v194, v195
v_accvgpr_read_b32 v196, a36
v_accvgpr_read_b32 v197, a37
v_accvgpr_read_b32 v198, a38
v_accvgpr_read_b32 v199, a39
v_mul_f32 v196, v196, v249
v_mul_f32 v197, v197, v249
v_mul_f32 v198, v198, v249
v_mul_f32 v199, v199, v249
v_cvt_pk_bf16_f32 v32, v196, v197
v_cvt_pk_bf16_f32 v33, v198, v199
v_accvgpr_read_b32 v160, a96
v_accvgpr_read_b32 v161, a97
v_accvgpr_read_b32 v162, a98
v_accvgpr_read_b32 v163, a99
v_mul_f32 v160, v160, v248
v_mul_f32 v161, v161, v248
v_mul_f32 v162, v162, v248
v_mul_f32 v163, v163, v248
v_cvt_pk_bf16_f32 v8, v160, v161
v_cvt_pk_bf16_f32 v9, v162, v163
v_accvgpr_read_b32 v164, a100
v_accvgpr_read_b32 v165, a101
v_accvgpr_read_b32 v166, a102
v_accvgpr_read_b32 v167, a103
v_mul_f32 v164, v164, v249
v_mul_f32 v165, v165, v249
v_mul_f32 v166, v166, v249
v_mul_f32 v167, v167, v249
v_cvt_pk_bf16_f32 v40, v164, v165
v_cvt_pk_bf16_f32 v41, v166, v167
v_accvgpr_read_b32 v168, a160
v_accvgpr_read_b32 v169, a161
v_accvgpr_read_b32 v170, a162
v_accvgpr_read_b32 v171, a163
v_mul_f32 v168, v168, v248
v_mul_f32 v169, v169, v248
v_mul_f32 v170, v170, v248
v_mul_f32 v171, v171, v248
v_cvt_pk_bf16_f32 v16, v168, v169
v_cvt_pk_bf16_f32 v17, v170, v171
v_accvgpr_read_b32 v172, a164
v_accvgpr_read_b32 v173, a165
v_accvgpr_read_b32 v174, a166
v_accvgpr_read_b32 v175, a167
v_mul_f32 v172, v172, v249
v_mul_f32 v173, v173, v249
v_mul_f32 v174, v174, v249
v_mul_f32 v175, v175, v249
v_cvt_pk_bf16_f32 v48, v172, v173
v_cvt_pk_bf16_f32 v49, v174, v175
v_accvgpr_read_b32 v192, a224
v_accvgpr_read_b32 v193, a225
v_accvgpr_read_b32 v194, a226
v_accvgpr_read_b32 v195, a227
v_mul_f32 v192, v192, v248
v_mul_f32 v193, v193, v248
v_mul_f32 v194, v194, v248
v_mul_f32 v195, v195, v248
v_cvt_pk_bf16_f32 v24, v192, v193
v_cvt_pk_bf16_f32 v25, v194, v195
v_accvgpr_read_b32 v196, a228
v_accvgpr_read_b32 v197, a229
v_accvgpr_read_b32 v198, a230
v_accvgpr_read_b32 v199, a231
v_mul_f32 v196, v196, v249
v_mul_f32 v197, v197, v249
v_mul_f32 v198, v198, v249
v_mul_f32 v199, v199, v249
v_cvt_pk_bf16_f32 v56, v196, v197
v_cvt_pk_bf16_f32 v57, v198, v199
v_accvgpr_read_b32 v160, a48
v_accvgpr_read_b32 v161, a49
v_accvgpr_read_b32 v162, a50
v_accvgpr_read_b32 v163, a51
v_mul_f32 v160, v160, v248
v_mul_f32 v161, v161, v248
v_mul_f32 v162, v162, v248
v_mul_f32 v163, v163, v248
v_cvt_pk_bf16_f32 v2, v160, v161
v_cvt_pk_bf16_f32 v3, v162, v163
v_accvgpr_read_b32 v164, a52
v_accvgpr_read_b32 v165, a53
v_accvgpr_read_b32 v166, a54
v_accvgpr_read_b32 v167, a55
v_mul_f32 v164, v164, v249
v_mul_f32 v165, v165, v249
v_mul_f32 v166, v166, v249
v_mul_f32 v167, v167, v249
v_cvt_pk_bf16_f32 v34, v164, v165
v_cvt_pk_bf16_f32 v35, v166, v167
v_accvgpr_read_b32 v168, a112
v_accvgpr_read_b32 v169, a113
v_accvgpr_read_b32 v170, a114
v_accvgpr_read_b32 v171, a115
v_mul_f32 v168, v168, v248
v_mul_f32 v169, v169, v248
v_mul_f32 v170, v170, v248
v_mul_f32 v171, v171, v248
v_cvt_pk_bf16_f32 v10, v168, v169
v_cvt_pk_bf16_f32 v11, v170, v171
v_accvgpr_read_b32 v172, a116
v_accvgpr_read_b32 v173, a117
v_accvgpr_read_b32 v174, a118
v_accvgpr_read_b32 v175, a119
v_mul_f32 v172, v172, v249
v_mul_f32 v173, v173, v249
v_mul_f32 v174, v174, v249
v_mul_f32 v175, v175, v249
v_cvt_pk_bf16_f32 v42, v172, v173
v_cvt_pk_bf16_f32 v43, v174, v175
v_accvgpr_read_b32 v192, a176
v_accvgpr_read_b32 v193, a177
v_accvgpr_read_b32 v194, a178
v_accvgpr_read_b32 v195, a179
v_mul_f32 v192, v192, v248
v_mul_f32 v193, v193, v248
v_mul_f32 v194, v194, v248
v_mul_f32 v195, v195, v248
v_cvt_pk_bf16_f32 v18, v192, v193
v_cvt_pk_bf16_f32 v19, v194, v195
v_accvgpr_read_b32 v196, a180
v_accvgpr_read_b32 v197, a181
v_accvgpr_read_b32 v198, a182
v_accvgpr_read_b32 v199, a183
v_mul_f32 v196, v196, v249
v_mul_f32 v197, v197, v249
v_mul_f32 v198, v198, v249
v_mul_f32 v199, v199, v249
v_cvt_pk_bf16_f32 v50, v196, v197
v_cvt_pk_bf16_f32 v51, v198, v199
v_accvgpr_read_b32 v160, a240
v_accvgpr_read_b32 v161, a241
v_accvgpr_read_b32 v162, a242
v_accvgpr_read_b32 v163, a243
v_mul_f32 v160, v160, v248
v_mul_f32 v161, v161, v248
v_mul_f32 v162, v162, v248
v_mul_f32 v163, v163, v248
v_cvt_pk_bf16_f32 v26, v160, v161
v_cvt_pk_bf16_f32 v27, v162, v163
v_accvgpr_read_b32 v164, a244
v_accvgpr_read_b32 v165, a245
v_accvgpr_read_b32 v166, a246
v_accvgpr_read_b32 v167, a247
v_mul_f32 v164, v164, v249
v_mul_f32 v165, v165, v249
v_mul_f32 v166, v166, v249
v_mul_f32 v167, v167, v249
v_cvt_pk_bf16_f32 v58, v164, v165
v_cvt_pk_bf16_f32 v59, v166, v167
s_waitcnt vmcnt(0) lgkmcnt(0)
s_barrier
ds_read_b64_tr_b16 a[176:177], v236 offset:0
ds_read_b64_tr_b16 a[178:179], v236 offset:2048
ds_read_b64 a[0:1], v247 offset:0
ds_read_b64 a[2:3], v247 offset:512
ds_read_b64_tr_b16 a[180:181], v237 offset:0
ds_read_b64_tr_b16 a[182:183], v237 offset:2048
ds_read_b64_tr_b16 a[192:193], v242 offset:0
ds_read_b64_tr_b16 a[194:195], v242 offset:2048
ds_read_b64_tr_b16 a[196:197], v243 offset:0
ds_read_b64_tr_b16 a[198:199], v243 offset:2048
s_waitcnt lgkmcnt(8)
v_mfma_f32_16x16x32_bf16 v[128:131], a[176:179], v[0:3], 0
ds_read_b64_tr_b16 a[208:209], v236 offset:4096
v_add_u32 v252, 128, v253
v_mfma_f32_16x16x32_bf16 v[132:135], a[176:179], v[32:35], 0
s_waitcnt lgkmcnt(7)
ds_read_b64_tr_b16 a[210:211], v236 offset:6144
s_add_u32 m0, s29, 65536
v_mfma_f32_16x16x32_bf16 v[208:211], a[176:179], a[0:3], 0
s_waitcnt lgkmcnt(6)
ds_read_b64 a[4:5], v247 offset:1024
v_accvgpr_read_b32 v160, a8
v_mfma_f32_16x16x32_bf16 v[136:139], a[180:183], v[0:3], 0
ds_read_b64 a[6:7], v247 offset:1536
v_accvgpr_read_b32 v161, a9
v_mfma_f32_16x16x32_bf16 v[140:143], a[180:183], v[32:35], 0
s_waitcnt lgkmcnt(6)
ds_read_b64_tr_b16 a[212:213], v237 offset:4096
v_accvgpr_read_b32 v162, a10
v_mfma_f32_16x16x32_bf16 v[144:147], a[192:195], v[0:3], 0
ds_read_b64_tr_b16 a[214:215], v237 offset:6144
buffer_load_dwordx4 v252, s[20:23], s52 offen  lds
v_mfma_f32_16x16x32_bf16 v[148:151], a[192:195], v[32:35], 0
s_waitcnt lgkmcnt(6)
ds_read_b64_tr_b16 a[224:225], v242 offset:4096
s_add_u32 m0, s29, 69632
v_mfma_f32_16x16x32_bf16 v[152:155], a[196:199], v[0:3], 0
ds_read_b64_tr_b16 a[226:227], v242 offset:6144
v_accvgpr_read_b32 v163, a11
v_mfma_f32_16x16x32_bf16 v[156:159], a[196:199], v[32:35], 0
s_waitcnt lgkmcnt(6)
ds_read_b64_tr_b16 a[228:229], v243 offset:4096
buffer_load_dwordx4 v252, s[20:23], s53 offen  lds
v_mfma_f32_16x16x32_bf16 v[128:131], a[208:211], v[4:7], v[128:131]
ds_read_b64_tr_b16 a[230:231], v243 offset:6144
s_add_u32 m0, s29, 73728
v_mfma_f32_16x16x32_bf16 v[132:135], a[208:211], v[36:39], v[132:135]
s_waitcnt lgkmcnt(6)
ds_read_b64_tr_b16 a[240:241], v236 offset:8192
v_mul_f32 v160, v160, v250
v_mfma_f32_16x16x32_bf16 v[208:211], a[208:211], a[4:7], v[208:211]
s_waitcnt lgkmcnt(5)
ds_read_b64_tr_b16 a[242:243], v236 offset:10240
v_mul_f32 v161, v161, v250
v_mfma_f32_16x16x32_bf16 v[136:139], a[212:215], v[4:7], v[136:139]
ds_read_b64 a[16:17], v247 offset:2048
buffer_load_dwordx4 v252, s[20:23], s54 offen  lds
v_mfma_f32_16x16x32_bf16 v[140:143], a[212:215], v[36:39], v[140:143]
s_waitcnt lgkmcnt(5)
ds_read_b64 a[18:19], v247 offset:2560
s_add_u32 m0, s29, 77824
v_mfma_f32_16x16x32_bf16 v[144:147], a[224:227], v[4:7], v[144:147]
ds_read_b64_tr_b16 a[244:245], v237 offset:8192
v_mul_f32 v162, v162, v250
v_mfma_f32_16x16x32_bf16 v[148:151], a[224:227], v[36:39], v[148:151]
s_waitcnt lgkmcnt(5)
ds_read_b64_tr_b16 a[246:247], v237 offset:10240
v_mul_f32 v163, v163, v250
v_mfma_f32_16x16x32_bf16 v[152:155], a[228:231], v[4:7], v[152:155]
ds_read_b64_tr_b16 a[176:177], v242 offset:8192
buffer_load_dwordx4 v252, s[20:23], s55 offen  lds
v_mfma_f32_16x16x32_bf16 v[156:159], a[228:231], v[36:39], v[156:159]
s_waitcnt lgkmcnt(5)
ds_read_b64_tr_b16 a[178:179], v242 offset:10240
s_add_u32 m0, s29, 81920
v_mfma_f32_16x16x32_bf16 v[128:131], a[240:243], v[8:11], v[128:131]
ds_read_b64_tr_b16 a[180:181], v243 offset:8192
v_cvt_pk_bf16_f32 v68, v160, v161
v_mfma_f32_16x16x32_bf16 v[132:135], a[240:243], v[40:43], v[132:135]
s_waitcnt lgkmcnt(5)
ds_read_b64_tr_b16 a[182:183], v243 offset:10240
v_cvt_pk_bf16_f32 v69, v162, v163
v_mfma_f32_16x16x32_bf16 v[208:211], a[240:243], a[16:19], v[208:211]
s_waitcnt lgkmcnt(4)
ds_read_b64_tr_b16 a[192:193], v236 offset:12288
buffer_load_dwordx4 v252, s[20:23], s56 offen  lds
v_mfma_f32_16x16x32_bf16 v[136:139], a[244:247], v[8:11], v[136:139]
ds_read_b64_tr_b16 a[194:195], v236 offset:14336
s_add_u32 m0, s29, 86016
v_mfma_f32_16x16x32_bf16 v[140:143], a[244:247], v[40:43], v[140:143]
s_waitcnt lgkmcnt(4)
ds_read_b64 a[20:21], v247 offset:3072
v_accvgpr_read_b32 v164, a12
v_mfma_f32_16x16x32_bf16 v[144:147], a[176:179], v[8:11], v[144:147]
ds_read_b64 a[22:23], v247 offset:3584
v_accvgpr_read_b32 v165, a13
v_mfma_f32_16x16x32_bf16 v[148:151], a[176:179], v[40:43], v[148:151]
s_waitcnt lgkmcnt(4)
ds_read_b64_tr_b16 a[196:197], v237 offset:12288
buffer_load_dwordx4 v252, s[20:23], s57 offen  lds
v_mfma_f32_16x16x32_bf16 v[152:155], a[180:183], v[8:11], v[152:155]
ds_read_b64_tr_b16 a[198:199], v237 offset:14336
s_add_u32 m0, s29, 90112
v_mfma_f32_16x16x32_bf16 v[156:159], a[180:183], v[40:43], v[156:159]
s_waitcnt lgkmcnt(4)
ds_read_b64_tr_b16 a[208:209], v242 offset:12288
v_accvgpr_read_b32 v166, a14
v_mfma_f32_16x16x32_bf16 v[128:131], a[192:195], v[12:15], v[128:131]
ds_read_b64_tr_b16 a[210:211], v242 offset:14336
v_accvgpr_read_b32 v167, a15
v_mfma_f32_16x16x32_bf16 v[132:135], a[192:195], v[44:47], v[132:135]
s_waitcnt lgkmcnt(4)
ds_read_b64_tr_b16 a[212:213], v243 offset:12288
buffer_load_dwordx4 v252, s[20:23], s58 offen  lds
v_mfma_f32_16x16x32_bf16 v[208:211], a[192:195], a[20:23], v[208:211]
s_waitcnt lgkmcnt(3)
ds_read_b64_tr_b16 a[214:215], v243 offset:14336
s_add_u32 m0, s29, 94208
v_mfma_f32_16x16x32_bf16 v[136:139], a[196:199], v[12:15], v[136:139]
ds_read_b64_tr_b16 a[224:225], v236 offset:16384
v_mul_f32 v164, v164, v251
v_mfma_f32_16x16x32_bf16 v[140:143], a[196:199], v[44:47], v[140:143]
s_waitcnt lgkmcnt(3)
ds_read_b64_tr_b16 a[226:227], v236 offset:18432
v_mul_f32 v165, v165, v251
v_mfma_f32_16x16x32_bf16 v[144:147], a[208:211], v[12:15], v[144:147]
ds_read_b64 a[32:33], v247 offset:4096
buffer_load_dwordx4 v252, s[20:23], s59 offen  lds
v_mfma_f32_16x16x32_bf16 v[148:151], a[208:211], v[44:47], v[148:151]
s_waitcnt lgkmcnt(3)
ds_read_b64 a[34:35], v247 offset:4608
v_mul_f32 v166, v166, v251
v_mfma_f32_16x16x32_bf16 v[152:155], a[212:215], v[12:15], v[152:155]
ds_read_b64_tr_b16 a[228:229], v237 offset:16384
v_add_u32 v252, 229504, v253
v_mfma_f32_16x16x32_bf16 v[156:159], a[212:215], v[44:47], v[156:159]
s_waitcnt lgkmcnt(3)
ds_read_b64_tr_b16 a[230:231], v237 offset:18432
s_add_u32 m0, s29, 98304
v_mfma_f32_16x16x32_bf16 v[128:131], a[224:227], v[16:19], v[128:131]
ds_read_b64_tr_b16 a[240:241], v242 offset:16384
v_mul_f32 v167, v167, v251
v_mfma_f32_16x16x32_bf16 v[132:135], a[224:227], v[48:51], v[132:135]
s_waitcnt lgkmcnt(3)
ds_read_b64_tr_b16 a[242:243], v242 offset:18432
v_cvt_pk_bf16_f32 v100, v164, v165
v_mfma_f32_16x16x32_bf16 v[208:211], a[224:227], a[32:35], v[208:211]
s_waitcnt lgkmcnt(2)
ds_read_b64_tr_b16 a[244:245], v243 offset:16384
v_cvt_pk_bf16_f32 v101, v166, v167
v_mfma_f32_16x16x32_bf16 v[136:139], a[228:231], v[16:19], v[136:139]
ds_read_b64_tr_b16 a[246:247], v243 offset:18432
v_accvgpr_read_b32 v168, a24
v_mfma_f32_16x16x32_bf16 v[140:143], a[228:231], v[48:51], v[140:143]
s_waitcnt lgkmcnt(2)
ds_read_b64_tr_b16 a[176:177], v236 offset:20480
buffer_load_dwordx4 v252, s[20:23], s52 offen  lds
v_mfma_f32_16x16x32_bf16 v[144:147], a[240:243], v[16:19], v[144:147]
ds_read_b64_tr_b16 a[178:179], v236 offset:22528
s_add_u32 m0, s29, 102400
v_mfma_f32_16x16x32_bf16 v[148:151], a[240:243], v[48:51], v[148:151]
s_waitcnt lgkmcnt(2)
ds_read_b64 a[36:37], v247 offset:5120
v_accvgpr_read_b32 v169, a25
v_mfma_f32_16x16x32_bf16 v[152:155], a[244:247], v[16:19], v[152:155]
ds_read_b64 a[38:39], v247 offset:5632
buffer_load_dwordx4 v252, s[20:23], s53 offen  lds
v_mfma_f32_16x16x32_bf16 v[156:159], a[244:247], v[48:51], v[156:159]
s_waitcnt lgkmcnt(2)
ds_read_b64_tr_b16 a[180:181], v237 offset:20480
s_add_u32 m0, s29, 106496
v_mfma_f32_16x16x32_bf16 v[128:131], a[176:179], v[20:23], v[128:131]
ds_read_b64_tr_b16 a[182:183], v237 offset:22528
v_accvgpr_read_b32 v170, a26
v_mfma_f32_16x16x32_bf16 v[132:135], a[176:179], v[52:55], v[132:135]
s_waitcnt lgkmcnt(2)
ds_read_b64_tr_b16 a[192:193], v242 offset:20480
v_accvgpr_read_b32 v171, a27
v_mfma_f32_16x16x32_bf16 v[208:211], a[176:179], a[36:39], v[208:211]
s_waitcnt lgkmcnt(1)
ds_read_b64_tr_b16 a[194:195], v242 offset:22528
buffer_load_dwordx4 v252, s[20:23], s54 offen  lds
v_mfma_f32_16x16x32_bf16 v[136:139], a[180:183], v[20:23], v[136:139]
ds_read_b64_tr_b16 a[196:197], v243 offset:20480
s_add_u32 m0, s29, 110592
v_mfma_f32_16x16x32_bf16 v[140:143], a[180:183], v[52:55], v[140:143]
s_waitcnt lgkmcnt(1)
ds_read_b64_tr_b16 a[198:199], v243 offset:22528
v_mul_f32 v168, v168, v250
v_mfma_f32_16x16x32_bf16 v[144:147], a[192:195], v[20:23], v[144:147]
ds_read_b64_tr_b16 a[208:209], v236 offset:24576
buffer_load_dwordx4 v252, s[20:23], s55 offen  lds
v_mfma_f32_16x16x32_bf16 v[148:151], a[192:195], v[52:55], v[148:151]
s_waitcnt lgkmcnt(1)
ds_read_b64_tr_b16 a[210:211], v236 offset:26624
s_add_u32 m0, s29, 114688
v_mfma_f32_16x16x32_bf16 v[152:155], a[196:199], v[20:23], v[152:155]
ds_read_b64 a[48:49], v247 offset:6144
v_mul_f32 v169, v169, v250
v_mfma_f32_16x16x32_bf16 v[156:159], a[196:199], v[52:55], v[156:159]
s_waitcnt lgkmcnt(1)
ds_read_b64 a[50:51], v247 offset:6656
v_mul_f32 v170, v170, v250
v_mfma_f32_16x16x32_bf16 v[128:131], a[208:211], v[24:27], v[128:131]
ds_read_b64_tr_b16 a[212:213], v237 offset:24576
buffer_load_dwordx4 v252, s[20:23], s56 offen  lds
v_mfma_f32_16x16x32_bf16 v[132:135], a[208:211], v[56:59], v[132:135]
s_waitcnt lgkmcnt(1)
ds_read_b64_tr_b16 a[214:215], v237 offset:26624
s_add_u32 m0, s29, 118784
v_mfma_f32_16x16x32_bf16 v[208:211], a[208:211], a[48:51], v[208:211]
s_waitcnt lgkmcnt(0)
ds_read_b64_tr_b16 a[224:225], v242 offset:24576
v_mul_f32 v171, v171, v250
v_mfma_f32_16x16x32_bf16 v[136:139], a[212:215], v[24:27], v[136:139]
ds_read_b64_tr_b16 a[226:227], v242 offset:26624
buffer_load_dwordx4 v252, s[20:23], s57 offen  lds
v_mfma_f32_16x16x32_bf16 v[140:143], a[212:215], v[56:59], v[140:143]
s_waitcnt lgkmcnt(0)
ds_read_b64_tr_b16 a[228:229], v243 offset:24576
s_add_u32 m0, s29, 122880
v_mfma_f32_16x16x32_bf16 v[144:147], a[224:227], v[24:27], v[144:147]
ds_read_b64_tr_b16 a[230:231], v243 offset:26624
v_cvt_pk_bf16_f32 v70, v168, v169
v_mfma_f32_16x16x32_bf16 v[148:151], a[224:227], v[56:59], v[148:151]
s_waitcnt lgkmcnt(0)
ds_read_b64_tr_b16 a[240:241], v236 offset:28672
v_cvt_pk_bf16_f32 v71, v170, v171
v_mfma_f32_16x16x32_bf16 v[152:155], a[228:231], v[24:27], v[152:155]
ds_read_b64_tr_b16 a[242:243], v236 offset:30720
buffer_load_dwordx4 v252, s[20:23], s58 offen  lds
v_mfma_f32_16x16x32_bf16 v[156:159], a[228:231], v[56:59], v[156:159]
s_waitcnt lgkmcnt(0)
ds_read_b64 a[52:53], v247 offset:7168
s_add_u32 m0, s29, 126976
v_mfma_f32_16x16x32_bf16 v[128:131], a[240:243], v[28:31], v[128:131]
ds_read_b64 a[54:55], v247 offset:7680
v_accvgpr_read_b32 v172, a28
v_mfma_f32_16x16x32_bf16 v[132:135], a[240:243], v[60:63], v[132:135]
s_waitcnt lgkmcnt(0)
ds_read_b64_tr_b16 a[244:245], v237 offset:28672
buffer_load_dwordx4 v252, s[20:23], s59 offen  lds
v_mfma_f32_16x16x32_bf16 v[208:211], a[240:243], a[52:55], v[208:211]
ds_read_b64_tr_b16 a[246:247], v237 offset:30720
s_waitcnt lgkmcnt(0)
ds_read_b64_tr_b16 a[212:213], v242 offset:28672
v_accvgpr_read_b32 v173, a29
v_mfma_f32_16x16x32_bf16 v[136:139], a[244:247], v[28:31], v[136:139]
ds_read_b64_tr_b16 a[214:215], v242 offset:30720
v_accvgpr_read_b32 v174, a30
v_mfma_f32_16x16x32_bf16 v[140:143], a[244:247], v[60:63], v[140:143]
s_waitcnt lgkmcnt(0)
ds_read_b64_tr_b16 a[224:225], v243 offset:28672
v_accvgpr_read_b32 v175, a31
v_mfma_f32_16x16x32_bf16 v[144:147], a[212:215], v[28:31], v[144:147]
ds_read_b64_tr_b16 a[226:227], v243 offset:30720
v_mul_f32 v172, v172, v251
v_mfma_f32_16x16x32_bf16 v[148:151], a[212:215], v[60:63], v[148:151]
s_waitcnt lgkmcnt(0)
ds_read_b64_tr_b16 a[176:177], v236 offset:32768
v_mul_f32 v173, v173, v251
v_mfma_f32_16x16x32_bf16 v[152:155], a[224:227], v[28:31], v[152:155]
ds_read_b64_tr_b16 a[178:179], v236 offset:34816
v_mul_f32 v174, v174, v251
v_mfma_f32_16x16x32_bf16 v[156:159], a[224:227], v[60:63], v[156:159]
ds_read_b64_tr_b16 a[180:181], v237 offset:32768
v_mul_f32 v175, v175, v251
v_cvt_pk_bf16_f32 v102, v172, v173
ds_read_b64_tr_b16 a[182:183], v237 offset:34816
v_cvt_pk_bf16_f32 v103, v174, v175
ds_read_b64_tr_b16 a[192:193], v242 offset:32768
v_accvgpr_read_b32 v176, a40
ds_read_b64_tr_b16 a[194:195], v242 offset:34816
v_accvgpr_read_b32 v177, a41
ds_read_b64_tr_b16 a[196:197], v243 offset:32768
v_accvgpr_read_b32 v178, a42
ds_read_b64_tr_b16 a[198:199], v243 offset:34816
v_accvgpr_read_b32 v179, a43
ds_read_b64_tr_b16 a[208:209], v236 offset:36864
v_mul_f32 v176, v176, v250
ds_read_b64_tr_b16 a[210:211], v236 offset:38912
v_mul_f32 v177, v177, v250
v_mul_f32 v178, v178, v250
v_mul_f32 v179, v179, v250
v_cvt_pk_bf16_f32 v64, v176, v177
v_cvt_pk_bf16_f32 v65, v178, v179
v_accvgpr_read_b32 v180, a44
v_accvgpr_read_b32 v181, a45
v_accvgpr_read_b32 v182, a46
v_accvgpr_read_b32 v183, a47
v_mul_f32 v180, v180, v251
v_mul_f32 v181, v181, v251
v_mul_f32 v182, v182, v251
v_mul_f32 v183, v183, v251
v_cvt_pk_bf16_f32 v96, v180, v181
v_cvt_pk_bf16_f32 v97, v182, v183
v_accvgpr_read_b32 v184, a56
v_accvgpr_read_b32 v185, a57
v_accvgpr_read_b32 v186, a58
v_accvgpr_read_b32 v187, a59
v_mul_f32 v184, v184, v250
v_mul_f32 v185, v185, v250
v_mul_f32 v186, v186, v250
v_mul_f32 v187, v187, v250
v_cvt_pk_bf16_f32 v66, v184, v185
v_cvt_pk_bf16_f32 v67, v186, v187
v_accvgpr_read_b32 v188, a60
v_accvgpr_read_b32 v189, a61
v_accvgpr_read_b32 v190, a62
v_accvgpr_read_b32 v191, a63
v_mul_f32 v188, v188, v251
v_mul_f32 v189, v189, v251
v_mul_f32 v190, v190, v251
v_mul_f32 v191, v191, v251
v_cvt_pk_bf16_f32 v98, v188, v189
v_cvt_pk_bf16_f32 v99, v190, v191
v_accvgpr_read_b32 v160, a72
v_accvgpr_read_b32 v161, a73
v_accvgpr_read_b32 v162, a74
v_accvgpr_read_b32 v163, a75
v_mul_f32 v160, v160, v250
v_mul_f32 v161, v161, v250
v_mul_f32 v162, v162, v250
v_mul_f32 v163, v163, v250
v_cvt_pk_bf16_f32 v76, v160, v161
v_cvt_pk_bf16_f32 v77, v162, v163
v_accvgpr_read_b32 v164, a76
v_accvgpr_read_b32 v165, a77
v_accvgpr_read_b32 v166, a78
v_accvgpr_read_b32 v167, a79
v_mul_f32 v164, v164, v251
v_mul_f32 v165, v165, v251
v_mul_f32 v166, v166, v251
v_mul_f32 v167, v167, v251
v_cvt_pk_bf16_f32 v108, v164, v165
v_cvt_pk_bf16_f32 v109, v166, v167
v_accvgpr_read_b32 v168, a88
v_accvgpr_read_b32 v169, a89
v_accvgpr_read_b32 v170, a90
v_accvgpr_read_b32 v171, a91
v_mul_f32 v168, v168, v250
v_mul_f32 v169, v169, v250
v_mul_f32 v170, v170, v250
v_mul_f32 v171, v171, v250
v_cvt_pk_bf16_f32 v78, v168, v169
v_cvt_pk_bf16_f32 v79, v170, v171
v_accvgpr_read_b32 v172, a92
v_accvgpr_read_b32 v173, a93
v_accvgpr_read_b32 v174, a94
v_accvgpr_read_b32 v175, a95
v_mul_f32 v172, v172, v251
v_mul_f32 v173, v173, v251
v_mul_f32 v174, v174, v251
v_mul_f32 v175, v175, v251
v_cvt_pk_bf16_f32 v110, v172, v173
v_cvt_pk_bf16_f32 v111, v174, v175
v_accvgpr_read_b32 v176, a104
v_accvgpr_read_b32 v177, a105
v_accvgpr_read_b32 v178, a106
v_accvgpr_read_b32 v179, a107
v_mul_f32 v176, v176, v250
v_mul_f32 v177, v177, v250
v_mul_f32 v178, v178, v250
v_mul_f32 v179, v179, v250
v_cvt_pk_bf16_f32 v72, v176, v177
v_cvt_pk_bf16_f32 v73, v178, v179
v_accvgpr_read_b32 v180, a108
v_accvgpr_read_b32 v181, a109
v_accvgpr_read_b32 v182, a110
v_accvgpr_read_b32 v183, a111
v_mul_f32 v180, v180, v251
v_mul_f32 v181, v181, v251
v_mul_f32 v182, v182, v251
v_mul_f32 v183, v183, v251
v_cvt_pk_bf16_f32 v104, v180, v181
v_cvt_pk_bf16_f32 v105, v182, v183
v_accvgpr_read_b32 v184, a120
v_accvgpr_read_b32 v185, a121
v_accvgpr_read_b32 v186, a122
v_accvgpr_read_b32 v187, a123
v_mul_f32 v184, v184, v250
v_mul_f32 v185, v185, v250
v_mul_f32 v186, v186, v250
v_mul_f32 v187, v187, v250
v_cvt_pk_bf16_f32 v74, v184, v185
v_cvt_pk_bf16_f32 v75, v186, v187
v_accvgpr_read_b32 v188, a124
v_accvgpr_read_b32 v189, a125
v_accvgpr_read_b32 v190, a126
v_accvgpr_read_b32 v191, a127
v_mul_f32 v188, v188, v251
v_mul_f32 v189, v189, v251
v_mul_f32 v190, v190, v251
v_mul_f32 v191, v191, v251
v_cvt_pk_bf16_f32 v106, v188, v189
v_cvt_pk_bf16_f32 v107, v190, v191
v_accvgpr_read_b32 v160, a136
v_accvgpr_read_b32 v161, a137
v_accvgpr_read_b32 v162, a138
v_accvgpr_read_b32 v163, a139
v_mul_f32 v160, v160, v250
v_mul_f32 v161, v161, v250
v_mul_f32 v162, v162, v250
v_mul_f32 v163, v163, v250
v_cvt_pk_bf16_f32 v84, v160, v161
v_cvt_pk_bf16_f32 v85, v162, v163
v_accvgpr_read_b32 v164, a140
v_accvgpr_read_b32 v165, a141
v_accvgpr_read_b32 v166, a142
v_accvgpr_read_b32 v167, a143
v_mul_f32 v164, v164, v251
v_mul_f32 v165, v165, v251
v_mul_f32 v166, v166, v251
v_mul_f32 v167, v167, v251
v_cvt_pk_bf16_f32 v116, v164, v165
v_cvt_pk_bf16_f32 v117, v166, v167
v_accvgpr_read_b32 v168, a152
v_accvgpr_read_b32 v169, a153
v_accvgpr_read_b32 v170, a154
v_accvgpr_read_b32 v171, a155
v_mul_f32 v168, v168, v250
v_mul_f32 v169, v169, v250
v_mul_f32 v170, v170, v250
v_mul_f32 v171, v171, v250
v_cvt_pk_bf16_f32 v86, v168, v169
v_cvt_pk_bf16_f32 v87, v170, v171
v_accvgpr_read_b32 v172, a156
v_accvgpr_read_b32 v173, a157
v_accvgpr_read_b32 v174, a158
v_accvgpr_read_b32 v175, a159
v_mul_f32 v172, v172, v251
v_mul_f32 v173, v173, v251
v_mul_f32 v174, v174, v251
v_mul_f32 v175, v175, v251
v_cvt_pk_bf16_f32 v118, v172, v173
v_cvt_pk_bf16_f32 v119, v174, v175
v_accvgpr_read_b32 v176, a168
v_accvgpr_read_b32 v177, a169
v_accvgpr_read_b32 v178, a170
v_accvgpr_read_b32 v179, a171
v_mul_f32 v176, v176, v250
v_mul_f32 v177, v177, v250
v_mul_f32 v178, v178, v250
v_mul_f32 v179, v179, v250
v_cvt_pk_bf16_f32 v80, v176, v177
v_cvt_pk_bf16_f32 v81, v178, v179
v_accvgpr_read_b32 v180, a172
v_accvgpr_read_b32 v181, a173
v_accvgpr_read_b32 v182, a174
v_accvgpr_read_b32 v183, a175
v_mul_f32 v180, v180, v251
v_mul_f32 v181, v181, v251
v_mul_f32 v182, v182, v251
v_mul_f32 v183, v183, v251
v_cvt_pk_bf16_f32 v112, v180, v181
v_cvt_pk_bf16_f32 v113, v182, v183
v_accvgpr_read_b32 v184, a184
v_accvgpr_read_b32 v185, a185
v_accvgpr_read_b32 v186, a186
v_accvgpr_read_b32 v187, a187
v_mul_f32 v184, v184, v250
v_mul_f32 v185, v185, v250
v_mul_f32 v186, v186, v250
v_mul_f32 v187, v187, v250
v_cvt_pk_bf16_f32 v82, v184, v185
v_cvt_pk_bf16_f32 v83, v186, v187
v_accvgpr_read_b32 v188, a188
v_accvgpr_read_b32 v189, a189
v_accvgpr_read_b32 v190, a190
v_accvgpr_read_b32 v191, a191
v_mul_f32 v188, v188, v251
v_mul_f32 v189, v189, v251
v_mul_f32 v190, v190, v251
v_mul_f32 v191, v191, v251
v_cvt_pk_bf16_f32 v114, v188, v189
v_cvt_pk_bf16_f32 v115, v190, v191
v_accvgpr_read_b32 v160, a200
v_accvgpr_read_b32 v161, a201
v_accvgpr_read_b32 v162, a202
v_accvgpr_read_b32 v163, a203
v_mul_f32 v160, v160, v250
v_mul_f32 v161, v161, v250
v_mul_f32 v162, v162, v250
v_mul_f32 v163, v163, v250
v_cvt_pk_bf16_f32 v92, v160, v161
v_cvt_pk_bf16_f32 v93, v162, v163
v_accvgpr_read_b32 v164, a204
v_accvgpr_read_b32 v165, a205
v_accvgpr_read_b32 v166, a206
v_accvgpr_read_b32 v167, a207
v_mul_f32 v164, v164, v251
v_mul_f32 v165, v165, v251
v_mul_f32 v166, v166, v251
v_mul_f32 v167, v167, v251
v_cvt_pk_bf16_f32 v124, v164, v165
v_cvt_pk_bf16_f32 v125, v166, v167
v_accvgpr_read_b32 v168, a216
v_accvgpr_read_b32 v169, a217
v_accvgpr_read_b32 v170, a218
v_accvgpr_read_b32 v171, a219
v_mul_f32 v168, v168, v250
v_mul_f32 v169, v169, v250
v_mul_f32 v170, v170, v250
v_mul_f32 v171, v171, v250
v_cvt_pk_bf16_f32 v94, v168, v169
v_cvt_pk_bf16_f32 v95, v170, v171
v_accvgpr_read_b32 v172, a220
v_accvgpr_read_b32 v173, a221
v_accvgpr_read_b32 v174, a222
v_accvgpr_read_b32 v175, a223
v_mul_f32 v172, v172, v251
v_mul_f32 v173, v173, v251
v_mul_f32 v174, v174, v251
v_mul_f32 v175, v175, v251
v_cvt_pk_bf16_f32 v126, v172, v173
v_cvt_pk_bf16_f32 v127, v174, v175
v_accvgpr_read_b32 v176, a232
v_accvgpr_read_b32 v177, a233
v_accvgpr_read_b32 v178, a234
v_accvgpr_read_b32 v179, a235
v_mul_f32 v176, v176, v250
v_mul_f32 v177, v177, v250
v_mul_f32 v178, v178, v250
v_mul_f32 v179, v179, v250
v_cvt_pk_bf16_f32 v88, v176, v177
v_cvt_pk_bf16_f32 v89, v178, v179
v_accvgpr_read_b32 v180, a236
v_accvgpr_read_b32 v181, a237
v_accvgpr_read_b32 v182, a238
v_accvgpr_read_b32 v183, a239
v_mul_f32 v180, v180, v251
v_mul_f32 v181, v181, v251
v_mul_f32 v182, v182, v251
v_mul_f32 v183, v183, v251
v_cvt_pk_bf16_f32 v120, v180, v181
v_cvt_pk_bf16_f32 v121, v182, v183
v_accvgpr_read_b32 v184, a248
v_accvgpr_read_b32 v185, a249
v_accvgpr_read_b32 v186, a250
v_accvgpr_read_b32 v187, a251
v_mul_f32 v184, v184, v250
v_mul_f32 v185, v185, v250
v_mul_f32 v186, v186, v250
v_mul_f32 v187, v187, v250
v_cvt_pk_bf16_f32 v90, v184, v185
v_cvt_pk_bf16_f32 v91, v186, v187
v_accvgpr_read_b32 v188, a252
v_accvgpr_read_b32 v189, a253
v_accvgpr_read_b32 v190, a254
v_accvgpr_read_b32 v191, a255
v_mul_f32 v188, v188, v251
v_mul_f32 v189, v189, v251
v_mul_f32 v190, v190, v251
v_mul_f32 v191, v191, v251
v_cvt_pk_bf16_f32 v122, v188, v189
v_cvt_pk_bf16_f32 v123, v190, v191
s_waitcnt vmcnt(8) lgkmcnt(10)
s_barrier
s_branch L_out1
L_tw3:
ds_read_b64_tr_b16 v[220:221], v239 offset:32768
ds_read_b64_tr_b16 v[222:223], v239 offset:34816
ds_read_b64_tr_b16 v[224:225], v239 offset:36864
ds_read_b64_tr_b16 v[226:227], v239 offset:38912
ds_read_b64_tr_b16 v[228:229], v239 offset:40960
ds_read_b64_tr_b16 v[230:231], v239 offset:43008
s_waitcnt lgkmcnt(4)
v_mfma_f32_16x16x32_bf16 a[16:19], v[220:223], v[176:179], a[16:19]
ds_read_b64_tr_b16 v[232:233], v239 offset:45056
v_add_u32 v252, 0, v253
v_mfma_f32_16x16x32_bf16 a[20:23], v[220:223], v[180:183], a[20:23]
ds_read_b64_tr_b16 v[234:235], v239 offset:47104
s_add_u32 m0, s29, 0
v_mfma_f32_16x16x32_bf16 a[24:27], v[220:223], v[184:187], a[24:27]
buffer_load_dwordx4 v252, s[20:23], s52 offen  lds
v_mfma_f32_16x16x32_bf16 a[28:31], v[220:223], v[188:191], a[28:31]
s_waitcnt lgkmcnt(4)
ds_read_b128 v[212:215], v244 offset:2048
s_add_u32 m0, s29, 4096
v_mfma_f32_16x16x32_bf16 a[80:83], v[224:227], v[176:179], a[80:83]
buffer_load_dwordx4 v252, s[20:23], s53 offen  lds
v_mfma_f32_16x16x32_bf16 a[84:87], v[224:227], v[180:183], a[84:87]
ds_read_b128 v[216:219], v244 offset:3072
v_mfma_f32_16x16x32_bf16 a[88:91], v[224:227], v[184:187], a[88:91]
ds_read_b64_tr_b16 v[220:221], v238 offset:32768
s_add_u32 m0, s29, 8192
v_mfma_f32_16x16x32_bf16 a[92:95], v[224:227], v[188:191], a[92:95]
s_waitcnt lgkmcnt(5)
ds_read_b64_tr_b16 v[222:223], v238 offset:34816
v_accvgpr_read_b32 v160, a16
v_mfma_f32_16x16x32_bf16 a[144:147], v[228:231], v[176:179], a[144:147]
buffer_load_dwordx4 v252, s[20:23], s54 offen  lds
v_mfma_f32_16x16x32_bf16 a[148:151], v[228:231], v[180:183], a[148:151]
ds_read_b64_tr_b16 v[224:225], v238 offset:36864
v_accvgpr_read_b32 v161, a17
v_mfma_f32_16x16x32_bf16 a[152:155], v[228:231], v[184:187], a[152:155]
ds_read_b64_tr_b16 v[226:227], v238 offset:38912
s_add_u32 m0, s29, 12288
v_mfma_f32_16x16x32_bf16 a[156:159], v[228:231], v[188:191], a[156:159]
s_waitcnt lgkmcnt(6)
v_accvgpr_read_b32 v162, a18
v_accvgpr_read_b32 v163, a19
v_mfma_f32_16x16x32_bf16 a[208:211], v[232:235], v[176:179], a[208:211]
buffer_load_dwordx4 v252, s[20:23], s55 offen  lds
v_mfma_f32_16x16x32_bf16 a[212:215], v[232:235], v[180:183], a[212:215]
ds_read_b64_tr_b16 v[228:229], v238 offset:40960
v_mul_f32 v160, v160, v248
v_mfma_f32_16x16x32_bf16 a[216:219], v[232:235], v[184:187], a[216:219]
ds_read_b64_tr_b16 v[230:231], v238 offset:43008
s_add_u32 m0, s29, 16384
v_mfma_f32_16x16x32_bf16 a[220:223], v[232:235], v[188:191], a[220:223]
s_waitcnt lgkmcnt(4)
v_mul_f32 v161, v161, v248
v_mul_f32 v162, v162, v248
v_mfma_f32_16x16x32_bf16 a[0:3], v[220:223], v[176:179], a[0:3]
buffer_load_dwordx4 v252, s[20:23], s56 offen  lds
v_mfma_f32_16x16x32_bf16 a[4:7], v[220:223], v[180:183], a[4:7]
v_mul_f32 v163, v163, v248
v_cvt_pk_bf16_f32 v4, v160, v161
v_mfma_f32_16x16x32_bf16 v[128:131], v[220:223], v[212:215], v[128:131]
ds_read_b64_tr_b16 v[232:233], v238 offset:45056
s_add_u32 m0, s29, 20480
v_mfma_f32_16x16x32_bf16 a[8:11], v[220:223], v[184:187], a[8:11]
ds_read_b64_tr_b16 v[234:235], v238 offset:47104
v_cvt_pk_bf16_f32 v5, v162, v163
v_mfma_f32_16x16x32_bf16 v[132:135], v[220:223], v[216:219], v[132:135]
buffer_load_dwordx4 v252, s[20:23], s57 offen  lds
v_mfma_f32_16x16x32_bf16 a[12:15], v[220:223], v[188:191], a[12:15]
s_waitcnt lgkmcnt(4)
v_accvgpr_read_b32 v164, a20
v_accvgpr_read_b32 v165, a21
v_mfma_f32_16x16x32_bf16 a[64:67], v[224:227], v[176:179], a[64:67]
s_add_u32 m0, s29, 24576
v_accvgpr_read_b32 v166, a22
v_mfma_f32_16x16x32_bf16 a[68:71], v[224:227], v[180:183], a[68:71]
v_accvgpr_read_b32 v167, a23
v_mul_f32 v164, v164, v249
v_mfma_f32_16x16x32_bf16 v[136:139], v[224:227], v[212:215], v[136:139]
buffer_load_dwordx4 v252, s[20:23], s58 offen  lds
v_mfma_f32_16x16x32_bf16 a[72:75], v[224:227], v[184:187], a[72:75]
ds_read_b64_tr_b16 v[220:221], v240 offset:32768
v_mul_f32 v165, v165, v249
v_mfma_f32_16x16x32_bf16 v[140:143], v[224:227], v[216:219], v[140:143]
ds_read_b64_tr_b16 v[222:223], v240 offset:34816
s_add_u32 m0, s29, 28672
v_mfma_f32_16x16x32_bf16 a[76:79], v[224:227], v[188:191], a[76:79]
s_waitcnt lgkmcnt(2)
v_mul_f32 v166, v166, v249
v_mul_f32 v167, v167, v249
v_mfma_f32_16x16x32_bf16 a[128:131], v[228:231], v[176:179], a[128:131]
buffer_load_dwordx4 v252, s[20:23], s59 offen  lds
v_mfma_f32_16x16x32_bf16 a[132:135], v[228:231], v[180:183], a[132:135]
ds_read_b64_tr_b16 v[224:225], v240 offset:36864
v_cvt_pk_bf16_f32 v36, v164, v165
v_mfma_f32_16x16x32_bf16 v[144:147], v[228:231], v[212:215], v[144:147]
ds_read_b64_tr_b16 v[226:227], v240 offset:38912
v_add_u32 v252, 229376, v253
v_mfma_f32_16x16x32_bf16 a[136:139], v[228:231], v[184:187], a[136:139]
s_add_u32 m0, s29, 32768
v_cvt_pk_bf16_f32 v37, v166, v167
v_mfma_f32_16x16x32_bf16 v[148:151], v[228:231], v[216:219], v[148:151]
buffer_load_dwordx4 v252, s[20:23], s52 offen  lds
v_mfma_f32_16x16x32_bf16 a[140:143], v[228:231], v[188:191], a[140:143]
ds_read_b64_tr_b16 v[228:229], v240 offset:40960
v_accvgpr_read_b32 v168, a80
v_mfma_f32_16x16x32_bf16 a[192:195], v[232:235], v[176:179], a[192:195]
ds_read_b64_tr_b16 v[230:231], v240 offset:43008
s_add_u32 m0, s29, 36864
v_mfma_f32_16x16x32_bf16 a[196:199], v[232:235], v[180:183], a[196:199]
v_accvgpr_read_b32 v169, a81
v_accvgpr_read_b32 v170, a82
v_mfma_f32_16x16x32_bf16 v[152:155], v[232:235], v[212:215], v[152:155]
buffer_load_dwordx4 v252, s[20:23], s53 offen  lds
v_mfma_f32_16x16x32_bf16 a[200:203], v[232:235], v[184:187], a[200:203]
v_accvgpr_read_b32 v171, a83
v_mul_f32 v168, v168, v248
v_mfma_f32_16x16x32_bf16 v[156:159], v[232:235], v[216:219], v[156:159]
s_add_u32 m0, s29, 40960
v_mul_f32 v169, v169, v248
v_mfma_f32_16x16x32_bf16 a[204:207], v[232:235], v[188:191], a[204:207]
s_waitcnt lgkmcnt(2)
ds_read_b64_tr_b16 v[232:233], v240 offset:45056
v_mul_f32 v170, v170, v248
v_mfma_f32_16x16x32_bf16 a[32:35], v[220:223], v[176:179], a[32:35]
buffer_load_dwordx4 v252, s[20:23], s54 offen  lds
v_mfma_f32_16x16x32_bf16 a[36:39], v[220:223], v[180:183], a[36:39]
ds_read_b64_tr_b16 v[234:235], v240 offset:47104
v_mul_f32 v171, v171, v248
v_mfma_f32_16x16x32_bf16 a[40:43], v[220:223], v[184:187], a[40:43]
s_add_u32 m0, s29, 45056
v_cvt_pk_bf16_f32 v12, v168, v169
v_mfma_f32_16x16x32_bf16 a[44:47], v[220:223], v[188:191], a[44:47]
ds_read_b64_tr_b16 v[220:221], v241 offset:32768
v_mul_f32 v128, v128, v206
v_mfma_f32_16x16x32_bf16 a[96:99], v[224:227], v[176:179], a[96:99]
buffer_load_dwordx4 v252, s[20:23], s55 offen  lds
v_mfma_f32_16x16x32_bf16 a[100:103], v[224:227], v[180:183], a[100:103]
ds_read_b64_tr_b16 v[222:223], v241 offset:34816
v_mul_f32 v129, v129, v206
v_mfma_f32_16x16x32_bf16 a[104:107], v[224:227], v[184:187], a[104:107]
s_add_u32 m0, s29, 49152
v_mul_f32 v130, v130, v206
v_mfma_f32_16x16x32_bf16 a[108:111], v[224:227], v[188:191], a[108:111]
s_waitcnt lgkmcnt(4)
ds_read_b64_tr_b16 v[224:225], v241 offset:36864
v_mul_f32 v131, v131, v206
v_mfma_f32_16x16x32_bf16 a[160:163], v[228:231], v[176:179], a[160:163]
buffer_load_dwordx4 v252, s[20:23], s56 offen  lds
v_mfma_f32_16x16x32_bf16 a[164:167], v[228:231], v[180:183], a[164:167]
ds_read_b64_tr_b16 v[226:227], v241 offset:38912
v_cvt_pk_bf16_f32 v128, v128, v129
v_mfma_f32_16x16x32_bf16 a[168:171], v[228:231], v[184:187], a[168:171]
s_add_u32 m0, s29, 53248
v_cvt_pk_bf16_f32 v129, v130, v131
v_mfma_f32_16x16x32_bf16 a[172:175], v[228:231], v[188:191], a[172:175]
s_waitcnt lgkmcnt(4)
ds_write_b64 v246, v[128:129] offset:0
v_mfma_f32_16x16x32_bf16 a[224:227], v[232:235], v[176:179], a[224:227]
buffer_load_dwordx4 v252, s[20:23], s57 offen  lds
v_mfma_f32_16x16x32_bf16 a[228:231], v[232:235], v[180:183], a[228:231]
ds_read_b64_tr_b16 v[228:229], v241 offset:40960
v_mul_f32 v132, v132, v207
v_mfma_f32_16x16x32_bf16 a[232:235], v[232:235], v[184:187], a[232:235]
ds_read_b64_tr_b16 v[230:231], v241 offset:43008
s_add_u32 m0, s29, 57344
v_mfma_f32_16x16x32_bf16 a[236:239], v[232:235], v[188:191], a[236:239]
s_waitcnt lgkmcnt(5)
ds_read_b64_tr_b16 v[232:233], v241 offset:45056
v_mul_f32 v133, v133, v207
v_mfma_f32_16x16x32_bf16 a[48:51], v[220:223], v[176:179], a[48:51]
buffer_load_dwordx4 v252, s[20:23], s58 offen  lds
v_mfma_f32_16x16x32_bf16 a[52:55], v[220:223], v[180:183], a[52:55]
ds_read_b64_tr_b16 v[234:235], v241 offset:47104
v_mul_f32 v134, v134, v207
v_mfma_f32_16x16x32_bf16 a[56:59], v[220:223], v[184:187], a[56:59]
s_add_u32 m0, s29, 61440
v_mul_f32 v135, v135, v207
v_mfma_f32_16x16x32_bf16 a[60:63], v[220:223], v[188:191], a[60:63]
s_waitcnt lgkmcnt(5)
v_cvt_pk_bf16_f32 v132, v132, v133
v_cvt_pk_bf16_f32 v133, v134, v135
v_mfma_f32_16x16x32_bf16 a[112:115], v[224:227], v[176:179], a[112:115]
buffer_load_dwordx4 v252, s[20:23], s59 offen  lds
v_mfma_f32_16x16x32_bf16 a[116:119], v[224:227], v[180:183], a[116:119]
ds_write_b64 v246, v[132:133] offset:8192
v_mfma_f32_16x16x32_bf16 a[120:123], v[224:227], v[184:187], a[120:123]
v_mul_f32 v136, v136, v206
v_mul_f32 v137, v137, v206
v_mfma_f32_16x16x32_bf16 a[124:127], v[224:227], v[188:191], a[124:127]
s_waitcnt lgkmcnt(3)
v_mul_f32 v138, v138, v206
v_mul_f32 v139, v139, v206
v_mfma_f32_16x16x32_bf16 a[176:179], v[228:231], v[176:179], a[176:179]
v_cvt_pk_bf16_f32 v136, v136, v137
v_cvt_pk_bf16_f32 v137, v138, v139
v_mfma_f32_16x16x32_bf16 a[180:183], v[228:231], v[180:183], a[180:183]
ds_write_b64 v246, v[136:137] offset:2048
v_mfma_f32_16x16x32_bf16 a[184:187], v[228:231], v[184:187], a[184:187]
v_mul_f32 v140, v140, v207
v_mul_f32 v141, v141, v207
v_mfma_f32_16x16x32_bf16 a[188:191], v[228:231], v[188:191], a[188:191]
s_waitcnt lgkmcnt(2)
v_mul_f32 v142, v142, v207
v_mul_f32 v143, v143, v207
v_mfma_f32_16x16x32_bf16 a[240:243], v[232:235], v[176:179], a[240:243]
v_cvt_pk_bf16_f32 v140, v140, v141
v_cvt_pk_bf16_f32 v141, v142, v143
v_mfma_f32_16x16x32_bf16 a[244:247], v[232:235], v[180:183], a[244:247]
ds_write_b64 v246, v[140:141] offset:10240
v_mfma_f32_16x16x32_bf16 a[248:251], v[232:235], v[184:187], a[248:251]
v_mul_f32 v144, v144, v206
v_mul_f32 v145, v145, v206
v_mfma_f32_16x16x32_bf16 a[252:255], v[232:235], v[188:191], a[252:255]
v_mul_f32 v146, v146, v206
v_mul_f32 v147, v147, v206
v_cvt_pk_bf16_f32 v13, v170, v171
v_accvgpr_read_b32 v172, a84
v_accvgpr_read_b32 v173, a85
v_accvgpr_read_b32 v174, a86
v_accvgpr_read_b32 v175, a87
v_mul_f32 v172, v172, v249
v_mul_f32 v173, v173, v249
v_mul_f32 v174, v174, v249
v_mul_f32 v175, v175, v249
v_cvt_pk_bf16_f32 v44, v172, v173
v_cvt_pk_bf16_f32 v45, v174, v175
v_accvgpr_read_b32 v192, a144
v_accvgpr_read_b32 v193, a145
v_accvgpr_read_b32 v194, a146
v_accvgpr_read_b32 v195, a147
v_mul_f32 v192, v192, v248
v_mul_f32 v193, v193, v248
v_mul_f32 v194, v194, v248
v_mul_f32 v195, v195, v248
v_cvt_pk_bf16_f32 v20, v192, v193
v_cvt_pk_bf16_f32 v21, v194, v195
v_accvgpr_read_b32 v196, a148
v_accvgpr_read_b32 v197, a149
v_accvgpr_read_b32 v198, a150
v_accvgpr_read_b32 v199, a151
v_mul_f32 v196, v196, v249
v_mul_f32 v197, v197, v249
v_mul_f32 v198, v198, v249
v_mul_f32 v199, v199, v249
v_cvt_pk_bf16_f32 v52, v196, v197
v_cvt_pk_bf16_f32 v53, v198, v199
v_accvgpr_read_b32 v160, a208
v_accvgpr_read_b32 v161, a209
v_accvgpr_read_b32 v162, a210
v_accvgpr_read_b32 v163, a211
v_mul_f32 v160, v160, v248
v_mul_f32 v161, v161, v248
v_mul_f32 v162, v162, v248
v_mul_f32 v163, v163, v248
v_cvt_pk_bf16_f32 v28, v160, v161
v_cvt_pk_bf16_f32 v29, v162, v163
v_accvgpr_read_b32 v164, a212
v_accvgpr_read_b32 v165, a213
v_accvgpr_read_b32 v166, a214
v_accvgpr_read_b32 v167, a215
v_mul_f32 v164, v164, v249
v_mul_f32 v165, v165, v249
v_mul_f32 v166, v166, v249
v_mul_f32 v167, v167, v249
v_cvt_pk_bf16_f32 v60, v164, v165
v_cvt_pk_bf16_f32 v61, v166, v167
v_accvgpr_read_b32 v168, a0
v_accvgpr_read_b32 v169, a1
v_accvgpr_read_b32 v170, a2
v_accvgpr_read_b32 v171, a3
v_mul_f32 v168, v168, v248
v_mul_f32 v169, v169, v248
v_mul_f32 v170, v170, v248
v_mul_f32 v171, v171, v248
v_cvt_pk_bf16_f32 v6, v168, v169
v_cvt_pk_bf16_f32 v7, v170, v171
v_accvgpr_read_b32 v172, a4
v_accvgpr_read_b32 v173, a5
v_accvgpr_read_b32 v174, a6
v_accvgpr_read_b32 v175, a7
v_mul_f32 v172, v172, v249
v_mul_f32 v173, v173, v249
v_mul_f32 v174, v174, v249
v_mul_f32 v175, v175, v249
v_cvt_pk_bf16_f32 v38, v172, v173
v_cvt_pk_bf16_f32 v39, v174, v175
v_accvgpr_read_b32 v192, a64
v_accvgpr_read_b32 v193, a65
v_accvgpr_read_b32 v194, a66
v_accvgpr_read_b32 v195, a67
v_mul_f32 v192, v192, v248
v_mul_f32 v193, v193, v248
v_mul_f32 v194, v194, v248
v_mul_f32 v195, v195, v248
v_cvt_pk_bf16_f32 v14, v192, v193
v_cvt_pk_bf16_f32 v15, v194, v195
v_accvgpr_read_b32 v196, a68
v_accvgpr_read_b32 v197, a69
v_accvgpr_read_b32 v198, a70
v_accvgpr_read_b32 v199, a71
v_mul_f32 v196, v196, v249
v_mul_f32 v197, v197, v249
v_mul_f32 v198, v198, v249
v_mul_f32 v199, v199, v249
v_cvt_pk_bf16_f32 v46, v196, v197
v_cvt_pk_bf16_f32 v47, v198, v199
v_accvgpr_read_b32 v160, a128
v_accvgpr_read_b32 v161, a129
v_accvgpr_read_b32 v162, a130
v_accvgpr_read_b32 v163, a131
v_mul_f32 v160, v160, v248
v_mul_f32 v161, v161, v248
v_mul_f32 v162, v162, v248
v_mul_f32 v163, v163, v248
v_cvt_pk_bf16_f32 v22, v160, v161
v_cvt_pk_bf16_f32 v23, v162, v163
v_accvgpr_read_b32 v164, a132
v_accvgpr_read_b32 v165, a133
v_accvgpr_read_b32 v166, a134
v_accvgpr_read_b32 v167, a135
v_mul_f32 v164, v164, v249
v_mul_f32 v165, v165, v249
v_mul_f32 v166, v166, v249
v_mul_f32 v167, v167, v249
v_cvt_pk_bf16_f32 v54, v164, v165
v_cvt_pk_bf16_f32 v55, v166, v167
v_cvt_pk_bf16_f32 v144, v144, v145
v_cvt_pk_bf16_f32 v145, v146, v147
ds_write_b64 v246, v[144:145] offset:4096
v_mul_f32 v148, v148, v207
v_mul_f32 v149, v149, v207
v_mul_f32 v150, v150, v207
v_mul_f32 v151, v151, v207
v_cvt_pk_bf16_f32 v148, v148, v149
v_cvt_pk_bf16_f32 v149, v150, v151
ds_write_b64 v246, v[148:149] offset:12288
v_mul_f32 v152, v152, v206
v_mul_f32 v153, v153, v206
v_mul_f32 v154, v154, v206
v_mul_f32 v155, v155, v206
v_cvt_pk_bf16_f32 v152, v152, v153
v_cvt_pk_bf16_f32 v153, v154, v155
ds_write_b64 v246, v[152:153] offset:6144
v_mul_f32 v156, v156, v207
v_mul_f32 v157, v157, v207
v_mul_f32 v158, v158, v207
v_mul_f32 v159, v159, v207
v_cvt_pk_bf16_f32 v156, v156, v157
v_cvt_pk_bf16_f32 v157, v158, v159
ds_write_b64 v246, v[156:157] offset:14336
v_accvgpr_read_b32 v168, a192
v_accvgpr_read_b32 v169, a193
v_accvgpr_read_b32 v170, a194
v_accvgpr_read_b32 v171, a195
v_mul_f32 v168, v168, v248
v_mul_f32 v169, v169, v248
v_mul_f32 v170, v170, v248
v_mul_f32 v171, v171, v248
v_cvt_pk_bf16_f32 v30, v168, v169
v_cvt_pk_bf16_f32 v31, v170, v171
v_accvgpr_read_b32 v172, a196
v_accvgpr_read_b32 v173, a197
v_accvgpr_read_b32 v174, a198
v_accvgpr_read_b32 v175, a199
v_mul_f32 v172, v172, v249
v_mul_f32 v173, v173, v249
v_mul_f32 v174, v174, v249
v_mul_f32 v175, v175, v249
v_cvt_pk_bf16_f32 v62, v172, v173
v_cvt_pk_bf16_f32 v63, v174, v175
v_accvgpr_read_b32 v192, a32
v_accvgpr_read_b32 v193, a33
v_accvgpr_read_b32 v194, a34
v_accvgpr_read_b32 v195, a35
v_mul_f32 v192, v192, v248
v_mul_f32 v193, v193, v248
v_mul_f32 v194, v194, v248
v_mul_f32 v195, v195, v248
v_cvt_pk_bf16_f32 v2, v192, v193
v_cvt_pk_bf16_f32 v3, v194, v195
v_accvgpr_read_b32 v196, a36
v_accvgpr_read_b32 v197, a37
v_accvgpr_read_b32 v198, a38
v_accvgpr_read_b32 v199, a39
v_mul_f32 v196, v196, v249
v_mul_f32 v197, v197, v249
v_mul_f32 v198, v198, v249
v_mul_f32 v199, v199, v249
v_cvt_pk_bf16_f32 v34, v196, v197
v_cvt_pk_bf16_f32 v35, v198, v199
v_accvgpr_read_b32 v160, a96
v_accvgpr_read_b32 v161, a97
v_accvgpr_read_b32 v162, a98
v_accvgpr_read_b32 v163, a99
v_mul_f32 v160, v160, v248
v_mul_f32 v161, v161, v248
v_mul_f32 v162, v162, v248
v_mul_f32 v163, v163, v248
v_cvt_pk_bf16_f32 v10, v160, v161
v_cvt_pk_bf16_f32 v11, v162, v163
v_accvgpr_read_b32 v164, a100
v_accvgpr_read_b32 v165, a101
v_accvgpr_read_b32 v166, a102
v_accvgpr_read_b32 v167, a103
v_mul_f32 v164, v164, v249
v_mul_f32 v165, v165, v249
v_mul_f32 v166, v166, v249
v_mul_f32 v167, v167, v249
v_cvt_pk_bf16_f32 v42, v164, v165
v_cvt_pk_bf16_f32 v43, v166, v167
v_accvgpr_read_b32 v168, a160
v_accvgpr_read_b32 v169, a161
v_accvgpr_read_b32 v170, a162
v_accvgpr_read_b32 v171, a163
v_mul_f32 v168, v168, v248
v_mul_f32 v169, v169, v248
v_mul_f32 v170, v170, v248
v_mul_f32 v171, v171, v248
v_cvt_pk_bf16_f32 v18, v168, v169
v_cvt_pk_bf16_f32 v19, v170, v171
v_accvgpr_read_b32 v172, a164
v_accvgpr_read_b32 v173, a165
v_accvgpr_read_b32 v174, a166
v_accvgpr_read_b32 v175, a167
v_mul_f32 v172, v172, v249
v_mul_f32 v173, v173, v249
v_mul_f32 v174, v174, v249
v_mul_f32 v175, v175, v249
v_cvt_pk_bf16_f32 v50, v172, v173
v_cvt_pk_bf16_f32 v51, v174, v175
v_accvgpr_read_b32 v192, a224
v_accvgpr_read_b32 v193, a225
v_accvgpr_read_b32 v194, a226
v_accvgpr_read_b32 v195, a227
v_mul_f32 v192, v192, v248
v_mul_f32 v193, v193, v248
v_mul_f32 v194, v194, v248
v_mul_f32 v195, v195, v248
v_cvt_pk_bf16_f32 v26, v192, v193
v_cvt_pk_bf16_f32 v27, v194, v195
v_accvgpr_read_b32 v196, a228
v_accvgpr_read_b32 v197, a229
v_accvgpr_read_b32 v198, a230
v_accvgpr_read_b32 v199, a231
v_mul_f32 v196, v196, v249
v_mul_f32 v197, v197, v249
v_mul_f32 v198, v198, v249
v_mul_f32 v199, v199, v249
v_cvt_pk_bf16_f32 v58, v196, v197
v_cvt_pk_bf16_f32 v59, v198, v199
v_accvgpr_read_b32 v160, a48
v_accvgpr_read_b32 v161, a49
v_accvgpr_read_b32 v162, a50
v_accvgpr_read_b32 v163, a51
v_mul_f32 v160, v160, v248
v_mul_f32 v161, v161, v248
v_mul_f32 v162, v162, v248
v_mul_f32 v163, v163, v248
v_cvt_pk_bf16_f32 v0, v160, v161
v_cvt_pk_bf16_f32 v1, v162, v163
v_accvgpr_read_b32 v164, a52
v_accvgpr_read_b32 v165, a53
v_accvgpr_read_b32 v166, a54
v_accvgpr_read_b32 v167, a55
v_mul_f32 v164, v164, v249
v_mul_f32 v165, v165, v249
v_mul_f32 v166, v166, v249
v_mul_f32 v167, v167, v249
v_cvt_pk_bf16_f32 v32, v164, v165
v_cvt_pk_bf16_f32 v33, v166, v167
v_accvgpr_read_b32 v168, a112
v_accvgpr_read_b32 v169, a113
v_accvgpr_read_b32 v170, a114
v_accvgpr_read_b32 v171, a115
v_mul_f32 v168, v168, v248
v_mul_f32 v169, v169, v248
v_mul_f32 v170, v170, v248
v_mul_f32 v171, v171, v248
v_cvt_pk_bf16_f32 v8, v168, v169
v_cvt_pk_bf16_f32 v9, v170, v171
v_accvgpr_read_b32 v172, a116
v_accvgpr_read_b32 v173, a117
v_accvgpr_read_b32 v174, a118
v_accvgpr_read_b32 v175, a119
v_mul_f32 v172, v172, v249
v_mul_f32 v173, v173, v249
v_mul_f32 v174, v174, v249
v_mul_f32 v175, v175, v249
v_cvt_pk_bf16_f32 v40, v172, v173
v_cvt_pk_bf16_f32 v41, v174, v175
v_accvgpr_read_b32 v192, a176
v_accvgpr_read_b32 v193, a177
v_accvgpr_read_b32 v194, a178
v_accvgpr_read_b32 v195, a179
v_mul_f32 v192, v192, v248
v_mul_f32 v193, v193, v248
v_mul_f32 v194, v194, v248
v_mul_f32 v195, v195, v248
v_cvt_pk_bf16_f32 v16, v192, v193
v_cvt_pk_bf16_f32 v17, v194, v195
v_accvgpr_read_b32 v196, a180
v_accvgpr_read_b32 v197, a181
v_accvgpr_read_b32 v198, a182
v_accvgpr_read_b32 v199, a183
v_mul_f32 v196, v196, v249
v_mul_f32 v197, v197, v249
v_mul_f32 v198, v198, v249
v_mul_f32 v199, v199, v249
v_cvt_pk_bf16_f32 v48, v196, v197
v_cvt_pk_bf16_f32 v49, v198, v199
v_accvgpr_read_b32 v160, a240
v_accvgpr_read_b32 v161, a241
v_accvgpr_read_b32 v162, a242
v_accvgpr_read_b32 v163, a243
v_mul_f32 v160, v160, v248
v_mul_f32 v161, v161, v248
v_mul_f32 v162, v162, v248
v_mul_f32 v163, v163, v248
v_cvt_pk_bf16_f32 v24, v160, v161
v_cvt_pk_bf16_f32 v25, v162, v163
v_accvgpr_read_b32 v164, a244
v_accvgpr_read_b32 v165, a245
v_accvgpr_read_b32 v166, a246
v_accvgpr_read_b32 v167, a247
v_mul_f32 v164, v164, v249
v_mul_f32 v165, v165, v249
v_mul_f32 v166, v166, v249
v_mul_f32 v167, v167, v249
v_cvt_pk_bf16_f32 v56, v164, v165
v_cvt_pk_bf16_f32 v57, v166, v167
s_waitcnt vmcnt(0) lgkmcnt(0)
s_barrier
ds_read_b64_tr_b16 a[176:177], v236 offset:0
ds_read_b64_tr_b16 a[178:179], v236 offset:2048
ds_read_b64 a[0:1], v247 offset:0
ds_read_b64 a[2:3], v247 offset:512
ds_read_b64_tr_b16 a[180:181], v237 offset:0
ds_read_b64_tr_b16 a[182:183], v237 offset:2048
ds_read_b64_tr_b16 a[192:193], v242 offset:0
ds_read_b64_tr_b16 a[194:195], v242 offset:2048
ds_read_b64_tr_b16 a[196:197], v243 offset:0
ds_read_b64_tr_b16 a[198:199], v243 offset:2048
s_waitcnt lgkmcnt(8)
v_mfma_f32_16x16x32_bf16 v[128:131], a[176:179], v[0:3], 0
ds_read_b64_tr_b16 a[208:209], v236 offset:4096
v_add_u32 v252, 128, v253
v_mfma_f32_16x16x32_bf16 v[132:135], a[176:179], v[32:35], 0
s_waitcnt lgkmcnt(7)
ds_read_b64_tr_b16 a[210:211], v236 offset:6144
s_add_u32 m0, s29, 65536
v_mfma_f32_16x16x32_bf16 v[208:211], a[176:179], a[0:3], 0
s_waitcnt lgkmcnt(6)
ds_read_b64 a[4:5], v247 offset:1024
v_accvgpr_read_b32 v160, a8
v_mfma_f32_16x16x32_bf16 v[136:139], a[180:183], v[0:3], 0
ds_read_b64 a[6:7], v247 offset:1536
v_accvgpr_read_b32 v161, a9
v_mfma_f32_16x16x32_bf16 v[140:143], a[180:183], v[32:35], 0
s_waitcnt lgkmcnt(6)
ds_read_b64_tr_b16 a[212:213], v237 offset:4096
v_accvgpr_read_b32 v162, a10
v_mfma_f32_16x16x32_bf16 v[144:147], a[192:195], v[0:3], 0
ds_read_b64_tr_b16 a[214:215], v237 offset:6144
buffer_load_dwordx4 v252, s[20:23], s52 offen  lds
v_mfma_f32_16x16x32_bf16 v[148:151], a[192:195], v[32:35], 0
s_waitcnt lgkmcnt(6)
ds_read_b64_tr_b16 a[224:225], v242 offset:4096
s_add_u32 m0, s29, 69632
v_mfma_f32_16x16x32_bf16 v[152:155], a[196:199], v[0:3], 0
ds_read_b64_tr_b16 a[226:227], v242 offset:6144
v_accvgpr_read_b32 v163, a11
v_mfma_f32_16x16x32_bf16 v[156:159], a[196:199], v[32:35], 0
s_waitcnt lgkmcnt(6)
ds_read_b64_tr_b16 a[228:229], v243 offset:4096
buffer_load_dwordx4 v252, s[20:23], s53 offen  lds
v_mfma_f32_16x16x32_bf16 v[128:131], a[208:211], v[4:7], v[128:131]
ds_read_b64_tr_b16 a[230:231], v243 offset:6144
s_add_u32 m0, s29, 73728
v_mfma_f32_16x16x32_bf16 v[132:135], a[208:211], v[36:39], v[132:135]
s_waitcnt lgkmcnt(6)
ds_read_b64_tr_b16 a[240:241], v236 offset:8192
v_mul_f32 v160, v160, v250
v_mfma_f32_16x16x32_bf16 v[208:211], a[208:211], a[4:7], v[208:211]
s_waitcnt lgkmcnt(5)
ds_read_b64_tr_b16 a[242:243], v236 offset:10240
v_mul_f32 v161, v161, v250
v_mfma_f32_16x16x32_bf16 v[136:139], a[212:215], v[4:7], v[136:139]
ds_read_b64 a[16:17], v247 offset:2048
buffer_load_dwordx4 v252, s[20:23], s54 offen  lds
v_mfma_f32_16x16x32_bf16 v[140:143], a[212:215], v[36:39], v[140:143]
s_waitcnt lgkmcnt(5)
ds_read_b64 a[18:19], v247 offset:2560
s_add_u32 m0, s29, 77824
v_mfma_f32_16x16x32_bf16 v[144:147], a[224:227], v[4:7], v[144:147]
ds_read_b64_tr_b16 a[244:245], v237 offset:8192
v_mul_f32 v162, v162, v250
v_mfma_f32_16x16x32_bf16 v[148:151], a[224:227], v[36:39], v[148:151]
s_waitcnt lgkmcnt(5)
ds_read_b64_tr_b16 a[246:247], v237 offset:10240
v_mul_f32 v163, v163, v250
v_mfma_f32_16x16x32_bf16 v[152:155], a[228:231], v[4:7], v[152:155]
ds_read_b64_tr_b16 a[176:177], v242 offset:8192
buffer_load_dwordx4 v252, s[20:23], s55 offen  lds
v_mfma_f32_16x16x32_bf16 v[156:159], a[228:231], v[36:39], v[156:159]
s_waitcnt lgkmcnt(5)
ds_read_b64_tr_b16 a[178:179], v242 offset:10240
s_add_u32 m0, s29, 81920
v_mfma_f32_16x16x32_bf16 v[128:131], a[240:243], v[8:11], v[128:131]
ds_read_b64_tr_b16 a[180:181], v243 offset:8192
v_cvt_pk_bf16_f32 v70, v160, v161
v_mfma_f32_16x16x32_bf16 v[132:135], a[240:243], v[40:43], v[132:135]
s_waitcnt lgkmcnt(5)
ds_read_b64_tr_b16 a[182:183], v243 offset:10240
v_cvt_pk_bf16_f32 v71, v162, v163
v_mfma_f32_16x16x32_bf16 v[208:211], a[240:243], a[16:19], v[208:211]
s_waitcnt lgkmcnt(4)
ds_read_b64_tr_b16 a[192:193], v236 offset:12288
buffer_load_dwordx4 v252, s[20:23], s56 offen  lds
v_mfma_f32_16x16x32_bf16 v[136:139], a[244:247], v[8:11], v[136:139]
ds_read_b64_tr_b16 a[194:195], v236 offset:14336
s_add_u32 m0, s29, 86016
v_mfma_f32_16x16x32_bf16 v[140:143], a[244:247], v[40:43], v[140:143]
s_waitcnt lgkmcnt(4)
ds_read_b64 a[20:21], v247 offset:3072
v_accvgpr_read_b32 v164, a12
v_mfma_f32_16x16x32_bf16 v[144:147], a[176:179], v[8:11], v[144:147]
ds_read_b64 a[22:23], v247 offset:3584
v_accvgpr_read_b32 v165, a13
v_mfma_f32_16x16x32_bf16 v[148:151], a[176:179], v[40:43], v[148:151]
s_waitcnt lgkmcnt(4)
ds_read_b64_tr_b16 a[196:197], v237 offset:12288
buffer_load_dwordx4 v252, s[20:23], s57 offen  lds
v_mfma_f32_16x16x32_bf16 v[152:155], a[180:183], v[8:11], v[152:155]
ds_read_b64_tr_b16 a[198:199], v237 offset:14336
s_add_u32 m0, s29, 90112
v_mfma_f32_16x16x32_bf16 v[156:159], a[180:183], v[40:43], v[156:159]
s_waitcnt lgkmcnt(4)
ds_read_b64_tr_b16 a[208:209], v242 offset:12288
v_accvgpr_read_b32 v166, a14
v_mfma_f32_16x16x32_bf16 v[128:131], a[192:195], v[12:15], v[128:131]
ds_read_b64_tr_b16 a[210:211], v242 offset:14336
v_accvgpr_read_b32 v167, a15
v_mfma_f32_16x16x32_bf16 v[132:135], a[192:195], v[44:47], v[132:135]
s_waitcnt lgkmcnt(4)
ds_read_b64_tr_b16 a[212:213], v243 offset:12288
buffer_load_dwordx4 v252, s[20:23], s58 offen  lds
v_mfma_f32_16x16x32_bf16 v[208:211], a[192:195], a[20:23], v[208:211]
s_waitcnt lgkmcnt(3)
ds_read_b64_tr_b16 a[214:215], v243 offset:14336
s_add_u32 m0, s29, 94208
v_mfma_f32_16x16x32_bf16 v[136:139], a[196:199], v[12:15], v[136:139]
ds_read_b64_tr_b16 a[224:225], v236 offset:16384
v_mul_f32 v164, v164, v251
v_mfma_f32_16x16x32_bf16 v[140:143], a[196:199], v[44:47], v[140:143]
s_waitcnt lgkmcnt(3)
ds_read_b64_tr_b16 a[226:227], v236 offset:18432
v_mul_f32 v165, v165, v251
v_mfma_f32_16x16x32_bf16 v[144:147], a[208:211], v[12:15], v[144:147]
ds_read_b64 a[32:33], v247 offset:4096
buffer_load_dwordx4 v252, s[20:23], s59 offen  lds
v_mfma_f32_16x16x32_bf16 v[148:151], a[208:211], v[44:47], v[148:151]
s_waitcnt lgkmcnt(3)
ds_read_b64 a[34:35], v247 offset:4608
v_mul_f32 v166, v166, v251
v_mfma_f32_16x16x32_bf16 v[152:155], a[212:215], v[12:15], v[152:155]
ds_read_b64_tr_b16 a[228:229], v237 offset:16384
v_add_u32 v252, 229504, v253
v_mfma_f32_16x16x32_bf16 v[156:159], a[212:215], v[44:47], v[156:159]
s_waitcnt lgkmcnt(3)
ds_read_b64_tr_b16 a[230:231], v237 offset:18432
s_add_u32 m0, s29, 98304
v_mfma_f32_16x16x32_bf16 v[128:131], a[224:227], v[16:19], v[128:131]
ds_read_b64_tr_b16 a[240:241], v242 offset:16384
v_mul_f32 v167, v167, v251
v_mfma_f32_16x16x32_bf16 v[132:135], a[224:227], v[48:51], v[132:135]
s_waitcnt lgkmcnt(3)
ds_read_b64_tr_b16 a[242:243], v242 offset:18432
v_cvt_pk_bf16_f32 v102, v164, v165
v_mfma_f32_16x16x32_bf16 v[208:211], a[224:227], a[32:35], v[208:211]
s_waitcnt lgkmcnt(2)
ds_read_b64_tr_b16 a[244:245], v243 offset:16384
v_cvt_pk_bf16_f32 v103, v166, v167
v_mfma_f32_16x16x32_bf16 v[136:139], a[228:231], v[16:19], v[136:139]
ds_read_b64_tr_b16 a[246:247], v243 offset:18432
v_accvgpr_read_b32 v168, a24
v_mfma_f32_16x16x32_bf16 v[140:143], a[228:231], v[48:51], v[140:143]
s_waitcnt lgkmcnt(2)
ds_read_b64_tr_b16 a[176:177], v236 offset:20480
buffer_load_dwordx4 v252, s[20:23], s52 offen  lds
v_mfma_f32_16x16x32_bf16 v[144:147], a[240:243], v[16:19], v[144:147]
ds_read_b64_tr_b16 a[178:179], v236 offset:22528
s_add_u32 m0, s29, 102400
v_mfma_f32_16x16x32_bf16 v[148:151], a[240:243], v[48:51], v[148:151]
s_waitcnt lgkmcnt(2)
ds_read_b64 a[36:37], v247 offset:5120
v_accvgpr_read_b32 v169, a25
v_mfma_f32_16x16x32_bf16 v[152:155], a[244:247], v[16:19], v[152:155]
ds_read_b64 a[38:39], v247 offset:5632
buffer_load_dwordx4 v252, s[20:23], s53 offen  lds
v_mfma_f32_16x16x32_bf16 v[156:159], a[244:247], v[48:51], v[156:159]
s_waitcnt lgkmcnt(2)
ds_read_b64_tr_b16 a[180:181], v237 offset:20480
s_add_u32 m0, s29, 106496
v_mfma_f32_16x16x32_bf16 v[128:131], a[176:179], v[20:23], v[128:131]
ds_read_b64_tr_b16 a[182:183], v237 offset:22528
v_accvgpr_read_b32 v170, a26
v_mfma_f32_16x16x32_bf16 v[132:135], a[176:179], v[52:55], v[132:135]
s_waitcnt lgkmcnt(2)
ds_read_b64_tr_b16 a[192:193], v242 offset:20480
v_accvgpr_read_b32 v171, a27
v_mfma_f32_16x16x32_bf16 v[208:211], a[176:179], a[36:39], v[208:211]
s_waitcnt lgkmcnt(1)
ds_read_b64_tr_b16 a[194:195], v242 offset:22528
buffer_load_dwordx4 v252, s[20:23], s54 offen  lds
v_mfma_f32_16x16x32_bf16 v[136:139], a[180:183], v[20:23], v[136:139]
ds_read_b64_tr_b16 a[196:197], v243 offset:20480
s_add_u32 m0, s29, 110592
v_mfma_f32_16x16x32_bf16 v[140:143], a[180:183], v[52:55], v[140:143]
s_waitcnt lgkmcnt(1)
ds_read_b64_tr_b16 a[198:199], v243 offset:22528
v_mul_f32 v168, v168, v250
v_mfma_f32_16x16x32_bf16 v[144:147], a[192:195], v[20:23], v[144:147]
ds_read_b64_tr_b16 a[208:209], v236 offset:24576
buffer_load_dwordx4 v252, s[20:23], s55 offen  lds
v_mfma_f32_16x16x32_bf16 v[148:151], a[192:195], v[52:55], v[148:151]
s_waitcnt lgkmcnt(1)
ds_read_b64_tr_b16 a[210:211], v236 offset:26624
s_add_u32 m0, s29, 114688
v_mfma_f32_16x16x32_bf16 v[152:155], a[196:199], v[20:23], v[152:155]
ds_read_b64 a[48:49], v247 offset:6144
v_mul_f32 v169, v169, v250
v_mfma_f32_16x16x32_bf16 v[156:159], a[196:199], v[52:55], v[156:159]
s_waitcnt lgkmcnt(1)
ds_read_b64 a[50:51], v247 offset:6656
v_mul_f32 v170, v170, v250
v_mfma_f32_16x16x32_bf16 v[128:131], a[208:211], v[24:27], v[128:131]
ds_read_b64_tr_b16 a[212:213], v237 offset:24576
buffer_load_dwordx4 v252, s[20:23], s56 offen  lds
v_mfma_f32_16x16x32_bf16 v[132:135], a[208:211], v[56:59], v[132:135]
s_waitcnt lgkmcnt(1)
ds_read_b64_tr_b16 a[214:215], v237 offset:26624
s_add_u32 m0, s29, 118784
v_mfma_f32_16x16x32_bf16 v[208:211], a[208:211], a[48:51], v[208:211]
s_waitcnt lgkmcnt(0)
ds_read_b64_tr_b16 a[224:225], v242 offset:24576
v_mul_f32 v171, v171, v250
v_mfma_f32_16x16x32_bf16 v[136:139], a[212:215], v[24:27], v[136:139]
ds_read_b64_tr_b16 a[226:227], v242 offset:26624
buffer_load_dwordx4 v252, s[20:23], s57 offen  lds
v_mfma_f32_16x16x32_bf16 v[140:143], a[212:215], v[56:59], v[140:143]
s_waitcnt lgkmcnt(0)
ds_read_b64_tr_b16 a[228:229], v243 offset:24576
s_add_u32 m0, s29, 122880
v_mfma_f32_16x16x32_bf16 v[144:147], a[224:227], v[24:27], v[144:147]
ds_read_b64_tr_b16 a[230:231], v243 offset:26624
v_cvt_pk_bf16_f32 v68, v168, v169
v_mfma_f32_16x16x32_bf16 v[148:151], a[224:227], v[56:59], v[148:151]
s_waitcnt lgkmcnt(0)
ds_read_b64_tr_b16 a[240:241], v236 offset:28672
v_cvt_pk_bf16_f32 v69, v170, v171
v_mfma_f32_16x16x32_bf16 v[152:155], a[228:231], v[24:27], v[152:155]
ds_read_b64_tr_b16 a[242:243], v236 offset:30720
buffer_load_dwordx4 v252, s[20:23], s58 offen  lds
v_mfma_f32_16x16x32_bf16 v[156:159], a[228:231], v[56:59], v[156:159]
s_waitcnt lgkmcnt(0)
ds_read_b64 a[52:53], v247 offset:7168
s_add_u32 m0, s29, 126976
v_mfma_f32_16x16x32_bf16 v[128:131], a[240:243], v[28:31], v[128:131]
ds_read_b64 a[54:55], v247 offset:7680
v_accvgpr_read_b32 v172, a28
v_mfma_f32_16x16x32_bf16 v[132:135], a[240:243], v[60:63], v[132:135]
s_waitcnt lgkmcnt(0)
ds_read_b64_tr_b16 a[244:245], v237 offset:28672
buffer_load_dwordx4 v252, s[20:23], s59 offen  lds
v_mfma_f32_16x16x32_bf16 v[208:211], a[240:243], a[52:55], v[208:211]
ds_read_b64_tr_b16 a[246:247], v237 offset:30720
s_waitcnt lgkmcnt(0)
ds_read_b64_tr_b16 a[212:213], v242 offset:28672
v_accvgpr_read_b32 v173, a29
v_mfma_f32_16x16x32_bf16 v[136:139], a[244:247], v[28:31], v[136:139]
ds_read_b64_tr_b16 a[214:215], v242 offset:30720
v_accvgpr_read_b32 v174, a30
v_mfma_f32_16x16x32_bf16 v[140:143], a[244:247], v[60:63], v[140:143]
s_waitcnt lgkmcnt(0)
ds_read_b64_tr_b16 a[224:225], v243 offset:28672
v_accvgpr_read_b32 v175, a31
v_mfma_f32_16x16x32_bf16 v[144:147], a[212:215], v[28:31], v[144:147]
ds_read_b64_tr_b16 a[226:227], v243 offset:30720
v_mul_f32 v172, v172, v251
v_mfma_f32_16x16x32_bf16 v[148:151], a[212:215], v[60:63], v[148:151]
s_waitcnt lgkmcnt(0)
ds_read_b64_tr_b16 a[176:177], v236 offset:32768
v_mul_f32 v173, v173, v251
v_mfma_f32_16x16x32_bf16 v[152:155], a[224:227], v[28:31], v[152:155]
ds_read_b64_tr_b16 a[178:179], v236 offset:34816
v_mul_f32 v174, v174, v251
v_mfma_f32_16x16x32_bf16 v[156:159], a[224:227], v[60:63], v[156:159]
ds_read_b64_tr_b16 a[180:181], v237 offset:32768
v_mul_f32 v175, v175, v251
v_cvt_pk_bf16_f32 v100, v172, v173
ds_read_b64_tr_b16 a[182:183], v237 offset:34816
v_cvt_pk_bf16_f32 v101, v174, v175
ds_read_b64_tr_b16 a[192:193], v242 offset:32768
v_accvgpr_read_b32 v176, a40
ds_read_b64_tr_b16 a[194:195], v242 offset:34816
v_accvgpr_read_b32 v177, a41
ds_read_b64_tr_b16 a[196:197], v243 offset:32768
v_accvgpr_read_b32 v178, a42
ds_read_b64_tr_b16 a[198:199], v243 offset:34816
v_accvgpr_read_b32 v179, a43
ds_read_b64_tr_b16 a[208:209], v236 offset:36864
v_mul_f32 v176, v176, v250
ds_read_b64_tr_b16 a[210:211], v236 offset:38912
v_mul_f32 v177, v177, v250
v_mul_f32 v178, v178, v250
v_mul_f32 v179, v179, v250
v_cvt_pk_bf16_f32 v66, v176, v177
v_cvt_pk_bf16_f32 v67, v178, v179
v_accvgpr_read_b32 v180, a44
v_accvgpr_read_b32 v181, a45
v_accvgpr_read_b32 v182, a46
v_accvgpr_read_b32 v183, a47
v_mul_f32 v180, v180, v251
v_mul_f32 v181, v181, v251
v_mul_f32 v182, v182, v251
v_mul_f32 v183, v183, v251
v_cvt_pk_bf16_f32 v98, v180, v181
v_cvt_pk_bf16_f32 v99, v182, v183
v_accvgpr_read_b32 v184, a56
v_accvgpr_read_b32 v185, a57
v_accvgpr_read_b32 v186, a58
v_accvgpr_read_b32 v187, a59
v_mul_f32 v184, v184, v250
v_mul_f32 v185, v185, v250
v_mul_f32 v186, v186, v250
v_mul_f32 v187, v187, v250
v_cvt_pk_bf16_f32 v64, v184, v185
v_cvt_pk_bf16_f32 v65, v186, v187
v_accvgpr_read_b32 v188, a60
v_accvgpr_read_b32 v189, a61
v_accvgpr_read_b32 v190, a62
v_accvgpr_read_b32 v191, a63
v_mul_f32 v188, v188, v251
v_mul_f32 v189, v189, v251
v_mul_f32 v190, v190, v251
v_mul_f32 v191, v191, v251
v_cvt_pk_bf16_f32 v96, v188, v189
v_cvt_pk_bf16_f32 v97, v190, v191
v_accvgpr_read_b32 v160, a72
v_accvgpr_read_b32 v161, a73
v_accvgpr_read_b32 v162, a74
v_accvgpr_read_b32 v163, a75
v_mul_f32 v160, v160, v250
v_mul_f32 v161, v161, v250
v_mul_f32 v162, v162, v250
v_mul_f32 v163, v163, v250
v_cvt_pk_bf16_f32 v78, v160, v161
v_cvt_pk_bf16_f32 v79, v162, v163
v_accvgpr_read_b32 v164, a76
v_accvgpr_read_b32 v165, a77
v_accvgpr_read_b32 v166, a78
v_accvgpr_read_b32 v167, a79
v_mul_f32 v164, v164, v251
v_mul_f32 v165, v165, v251
v_mul_f32 v166, v166, v251
v_mul_f32 v167, v167, v251
v_cvt_pk_bf16_f32 v110, v164, v165
v_cvt_pk_bf16_f32 v111, v166, v167
v_accvgpr_read_b32 v168, a88
v_accvgpr_read_b32 v169, a89
v_accvgpr_read_b32 v170, a90
v_accvgpr_read_b32 v171, a91
v_mul_f32 v168, v168, v250
v_mul_f32 v169, v169, v250
v_mul_f32 v170, v170, v250
v_mul_f32 v171, v171, v250
v_cvt_pk_bf16_f32 v76, v168, v169
v_cvt_pk_bf16_f32 v77, v170, v171
v_accvgpr_read_b32 v172, a92
v_accvgpr_read_b32 v173, a93
v_accvgpr_read_b32 v174, a94
v_accvgpr_read_b32 v175, a95
v_mul_f32 v172, v172, v251
v_mul_f32 v173, v173, v251
v_mul_f32 v174, v174, v251
v_mul_f32 v175, v175, v251
v_cvt_pk_bf16_f32 v108, v172, v173
v_cvt_pk_bf16_f32 v109, v174, v175
v_accvgpr_read_b32 v176, a104
v_accvgpr_read_b32 v177, a105
v_accvgpr_read_b32 v178, a106
v_accvgpr_read_b32 v179, a107
v_mul_f32 v176, v176, v250
v_mul_f32 v177, v177, v250
v_mul_f32 v178, v178, v250
v_mul_f32 v179, v179, v250
v_cvt_pk_bf16_f32 v74, v176, v177
v_cvt_pk_bf16_f32 v75, v178, v179
v_accvgpr_read_b32 v180, a108
v_accvgpr_read_b32 v181, a109
v_accvgpr_read_b32 v182, a110
v_accvgpr_read_b32 v183, a111
v_mul_f32 v180, v180, v251
v_mul_f32 v181, v181, v251
v_mul_f32 v182, v182, v251
v_mul_f32 v183, v183, v251
v_cvt_pk_bf16_f32 v106, v180, v181
v_cvt_pk_bf16_f32 v107, v182, v183
v_accvgpr_read_b32 v184, a120
v_accvgpr_read_b32 v185, a121
v_accvgpr_read_b32 v186, a122
v_accvgpr_read_b32 v187, a123
v_mul_f32 v184, v184, v250
v_mul_f32 v185, v185, v250
v_mul_f32 v186, v186, v250
v_mul_f32 v187, v187, v250
v_cvt_pk_bf16_f32 v72, v184, v185
v_cvt_pk_bf16_f32 v73, v186, v187
v_accvgpr_read_b32 v188, a124
v_accvgpr_read_b32 v189, a125
v_accvgpr_read_b32 v190, a126
v_accvgpr_read_b32 v191, a127
v_mul_f32 v188, v188, v251
v_mul_f32 v189, v189, v251
v_mul_f32 v190, v190, v251
v_mul_f32 v191, v191, v251
v_cvt_pk_bf16_f32 v104, v188, v189
v_cvt_pk_bf16_f32 v105, v190, v191
v_accvgpr_read_b32 v160, a136
v_accvgpr_read_b32 v161, a137
v_accvgpr_read_b32 v162, a138
v_accvgpr_read_b32 v163, a139
v_mul_f32 v160, v160, v250
v_mul_f32 v161, v161, v250
v_mul_f32 v162, v162, v250
v_mul_f32 v163, v163, v250
v_cvt_pk_bf16_f32 v86, v160, v161
v_cvt_pk_bf16_f32 v87, v162, v163
v_accvgpr_read_b32 v164, a140
v_accvgpr_read_b32 v165, a141
v_accvgpr_read_b32 v166, a142
v_accvgpr_read_b32 v167, a143
v_mul_f32 v164, v164, v251
v_mul_f32 v165, v165, v251
v_mul_f32 v166, v166, v251
v_mul_f32 v167, v167, v251
v_cvt_pk_bf16_f32 v118, v164, v165
v_cvt_pk_bf16_f32 v119, v166, v167
v_accvgpr_read_b32 v168, a152
v_accvgpr_read_b32 v169, a153
v_accvgpr_read_b32 v170, a154
v_accvgpr_read_b32 v171, a155
v_mul_f32 v168, v168, v250
v_mul_f32 v169, v169, v250
v_mul_f32 v170, v170, v250
v_mul_f32 v171, v171, v250
v_cvt_pk_bf16_f32 v84, v168, v169
v_cvt_pk_bf16_f32 v85, v170, v171
v_accvgpr_read_b32 v172, a156
v_accvgpr_read_b32 v173, a157
v_accvgpr_read_b32 v174, a158
v_accvgpr_read_b32 v175, a159
v_mul_f32 v172, v172, v251
v_mul_f32 v173, v173, v251
v_mul_f32 v174, v174, v251
v_mul_f32 v175, v175, v251
v_cvt_pk_bf16_f32 v116, v172, v173
v_cvt_pk_bf16_f32 v117, v174, v175
v_accvgpr_read_b32 v176, a168
v_accvgpr_read_b32 v177, a169
v_accvgpr_read_b32 v178, a170
v_accvgpr_read_b32 v179, a171
v_mul_f32 v176, v176, v250
v_mul_f32 v177, v177, v250
v_mul_f32 v178, v178, v250
v_mul_f32 v179, v179, v250
v_cvt_pk_bf16_f32 v82, v176, v177
v_cvt_pk_bf16_f32 v83, v178, v179
v_accvgpr_read_b32 v180, a172
v_accvgpr_read_b32 v181, a173
v_accvgpr_read_b32 v182, a174
v_accvgpr_read_b32 v183, a175
v_mul_f32 v180, v180, v251
v_mul_f32 v181, v181, v251
v_mul_f32 v182, v182, v251
v_mul_f32 v183, v183, v251
v_cvt_pk_bf16_f32 v114, v180, v181
v_cvt_pk_bf16_f32 v115, v182, v183
v_accvgpr_read_b32 v184, a184
v_accvgpr_read_b32 v185, a185
v_accvgpr_read_b32 v186, a186
v_accvgpr_read_b32 v187, a187
v_mul_f32 v184, v184, v250
v_mul_f32 v185, v185, v250
v_mul_f32 v186, v186, v250
v_mul_f32 v187, v187, v250
v_cvt_pk_bf16_f32 v80, v184, v185
v_cvt_pk_bf16_f32 v81, v186, v187
v_accvgpr_read_b32 v188, a188
v_accvgpr_read_b32 v189, a189
v_accvgpr_read_b32 v190, a190
v_accvgpr_read_b32 v191, a191
v_mul_f32 v188, v188, v251
v_mul_f32 v189, v189, v251
v_mul_f32 v190, v190, v251
v_mul_f32 v191, v191, v251
v_cvt_pk_bf16_f32 v112, v188, v189
v_cvt_pk_bf16_f32 v113, v190, v191
v_accvgpr_read_b32 v160, a200
v_accvgpr_read_b32 v161, a201
v_accvgpr_read_b32 v162, a202
v_accvgpr_read_b32 v163, a203
v_mul_f32 v160, v160, v250
v_mul_f32 v161, v161, v250
v_mul_f32 v162, v162, v250
v_mul_f32 v163, v163, v250
v_cvt_pk_bf16_f32 v94, v160, v161
v_cvt_pk_bf16_f32 v95, v162, v163
v_accvgpr_read_b32 v164, a204
v_accvgpr_read_b32 v165, a205
v_accvgpr_read_b32 v166, a206
v_accvgpr_read_b32 v167, a207
v_mul_f32 v164, v164, v251
v_mul_f32 v165, v165, v251
v_mul_f32 v166, v166, v251
v_mul_f32 v167, v167, v251
v_cvt_pk_bf16_f32 v126, v164, v165
v_cvt_pk_bf16_f32 v127, v166, v167
v_accvgpr_read_b32 v168, a216
v_accvgpr_read_b32 v169, a217
v_accvgpr_read_b32 v170, a218
v_accvgpr_read_b32 v171, a219
v_mul_f32 v168, v168, v250
v_mul_f32 v169, v169, v250
v_mul_f32 v170, v170, v250
v_mul_f32 v171, v171, v250
v_cvt_pk_bf16_f32 v92, v168, v169
v_cvt_pk_bf16_f32 v93, v170, v171
v_accvgpr_read_b32 v172, a220
v_accvgpr_read_b32 v173, a221
v_accvgpr_read_b32 v174, a222
v_accvgpr_read_b32 v175, a223
v_mul_f32 v172, v172, v251
v_mul_f32 v173, v173, v251
v_mul_f32 v174, v174, v251
v_mul_f32 v175, v175, v251
v_cvt_pk_bf16_f32 v124, v172, v173
v_cvt_pk_bf16_f32 v125, v174, v175
v_accvgpr_read_b32 v176, a232
v_accvgpr_read_b32 v177, a233
v_accvgpr_read_b32 v178, a234
v_accvgpr_read_b32 v179, a235
v_mul_f32 v176, v176, v250
v_mul_f32 v177, v177, v250
v_mul_f32 v178, v178, v250
v_mul_f32 v179, v179, v250
v_cvt_pk_bf16_f32 v90, v176, v177
v_cvt_pk_bf16_f32 v91, v178, v179
v_accvgpr_read_b32 v180, a236
v_accvgpr_read_b32 v181, a237
v_accvgpr_read_b32 v182, a238
v_accvgpr_read_b32 v183, a239
v_mul_f32 v180, v180, v251
v_mul_f32 v181, v181, v251
v_mul_f32 v182, v182, v251
v_mul_f32 v183, v183, v251
v_cvt_pk_bf16_f32 v122, v180, v181
v_cvt_pk_bf16_f32 v123, v182, v183
v_accvgpr_read_b32 v184, a248
v_accvgpr_read_b32 v185, a249
v_accvgpr_read_b32 v186, a250
v_accvgpr_read_b32 v187, a251
v_mul_f32 v184, v184, v250
v_mul_f32 v185, v185, v250
v_mul_f32 v186, v186, v250
v_mul_f32 v187, v187, v250
v_cvt_pk_bf16_f32 v88, v184, v185
v_cvt_pk_bf16_f32 v89, v186, v187
v_accvgpr_read_b32 v188, a252
v_accvgpr_read_b32 v189, a253
v_accvgpr_read_b32 v190, a254
v_accvgpr_read_b32 v191, a255
v_mul_f32 v188, v188, v251
v_mul_f32 v189, v189, v251
v_mul_f32 v190, v190, v251
v_mul_f32 v191, v191, v251
v_cvt_pk_bf16_f32 v120, v188, v189
v_cvt_pk_bf16_f32 v121, v190, v191
s_waitcnt vmcnt(8) lgkmcnt(10)
s_barrier
s_branch L_out1
L_out1:
s_waitcnt lgkmcnt(8)
v_mfma_f32_16x16x32_bf16 v[128:131], a[176:179], v[64:67], v[128:131]
ds_read_b64 a[64:65], v247 offset:8192
v_add_u32 v252, 256, v253
v_mfma_f32_16x16x32_bf16 v[132:135], a[176:179], v[96:99], v[132:135]
ds_read_b64 a[66:67], v247 offset:8704
s_waitcnt lgkmcnt(0)
ds_read_b64 a[68:69], v247 offset:9216
s_add_u32 m0, s29, 0
v_mfma_f32_16x16x32_bf16 v[208:211], a[176:179], a[64:67], v[208:211]
ds_read_b64 a[70:71], v247 offset:9728
v_mfma_f32_16x16x32_bf16 v[136:139], a[180:183], v[64:67], v[136:139]
ds_read_b64_tr_b16 a[212:213], v237 offset:36864
v_mfma_f32_16x16x32_bf16 v[140:143], a[180:183], v[96:99], v[140:143]
ds_read_b64_tr_b16 a[214:215], v237 offset:38912
v_mfma_f32_16x16x32_bf16 v[144:147], a[192:195], v[64:67], v[144:147]
ds_read_b64_tr_b16 a[224:225], v242 offset:36864
buffer_load_dwordx4 v252, s[20:23], s52 offen  lds
v_mfma_f32_16x16x32_bf16 v[148:151], a[192:195], v[96:99], v[148:151]
ds_read_b64_tr_b16 a[226:227], v242 offset:38912
s_add_u32 m0, s29, 4096
v_mfma_f32_16x16x32_bf16 v[152:155], a[196:199], v[64:67], v[152:155]
ds_read_b64_tr_b16 a[228:229], v243 offset:36864
v_mfma_f32_16x16x32_bf16 v[156:159], a[196:199], v[96:99], v[156:159]
ds_read_b64_tr_b16 a[230:231], v243 offset:38912
v_mfma_f32_16x16x32_bf16 v[128:131], a[208:211], v[68:71], v[128:131]
ds_read_b64_tr_b16 a[240:241], v236 offset:40960
v_mfma_f32_16x16x32_bf16 v[132:135], a[208:211], v[100:103], v[132:135]
s_waitcnt lgkmcnt(7)
ds_read_b64_tr_b16 a[242:243], v236 offset:43008
v_mfma_f32_16x16x32_bf16 v[208:211], a[208:211], a[68:71], v[208:211]
s_waitcnt lgkmcnt(6)
ds_read_b64 a[80:81], v247 offset:10240
v_mfma_f32_16x16x32_bf16 v[136:139], a[212:215], v[68:71], v[136:139]
ds_read_b64 a[82:83], v247 offset:10752
buffer_load_dwordx4 v252, s[20:23], s53 offen  lds
v_mfma_f32_16x16x32_bf16 v[140:143], a[212:215], v[100:103], v[140:143]
s_waitcnt lgkmcnt(6)
ds_read_b64_tr_b16 a[244:245], v237 offset:40960
v_mfma_f32_16x16x32_bf16 v[144:147], a[224:227], v[68:71], v[144:147]
ds_read_b64_tr_b16 a[246:247], v237 offset:43008
s_add_u32 m0, s29, 8192
v_mfma_f32_16x16x32_bf16 v[148:151], a[224:227], v[100:103], v[148:151]
s_waitcnt lgkmcnt(6)
ds_read_b64_tr_b16 a[176:177], v242 offset:40960
v_mfma_f32_16x16x32_bf16 v[152:155], a[228:231], v[68:71], v[152:155]
ds_read_b64_tr_b16 a[178:179], v242 offset:43008
v_mfma_f32_16x16x32_bf16 v[156:159], a[228:231], v[100:103], v[156:159]
s_waitcnt lgkmcnt(6)
ds_read_b64_tr_b16 a[180:181], v243 offset:40960
v_mfma_f32_16x16x32_bf16 v[128:131], a[240:243], v[72:75], v[128:131]
ds_read_b64_tr_b16 a[182:183], v243 offset:43008
v_mfma_f32_16x16x32_bf16 v[132:135], a[240:243], v[104:107], v[132:135]
s_waitcnt lgkmcnt(6)
ds_read_b64_tr_b16 a[192:193], v236 offset:45056
v_mfma_f32_16x16x32_bf16 v[208:211], a[240:243], a[80:83], v[208:211]
s_waitcnt lgkmcnt(5)
ds_read_b64_tr_b16 a[194:195], v236 offset:47104
buffer_load_dwordx4 v252, s[20:23], s54 offen  lds
v_mfma_f32_16x16x32_bf16 v[136:139], a[244:247], v[72:75], v[136:139]
ds_read_b64 a[84:85], v247 offset:11264
s_add_u32 m0, s29, 12288
v_mfma_f32_16x16x32_bf16 v[140:143], a[244:247], v[104:107], v[140:143]
s_waitcnt lgkmcnt(5)
ds_read_b64 a[86:87], v247 offset:11776
v_mfma_f32_16x16x32_bf16 v[144:147], a[176:179], v[72:75], v[144:147]
ds_read_b64_tr_b16 a[196:197], v237 offset:45056
v_mfma_f32_16x16x32_bf16 v[148:151], a[176:179], v[104:107], v[148:151]
s_waitcnt lgkmcnt(5)
ds_read_b64_tr_b16 a[198:199], v237 offset:47104
v_mfma_f32_16x16x32_bf16 v[152:155], a[180:183], v[72:75], v[152:155]
ds_read_b64_tr_b16 a[208:209], v242 offset:45056
v_mfma_f32_16x16x32_bf16 v[156:159], a[180:183], v[104:107], v[156:159]
s_waitcnt lgkmcnt(5)
ds_read_b64_tr_b16 a[210:211], v242 offset:47104
v_mfma_f32_16x16x32_bf16 v[128:131], a[192:195], v[76:79], v[128:131]
ds_read_b64_tr_b16 a[212:213], v243 offset:45056
buffer_load_dwordx4 v252, s[20:23], s55 offen  lds
v_mfma_f32_16x16x32_bf16 v[132:135], a[192:195], v[108:111], v[132:135]
s_waitcnt lgkmcnt(5)
ds_read_b64_tr_b16 a[214:215], v243 offset:47104
v_mfma_f32_16x16x32_bf16 v[208:211], a[192:195], a[84:87], v[208:211]
s_waitcnt lgkmcnt(4)
ds_read_b64_tr_b16 a[224:225], v236 offset:49152
s_add_u32 m0, s29, 16384
v_mfma_f32_16x16x32_bf16 v[136:139], a[196:199], v[76:79], v[136:139]
ds_read_b64_tr_b16 a[226:227], v236 offset:51200
v_mfma_f32_16x16x32_bf16 v[140:143], a[196:199], v[108:111], v[140:143]
s_waitcnt lgkmcnt(4)
ds_read_b64 a[96:97], v247 offset:12288
v_mfma_f32_16x16x32_bf16 v[144:147], a[208:211], v[76:79], v[144:147]
ds_read_b64 a[98:99], v247 offset:12800
v_mfma_f32_16x16x32_bf16 v[148:151], a[208:211], v[108:111], v[148:151]
s_waitcnt lgkmcnt(4)
ds_read_b64_tr_b16 a[228:229], v237 offset:49152
v_mfma_f32_16x16x32_bf16 v[152:155], a[212:215], v[76:79], v[152:155]
ds_read_b64_tr_b16 a[230:231], v237 offset:51200
v_mfma_f32_16x16x32_bf16 v[156:159], a[212:215], v[108:111], v[156:159]
s_waitcnt lgkmcnt(4)
ds_read_b64_tr_b16 a[240:241], v242 offset:49152
buffer_load_dwordx4 v252, s[20:23], s56 offen  lds
v_mfma_f32_16x16x32_bf16 v[128:131], a[224:227], v[80:83], v[128:131]
ds_read_b64_tr_b16 a[242:243], v242 offset:51200
v_mfma_f32_16x16x32_bf16 v[132:135], a[224:227], v[112:115], v[132:135]
s_waitcnt lgkmcnt(4)
ds_read_b64_tr_b16 a[244:245], v243 offset:49152
s_add_u32 m0, s29, 20480
v_mfma_f32_16x16x32_bf16 v[208:211], a[224:227], a[96:99], v[208:211]
s_waitcnt lgkmcnt(3)
ds_read_b64_tr_b16 a[246:247], v243 offset:51200
v_mfma_f32_16x16x32_bf16 v[136:139], a[228:231], v[80:83], v[136:139]
ds_read_b64_tr_b16 a[176:177], v236 offset:53248
v_mfma_f32_16x16x32_bf16 v[140:143], a[228:231], v[112:115], v[140:143]
s_waitcnt lgkmcnt(3)
ds_read_b64_tr_b16 a[178:179], v236 offset:55296
v_mfma_f32_16x16x32_bf16 v[144:147], a[240:243], v[80:83], v[144:147]
ds_read_b64 a[100:101], v247 offset:13312
v_mfma_f32_16x16x32_bf16 v[148:151], a[240:243], v[112:115], v[148:151]
s_waitcnt lgkmcnt(3)
ds_read_b64 a[102:103], v247 offset:13824
v_mfma_f32_16x16x32_bf16 v[152:155], a[244:247], v[80:83], v[152:155]
ds_read_b64_tr_b16 a[180:181], v237 offset:53248
buffer_load_dwordx4 v252, s[20:23], s57 offen  lds
v_mfma_f32_16x16x32_bf16 v[156:159], a[244:247], v[112:115], v[156:159]
s_waitcnt lgkmcnt(3)
ds_read_b64_tr_b16 a[182:183], v237 offset:55296
s_add_u32 m0, s29, 24576
v_mfma_f32_16x16x32_bf16 v[128:131], a[176:179], v[84:87], v[128:131]
ds_read_b64_tr_b16 a[192:193], v242 offset:53248
v_mfma_f32_16x16x32_bf16 v[132:135], a[176:179], v[116:119], v[132:135]
s_waitcnt lgkmcnt(3)
ds_read_b64_tr_b16 a[194:195], v242 offset:55296
v_mfma_f32_16x16x32_bf16 v[208:211], a[176:179], a[100:103], v[208:211]
s_waitcnt lgkmcnt(2)
ds_read_b64_tr_b16 a[196:197], v243 offset:53248
v_mfma_f32_16x16x32_bf16 v[136:139], a[180:183], v[84:87], v[136:139]
ds_read_b64_tr_b16 a[198:199], v243 offset:55296
v_mfma_f32_16x16x32_bf16 v[140:143], a[180:183], v[116:119], v[140:143]
s_waitcnt lgkmcnt(2)
ds_read_b64_tr_b16 a[208:209], v236 offset:57344
v_mfma_f32_16x16x32_bf16 v[144:147], a[192:195], v[84:87], v[144:147]
ds_read_b64_tr_b16 a[210:211], v236 offset:59392
buffer_load_dwordx4 v252, s[20:23], s58 offen  lds
v_mfma_f32_16x16x32_bf16 v[148:151], a[192:195], v[116:119], v[148:151]
s_waitcnt lgkmcnt(2)
ds_read_b64 a[112:113], v247 offset:14336
v_mfma_f32_16x16x32_bf16 v[152:155], a[196:199], v[84:87], v[152:155]
ds_read_b64 a[114:115], v247 offset:14848
s_add_u32 m0, s29, 28672
v_mfma_f32_16x16x32_bf16 v[156:159], a[196:199], v[116:119], v[156:159]
s_waitcnt lgkmcnt(2)
ds_read_b64_tr_b16 a[212:213], v237 offset:57344
v_mfma_f32_16x16x32_bf16 v[128:131], a[208:211], v[88:91], v[128:131]
ds_read_b64_tr_b16 a[214:215], v237 offset:59392
v_mfma_f32_16x16x32_bf16 v[132:135], a[208:211], v[120:123], v[132:135]
s_waitcnt lgkmcnt(2)
ds_read_b64_tr_b16 a[224:225], v242 offset:57344
v_mfma_f32_16x16x32_bf16 v[208:211], a[208:211], a[112:115], v[208:211]
s_waitcnt lgkmcnt(1)
ds_read_b64_tr_b16 a[226:227], v242 offset:59392
v_mfma_f32_16x16x32_bf16 v[136:139], a[212:215], v[88:91], v[136:139]
ds_read_b64_tr_b16 a[228:229], v243 offset:57344
v_mfma_f32_16x16x32_bf16 v[140:143], a[212:215], v[120:123], v[140:143]
s_waitcnt lgkmcnt(1)
ds_read_b64_tr_b16 a[230:231], v243 offset:59392
buffer_load_dwordx4 v252, s[20:23], s59 offen  lds
v_mfma_f32_16x16x32_bf16 v[144:147], a[224:227], v[88:91], v[144:147]
ds_read_b64_tr_b16 a[240:241], v236 offset:61440
v_mfma_f32_16x16x32_bf16 v[148:151], a[224:227], v[120:123], v[148:151]
s_waitcnt lgkmcnt(1)
ds_read_b64_tr_b16 a[242:243], v236 offset:63488
v_mfma_f32_16x16x32_bf16 v[152:155], a[228:231], v[88:91], v[152:155]
ds_read_b64 a[116:117], v247 offset:15360
v_mfma_f32_16x16x32_bf16 v[156:159], a[228:231], v[120:123], v[156:159]
s_waitcnt lgkmcnt(1)
ds_read_b64 a[118:119], v247 offset:15872
v_mfma_f32_16x16x32_bf16 v[128:131], a[240:243], v[92:95], v[128:131]
ds_read_b64_tr_b16 a[244:245], v237 offset:61440
v_mfma_f32_16x16x32_bf16 v[132:135], a[240:243], v[124:127], v[132:135]
s_waitcnt lgkmcnt(1)
ds_read_b64_tr_b16 a[246:247], v237 offset:63488
v_mfma_f32_16x16x32_bf16 v[208:211], a[240:243], a[116:119], v[208:211]
s_waitcnt lgkmcnt(0)
ds_read_b64_tr_b16 a[212:213], v242 offset:61440
v_mfma_f32_16x16x32_bf16 v[136:139], a[244:247], v[92:95], v[136:139]
ds_read_b64_tr_b16 a[214:215], v242 offset:63488
v_mfma_f32_16x16x32_bf16 v[140:143], a[244:247], v[124:127], v[140:143]
s_waitcnt lgkmcnt(0)
ds_read_b64_tr_b16 a[224:225], v243 offset:61440
v_mfma_f32_16x16x32_bf16 v[144:147], a[212:215], v[92:95], v[144:147]
ds_read_b64_tr_b16 a[226:227], v243 offset:63488
v_mfma_f32_16x16x32_bf16 v[148:151], a[212:215], v[124:127], v[148:151]
s_waitcnt lgkmcnt(0)
ds_read_b64_tr_b16 a[176:177], v238 offset:0
v_mfma_f32_16x16x32_bf16 v[152:155], a[224:227], v[92:95], v[152:155]
ds_read_b64_tr_b16 a[178:179], v238 offset:2048
v_mfma_f32_16x16x32_bf16 v[156:159], a[224:227], v[124:127], v[156:159]
ds_read_b64_tr_b16 a[180:181], v239 offset:0
ds_read_b64_tr_b16 a[182:183], v239 offset:2048
ds_read_b64_tr_b16 a[192:193], v240 offset:0
ds_read_b64_tr_b16 a[194:195], v240 offset:2048
ds_read_b64_tr_b16 a[196:197], v241 offset:0
ds_read_b64_tr_b16 a[198:199], v241 offset:2048
ds_read_b64_tr_b16 a[208:209], v238 offset:4096
ds_read_b64_tr_b16 a[210:211], v238 offset:6144
s_waitcnt vmcnt(8) lgkmcnt(10)
s_barrier
s_mov_b32 s31, 3
.p2align 3
L_oloop:
s_waitcnt lgkmcnt(8)
v_mfma_f32_16x16x32_bf16 v[160:163], a[176:179], v[0:3], 0
ds_read_b64_tr_b16 a[212:213], v239 offset:4096
v_add_u32 v252, 229632, v253
v_mfma_f32_16x16x32_bf16 v[164:167], a[176:179], v[32:35], 0
ds_read_b64_tr_b16 a[214:215], v239 offset:6144
s_add_u32 m0, s29, 32768
v_mfma_f32_16x16x32_bf16 v[212:215], a[176:179], a[0:3], 0
s_waitcnt lgkmcnt(8)
ds_read_b64_tr_b16 a[224:225], v240 offset:4096
v_mfma_f32_16x16x32_bf16 v[168:171], a[180:183], v[0:3], 0
ds_read_b64_tr_b16 a[226:227], v240 offset:6144
v_cvt_pk_bf16_f32 v128, v128, v129
v_mfma_f32_16x16x32_bf16 v[172:175], a[180:183], v[32:35], 0
s_waitcnt lgkmcnt(8)
ds_read_b64_tr_b16 a[228:229], v241 offset:4096
v_cvt_pk_bf16_f32 v129, v130, v131
v_mfma_f32_16x16x32_bf16 v[176:179], a[192:195], v[0:3], 0
ds_read_b64_tr_b16 a[230:231], v241 offset:6144
buffer_load_dwordx4 v252, s[20:23], s52 offen  lds
v_mfma_f32_16x16x32_bf16 v[180:183], a[192:195], v[32:35], 0
s_waitcnt lgkmcnt(8)
ds_read_b64_tr_b16 a[240:241], v238 offset:8192
v_cvt_pk_bf16_f32 v130, v136, v137
v_mfma_f32_16x16x32_bf16 v[184:187], a[196:199], v[0:3], 0
ds_read_b64_tr_b16 a[242:243], v238 offset:10240
v_cvt_pk_bf16_f32 v131, v138, v139
v_mfma_f32_16x16x32_bf16 v[188:191], a[196:199], v[32:35], 0
s_waitcnt lgkmcnt(8)
ds_read_b64_tr_b16 a[244:245], v239 offset:8192
s_add_u32 m0, s29, 36864
v_mfma_f32_16x16x32_bf16 v[160:163], a[208:211], v[4:7], v[160:163]
ds_read_b64_tr_b16 a[246:247], v239 offset:10240
v_cvt_pk_bf16_f32 v144, v144, v145
v_mfma_f32_16x16x32_bf16 v[164:167], a[208:211], v[36:39], v[164:167]
buffer_load_dwordx4 v252, s[20:23], s53 offen  lds
v_mfma_f32_16x16x32_bf16 v[212:215], a[208:211], a[4:7], v[212:215]
s_waitcnt lgkmcnt(8)
ds_read_b64_tr_b16 a[176:177], v240 offset:8192
v_cvt_pk_bf16_f32 v145, v146, v147
v_mfma_f32_16x16x32_bf16 v[168:171], a[212:215], v[4:7], v[168:171]
ds_read_b64_tr_b16 a[178:179], v240 offset:10240
v_cvt_pk_bf16_f32 v146, v152, v153
v_mfma_f32_16x16x32_bf16 v[172:175], a[212:215], v[36:39], v[172:175]
s_waitcnt lgkmcnt(8)
ds_read_b64_tr_b16 a[180:181], v241 offset:8192
v_cvt_pk_bf16_f32 v147, v154, v155
v_mfma_f32_16x16x32_bf16 v[176:179], a[224:227], v[4:7], v[176:179]
ds_read_b64_tr_b16 a[182:183], v241 offset:10240
s_add_u32 m0, s29, 40960
v_mfma_f32_16x16x32_bf16 v[180:183], a[224:227], v[36:39], v[180:183]
s_waitcnt lgkmcnt(8)
ds_read_b64_tr_b16 a[192:193], v238 offset:12288
v_cvt_pk_bf16_f32 v208, v208, v209
v_mfma_f32_16x16x32_bf16 v[184:187], a[228:231], v[4:7], v[184:187]
ds_read_b64_tr_b16 a[194:195], v238 offset:14336
buffer_store_dwordx4 v[128:131], v254, s[24:27], s44 offen offset:0 sc1
v_mfma_f32_16x16x32_bf16 v[188:191], a[228:231], v[36:39], v[188:191]
s_waitcnt lgkmcnt(8)
buffer_load_dwordx4 v252, s[20:23], s54 offen  lds
v_mfma_f32_16x16x32_bf16 v[160:163], a[240:243], v[8:11], v[160:163]
ds_read_b64_tr_b16 a[196:197], v239 offset:12288
v_cvt_pk_bf16_f32 v209, v210, v211
v_mfma_f32_16x16x32_bf16 v[164:167], a[240:243], v[40:43], v[164:167]
ds_read_b64_tr_b16 a[198:199], v239 offset:14336
v_mfma_f32_16x16x32_bf16 v[212:215], a[240:243], a[16:19], v[212:215]
s_waitcnt lgkmcnt(8)
ds_read_b64_tr_b16 a[208:209], v240 offset:12288
v_mfma_f32_16x16x32_bf16 v[168:171], a[244:247], v[8:11], v[168:171]
ds_read_b64_tr_b16 a[210:211], v240 offset:14336
s_add_u32 m0, s29, 45056
v_mfma_f32_16x16x32_bf16 v[172:175], a[244:247], v[40:43], v[172:175]
s_waitcnt lgkmcnt(8)
ds_read_b64_tr_b16 a[212:213], v241 offset:12288
v_mfma_f32_16x16x32_bf16 v[176:179], a[176:179], v[8:11], v[176:179]
ds_read_b64_tr_b16 a[214:215], v241 offset:14336
v_mfma_f32_16x16x32_bf16 v[180:183], a[176:179], v[40:43], v[180:183]
s_waitcnt lgkmcnt(8)
ds_read_b64_tr_b16 a[224:225], v238 offset:16384
v_mfma_f32_16x16x32_bf16 v[184:187], a[180:183], v[8:11], v[184:187]
ds_read_b64_tr_b16 a[226:227], v238 offset:18432
v_mfma_f32_16x16x32_bf16 v[188:191], a[180:183], v[40:43], v[188:191]
s_waitcnt lgkmcnt(8)
buffer_load_dwordx4 v252, s[20:23], s55 offen  lds
v_mfma_f32_16x16x32_bf16 v[160:163], a[192:195], v[12:15], v[160:163]
ds_read_b64_tr_b16 a[228:229], v239 offset:16384
v_mfma_f32_16x16x32_bf16 v[164:167], a[192:195], v[44:47], v[164:167]
ds_read_b64_tr_b16 a[230:231], v239 offset:18432
v_mfma_f32_16x16x32_bf16 v[212:215], a[192:195], a[20:23], v[212:215]
s_waitcnt lgkmcnt(8)
ds_read_b64_tr_b16 a[240:241], v240 offset:16384
s_add_u32 m0, s29, 49152
v_mfma_f32_16x16x32_bf16 v[168:171], a[196:199], v[12:15], v[168:171]
ds_read_b64_tr_b16 a[242:243], v240 offset:18432
v_mfma_f32_16x16x32_bf16 v[172:175], a[196:199], v[44:47], v[172:175]
s_waitcnt lgkmcnt(8)
ds_read_b64_tr_b16 a[244:245], v241 offset:16384
v_mfma_f32_16x16x32_bf16 v[176:179], a[208:211], v[12:15], v[176:179]
ds_read_b64_tr_b16 a[246:247], v241 offset:18432
buffer_store_dwordx4 v[144:147], v254, s[24:27], s44 offen offset:1024 sc1
v_mfma_f32_16x16x32_bf16 v[180:183], a[208:211], v[44:47], v[180:183]
s_waitcnt lgkmcnt(8)
ds_read_b64_tr_b16 a[176:177], v238 offset:20480
v_mfma_f32_16x16x32_bf16 v[184:187], a[212:215], v[12:15], v[184:187]
ds_read_b64_tr_b16 a[178:179], v238 offset:22528
v_mfma_f32_16x16x32_bf16 v[188:191], a[212:215], v[44:47], v[188:191]
s_waitcnt lgkmcnt(8)
buffer_load_dwordx4 v252, s[20:23], s56 offen  lds
v_mfma_f32_16x16x32_bf16 v[160:163], a[224:227], v[16:19], v[160:163]
ds_read_b64_tr_b16 a[180:181], v239 offset:20480
v_mfma_f32_16x16x32_bf16 v[164:167], a[224:227], v[48:51], v[164:167]
ds_read_b64_tr_b16 a[182:183], v239 offset:22528
s_add_u32 m0, s29, 53248
v_mfma_f32_16x16x32_bf16 v[212:215], a[224:227], a[32:35], v[212:215]
s_waitcnt lgkmcnt(8)
ds_read_b64_tr_b16 a[192:193], v240 offset:20480
v_mfma_f32_16x16x32_bf16 v[168:171], a[228:231], v[16:19], v[168:171]
ds_read_b64_tr_b16 a[194:195], v240 offset:22528
v_mfma_f32_16x16x32_bf16 v[172:175], a[228:231], v[48:51], v[172:175]
s_waitcnt lgkmcnt(8)
ds_read_b64_tr_b16 a[196:197], v241 offset:20480
v_mfma_f32_16x16x32_bf16 v[176:179], a[240:243], v[16:19], v[176:179]
ds_read_b64_tr_b16 a[198:199], v241 offset:22528
v_mfma_f32_16x16x32_bf16 v[180:183], a[240:243], v[48:51], v[180:183]
s_waitcnt lgkmcnt(8)
ds_read_b64_tr_b16 a[208:209], v238 offset:24576
v_mfma_f32_16x16x32_bf16 v[184:187], a[244:247], v[16:19], v[184:187]
ds_read_b64_tr_b16 a[210:211], v238 offset:26624
buffer_load_dwordx4 v252, s[20:23], s57 offen  lds
v_mfma_f32_16x16x32_bf16 v[188:191], a[244:247], v[48:51], v[188:191]
s_waitcnt lgkmcnt(8)
ds_read_b64_tr_b16 a[212:213], v239 offset:24576
s_add_u32 m0, s29, 57344
v_mfma_f32_16x16x32_bf16 v[160:163], a[176:179], v[20:23], v[160:163]
ds_read_b64_tr_b16 a[214:215], v239 offset:26624
v_mfma_f32_16x16x32_bf16 v[164:167], a[176:179], v[52:55], v[164:167]
buffer_load_dwordx4 v252, s[20:23], s58 offen  lds
v_mfma_f32_16x16x32_bf16 v[212:215], a[176:179], a[36:39], v[212:215]
s_waitcnt lgkmcnt(8)
ds_read_b64_tr_b16 a[224:225], v240 offset:24576
v_mfma_f32_16x16x32_bf16 v[168:171], a[180:183], v[20:23], v[168:171]
ds_read_b64_tr_b16 a[226:227], v240 offset:26624
v_mfma_f32_16x16x32_bf16 v[172:175], a[180:183], v[52:55], v[172:175]
s_waitcnt lgkmcnt(8)
ds_read_b64_tr_b16 a[228:229], v241 offset:24576
buffer_store_dwordx2 v[208:209], v255, s[24:27], s45 offen sc1
v_mfma_f32_16x16x32_bf16 v[176:179], a[192:195], v[20:23], v[176:179]
ds_read_b64_tr_b16 a[230:231], v241 offset:26624
v_mfma_f32_16x16x32_bf16 v[180:183], a[192:195], v[52:55], v[180:183]
s_waitcnt lgkmcnt(8)
ds_read_b64_tr_b16 a[240:241], v238 offset:28672
v_mfma_f32_16x16x32_bf16 v[184:187], a[196:199], v[20:23], v[184:187]
ds_read_b64_tr_b16 a[242:243], v238 offset:30720
s_add_u32 m0, s29, 61440
v_mfma_f32_16x16x32_bf16 v[188:191], a[196:199], v[52:55], v[188:191]
s_waitcnt lgkmcnt(8)
ds_read_b64_tr_b16 a[244:245], v239 offset:28672
v_mfma_f32_16x16x32_bf16 v[160:163], a[208:211], v[24:27], v[160:163]
ds_read_b64_tr_b16 a[246:247], v239 offset:30720
v_mfma_f32_16x16x32_bf16 v[164:167], a[208:211], v[56:59], v[164:167]
buffer_load_dwordx4 v252, s[20:23], s59 offen  lds
v_mfma_f32_16x16x32_bf16 v[212:215], a[208:211], a[48:51], v[212:215]
s_waitcnt lgkmcnt(8)
v_mfma_f32_16x16x32_bf16 v[168:171], a[212:215], v[24:27], v[168:171]
v_mfma_f32_16x16x32_bf16 v[172:175], a[212:215], v[56:59], v[172:175]
s_waitcnt lgkmcnt(6)
ds_read_b64_tr_b16 a[212:213], v240 offset:28672
v_mfma_f32_16x16x32_bf16 v[176:179], a[224:227], v[24:27], v[176:179]
ds_read_b64_tr_b16 a[214:215], v240 offset:30720
v_mfma_f32_16x16x32_bf16 v[180:183], a[224:227], v[56:59], v[180:183]
s_waitcnt lgkmcnt(6)
ds_read_b64_tr_b16 a[224:225], v241 offset:28672
v_mfma_f32_16x16x32_bf16 v[184:187], a[228:231], v[24:27], v[184:187]
ds_read_b64_tr_b16 a[226:227], v241 offset:30720
v_mfma_f32_16x16x32_bf16 v[188:191], a[228:231], v[56:59], v[188:191]
s_waitcnt lgkmcnt(6)
ds_read_b64_tr_b16 a[176:177], v238 offset:32768
v_mfma_f32_16x16x32_bf16 v[160:163], a[240:243], v[28:31], v[160:163]
ds_read_b64_tr_b16 a[178:179], v238 offset:34816
v_mfma_f32_16x16x32_bf16 v[164:167], a[240:243], v[60:63], v[164:167]
ds_read_b64_tr_b16 a[180:181], v239 offset:32768
v_mfma_f32_16x16x32_bf16 v[212:215], a[240:243], a[52:55], v[212:215]
s_waitcnt lgkmcnt(7)
ds_read_b64_tr_b16 a[182:183], v239 offset:34816
v_mfma_f32_16x16x32_bf16 v[168:171], a[244:247], v[28:31], v[168:171]
ds_read_b64_tr_b16 a[192:193], v240 offset:32768
v_mfma_f32_16x16x32_bf16 v[172:175], a[244:247], v[60:63], v[172:175]
s_waitcnt lgkmcnt(7)
ds_read_b64_tr_b16 a[194:195], v240 offset:34816
v_mfma_f32_16x16x32_bf16 v[176:179], a[212:215], v[28:31], v[176:179]
ds_read_b64_tr_b16 a[196:197], v241 offset:32768
v_mfma_f32_16x16x32_bf16 v[180:183], a[212:215], v[60:63], v[180:183]
s_waitcnt lgkmcnt(7)
ds_read_b64_tr_b16 a[198:199], v241 offset:34816
v_mfma_f32_16x16x32_bf16 v[184:187], a[224:227], v[28:31], v[184:187]
ds_read_b64_tr_b16 a[208:209], v238 offset:36864
v_mfma_f32_16x16x32_bf16 v[188:191], a[224:227], v[60:63], v[188:191]
ds_read_b64_tr_b16 a[210:211], v238 offset:38912
s_waitcnt vmcnt(11) lgkmcnt(10)
s_barrier
s_waitcnt lgkmcnt(8)
v_mfma_f32_16x16x32_bf16 v[160:163], a[176:179], v[64:67], v[160:163]
ds_read_b64_tr_b16 a[212:213], v239 offset:36864
v_add_u32 v252, 384, v253
v_mfma_f32_16x16x32_bf16 v[164:167], a[176:179], v[96:99], v[164:167]
ds_read_b64_tr_b16 a[214:215], v239 offset:38912
s_add_u32 m0, s29, 65536
v_mfma_f32_16x16x32_bf16 v[212:215], a[176:179], a[64:67], v[212:215]
s_waitcnt lgkmcnt(8)
ds_read_b64_tr_b16 a[224:225], v240 offset:36864
v_mfma_f32_16x16x32_bf16 v[168:171], a[180:183], v[64:67], v[168:171]
ds_read_b64_tr_b16 a[226:227], v240 offset:38912
v_cvt_pk_bf16_f32 v132, v132, v133
v_mfma_f32_16x16x32_bf16 v[172:175], a[180:183], v[96:99], v[172:175]
s_waitcnt lgkmcnt(8)
ds_read_b64_tr_b16 a[228:229], v241 offset:36864
v_cvt_pk_bf16_f32 v133, v134, v135
v_mfma_f32_16x16x32_bf16 v[176:179], a[192:195], v[64:67], v[176:179]
ds_read_b64_tr_b16 a[230:231], v241 offset:38912
buffer_load_dwordx4 v252, s[20:23], s52 offen  lds
v_mfma_f32_16x16x32_bf16 v[180:183], a[192:195], v[96:99], v[180:183]
s_waitcnt lgkmcnt(8)
ds_read_b64_tr_b16 a[240:241], v238 offset:40960
v_cvt_pk_bf16_f32 v134, v140, v141
v_mfma_f32_16x16x32_bf16 v[184:187], a[196:199], v[64:67], v[184:187]
ds_read_b64_tr_b16 a[242:243], v238 offset:43008
v_cvt_pk_bf16_f32 v135, v142, v143
v_mfma_f32_16x16x32_bf16 v[188:191], a[196:199], v[96:99], v[188:191]
s_waitcnt lgkmcnt(8)
ds_read_b64_tr_b16 a[244:245], v239 offset:40960
s_add_u32 m0, s29, 69632
v_mfma_f32_16x16x32_bf16 v[160:163], a[208:211], v[68:71], v[160:163]
ds_read_b64_tr_b16 a[246:247], v239 offset:43008
v_cvt_pk_bf16_f32 v148, v148, v149
v_mfma_f32_16x16x32_bf16 v[164:167], a[208:211], v[100:103], v[164:167]
buffer_load_dwordx4 v252, s[20:23], s53 offen  lds
v_mfma_f32_16x16x32_bf16 v[212:215], a[208:211], a[68:71], v[212:215]
s_waitcnt lgkmcnt(8)
ds_read_b64_tr_b16 a[176:177], v240 offset:40960
v_cvt_pk_bf16_f32 v149, v150, v151
v_mfma_f32_16x16x32_bf16 v[168:171], a[212:215], v[68:71], v[168:171]
ds_read_b64_tr_b16 a[178:179], v240 offset:43008
v_cvt_pk_bf16_f32 v150, v156, v157
v_mfma_f32_16x16x32_bf16 v[172:175], a[212:215], v[100:103], v[172:175]
s_waitcnt lgkmcnt(8)
ds_read_b64_tr_b16 a[180:181], v241 offset:40960
v_cvt_pk_bf16_f32 v151, v158, v159
v_mfma_f32_16x16x32_bf16 v[176:179], a[224:227], v[68:71], v[176:179]
ds_read_b64_tr_b16 a[182:183], v241 offset:43008
s_add_u32 m0, s29, 73728
v_mfma_f32_16x16x32_bf16 v[180:183], a[224:227], v[100:103], v[180:183]
s_waitcnt lgkmcnt(8)
ds_read_b64_tr_b16 a[192:193], v238 offset:45056
v_mfma_f32_16x16x32_bf16 v[184:187], a[228:231], v[68:71], v[184:187]
ds_read_b64_tr_b16 a[194:195], v238 offset:47104
buffer_store_dwordx4 v[132:135], v254, s[24:27], s44 offen offset:2048 sc1
v_mfma_f32_16x16x32_bf16 v[188:191], a[228:231], v[100:103], v[188:191]
s_waitcnt lgkmcnt(8)
buffer_load_dwordx4 v252, s[20:23], s54 offen  lds
v_mfma_f32_16x16x32_bf16 v[160:163], a[240:243], v[72:75], v[160:163]
ds_read_b64_tr_b16 a[196:197], v239 offset:45056
v_mfma_f32_16x16x32_bf16 v[164:167], a[240:243], v[104:107], v[164:167]
ds_read_b64_tr_b16 a[198:199], v239 offset:47104
v_mfma_f32_16x16x32_bf16 v[212:215], a[240:243], a[80:83], v[212:215]
s_waitcnt lgkmcnt(8)
ds_read_b64_tr_b16 a[208:209], v240 offset:45056
v_mfma_f32_16x16x32_bf16 v[168:171], a[244:247], v[72:75], v[168:171]
ds_read_b64_tr_b16 a[210:211], v240 offset:47104
s_add_u32 m0, s29, 77824
v_mfma_f32_16x16x32_bf16 v[172:175], a[244:247], v[104:107], v[172:175]
s_waitcnt lgkmcnt(8)
ds_read_b64_tr_b16 a[212:213], v241 offset:45056
v_mfma_f32_16x16x32_bf16 v[176:179], a[176:179], v[72:75], v[176:179]
ds_read_b64_tr_b16 a[214:215], v241 offset:47104
v_mfma_f32_16x16x32_bf16 v[180:183], a[176:179], v[104:107], v[180:183]
s_waitcnt lgkmcnt(8)
ds_read_b64_tr_b16 a[224:225], v238 offset:49152
v_mfma_f32_16x16x32_bf16 v[184:187], a[180:183], v[72:75], v[184:187]
ds_read_b64_tr_b16 a[226:227], v238 offset:51200
v_mfma_f32_16x16x32_bf16 v[188:191], a[180:183], v[104:107], v[188:191]
s_waitcnt lgkmcnt(8)
buffer_load_dwordx4 v252, s[20:23], s55 offen  lds
v_mfma_f32_16x16x32_bf16 v[160:163], a[192:195], v[76:79], v[160:163]
ds_read_b64_tr_b16 a[228:229], v239 offset:49152
v_mfma_f32_16x16x32_bf16 v[164:167], a[192:195], v[108:111], v[164:167]
ds_read_b64_tr_b16 a[230:231], v239 offset:51200
v_mfma_f32_16x16x32_bf16 v[212:215], a[192:195], a[84:87], v[212:215]
s_waitcnt lgkmcnt(8)
ds_read_b64_tr_b16 a[240:241], v240 offset:49152
s_add_u32 m0, s29, 81920
v_mfma_f32_16x16x32_bf16 v[168:171], a[196:199], v[76:79], v[168:171]
ds_read_b64_tr_b16 a[242:243], v240 offset:51200
v_mfma_f32_16x16x32_bf16 v[172:175], a[196:199], v[108:111], v[172:175]
s_waitcnt lgkmcnt(8)
ds_read_b64_tr_b16 a[244:245], v241 offset:49152
v_mfma_f32_16x16x32_bf16 v[176:179], a[208:211], v[76:79], v[176:179]
ds_read_b64_tr_b16 a[246:247], v241 offset:51200
v_mfma_f32_16x16x32_bf16 v[180:183], a[208:211], v[108:111], v[180:183]
s_waitcnt lgkmcnt(8)
ds_read_b64_tr_b16 a[176:177], v238 offset:53248
v_mfma_f32_16x16x32_bf16 v[184:187], a[212:215], v[76:79], v[184:187]
ds_read_b64_tr_b16 a[178:179], v238 offset:55296
v_mfma_f32_16x16x32_bf16 v[188:191], a[212:215], v[108:111], v[188:191]
s_waitcnt lgkmcnt(8)
buffer_load_dwordx4 v252, s[20:23], s56 offen  lds
v_mfma_f32_16x16x32_bf16 v[160:163], a[224:227], v[80:83], v[160:163]
ds_read_b64_tr_b16 a[180:181], v239 offset:53248
v_mfma_f32_16x16x32_bf16 v[164:167], a[224:227], v[112:115], v[164:167]
ds_read_b64_tr_b16 a[182:183], v239 offset:55296
s_add_u32 m0, s29, 86016
v_mfma_f32_16x16x32_bf16 v[212:215], a[224:227], a[96:99], v[212:215]
s_waitcnt lgkmcnt(8)
ds_read_b64_tr_b16 a[192:193], v240 offset:53248
v_mfma_f32_16x16x32_bf16 v[168:171], a[228:231], v[80:83], v[168:171]
ds_read_b64_tr_b16 a[194:195], v240 offset:55296
v_mfma_f32_16x16x32_bf16 v[172:175], a[228:231], v[112:115], v[172:175]
s_waitcnt lgkmcnt(8)
ds_read_b64_tr_b16 a[196:197], v241 offset:53248
v_mfma_f32_16x16x32_bf16 v[176:179], a[240:243], v[80:83], v[176:179]
ds_read_b64_tr_b16 a[198:199], v241 offset:55296
buffer_store_dwordx4 v[148:151], v254, s[24:27], s44 offen offset:3072 sc1
v_mfma_f32_16x16x32_bf16 v[180:183], a[240:243], v[112:115], v[180:183]
s_waitcnt lgkmcnt(8)
ds_read_b64_tr_b16 a[208:209], v238 offset:57344
v_mfma_f32_16x16x32_bf16 v[184:187], a[244:247], v[80:83], v[184:187]
ds_read_b64_tr_b16 a[210:211], v238 offset:59392
buffer_load_dwordx4 v252, s[20:23], s57 offen  lds
v_mfma_f32_16x16x32_bf16 v[188:191], a[244:247], v[112:115], v[188:191]
s_waitcnt lgkmcnt(8)
ds_read_b64_tr_b16 a[212:213], v239 offset:57344
s_add_u32 m0, s29, 90112
v_mfma_f32_16x16x32_bf16 v[160:163], a[176:179], v[84:87], v[160:163]
ds_read_b64_tr_b16 a[214:215], v239 offset:59392
v_mfma_f32_16x16x32_bf16 v[164:167], a[176:179], v[116:119], v[164:167]
buffer_load_dwordx4 v252, s[20:23], s58 offen  lds
v_mfma_f32_16x16x32_bf16 v[212:215], a[176:179], a[100:103], v[212:215]
s_waitcnt lgkmcnt(8)
ds_read_b64_tr_b16 a[224:225], v240 offset:57344
v_mfma_f32_16x16x32_bf16 v[168:171], a[180:183], v[84:87], v[168:171]
ds_read_b64_tr_b16 a[226:227], v240 offset:59392
v_mfma_f32_16x16x32_bf16 v[172:175], a[180:183], v[116:119], v[172:175]
s_waitcnt lgkmcnt(8)
ds_read_b64_tr_b16 a[228:229], v241 offset:57344
v_mfma_f32_16x16x32_bf16 v[176:179], a[192:195], v[84:87], v[176:179]
ds_read_b64_tr_b16 a[230:231], v241 offset:59392
v_mfma_f32_16x16x32_bf16 v[180:183], a[192:195], v[116:119], v[180:183]
s_waitcnt lgkmcnt(8)
ds_read_b64_tr_b16 a[240:241], v238 offset:61440
v_mfma_f32_16x16x32_bf16 v[184:187], a[196:199], v[84:87], v[184:187]
ds_read_b64_tr_b16 a[242:243], v238 offset:63488
s_add_u32 m0, s29, 94208
v_mfma_f32_16x16x32_bf16 v[188:191], a[196:199], v[116:119], v[188:191]
s_waitcnt lgkmcnt(8)
ds_read_b64_tr_b16 a[244:245], v239 offset:61440
v_mfma_f32_16x16x32_bf16 v[160:163], a[208:211], v[88:91], v[160:163]
ds_read_b64_tr_b16 a[246:247], v239 offset:63488
v_mfma_f32_16x16x32_bf16 v[164:167], a[208:211], v[120:123], v[164:167]
buffer_load_dwordx4 v252, s[20:23], s59 offen  lds
v_mfma_f32_16x16x32_bf16 v[212:215], a[208:211], a[112:115], v[212:215]
s_waitcnt lgkmcnt(8)
v_mfma_f32_16x16x32_bf16 v[168:171], a[212:215], v[88:91], v[168:171]
v_mfma_f32_16x16x32_bf16 v[172:175], a[212:215], v[120:123], v[172:175]
s_waitcnt lgkmcnt(6)
ds_read_b64_tr_b16 a[212:213], v240 offset:61440
v_mfma_f32_16x16x32_bf16 v[176:179], a[224:227], v[88:91], v[176:179]
ds_read_b64_tr_b16 a[214:215], v240 offset:63488
v_mfma_f32_16x16x32_bf16 v[180:183], a[224:227], v[120:123], v[180:183]
s_waitcnt lgkmcnt(6)
ds_read_b64_tr_b16 a[224:225], v241 offset:61440
v_mfma_f32_16x16x32_bf16 v[184:187], a[228:231], v[88:91], v[184:187]
ds_read_b64_tr_b16 a[226:227], v241 offset:63488
v_mfma_f32_16x16x32_bf16 v[188:191], a[228:231], v[120:123], v[188:191]
s_waitcnt lgkmcnt(6)
ds_read_b64_tr_b16 a[176:177], v236 offset:0
v_mfma_f32_16x16x32_bf16 v[160:163], a[240:243], v[92:95], v[160:163]
ds_read_b64_tr_b16 a[178:179], v236 offset:2048
v_mfma_f32_16x16x32_bf16 v[164:167], a[240:243], v[124:127], v[164:167]
ds_read_b64_tr_b16 a[180:181], v237 offset:0
v_mfma_f32_16x16x32_bf16 v[212:215], a[240:243], a[116:119], v[212:215]
s_waitcnt lgkmcnt(7)
ds_read_b64_tr_b16 a[182:183], v237 offset:2048
v_mfma_f32_16x16x32_bf16 v[168:171], a[244:247], v[92:95], v[168:171]
ds_read_b64_tr_b16 a[192:193], v242 offset:0
v_mfma_f32_16x16x32_bf16 v[172:175], a[244:247], v[124:127], v[172:175]
s_waitcnt lgkmcnt(7)
ds_read_b64_tr_b16 a[194:195], v242 offset:2048
s_add_u32 s44, s44, 16384
v_mfma_f32_16x16x32_bf16 v[176:179], a[212:215], v[92:95], v[176:179]
ds_read_b64_tr_b16 a[196:197], v243 offset:0
s_add_u32 s45, s45, 2048
v_mfma_f32_16x16x32_bf16 v[180:183], a[212:215], v[124:127], v[180:183]
s_waitcnt lgkmcnt(7)
ds_read_b64_tr_b16 a[198:199], v243 offset:2048
v_mfma_f32_16x16x32_bf16 v[184:187], a[224:227], v[92:95], v[184:187]
ds_read_b64_tr_b16 a[208:209], v236 offset:4096
v_mfma_f32_16x16x32_bf16 v[188:191], a[224:227], v[124:127], v[188:191]
ds_read_b64_tr_b16 a[210:211], v236 offset:6144
s_waitcnt vmcnt(10) lgkmcnt(10)
s_barrier
s_waitcnt lgkmcnt(8)
v_mfma_f32_16x16x32_bf16 v[128:131], a[176:179], v[0:3], 0
ds_read_b64_tr_b16 a[212:213], v237 offset:4096
v_add_u32 v252, 229760, v253
v_mfma_f32_16x16x32_bf16 v[132:135], a[176:179], v[32:35], 0
ds_read_b64_tr_b16 a[214:215], v237 offset:6144
s_add_u32 m0, s29, 98304
v_mfma_f32_16x16x32_bf16 v[208:211], a[176:179], a[0:3], 0
s_waitcnt lgkmcnt(8)
ds_read_b64_tr_b16 a[224:225], v242 offset:4096
v_mfma_f32_16x16x32_bf16 v[136:139], a[180:183], v[0:3], 0
ds_read_b64_tr_b16 a[226:227], v242 offset:6144
v_cvt_pk_bf16_f32 v160, v160, v161
v_mfma_f32_16x16x32_bf16 v[140:143], a[180:183], v[32:35], 0
s_waitcnt lgkmcnt(8)
ds_read_b64_tr_b16 a[228:229], v243 offset:4096
v_cvt_pk_bf16_f32 v161, v162, v163
v_mfma_f32_16x16x32_bf16 v[144:147], a[192:195], v[0:3], 0
ds_read_b64_tr_b16 a[230:231], v243 offset:6144
buffer_load_dwordx4 v252, s[20:23], s52 offen  lds
v_mfma_f32_16x16x32_bf16 v[148:151], a[192:195], v[32:35], 0
s_waitcnt lgkmcnt(8)
ds_read_b64_tr_b16 a[240:241], v236 offset:8192
v_cvt_pk_bf16_f32 v162, v168, v169
v_mfma_f32_16x16x32_bf16 v[152:155], a[196:199], v[0:3], 0
ds_read_b64_tr_b16 a[242:243], v236 offset:10240
v_cvt_pk_bf16_f32 v163, v170, v171
v_mfma_f32_16x16x32_bf16 v[156:159], a[196:199], v[32:35], 0
s_waitcnt lgkmcnt(8)
ds_read_b64_tr_b16 a[244:245], v237 offset:8192
s_add_u32 m0, s29, 102400
v_mfma_f32_16x16x32_bf16 v[128:131], a[208:211], v[4:7], v[128:131]
ds_read_b64_tr_b16 a[246:247], v237 offset:10240
v_cvt_pk_bf16_f32 v176, v176, v177
v_mfma_f32_16x16x32_bf16 v[132:135], a[208:211], v[36:39], v[132:135]
buffer_load_dwordx4 v252, s[20:23], s53 offen  lds
v_mfma_f32_16x16x32_bf16 v[208:211], a[208:211], a[4:7], v[208:211]
s_waitcnt lgkmcnt(8)
ds_read_b64_tr_b16 a[176:177], v242 offset:8192
v_cvt_pk_bf16_f32 v177, v178, v179
v_mfma_f32_16x16x32_bf16 v[136:139], a[212:215], v[4:7], v[136:139]
ds_read_b64_tr_b16 a[178:179], v242 offset:10240
v_cvt_pk_bf16_f32 v178, v184, v185
v_mfma_f32_16x16x32_bf16 v[140:143], a[212:215], v[36:39], v[140:143]
s_waitcnt lgkmcnt(8)
ds_read_b64_tr_b16 a[180:181], v243 offset:8192
v_cvt_pk_bf16_f32 v179, v186, v187
v_mfma_f32_16x16x32_bf16 v[144:147], a[224:227], v[4:7], v[144:147]
ds_read_b64_tr_b16 a[182:183], v243 offset:10240
s_add_u32 m0, s29, 106496
v_mfma_f32_16x16x32_bf16 v[148:151], a[224:227], v[36:39], v[148:151]
s_waitcnt lgkmcnt(8)
ds_read_b64_tr_b16 a[192:193], v236 offset:12288
v_cvt_pk_bf16_f32 v212, v212, v213
v_mfma_f32_16x16x32_bf16 v[152:155], a[228:231], v[4:7], v[152:155]
ds_read_b64_tr_b16 a[194:195], v236 offset:14336
buffer_store_dwordx4 v[160:163], v254, s[24:27], s44 offen offset:0 sc1
v_mfma_f32_16x16x32_bf16 v[156:159], a[228:231], v[36:39], v[156:159]
s_waitcnt lgkmcnt(8)
buffer_load_dwordx4 v252, s[20:23], s54 offen  lds
v_mfma_f32_16x16x32_bf16 v[128:131], a[240:243], v[8:11], v[128:131]
ds_read_b64_tr_b16 a[196:197], v237 offset:12288
v_cvt_pk_bf16_f32 v213, v214, v215
v_mfma_f32_16x16x32_bf16 v[132:135], a[240:243], v[40:43], v[132:135]
ds_read_b64_tr_b16 a[198:199], v237 offset:14336
v_mfma_f32_16x16x32_bf16 v[208:211], a[240:243], a[16:19], v[208:211]
s_waitcnt lgkmcnt(8)
ds_read_b64_tr_b16 a[208:209], v242 offset:12288
v_mfma_f32_16x16x32_bf16 v[136:139], a[244:247], v[8:11], v[136:139]
ds_read_b64_tr_b16 a[210:211], v242 offset:14336
s_add_u32 m0, s29, 110592
v_mfma_f32_16x16x32_bf16 v[140:143], a[244:247], v[40:43], v[140:143]
s_waitcnt lgkmcnt(8)
ds_read_b64_tr_b16 a[212:213], v243 offset:12288
v_mfma_f32_16x16x32_bf16 v[144:147], a[176:179], v[8:11], v[144:147]
ds_read_b64_tr_b16 a[214:215], v243 offset:14336
v_mfma_f32_16x16x32_bf16 v[148:151], a[176:179], v[40:43], v[148:151]
s_waitcnt lgkmcnt(8)
ds_read_b64_tr_b16 a[224:225], v236 offset:16384
v_mfma_f32_16x16x32_bf16 v[152:155], a[180:183], v[8:11], v[152:155]
ds_read_b64_tr_b16 a[226:227], v236 offset:18432
v_mfma_f32_16x16x32_bf16 v[156:159], a[180:183], v[40:43], v[156:159]
s_waitcnt lgkmcnt(8)
buffer_load_dwordx4 v252, s[20:23], s55 offen  lds
v_mfma_f32_16x16x32_bf16 v[128:131], a[192:195], v[12:15], v[128:131]
ds_read_b64_tr_b16 a[228:229], v237 offset:16384
v_mfma_f32_16x16x32_bf16 v[132:135], a[192:195], v[44:47], v[132:135]
ds_read_b64_tr_b16 a[230:231], v237 offset:18432
v_mfma_f32_16x16x32_bf16 v[208:211], a[192:195], a[20:23], v[208:211]
s_waitcnt lgkmcnt(8)
ds_read_b64_tr_b16 a[240:241], v242 offset:16384
s_add_u32 m0, s29, 114688
v_mfma_f32_16x16x32_bf16 v[136:139], a[196:199], v[12:15], v[136:139]
ds_read_b64_tr_b16 a[242:243], v242 offset:18432
v_mfma_f32_16x16x32_bf16 v[140:143], a[196:199], v[44:47], v[140:143]
s_waitcnt lgkmcnt(8)
ds_read_b64_tr_b16 a[244:245], v243 offset:16384
v_mfma_f32_16x16x32_bf16 v[144:147], a[208:211], v[12:15], v[144:147]
ds_read_b64_tr_b16 a[246:247], v243 offset:18432
buffer_store_dwordx4 v[176:179], v254, s[24:27], s44 offen offset:1024 sc1
v_mfma_f32_16x16x32_bf16 v[148:151], a[208:211], v[44:47], v[148:151]
s_waitcnt lgkmcnt(8)
ds_read_b64_tr_b16 a[176:177], v236 offset:20480
v_mfma_f32_16x16x32_bf16 v[152:155], a[212:215], v[12:15], v[152:155]
ds_read_b64_tr_b16 a[178:179], v236 offset:22528
v_mfma_f32_16x16x32_bf16 v[156:159], a[212:215], v[44:47], v[156:159]
s_waitcnt lgkmcnt(8)
buffer_load_dwordx4 v252, s[20:23], s56 offen  lds
v_mfma_f32_16x16x32_bf16 v[128:131], a[224:227], v[16:19], v[128:131]
ds_read_b64_tr_b16 a[180:181], v237 offset:20480
v_mfma_f32_16x16x32_bf16 v[132:135], a[224:227], v[48:51], v[132:135]
ds_read_b64_tr_b16 a[182:183], v237 offset:22528
s_add_u32 m0, s29, 118784
v_mfma_f32_16x16x32_bf16 v[208:211], a[224:227], a[32:35], v[208:211]
s_waitcnt lgkmcnt(8)
ds_read_b64_tr_b16 a[192:193], v242 offset:20480
v_mfma_f32_16x16x32_bf16 v[136:139], a[228:231], v[16:19], v[136:139]
ds_read_b64_tr_b16 a[194:195], v242 offset:22528
v_mfma_f32_16x16x32_bf16 v[140:143], a[228:231], v[48:51], v[140:143]
s_waitcnt lgkmcnt(8)
ds_read_b64_tr_b16 a[196:197], v243 offset:20480
v_mfma_f32_16x16x32_bf16 v[144:147], a[240:243], v[16:19], v[144:147]
ds_read_b64_tr_b16 a[198:199], v243 offset:22528
v_mfma_f32_16x16x32_bf16 v[148:151], a[240:243], v[48:51], v[148:151]
s_waitcnt lgkmcnt(8)
ds_read_b64_tr_b16 a[208:209], v236 offset:24576
v_mfma_f32_16x16x32_bf16 v[152:155], a[244:247], v[16:19], v[152:155]
ds_read_b64_tr_b16 a[210:211], v236 offset:26624
buffer_load_dwordx4 v252, s[20:23], s57 offen  lds
v_mfma_f32_16x16x32_bf16 v[156:159], a[244:247], v[48:51], v[156:159]
s_waitcnt lgkmcnt(8)
ds_read_b64_tr_b16 a[212:213], v237 offset:24576
s_add_u32 m0, s29, 122880
v_mfma_f32_16x16x32_bf16 v[128:131], a[176:179], v[20:23], v[128:131]
ds_read_b64_tr_b16 a[214:215], v237 offset:26624
v_mfma_f32_16x16x32_bf16 v[132:135], a[176:179], v[52:55], v[132:135]
buffer_load_dwordx4 v252, s[20:23], s58 offen  lds
v_mfma_f32_16x16x32_bf16 v[208:211], a[176:179], a[36:39], v[208:211]
s_waitcnt lgkmcnt(8)
ds_read_b64_tr_b16 a[224:225], v242 offset:24576
v_mfma_f32_16x16x32_bf16 v[136:139], a[180:183], v[20:23], v[136:139]
ds_read_b64_tr_b16 a[226:227], v242 offset:26624
v_mfma_f32_16x16x32_bf16 v[140:143], a[180:183], v[52:55], v[140:143]
s_waitcnt lgkmcnt(8)
ds_read_b64_tr_b16 a[228:229], v243 offset:24576
buffer_store_dwordx2 v[212:213], v255, s[24:27], s45 offen sc1
v_mfma_f32_16x16x32_bf16 v[144:147], a[192:195], v[20:23], v[144:147]
ds_read_b64_tr_b16 a[230:231], v243 offset:26624
v_mfma_f32_16x16x32_bf16 v[148:151], a[192:195], v[52:55], v[148:151]
s_waitcnt lgkmcnt(8)
ds_read_b64_tr_b16 a[240:241], v236 offset:28672
v_mfma_f32_16x16x32_bf16 v[152:155], a[196:199], v[20:23], v[152:155]
ds_read_b64_tr_b16 a[242:243], v236 offset:30720
s_add_u32 m0, s29, 126976
v_mfma_f32_16x16x32_bf16 v[156:159], a[196:199], v[52:55], v[156:159]
s_waitcnt lgkmcnt(8)
ds_read_b64_tr_b16 a[244:245], v237 offset:28672
v_mfma_f32_16x16x32_bf16 v[128:131], a[208:211], v[24:27], v[128:131]
ds_read_b64_tr_b16 a[246:247], v237 offset:30720
v_mfma_f32_16x16x32_bf16 v[132:135], a[208:211], v[56:59], v[132:135]
buffer_load_dwordx4 v252, s[20:23], s59 offen  lds
v_mfma_f32_16x16x32_bf16 v[208:211], a[208:211], a[48:51], v[208:211]
s_waitcnt lgkmcnt(8)
v_mfma_f32_16x16x32_bf16 v[136:139], a[212:215], v[24:27], v[136:139]
v_mfma_f32_16x16x32_bf16 v[140:143], a[212:215], v[56:59], v[140:143]
s_waitcnt lgkmcnt(6)
ds_read_b64_tr_b16 a[212:213], v242 offset:28672
v_mfma_f32_16x16x32_bf16 v[144:147], a[224:227], v[24:27], v[144:147]
ds_read_b64_tr_b16 a[214:215], v242 offset:30720
v_mfma_f32_16x16x32_bf16 v[148:151], a[224:227], v[56:59], v[148:151]
s_waitcnt lgkmcnt(6)
ds_read_b64_tr_b16 a[224:225], v243 offset:28672
v_mfma_f32_16x16x32_bf16 v[152:155], a[228:231], v[24:27], v[152:155]
ds_read_b64_tr_b16 a[226:227], v243 offset:30720
v_mfma_f32_16x16x32_bf16 v[156:159], a[228:231], v[56:59], v[156:159]
s_waitcnt lgkmcnt(6)
ds_read_b64_tr_b16 a[176:177], v236 offset:32768
v_mfma_f32_16x16x32_bf16 v[128:131], a[240:243], v[28:31], v[128:131]
ds_read_b64_tr_b16 a[178:179], v236 offset:34816
v_mfma_f32_16x16x32_bf16 v[132:135], a[240:243], v[60:63], v[132:135]
ds_read_b64_tr_b16 a[180:181], v237 offset:32768
v_mfma_f32_16x16x32_bf16 v[208:211], a[240:243], a[52:55], v[208:211]
s_waitcnt lgkmcnt(7)
ds_read_b64_tr_b16 a[182:183], v237 offset:34816
v_mfma_f32_16x16x32_bf16 v[136:139], a[244:247], v[28:31], v[136:139]
ds_read_b64_tr_b16 a[192:193], v242 offset:32768
v_mfma_f32_16x16x32_bf16 v[140:143], a[244:247], v[60:63], v[140:143]
s_waitcnt lgkmcnt(7)
ds_read_b64_tr_b16 a[194:195], v242 offset:34816
v_mfma_f32_16x16x32_bf16 v[144:147], a[212:215], v[28:31], v[144:147]
ds_read_b64_tr_b16 a[196:197], v243 offset:32768
v_mfma_f32_16x16x32_bf16 v[148:151], a[212:215], v[60:63], v[148:151]
s_waitcnt lgkmcnt(7)
ds_read_b64_tr_b16 a[198:199], v243 offset:34816
v_mfma_f32_16x16x32_bf16 v[152:155], a[224:227], v[28:31], v[152:155]
ds_read_b64_tr_b16 a[208:209], v236 offset:36864
v_mfma_f32_16x16x32_bf16 v[156:159], a[224:227], v[60:63], v[156:159]
ds_read_b64_tr_b16 a[210:211], v236 offset:38912
s_waitcnt vmcnt(11) lgkmcnt(10)
s_barrier
s_waitcnt lgkmcnt(8)
v_mfma_f32_16x16x32_bf16 v[128:131], a[176:179], v[64:67], v[128:131]
ds_read_b64_tr_b16 a[212:213], v237 offset:36864
v_add_u32 v252, 512, v253
v_mfma_f32_16x16x32_bf16 v[132:135], a[176:179], v[96:99], v[132:135]
ds_read_b64_tr_b16 a[214:215], v237 offset:38912
s_add_u32 m0, s29, 0
v_mfma_f32_16x16x32_bf16 v[208:211], a[176:179], a[64:67], v[208:211]
s_waitcnt lgkmcnt(8)
ds_read_b64_tr_b16 a[224:225], v242 offset:36864
v_mfma_f32_16x16x32_bf16 v[136:139], a[180:183], v[64:67], v[136:139]
ds_read_b64_tr_b16 a[226:227], v242 offset:38912
v_cvt_pk_bf16_f32 v164, v164, v165
v_mfma_f32_16x16x32_bf16 v[140:143], a[180:183], v[96:99], v[140:143]
s_waitcnt lgkmcnt(8)
ds_read_b64_tr_b16 a[228:229], v243 offset:36864
v_cvt_pk_bf16_f32 v165, v166, v167
v_mfma_f32_16x16x32_bf16 v[144:147], a[192:195], v[64:67], v[144:147]
ds_read_b64_tr_b16 a[230:231], v243 offset:38912
buffer_load_dwordx4 v252, s[20:23], s52 offen  lds
v_mfma_f32_16x16x32_bf16 v[148:151], a[192:195], v[96:99], v[148:151]
s_waitcnt lgkmcnt(8)
ds_read_b64_tr_b16 a[240:241], v236 offset:40960
v_cvt_pk_bf16_f32 v166, v172, v173
v_mfma_f32_16x16x32_bf16 v[152:155], a[196:199], v[64:67], v[152:155]
ds_read_b64_tr_b16 a[242:243], v236 offset:43008
v_cvt_pk_bf16_f32 v167, v174, v175
v_mfma_f32_16x16x32_bf16 v[156:159], a[196:199], v[96:99], v[156:159]
s_waitcnt lgkmcnt(8)
ds_read_b64_tr_b16 a[244:245], v237 offset:40960
s_add_u32 m0, s29, 4096
v_mfma_f32_16x16x32_bf16 v[128:131], a[208:211], v[68:71], v[128:131]
ds_read_b64_tr_b16 a[246:247], v237 offset:43008
v_cvt_pk_bf16_f32 v180, v180, v181
v_mfma_f32_16x16x32_bf16 v[132:135], a[208:211], v[100:103], v[132:135]
buffer_load_dwordx4 v252, s[20:23], s53 offen  lds
v_mfma_f32_16x16x32_bf16 v[208:211], a[208:211], a[68:71], v[208:211]
s_waitcnt lgkmcnt(8)
ds_read_b64_tr_b16 a[176:177], v242 offset:40960
v_cvt_pk_bf16_f32 v181, v182, v183
v_mfma_f32_16x16x32_bf16 v[136:139], a[212:215], v[68:71], v[136:139]
ds_read_b64_tr_b16 a[178:179], v242 offset:43008
v_cvt_pk_bf16_f32 v182, v188, v189
v_mfma_f32_16x16x32_bf16 v[140:143], a[212:215], v[100:103], v[140:143]
s_waitcnt lgkmcnt(8)
ds_read_b64_tr_b16 a[180:181], v243 offset:40960
v_cvt_pk_bf16_f32 v183, v190, v191
v_mfma_f32_16x16x32_bf16 v[144:147], a[224:227], v[68:71], v[144:147]
ds_read_b64_tr_b16 a[182:183], v243 offset:43008
s_add_u32 m0, s29, 8192
v_mfma_f32_16x16x32_bf16 v[148:151], a[224:227], v[100:103], v[148:151]
s_waitcnt lgkmcnt(8)
ds_read_b64_tr_b16 a[192:193], v236 offset:45056
v_mfma_f32_16x16x32_bf16 v[152:155], a[228:231], v[68:71], v[152:155]
ds_read_b64_tr_b16 a[194:195], v236 offset:47104
buffer_store_dwordx4 v[164:167], v254, s[24:27], s44 offen offset:2048 sc1
v_mfma_f32_16x16x32_bf16 v[156:159], a[228:231], v[100:103], v[156:159]
s_waitcnt lgkmcnt(8)
buffer_load_dwordx4 v252, s[20:23], s54 offen  lds
v_mfma_f32_16x16x32_bf16 v[128:131], a[240:243], v[72:75], v[128:131]
ds_read_b64_tr_b16 a[196:197], v237 offset:45056
v_mfma_f32_16x16x32_bf16 v[132:135], a[240:243], v[104:107], v[132:135]
ds_read_b64_tr_b16 a[198:199], v237 offset:47104
v_mfma_f32_16x16x32_bf16 v[208:211], a[240:243], a[80:83], v[208:211]
s_waitcnt lgkmcnt(8)
ds_read_b64_tr_b16 a[208:209], v242 offset:45056
v_mfma_f32_16x16x32_bf16 v[136:139], a[244:247], v[72:75], v[136:139]
ds_read_b64_tr_b16 a[210:211], v242 offset:47104
s_add_u32 m0, s29, 12288
v_mfma_f32_16x16x32_bf16 v[140:143], a[244:247], v[104:107], v[140:143]
s_waitcnt lgkmcnt(8)
ds_read_b64_tr_b16 a[212:213], v243 offset:45056
v_mfma_f32_16x16x32_bf16 v[144:147], a[176:179], v[72:75], v[144:147]
ds_read_b64_tr_b16 a[214:215], v243 offset:47104
v_mfma_f32_16x16x32_bf16 v[148:151], a[176:179], v[104:107], v[148:151]
s_waitcnt lgkmcnt(8)
ds_read_b64_tr_b16 a[224:225], v236 offset:49152
v_mfma_f32_16x16x32_bf16 v[152:155], a[180:183], v[72:75], v[152:155]
ds_read_b64_tr_b16 a[226:227], v236 offset:51200
v_mfma_f32_16x16x32_bf16 v[156:159], a[180:183], v[104:107], v[156:159]
s_waitcnt lgkmcnt(8)
buffer_load_dwordx4 v252, s[20:23], s55 offen  lds
v_mfma_f32_16x16x32_bf16 v[128:131], a[192:195], v[76:79], v[128:131]
ds_read_b64_tr_b16 a[228:229], v237 offset:49152
v_mfma_f32_16x16x32_bf16 v[132:135], a[192:195], v[108:111], v[132:135]
ds_read_b64_tr_b16 a[230:231], v237 offset:51200
v_mfma_f32_16x16x32_bf16 v[208:211], a[192:195], a[84:87], v[208:211]
s_waitcnt lgkmcnt(8)
ds_read_b64_tr_b16 a[240:241], v242 offset:49152
s_add_u32 m0, s29, 16384
v_mfma_f32_16x16x32_bf16 v[136:139], a[196:199], v[76:79], v[136:139]
ds_read_b64_tr_b16 a[242:243], v242 offset:51200
v_mfma_f32_16x16x32_bf16 v[140:143], a[196:199], v[108:111], v[140:143]
s_waitcnt lgkmcnt(8)
ds_read_b64_tr_b16 a[244:245], v243 offset:49152
v_mfma_f32_16x16x32_bf16 v[144:147], a[208:211], v[76:79], v[144:147]
ds_read_b64_tr_b16 a[246:247], v243 offset:51200
v_mfma_f32_16x16x32_bf16 v[148:151], a[208:211], v[108:111], v[148:151]
s_waitcnt lgkmcnt(8)
ds_read_b64_tr_b16 a[176:177], v236 offset:53248
v_mfma_f32_16x16x32_bf16 v[152:155], a[212:215], v[76:79], v[152:155]
ds_read_b64_tr_b16 a[178:179], v236 offset:55296
v_mfma_f32_16x16x32_bf16 v[156:159], a[212:215], v[108:111], v[156:159]
s_waitcnt lgkmcnt(8)
buffer_load_dwordx4 v252, s[20:23], s56 offen  lds
v_mfma_f32_16x16x32_bf16 v[128:131], a[224:227], v[80:83], v[128:131]
ds_read_b64_tr_b16 a[180:181], v237 offset:53248
v_mfma_f32_16x16x32_bf16 v[132:135], a[224:227], v[112:115], v[132:135]
ds_read_b64_tr_b16 a[182:183], v237 offset:55296
s_add_u32 m0, s29, 20480
v_mfma_f32_16x16x32_bf16 v[208:211], a[224:227], a[96:99], v[208:211]
s_waitcnt lgkmcnt(8)
ds_read_b64_tr_b16 a[192:193], v242 offset:53248
v_mfma_f32_16x16x32_bf16 v[136:139], a[228:231], v[80:83], v[136:139]
ds_read_b64_tr_b16 a[194:195], v242 offset:55296
v_mfma_f32_16x16x32_bf16 v[140:143], a[228:231], v[112:115], v[140:143]
s_waitcnt lgkmcnt(8)
ds_read_b64_tr_b16 a[196:197], v243 offset:53248
v_mfma_f32_16x16x32_bf16 v[144:147], a[240:243], v[80:83], v[144:147]
ds_read_b64_tr_b16 a[198:199], v243 offset:55296
buffer_store_dwordx4 v[180:183], v254, s[24:27], s44 offen offset:3072 sc1
v_mfma_f32_16x16x32_bf16 v[148:151], a[240:243], v[112:115], v[148:151]
s_waitcnt lgkmcnt(8)
ds_read_b64_tr_b16 a[208:209], v236 offset:57344
v_mfma_f32_16x16x32_bf16 v[152:155], a[244:247], v[80:83], v[152:155]
ds_read_b64_tr_b16 a[210:211], v236 offset:59392
buffer_load_dwordx4 v252, s[20:23], s57 offen  lds
v_mfma_f32_16x16x32_bf16 v[156:159], a[244:247], v[112:115], v[156:159]
s_waitcnt lgkmcnt(8)
ds_read_b64_tr_b16 a[212:213], v237 offset:57344
s_add_u32 m0, s29, 24576
v_mfma_f32_16x16x32_bf16 v[128:131], a[176:179], v[84:87], v[128:131]
ds_read_b64_tr_b16 a[214:215], v237 offset:59392
v_mfma_f32_16x16x32_bf16 v[132:135], a[176:179], v[116:119], v[132:135]
buffer_load_dwordx4 v252, s[20:23], s58 offen  lds
v_mfma_f32_16x16x32_bf16 v[208:211], a[176:179], a[100:103], v[208:211]
s_waitcnt lgkmcnt(8)
ds_read_b64_tr_b16 a[224:225], v242 offset:57344
v_mfma_f32_16x16x32_bf16 v[136:139], a[180:183], v[84:87], v[136:139]
ds_read_b64_tr_b16 a[226:227], v242 offset:59392
v_mfma_f32_16x16x32_bf16 v[140:143], a[180:183], v[116:119], v[140:143]
s_waitcnt lgkmcnt(8)
ds_read_b64_tr_b16 a[228:229], v243 offset:57344
v_mfma_f32_16x16x32_bf16 v[144:147], a[192:195], v[84:87], v[144:147]
ds_read_b64_tr_b16 a[230:231], v243 offset:59392
v_mfma_f32_16x16x32_bf16 v[148:151], a[192:195], v[116:119], v[148:151]
s_waitcnt lgkmcnt(8)
ds_read_b64_tr_b16 a[240:241], v236 offset:61440
v_mfma_f32_16x16x32_bf16 v[152:155], a[196:199], v[84:87], v[152:155]
ds_read_b64_tr_b16 a[242:243], v236 offset:63488
s_add_u32 m0, s29, 28672
v_mfma_f32_16x16x32_bf16 v[156:159], a[196:199], v[116:119], v[156:159]
s_waitcnt lgkmcnt(8)
ds_read_b64_tr_b16 a[244:245], v237 offset:61440
v_mfma_f32_16x16x32_bf16 v[128:131], a[208:211], v[88:91], v[128:131]
ds_read_b64_tr_b16 a[246:247], v237 offset:63488
v_mfma_f32_16x16x32_bf16 v[132:135], a[208:211], v[120:123], v[132:135]
buffer_load_dwordx4 v252, s[20:23], s59 offen  lds
v_mfma_f32_16x16x32_bf16 v[208:211], a[208:211], a[112:115], v[208:211]
s_waitcnt lgkmcnt(8)
v_mfma_f32_16x16x32_bf16 v[136:139], a[212:215], v[88:91], v[136:139]
v_mfma_f32_16x16x32_bf16 v[140:143], a[212:215], v[120:123], v[140:143]
s_waitcnt lgkmcnt(6)
ds_read_b64_tr_b16 a[212:213], v242 offset:61440
v_mfma_f32_16x16x32_bf16 v[144:147], a[224:227], v[88:91], v[144:147]
ds_read_b64_tr_b16 a[214:215], v242 offset:63488
v_mfma_f32_16x16x32_bf16 v[148:151], a[224:227], v[120:123], v[148:151]
s_waitcnt lgkmcnt(6)
ds_read_b64_tr_b16 a[224:225], v243 offset:61440
v_mfma_f32_16x16x32_bf16 v[152:155], a[228:231], v[88:91], v[152:155]
ds_read_b64_tr_b16 a[226:227], v243 offset:63488
v_mfma_f32_16x16x32_bf16 v[156:159], a[228:231], v[120:123], v[156:159]
s_waitcnt lgkmcnt(6)
ds_read_b64_tr_b16 a[176:177], v238 offset:0
v_mfma_f32_16x16x32_bf16 v[128:131], a[240:243], v[92:95], v[128:131]
ds_read_b64_tr_b16 a[178:179], v238 offset:2048
v_mfma_f32_16x16x32_bf16 v[132:135], a[240:243], v[124:127], v[132:135]
ds_read_b64_tr_b16 a[180:181], v239 offset:0
v_mfma_f32_16x16x32_bf16 v[208:211], a[240:243], a[116:119], v[208:211]
s_waitcnt lgkmcnt(7)
ds_read_b64_tr_b16 a[182:183], v239 offset:2048
v_mfma_f32_16x16x32_bf16 v[136:139], a[244:247], v[92:95], v[136:139]
ds_read_b64_tr_b16 a[192:193], v240 offset:0
v_mfma_f32_16x16x32_bf16 v[140:143], a[244:247], v[124:127], v[140:143]
s_waitcnt lgkmcnt(7)
ds_read_b64_tr_b16 a[194:195], v240 offset:2048
s_add_u32 s44, s44, 16384
v_mfma_f32_16x16x32_bf16 v[144:147], a[212:215], v[92:95], v[144:147]
ds_read_b64_tr_b16 a[196:197], v241 offset:0
s_add_u32 s45, s45, 2048
v_mfma_f32_16x16x32_bf16 v[148:151], a[212:215], v[124:127], v[148:151]
s_waitcnt lgkmcnt(7)
ds_read_b64_tr_b16 a[198:199], v241 offset:2048
v_mfma_f32_16x16x32_bf16 v[152:155], a[224:227], v[92:95], v[152:155]
ds_read_b64_tr_b16 a[208:209], v238 offset:4096
v_mfma_f32_16x16x32_bf16 v[156:159], a[224:227], v[124:127], v[156:159]
ds_read_b64_tr_b16 a[210:211], v238 offset:6144
s_waitcnt vmcnt(10) lgkmcnt(10)
s_barrier
v_add_u32 v253, 256, v253
s_sub_u32 s31, s31, 1
s_cmp_lg_u32 s31, 0
s_cbranch_scc1 L_oloop
s_waitcnt lgkmcnt(0)
s_nop 7
v_cvt_pk_bf16_f32 v128, v128, v129
v_cvt_pk_bf16_f32 v129, v130, v131
v_cvt_pk_bf16_f32 v130, v136, v137
v_cvt_pk_bf16_f32 v131, v138, v139
v_cvt_pk_bf16_f32 v144, v144, v145
v_cvt_pk_bf16_f32 v145, v146, v147
v_cvt_pk_bf16_f32 v146, v152, v153
v_cvt_pk_bf16_f32 v147, v154, v155
v_cvt_pk_bf16_f32 v132, v132, v133
v_cvt_pk_bf16_f32 v133, v134, v135
v_cvt_pk_bf16_f32 v134, v140, v141
v_cvt_pk_bf16_f32 v135, v142, v143
v_cvt_pk_bf16_f32 v148, v148, v149
v_cvt_pk_bf16_f32 v149, v150, v151
v_cvt_pk_bf16_f32 v150, v156, v157
v_cvt_pk_bf16_f32 v151, v158, v159
v_cvt_pk_bf16_f32 v208, v208, v209
v_cvt_pk_bf16_f32 v209, v210, v211
buffer_store_dwordx4 v[128:131], v254, s[24:27], s44 offen offset:0 sc1
buffer_store_dwordx4 v[144:147], v254, s[24:27], s44 offen offset:1024 sc1
buffer_store_dwordx4 v[132:135], v254, s[24:27], s44 offen offset:2048 sc1
buffer_store_dwordx4 v[148:151], v254, s[24:27], s44 offen offset:3072 sc1
buffer_store_dwordx2 v[208:209], v255, s[24:27], s45 offen sc1
s_waitcnt vmcnt(0)
s_endpgm
L_slow:
s_mov_b32 s49, 1
s_cmp_eq_u32 s39, 1
s_cbranch_scc1 L_slow1
v_mov_b32 v160, 0xff800000
v_mov_b32 v161, 0xff800000
v_mov_b32 v162, 0xff800000
v_mov_b32 v163, 0xff800000
v_mov_b32 v164, 0xff800000
s_mov_b32 s30, 0
s_mov_b32 s31, 32
L_smax0:
s_add_u32 m0, s29, 0
s_nop 0
buffer_load_dwordx4 v246, s[12:15], s30 offen offset:0 nt lds
s_add_u32 m0, s29, 3968
s_nop 0
buffer_load_dwordx4 v246, s[12:15], s30 offen offset:128 nt lds
s_add_u32 m0, s29, 7936
s_nop 0
buffer_load_dwordx4 v246, s[12:15], s30 offen offset:256 nt lds
s_add_u32 m0, s29, 11904
s_nop 0
buffer_load_dwordx4 v246, s[12:15], s30 offen offset:384 nt lds
s_waitcnt vmcnt(0)
s_barrier
ds_read_b128 v[220:223], v236 offset:0
ds_read_b128 v[224:227], v242 offset:0
ds_read_b128 v[228:231], v237 offset:0
ds_read_b128 v[232:235], v243 offset:0
ds_read_b128 v[212:215], v236 offset:4096
ds_read_b128 v[216:219], v242 offset:2048
s_waitcnt lgkmcnt(5)
v_mfma_f32_16x16x32_bf16 v[176:179], v[220:223], v[0:3], 0
v_mfma_f32_16x16x32_bf16 v[180:183], v[220:223], v[32:35], 0
v_mfma_f32_16x16x32_bf16 v[184:187], v[220:223], v[64:67], 0
v_mfma_f32_16x16x32_bf16 v[188:191], v[220:223], v[96:99], 0
s_waitcnt lgkmcnt(4)
v_mfma_f32_16x16x32_bf16 v[208:211], v[220:223], v[224:227], 0
s_waitcnt lgkmcnt(3)
ds_read_b128 v[220:223], v237 offset:4096
v_mfma_f32_16x16x32_bf16 v[176:179], v[228:231], v[4:7], v[176:179]
ds_read_b128 v[224:227], v243 offset:2048
v_mfma_f32_16x16x32_bf16 v[180:183], v[228:231], v[36:39], v[180:183]
v_mfma_f32_16x16x32_bf16 v[184:187], v[228:231], v[68:71], v[184:187]
v_mfma_f32_16x16x32_bf16 v[188:191], v[228:231], v[100:103], v[188:191]
s_waitcnt lgkmcnt(2)
v_mfma_f32_16x16x32_bf16 v[208:211], v[228:231], v[232:235], v[208:211]
ds_read_b128 v[228:231], v236 offset:8192
v_mfma_f32_16x16x32_bf16 v[176:179], v[212:215], v[8:11], v[176:179]
ds_read_b128 v[232:235], v242 offset:4096
v_mfma_f32_16x16x32_bf16 v[180:183], v[212:215], v[40:43], v[180:183]
v_mfma_f32_16x16x32_bf16 v[184:187], v[212:215], v[72:75], v[184:187]
v_mfma_f32_16x16x32_bf16 v[188:191], v[212:215], v[104:107], v[188:191]
v_mfma_f32_16x16x32_bf16 v[208:211], v[212:215], v[216:219], v[208:211]
s_waitcnt lgkmcnt(2)
ds_read_b128 v[212:215], v237 offset:8192
v_mfma_f32_16x16x32_bf16 v[176:179], v[220:223], v[12:15], v[176:179]
ds_read_b128 v[216:219], v243 offset:4096
v_mfma_f32_16x16x32_bf16 v[180:183], v[220:223], v[44:47], v[180:183]
v_mfma_f32_16x16x32_bf16 v[184:187], v[220:223], v[76:79], v[184:187]
v_mfma_f32_16x16x32_bf16 v[188:191], v[220:223], v[108:111], v[188:191]
v_mfma_f32_16x16x32_bf16 v[208:211], v[220:223], v[224:227], v[208:211]
s_waitcnt lgkmcnt(2)
ds_read_b128 v[220:223], v236 offset:12288
v_mfma_f32_16x16x32_bf16 v[176:179], v[228:231], v[16:19], v[176:179]
ds_read_b128 v[224:227], v242 offset:6144
v_mfma_f32_16x16x32_bf16 v[180:183], v[228:231], v[48:51], v[180:183]
v_mfma_f32_16x16x32_bf16 v[184:187], v[228:231], v[80:83], v[184:187]
v_mfma_f32_16x16x32_bf16 v[188:191], v[228:231], v[112:115], v[188:191]
v_mfma_f32_16x16x32_bf16 v[208:211], v[228:231], v[232:235], v[208:211]
s_waitcnt lgkmcnt(2)
ds_read_b128 v[228:231], v237 offset:12288
v_mfma_f32_16x16x32_bf16 v[176:179], v[212:215], v[20:23], v[176:179]
ds_read_b128 v[232:235], v243 offset:6144
v_mfma_f32_16x16x32_bf16 v[180:183], v[212:215], v[52:55], v[180:183]
v_mfma_f32_16x16x32_bf16 v[184:187], v[212:215], v[84:87], v[184:187]
v_mfma_f32_16x16x32_bf16 v[188:191], v[212:215], v[116:119], v[188:191]
v_mfma_f32_16x16x32_bf16 v[208:211], v[212:215], v[216:219], v[208:211]
s_waitcnt lgkmcnt(2)
ds_read_b128 v[212:215], v236 offset:2048
v_mfma_f32_16x16x32_bf16 v[176:179], v[220:223], v[24:27], v[176:179]
ds_read_b128 v[216:219], v237 offset:2048
v_mfma_f32_16x16x32_bf16 v[180:183], v[220:223], v[56:59], v[180:183]
v_mfma_f32_16x16x32_bf16 v[184:187], v[220:223], v[88:91], v[184:187]
v_mfma_f32_16x16x32_bf16 v[188:191], v[220:223], v[120:123], v[188:191]
v_mfma_f32_16x16x32_bf16 v[208:211], v[220:223], v[224:227], v[208:211]
s_waitcnt lgkmcnt(2)
ds_read_b128 v[220:223], v236 offset:6144
v_mfma_f32_16x16x32_bf16 v[176:179], v[228:231], v[28:31], v[176:179]
v_mfma_f32_16x16x32_bf16 v[180:183], v[228:231], v[60:63], v[180:183]
ds_read_b128 v[224:227], v237 offset:6144
v_mfma_f32_16x16x32_bf16 v[184:187], v[228:231], v[92:95], v[184:187]
v_mfma_f32_16x16x32_bf16 v[188:191], v[228:231], v[124:127], v[188:191]
v_mfma_f32_16x16x32_bf16 v[208:211], v[228:231], v[232:235], v[208:211]
s_waitcnt lgkmcnt(2)
v_mfma_f32_16x16x32_bf16 v[192:195], v[212:215], v[0:3], 0
ds_read_b128 v[228:231], v236 offset:10240
v_mfma_f32_16x16x32_bf16 v[196:199], v[212:215], v[32:35], 0
v_mfma_f32_16x16x32_bf16 v[200:203], v[212:215], v[64:67], 0
v_mfma_f32_16x16x32_bf16 v[204:207], v[212:215], v[96:99], 0
v_mfma_f32_16x16x32_bf16 v[192:195], v[216:219], v[4:7], v[192:195]
ds_read_b128 v[232:235], v237 offset:10240
v_mfma_f32_16x16x32_bf16 v[196:199], v[216:219], v[36:39], v[196:199]
v_mfma_f32_16x16x32_bf16 v[200:203], v[216:219], v[68:71], v[200:203]
v_mfma_f32_16x16x32_bf16 v[204:207], v[216:219], v[100:103], v[204:207]
s_waitcnt lgkmcnt(1)
v_mfma_f32_16x16x32_bf16 v[192:195], v[220:223], v[8:11], v[192:195]
ds_read_b128 v[212:215], v236 offset:14336
v_mfma_f32_16x16x32_bf16 v[196:199], v[220:223], v[40:43], v[196:199]
v_mfma_f32_16x16x32_bf16 v[200:203], v[220:223], v[72:75], v[200:203]
v_mfma_f32_16x16x32_bf16 v[204:207], v[220:223], v[104:107], v[204:207]
v_mfma_f32_16x16x32_bf16 v[192:195], v[224:227], v[12:15], v[192:195]
ds_read_b128 v[216:219], v237 offset:14336
v_mfma_f32_16x16x32_bf16 v[196:199], v[224:227], v[44:47], v[196:199]
v_mfma_f32_16x16x32_bf16 v[200:203], v[224:227], v[76:79], v[200:203]
v_mfma_f32_16x16x32_bf16 v[204:207], v[224:227], v[108:111], v[204:207]
v_mfma_f32_16x16x32_bf16 v[192:195], v[228:231], v[16:19], v[192:195]
v_mfma_f32_16x16x32_bf16 v[196:199], v[228:231], v[48:51], v[196:199]
v_mfma_f32_16x16x32_bf16 v[200:203], v[228:231], v[80:83], v[200:203]
v_mfma_f32_16x16x32_bf16 v[204:207], v[228:231], v[112:115], v[204:207]
s_waitcnt lgkmcnt(0)
v_mfma_f32_16x16x32_bf16 v[192:195], v[232:235], v[20:23], v[192:195]
v_mfma_f32_16x16x32_bf16 v[196:199], v[232:235], v[52:55], v[196:199]
v_mfma_f32_16x16x32_bf16 v[200:203], v[232:235], v[84:87], v[200:203]
v_mfma_f32_16x16x32_bf16 v[204:207], v[232:235], v[116:119], v[204:207]
v_mfma_f32_16x16x32_bf16 v[192:195], v[212:215], v[24:27], v[192:195]
v_mfma_f32_16x16x32_bf16 v[196:199], v[212:215], v[56:59], v[196:199]
v_mfma_f32_16x16x32_bf16 v[200:203], v[212:215], v[88:91], v[200:203]
v_mfma_f32_16x16x32_bf16 v[204:207], v[212:215], v[120:123], v[204:207]
v_mfma_f32_16x16x32_bf16 v[192:195], v[216:219], v[28:31], v[192:195]
v_mfma_f32_16x16x32_bf16 v[196:199], v[216:219], v[60:63], v[196:199]
v_mfma_f32_16x16x32_bf16 v[200:203], v[216:219], v[92:95], v[200:203]
v_mfma_f32_16x16x32_bf16 v[204:207], v[216:219], v[124:127], v[204:207]
s_nop 7
v_max3_f32 v160, v160, v176, v177
v_max3_f32 v160, v160, v178, v179
v_max3_f32 v160, v160, v192, v193
v_max3_f32 v160, v160, v194, v195
v_max3_f32 v161, v161, v180, v181
v_max3_f32 v161, v161, v182, v183
v_max3_f32 v161, v161, v196, v197
v_max3_f32 v161, v161, v198, v199
v_max3_f32 v162, v162, v184, v185
v_max3_f32 v162, v162, v186, v187
v_max3_f32 v162, v162, v200, v201
v_max3_f32 v162, v162, v202, v203
v_max3_f32 v163, v163, v188, v189
v_max3_f32 v163, v163, v190, v191
v_max3_f32 v163, v163, v204, v205
v_max3_f32 v163, v163, v206, v207
v_max3_f32 v164, v164, v208, v209
v_max3_f32 v164, v164, v210, v211
s_waitcnt lgkmcnt(0)
s_barrier
s_add_u32 s30, s30, 16384
s_sub_u32 s31, s31, 1
s_cmp_lg_u32 s31, 0
s_cbranch_scc1 L_smax0
v_mov_b32 v165, v160
s_nop 1
v_permlane32_swap_b32 v165, v160
s_nop 1
v_max_f32 v160, v160, v165
v_mov_b32 v165, v160
s_nop 1
v_permlane16_swap_b32 v165, v160
s_nop 1
v_max_f32 v160, v160, v165
v_mov_b32 v165, v161
s_nop 1
v_permlane32_swap_b32 v165, v161
s_nop 1
v_max_f32 v161, v161, v165
v_mov_b32 v165, v161
s_nop 1
v_permlane16_swap_b32 v165, v161
s_nop 1
v_max_f32 v161, v161, v165
v_mov_b32 v165, v162
s_nop 1
v_permlane32_swap_b32 v165, v162
s_nop 1
v_max_f32 v162, v162, v165
v_mov_b32 v165, v162
s_nop 1
v_permlane16_swap_b32 v165, v162
s_nop 1
v_max_f32 v162, v162, v165
v_mov_b32 v165, v163
s_nop 1
v_permlane32_swap_b32 v165, v163
s_nop 1
v_max_f32 v163, v163, v165
v_mov_b32 v165, v163
s_nop 1
v_permlane16_swap_b32 v165, v163
s_nop 1
v_max_f32 v163, v163, v165
v_mov_b32 v165, v164
s_nop 1
v_permlane32_swap_b32 v165, v164
s_nop 1
v_max_f32 v164, v164, v165
v_mov_b32 v165, v164
s_nop 1
v_permlane16_swap_b32 v165, v164
s_nop 1
v_max_f32 v164, v164, v165
v_mbcnt_lo_u32_b32 v165, -1, 0
v_mbcnt_hi_u32_b32 v165, -1, v165
v_lshlrev_b32 v165, 2, v165
s_lshl_b32 s33, s28, 8
s_add_u32 s33, s33, 151552
v_add_u32 v166, s33, v165
s_xor_b32 s33, s28, 1
s_lshl_b32 s33, s33, 8
s_add_u32 s33, s33, 151552
v_add_u32 v167, s33, v165
ds_write_b32 v166, v164
s_waitcnt lgkmcnt(0)
s_barrier
ds_read_b32 v168, v167
s_waitcnt lgkmcnt(0)
v_max_f32 v164, v164, v168
v_accvgpr_write_b32 a0, 0
v_accvgpr_write_b32 a1, 0
v_accvgpr_write_b32 a2, 0
v_accvgpr_write_b32 a3, 0
v_accvgpr_write_b32 a4, 0
v_accvgpr_write_b32 a5, 0
v_accvgpr_write_b32 a6, 0
v_accvgpr_write_b32 a7, 0
v_accvgpr_write_b32 a8, 0
v_accvgpr_write_b32 a9, 0
v_accvgpr_write_b32 a10, 0
v_accvgpr_write_b32 a11, 0
v_accvgpr_write_b32 a12, 0
v_accvgpr_write_b32 a13, 0
v_accvgpr_write_b32 a14, 0
v_accvgpr_write_b32 a15, 0
v_accvgpr_write_b32 a16, 0
v_accvgpr_write_b32 a17, 0
v_accvgpr_write_b32 a18, 0
v_accvgpr_write_b32 a19, 0
v_accvgpr_write_b32 a20, 0
v_accvgpr_write_b32 a21, 0
v_accvgpr_write_b32 a22, 0
v_accvgpr_write_b32 a23, 0
v_accvgpr_write_b32 a24, 0
v_accvgpr_write_b32 a25, 0
v_accvgpr_write_b32 a26, 0
v_accvgpr_write_b32 a27, 0
v_accvgpr_write_b32 a28, 0
v_accvgpr_write_b32 a29, 0
v_accvgpr_write_b32 a30, 0
v_accvgpr_write_b32 a31, 0
v_accvgpr_write_b32 a32, 0
v_accvgpr_write_b32 a33, 0
v_accvgpr_write_b32 a34, 0
v_accvgpr_write_b32 a35, 0
v_accvgpr_write_b32 a36, 0
v_accvgpr_write_b32 a37, 0
v_accvgpr_write_b32 a38, 0
v_accvgpr_write_b32 a39, 0
v_accvgpr_write_b32 a40, 0
v_accvgpr_write_b32 a41, 0
v_accvgpr_write_b32 a42, 0
v_accvgpr_write_b32 a43, 0
v_accvgpr_write_b32 a44, 0
v_accvgpr_write_b32 a45, 0
v_accvgpr_write_b32 a46, 0
v_accvgpr_write_b32 a47, 0
v_accvgpr_write_b32 a48, 0
v_accvgpr_write_b32 a49, 0
v_accvgpr_write_b32 a50, 0
v_accvgpr_write_b32 a51, 0
v_accvgpr_write_b32 a52, 0
v_accvgpr_write_b32 a53, 0
v_accvgpr_write_b32 a54, 0
v_accvgpr_write_b32 a55, 0
v_accvgpr_write_b32 a56, 0
v_accvgpr_write_b32 a57, 0
v_accvgpr_write_b32 a58, 0
v_accvgpr_write_b32 a59, 0
v_accvgpr_write_b32 a60, 0
v_accvgpr_write_b32 a61, 0
v_accvgpr_write_b32 a62, 0
v_accvgpr_write_b32 a63, 0
v_accvgpr_write_b32 a64, 0
v_accvgpr_write_b32 a65, 0
v_accvgpr_write_b32 a66, 0
v_accvgpr_write_b32 a67, 0
v_accvgpr_write_b32 a68, 0
v_accvgpr_write_b32 a69, 0
v_accvgpr_write_b32 a70, 0
v_accvgpr_write_b32 a71, 0
v_accvgpr_write_b32 a72, 0
v_accvgpr_write_b32 a73, 0
v_accvgpr_write_b32 a74, 0
v_accvgpr_write_b32 a75, 0
v_accvgpr_write_b32 a76, 0
v_accvgpr_write_b32 a77, 0
v_accvgpr_write_b32 a78, 0
v_accvgpr_write_b32 a79, 0
v_accvgpr_write_b32 a80, 0
v_accvgpr_write_b32 a81, 0
v_accvgpr_write_b32 a82, 0
v_accvgpr_write_b32 a83, 0
v_accvgpr_write_b32 a84, 0
v_accvgpr_write_b32 a85, 0
v_accvgpr_write_b32 a86, 0
v_accvgpr_write_b32 a87, 0
v_accvgpr_write_b32 a88, 0
v_accvgpr_write_b32 a89, 0
v_accvgpr_write_b32 a90, 0
v_accvgpr_write_b32 a91, 0
v_accvgpr_write_b32 a92, 0
v_accvgpr_write_b32 a93, 0
v_accvgpr_write_b32 a94, 0
v_accvgpr_write_b32 a95, 0
v_accvgpr_write_b32 a96, 0
v_accvgpr_write_b32 a97, 0
v_accvgpr_write_b32 a98, 0
v_accvgpr_write_b32 a99, 0
v_accvgpr_write_b32 a100, 0
v_accvgpr_write_b32 a101, 0
v_accvgpr_write_b32 a102, 0
v_accvgpr_write_b32 a103, 0
v_accvgpr_write_b32 a104, 0
v_accvgpr_write_b32 a105, 0
v_accvgpr_write_b32 a106, 0
v_accvgpr_write_b32 a107, 0
v_accvgpr_write_b32 a108, 0
v_accvgpr_write_b32 a109, 0
v_accvgpr_write_b32 a110, 0
v_accvgpr_write_b32 a111, 0
v_accvgpr_write_b32 a112, 0
v_accvgpr_write_b32 a113, 0
v_accvgpr_write_b32 a114, 0
v_accvgpr_write_b32 a115, 0
v_accvgpr_write_b32 a116, 0
v_accvgpr_write_b32 a117, 0
v_accvgpr_write_b32 a118, 0
v_accvgpr_write_b32 a119, 0
v_accvgpr_write_b32 a120, 0
v_accvgpr_write_b32 a121, 0
v_accvgpr_write_b32 a122, 0
v_accvgpr_write_b32 a123, 0
v_accvgpr_write_b32 a124, 0
v_accvgpr_write_b32 a125, 0
v_accvgpr_write_b32 a126, 0
v_accvgpr_write_b32 a127, 0
v_accvgpr_write_b32 a128, 0
v_accvgpr_write_b32 a129, 0
v_accvgpr_write_b32 a130, 0
v_accvgpr_write_b32 a131, 0
v_accvgpr_write_b32 a132, 0
v_accvgpr_write_b32 a133, 0
v_accvgpr_write_b32 a134, 0
v_accvgpr_write_b32 a135, 0
v_accvgpr_write_b32 a136, 0
v_accvgpr_write_b32 a137, 0
v_accvgpr_write_b32 a138, 0
v_accvgpr_write_b32 a139, 0
v_accvgpr_write_b32 a140, 0
v_accvgpr_write_b32 a141, 0
v_accvgpr_write_b32 a142, 0
v_accvgpr_write_b32 a143, 0
v_accvgpr_write_b32 a144, 0
v_accvgpr_write_b32 a145, 0
v_accvgpr_write_b32 a146, 0
v_accvgpr_write_b32 a147, 0
v_accvgpr_write_b32 a148, 0
v_accvgpr_write_b32 a149, 0
v_accvgpr_write_b32 a150, 0
v_accvgpr_write_b32 a151, 0
v_accvgpr_write_b32 a152, 0
v_accvgpr_write_b32 a153, 0
v_accvgpr_write_b32 a154, 0
v_accvgpr_write_b32 a155, 0
v_accvgpr_write_b32 a156, 0
v_accvgpr_write_b32 a157, 0
v_accvgpr_write_b32 a158, 0
v_accvgpr_write_b32 a159, 0
v_accvgpr_write_b32 a160, 0
v_accvgpr_write_b32 a161, 0
v_accvgpr_write_b32 a162, 0
v_accvgpr_write_b32 a163, 0
v_accvgpr_write_b32 a164, 0
v_accvgpr_write_b32 a165, 0
v_accvgpr_write_b32 a166, 0
v_accvgpr_write_b32 a167, 0
v_accvgpr_write_b32 a168, 0
v_accvgpr_write_b32 a169, 0
v_accvgpr_write_b32 a170, 0
v_accvgpr_write_b32 a171, 0
v_accvgpr_write_b32 a172, 0
v_accvgpr_write_b32 a173, 0
v_accvgpr_write_b32 a174, 0
v_accvgpr_write_b32 a175, 0
v_accvgpr_write_b32 a176, 0
v_accvgpr_write_b32 a177, 0
v_accvgpr_write_b32 a178, 0
v_accvgpr_write_b32 a179, 0
v_accvgpr_write_b32 a180, 0
v_accvgpr_write_b32 a181, 0
v_accvgpr_write_b32 a182, 0
v_accvgpr_write_b32 a183, 0
v_accvgpr_write_b32 a184, 0
v_accvgpr_write_b32 a185, 0
v_accvgpr_write_b32 a186, 0
v_accvgpr_write_b32 a187, 0
v_accvgpr_write_b32 a188, 0
v_accvgpr_write_b32 a189, 0
v_accvgpr_write_b32 a190, 0
v_accvgpr_write_b32 a191, 0
v_accvgpr_write_b32 a192, 0
v_accvgpr_write_b32 a193, 0
v_accvgpr_write_b32 a194, 0
v_accvgpr_write_b32 a195, 0
v_accvgpr_write_b32 a196, 0
v_accvgpr_write_b32 a197, 0
v_accvgpr_write_b32 a198, 0
v_accvgpr_write_b32 a199, 0
v_accvgpr_write_b32 a200, 0
v_accvgpr_write_b32 a201, 0
v_accvgpr_write_b32 a202, 0
v_accvgpr_write_b32 a203, 0
v_accvgpr_write_b32 a204, 0
v_accvgpr_write_b32 a205, 0
v_accvgpr_write_b32 a206, 0
v_accvgpr_write_b32 a207, 0
v_accvgpr_write_b32 a208, 0
v_accvgpr_write_b32 a209, 0
v_accvgpr_write_b32 a210, 0
v_accvgpr_write_b32 a211, 0
v_accvgpr_write_b32 a212, 0
v_accvgpr_write_b32 a213, 0
v_accvgpr_write_b32 a214, 0
v_accvgpr_write_b32 a215, 0
v_accvgpr_write_b32 a216, 0
v_accvgpr_write_b32 a217, 0
v_accvgpr_write_b32 a218, 0
v_accvgpr_write_b32 a219, 0
v_accvgpr_write_b32 a220, 0
v_accvgpr_write_b32 a221, 0
v_accvgpr_write_b32 a222, 0
v_accvgpr_write_b32 a223, 0
v_accvgpr_write_b32 a224, 0
v_accvgpr_write_b32 a225, 0
v_accvgpr_write_b32 a226, 0
v_accvgpr_write_b32 a227, 0
v_accvgpr_write_b32 a228, 0
v_accvgpr_write_b32 a229, 0
v_accvgpr_write_b32 a230, 0
v_accvgpr_write_b32 a231, 0
v_accvgpr_write_b32 a232, 0
v_accvgpr_write_b32 a233, 0
v_accvgpr_write_b32 a234, 0
v_accvgpr_write_b32 a235, 0
v_accvgpr_write_b32 a236, 0
v_accvgpr_write_b32 a237, 0
v_accvgpr_write_b32 a238, 0
v_accvgpr_write_b32 a239, 0
v_accvgpr_write_b32 a240, 0
v_accvgpr_write_b32 a241, 0
v_accvgpr_write_b32 a242, 0
v_accvgpr_write_b32 a243, 0
v_accvgpr_write_b32 a244, 0
v_accvgpr_write_b32 a245, 0
v_accvgpr_write_b32 a246, 0
v_accvgpr_write_b32 a247, 0
v_accvgpr_write_b32 a248, 0
v_accvgpr_write_b32 a249, 0
v_accvgpr_write_b32 a250, 0
v_accvgpr_write_b32 a251, 0
v_accvgpr_write_b32 a252, 0
v_accvgpr_write_b32 a253, 0
v_accvgpr_write_b32 a254, 0
v_accvgpr_write_b32 a255, 0
v_mov_b32 v128, 0
v_mov_b32 v129, 0
v_mov_b32 v130, 0
v_mov_b32 v131, 0
v_mov_b32 v132, 0
v_mov_b32 v133, 0
v_mov_b32 v134, 0
v_mov_b32 v135, 0
v_mov_b32 v136, 0
v_mov_b32 v137, 0
v_mov_b32 v138, 0
v_mov_b32 v139, 0
v_mov_b32 v140, 0
v_mov_b32 v141, 0
v_mov_b32 v142, 0
v_mov_b32 v143, 0
v_mov_b32 v144, 0
v_mov_b32 v145, 0
v_mov_b32 v146, 0
v_mov_b32 v147, 0
v_mov_b32 v148, 0
v_mov_b32 v149, 0
v_mov_b32 v150, 0
v_mov_b32 v151, 0
v_mov_b32 v152, 0
v_mov_b32 v153, 0
v_mov_b32 v154, 0
v_mov_b32 v155, 0
v_mov_b32 v156, 0
v_mov_b32 v157, 0
v_mov_b32 v158, 0
v_mov_b32 v159, 0
v_mov_b32 v248, 0
v_mov_b32 v249, 0
v_mov_b32 v250, 0
v_mov_b32 v251, 0
v_mov_b32 v252, 0
s_mov_b32 s30, 0
s_mov_b32 s31, 32
L_sloop0:
s_add_u32 s36, s30, 16384
s_add_u32 m0, s29, 0
s_nop 0
buffer_load_dwordx4 v246, s[12:15], s30 offen offset:0 nt lds
s_add_u32 m0, s29, 3968
s_nop 0
buffer_load_dwordx4 v246, s[12:15], s30 offen offset:128 nt lds
s_add_u32 m0, s29, 7936
s_nop 0
buffer_load_dwordx4 v246, s[12:15], s30 offen offset:256 nt lds
s_add_u32 m0, s29, 11904
s_nop 0
buffer_load_dwordx4 v246, s[12:15], s30 offen offset:384 nt lds
s_add_u32 m0, s29, 98304
s_nop 0
buffer_load_dwordx4 v247, s[16:19], s36 offen offset:0 nt lds
s_add_u32 m0, s29, 102272
s_nop 0
buffer_load_dwordx4 v247, s[16:19], s36 offen offset:128 nt lds
s_add_u32 m0, s29, 106240
s_nop 0
buffer_load_dwordx4 v247, s[16:19], s36 offen offset:256 nt lds
s_add_u32 m0, s29, 110208
s_nop 0
buffer_load_dwordx4 v247, s[16:19], s36 offen offset:384 nt lds
s_waitcnt vmcnt(0)
s_barrier
ds_read_b128 v[220:223], v236 offset:0
ds_read_b128 v[224:227], v242 offset:0
ds_read_b128 v[228:231], v237 offset:0
ds_read_b128 v[232:235], v243 offset:0
ds_read_b128 v[212:215], v236 offset:4096
ds_read_b128 v[216:219], v242 offset:2048
s_waitcnt lgkmcnt(5)
v_mfma_f32_16x16x32_bf16 v[176:179], v[220:223], v[0:3], 0
v_mfma_f32_16x16x32_bf16 v[180:183], v[220:223], v[32:35], 0
v_mfma_f32_16x16x32_bf16 v[184:187], v[220:223], v[64:67], 0
v_mfma_f32_16x16x32_bf16 v[188:191], v[220:223], v[96:99], 0
s_waitcnt lgkmcnt(4)
v_mfma_f32_16x16x32_bf16 v[208:211], v[220:223], v[224:227], 0
s_waitcnt lgkmcnt(3)
ds_read_b128 v[220:223], v237 offset:4096
v_mfma_f32_16x16x32_bf16 v[176:179], v[228:231], v[4:7], v[176:179]
ds_read_b128 v[224:227], v243 offset:2048
v_mfma_f32_16x16x32_bf16 v[180:183], v[228:231], v[36:39], v[180:183]
v_mfma_f32_16x16x32_bf16 v[184:187], v[228:231], v[68:71], v[184:187]
v_mfma_f32_16x16x32_bf16 v[188:191], v[228:231], v[100:103], v[188:191]
s_waitcnt lgkmcnt(2)
v_mfma_f32_16x16x32_bf16 v[208:211], v[228:231], v[232:235], v[208:211]
ds_read_b128 v[228:231], v236 offset:8192
v_mfma_f32_16x16x32_bf16 v[176:179], v[212:215], v[8:11], v[176:179]
ds_read_b128 v[232:235], v242 offset:4096
v_mfma_f32_16x16x32_bf16 v[180:183], v[212:215], v[40:43], v[180:183]
v_mfma_f32_16x16x32_bf16 v[184:187], v[212:215], v[72:75], v[184:187]
v_mfma_f32_16x16x32_bf16 v[188:191], v[212:215], v[104:107], v[188:191]
v_mfma_f32_16x16x32_bf16 v[208:211], v[212:215], v[216:219], v[208:211]
s_waitcnt lgkmcnt(2)
ds_read_b128 v[212:215], v237 offset:8192
v_mfma_f32_16x16x32_bf16 v[176:179], v[220:223], v[12:15], v[176:179]
ds_read_b128 v[216:219], v243 offset:4096
v_mfma_f32_16x16x32_bf16 v[180:183], v[220:223], v[44:47], v[180:183]
v_mfma_f32_16x16x32_bf16 v[184:187], v[220:223], v[76:79], v[184:187]
v_mfma_f32_16x16x32_bf16 v[188:191], v[220:223], v[108:111], v[188:191]
v_mfma_f32_16x16x32_bf16 v[208:211], v[220:223], v[224:227], v[208:211]
s_waitcnt lgkmcnt(2)
ds_read_b128 v[220:223], v236 offset:12288
v_mfma_f32_16x16x32_bf16 v[176:179], v[228:231], v[16:19], v[176:179]
ds_read_b128 v[224:227], v242 offset:6144
v_mfma_f32_16x16x32_bf16 v[180:183], v[228:231], v[48:51], v[180:183]
v_mfma_f32_16x16x32_bf16 v[184:187], v[228:231], v[80:83], v[184:187]
v_mfma_f32_16x16x32_bf16 v[188:191], v[228:231], v[112:115], v[188:191]
v_mfma_f32_16x16x32_bf16 v[208:211], v[228:231], v[232:235], v[208:211]
s_waitcnt lgkmcnt(2)
ds_read_b128 v[228:231], v237 offset:12288
v_mfma_f32_16x16x32_bf16 v[176:179], v[212:215], v[20:23], v[176:179]
ds_read_b128 v[232:235], v243 offset:6144
v_mfma_f32_16x16x32_bf16 v[180:183], v[212:215], v[52:55], v[180:183]
v_mfma_f32_16x16x32_bf16 v[184:187], v[212:215], v[84:87], v[184:187]
v_mfma_f32_16x16x32_bf16 v[188:191], v[212:215], v[116:119], v[188:191]
v_mfma_f32_16x16x32_bf16 v[208:211], v[212:215], v[216:219], v[208:211]
s_waitcnt lgkmcnt(2)
ds_read_b128 v[212:215], v236 offset:2048
v_mfma_f32_16x16x32_bf16 v[176:179], v[220:223], v[24:27], v[176:179]
ds_read_b128 v[216:219], v237 offset:2048
v_mfma_f32_16x16x32_bf16 v[180:183], v[220:223], v[56:59], v[180:183]
v_mfma_f32_16x16x32_bf16 v[184:187], v[220:223], v[88:91], v[184:187]
v_mfma_f32_16x16x32_bf16 v[188:191], v[220:223], v[120:123], v[188:191]
v_mfma_f32_16x16x32_bf16 v[208:211], v[220:223], v[224:227], v[208:211]
s_waitcnt lgkmcnt(2)
ds_read_b128 v[220:223], v236 offset:6144
v_mfma_f32_16x16x32_bf16 v[176:179], v[228:231], v[28:31], v[176:179]
v_mfma_f32_16x16x32_bf16 v[180:183], v[228:231], v[60:63], v[180:183]
ds_read_b128 v[224:227], v237 offset:6144
v_mfma_f32_16x16x32_bf16 v[184:187], v[228:231], v[92:95], v[184:187]
v_mfma_f32_16x16x32_bf16 v[188:191], v[228:231], v[124:127], v[188:191]
v_mfma_f32_16x16x32_bf16 v[208:211], v[228:231], v[232:235], v[208:211]
s_waitcnt lgkmcnt(2)
v_mfma_f32_16x16x32_bf16 v[192:195], v[212:215], v[0:3], 0
ds_read_b128 v[228:231], v236 offset:10240
v_mfma_f32_16x16x32_bf16 v[196:199], v[212:215], v[32:35], 0
v_mfma_f32_16x16x32_bf16 v[200:203], v[212:215], v[64:67], 0
v_mfma_f32_16x16x32_bf16 v[204:207], v[212:215], v[96:99], 0
v_mfma_f32_16x16x32_bf16 v[192:195], v[216:219], v[4:7], v[192:195]
ds_read_b128 v[232:235], v237 offset:10240
v_mfma_f32_16x16x32_bf16 v[196:199], v[216:219], v[36:39], v[196:199]
v_mfma_f32_16x16x32_bf16 v[200:203], v[216:219], v[68:71], v[200:203]
v_mfma_f32_16x16x32_bf16 v[204:207], v[216:219], v[100:103], v[204:207]
s_waitcnt lgkmcnt(1)
v_mfma_f32_16x16x32_bf16 v[192:195], v[220:223], v[8:11], v[192:195]
ds_read_b128 v[212:215], v236 offset:14336
v_mfma_f32_16x16x32_bf16 v[196:199], v[220:223], v[40:43], v[196:199]
v_mfma_f32_16x16x32_bf16 v[200:203], v[220:223], v[72:75], v[200:203]
v_mfma_f32_16x16x32_bf16 v[204:207], v[220:223], v[104:107], v[204:207]
v_mfma_f32_16x16x32_bf16 v[192:195], v[224:227], v[12:15], v[192:195]
ds_read_b128 v[216:219], v237 offset:14336
v_mfma_f32_16x16x32_bf16 v[196:199], v[224:227], v[44:47], v[196:199]
v_mfma_f32_16x16x32_bf16 v[200:203], v[224:227], v[76:79], v[200:203]
v_mfma_f32_16x16x32_bf16 v[204:207], v[224:227], v[108:111], v[204:207]
v_mfma_f32_16x16x32_bf16 v[192:195], v[228:231], v[16:19], v[192:195]
v_mfma_f32_16x16x32_bf16 v[196:199], v[228:231], v[48:51], v[196:199]
v_mfma_f32_16x16x32_bf16 v[200:203], v[228:231], v[80:83], v[200:203]
v_mfma_f32_16x16x32_bf16 v[204:207], v[228:231], v[112:115], v[204:207]
s_waitcnt lgkmcnt(0)
v_mfma_f32_16x16x32_bf16 v[192:195], v[232:235], v[20:23], v[192:195]
v_mfma_f32_16x16x32_bf16 v[196:199], v[232:235], v[52:55], v[196:199]
v_mfma_f32_16x16x32_bf16 v[200:203], v[232:235], v[84:87], v[200:203]
v_mfma_f32_16x16x32_bf16 v[204:207], v[232:235], v[116:119], v[204:207]
v_mfma_f32_16x16x32_bf16 v[192:195], v[212:215], v[24:27], v[192:195]
v_mfma_f32_16x16x32_bf16 v[196:199], v[212:215], v[56:59], v[196:199]
v_mfma_f32_16x16x32_bf16 v[200:203], v[212:215], v[88:91], v[200:203]
v_mfma_f32_16x16x32_bf16 v[204:207], v[212:215], v[120:123], v[204:207]
v_mfma_f32_16x16x32_bf16 v[192:195], v[216:219], v[28:31], v[192:195]
v_mfma_f32_16x16x32_bf16 v[196:199], v[216:219], v[60:63], v[196:199]
v_mfma_f32_16x16x32_bf16 v[200:203], v[216:219], v[92:95], v[200:203]
v_mfma_f32_16x16x32_bf16 v[204:207], v[216:219], v[124:127], v[204:207]
s_nop 7
v_sub_f32 v176, v176, v160
v_sub_f32 v177, v177, v160
v_sub_f32 v178, v178, v160
v_sub_f32 v179, v179, v160
v_exp_f32 v176, v176
v_exp_f32 v177, v177
v_exp_f32 v178, v178
v_exp_f32 v179, v179
s_nop 0
v_add_f32 v248, v248, v176
v_add_f32 v248, v248, v177
v_add_f32 v248, v248, v178
v_add_f32 v248, v248, v179
v_cvt_pk_bf16_f32 v176, v176, v177
v_cvt_pk_bf16_f32 v177, v178, v179
v_sub_f32 v192, v192, v160
v_sub_f32 v193, v193, v160
v_sub_f32 v194, v194, v160
v_sub_f32 v195, v195, v160
v_exp_f32 v192, v192
v_exp_f32 v193, v193
v_exp_f32 v194, v194
v_exp_f32 v195, v195
s_nop 0
v_add_f32 v248, v248, v192
v_add_f32 v248, v248, v193
v_add_f32 v248, v248, v194
v_add_f32 v248, v248, v195
v_cvt_pk_bf16_f32 v178, v192, v193
v_cvt_pk_bf16_f32 v179, v194, v195
v_sub_f32 v180, v180, v161
v_sub_f32 v181, v181, v161
v_sub_f32 v182, v182, v161
v_sub_f32 v183, v183, v161
v_exp_f32 v180, v180
v_exp_f32 v181, v181
v_exp_f32 v182, v182
v_exp_f32 v183, v183
s_nop 0
v_add_f32 v249, v249, v180
v_add_f32 v249, v249, v181
v_add_f32 v249, v249, v182
v_add_f32 v249, v249, v183
v_cvt_pk_bf16_f32 v180, v180, v181
v_cvt_pk_bf16_f32 v181, v182, v183
v_sub_f32 v196, v196, v161
v_sub_f32 v197, v197, v161
v_sub_f32 v198, v198, v161
v_sub_f32 v199, v199, v161
v_exp_f32 v196, v196
v_exp_f32 v197, v197
v_exp_f32 v198, v198
v_exp_f32 v199, v199
s_nop 0
v_add_f32 v249, v249, v196
v_add_f32 v249, v249, v197
v_add_f32 v249, v249, v198
v_add_f32 v249, v249, v199
v_cvt_pk_bf16_f32 v182, v196, v197
v_cvt_pk_bf16_f32 v183, v198, v199
v_sub_f32 v184, v184, v162
v_sub_f32 v185, v185, v162
v_sub_f32 v186, v186, v162
v_sub_f32 v187, v187, v162
v_exp_f32 v184, v184
v_exp_f32 v185, v185
v_exp_f32 v186, v186
v_exp_f32 v187, v187
s_nop 0
v_add_f32 v250, v250, v184
v_add_f32 v250, v250, v185
v_add_f32 v250, v250, v186
v_add_f32 v250, v250, v187
v_cvt_pk_bf16_f32 v184, v184, v185
v_cvt_pk_bf16_f32 v185, v186, v187
v_sub_f32 v200, v200, v162
v_sub_f32 v201, v201, v162
v_sub_f32 v202, v202, v162
v_sub_f32 v203, v203, v162
v_exp_f32 v200, v200
v_exp_f32 v201, v201
v_exp_f32 v202, v202
v_exp_f32 v203, v203
s_nop 0
v_add_f32 v250, v250, v200
v_add_f32 v250, v250, v201
v_add_f32 v250, v250, v202
v_add_f32 v250, v250, v203
v_cvt_pk_bf16_f32 v186, v200, v201
v_cvt_pk_bf16_f32 v187, v202, v203
v_sub_f32 v188, v188, v163
v_sub_f32 v189, v189, v163
v_sub_f32 v190, v190, v163
v_sub_f32 v191, v191, v163
v_exp_f32 v188, v188
v_exp_f32 v189, v189
v_exp_f32 v190, v190
v_exp_f32 v191, v191
s_nop 0
v_add_f32 v251, v251, v188
v_add_f32 v251, v251, v189
v_add_f32 v251, v251, v190
v_add_f32 v251, v251, v191
v_cvt_pk_bf16_f32 v188, v188, v189
v_cvt_pk_bf16_f32 v189, v190, v191
v_sub_f32 v204, v204, v163
v_sub_f32 v205, v205, v163
v_sub_f32 v206, v206, v163
v_sub_f32 v207, v207, v163
v_exp_f32 v204, v204
v_exp_f32 v205, v205
v_exp_f32 v206, v206
v_exp_f32 v207, v207
s_nop 0
v_add_f32 v251, v251, v204
v_add_f32 v251, v251, v205
v_add_f32 v251, v251, v206
v_add_f32 v251, v251, v207
v_cvt_pk_bf16_f32 v190, v204, v205
v_cvt_pk_bf16_f32 v191, v206, v207
v_sub_f32 v208, v208, v164
v_sub_f32 v209, v209, v164
v_sub_f32 v210, v210, v164
v_sub_f32 v211, v211, v164
v_exp_f32 v208, v208
v_exp_f32 v209, v209
v_exp_f32 v210, v210
v_exp_f32 v211, v211
s_nop 0
v_add_f32 v252, v252, v208
v_add_f32 v252, v252, v209
v_add_f32 v252, v252, v210
v_add_f32 v252, v252, v211
v_cvt_pk_bf16_f32 v208, v208, v209
v_cvt_pk_bf16_f32 v209, v210, v211
ds_write_b64 v245, v[208:209] offset:2048
s_waitcnt lgkmcnt(0)
s_barrier
s_sub_u32 s31, s31, 1
s_cmp_eq_u32 s31, 0
s_cbranch_scc0 L_spv0
s_branch L_tail
L_spv0:
ds_read_b64_tr_b16 v[220:221], v239 offset:32768
ds_read_b64_tr_b16 v[222:223], v239 offset:34816
ds_read_b64_tr_b16 v[224:225], v239 offset:36864
ds_read_b64_tr_b16 v[226:227], v239 offset:38912
ds_read_b64_tr_b16 v[228:229], v239 offset:40960
ds_read_b64_tr_b16 v[230:231], v239 offset:43008
s_waitcnt lgkmcnt(4)
v_mfma_f32_16x16x32_bf16 a[16:19], v[220:223], v[176:179], a[16:19]
ds_read_b64_tr_b16 v[232:233], v239 offset:45056
v_mfma_f32_16x16x32_bf16 a[20:23], v[220:223], v[180:183], a[20:23]
ds_read_b64_tr_b16 v[234:235], v239 offset:47104
v_mfma_f32_16x16x32_bf16 a[24:27], v[220:223], v[184:187], a[24:27]
ds_read_b128 v[212:215], v244 offset:2048
v_mfma_f32_16x16x32_bf16 a[28:31], v[220:223], v[188:191], a[28:31]
s_waitcnt lgkmcnt(5)
ds_read_b128 v[216:219], v244 offset:3072
v_mfma_f32_16x16x32_bf16 a[80:83], v[224:227], v[176:179], a[80:83]
ds_read_b64_tr_b16 v[220:221], v238 offset:32768
v_mfma_f32_16x16x32_bf16 a[84:87], v[224:227], v[180:183], a[84:87]
ds_read_b64_tr_b16 v[222:223], v238 offset:34816
v_mfma_f32_16x16x32_bf16 a[88:91], v[224:227], v[184:187], a[88:91]
v_mfma_f32_16x16x32_bf16 a[92:95], v[224:227], v[188:191], a[92:95]
s_waitcnt lgkmcnt(4)
ds_read_b64_tr_b16 v[224:225], v238 offset:36864
v_mfma_f32_16x16x32_bf16 a[144:147], v[228:231], v[176:179], a[144:147]
ds_read_b64_tr_b16 v[226:227], v238 offset:38912
v_mfma_f32_16x16x32_bf16 a[148:151], v[228:231], v[180:183], a[148:151]
v_mfma_f32_16x16x32_bf16 a[152:155], v[228:231], v[184:187], a[152:155]
v_mfma_f32_16x16x32_bf16 a[156:159], v[228:231], v[188:191], a[156:159]
v_mfma_f32_16x16x32_bf16 a[208:211], v[232:235], v[176:179], a[208:211]
ds_read_b64_tr_b16 v[228:229], v238 offset:40960
v_mfma_f32_16x16x32_bf16 a[212:215], v[232:235], v[180:183], a[212:215]
ds_read_b64_tr_b16 v[230:231], v238 offset:43008
v_mfma_f32_16x16x32_bf16 a[216:219], v[232:235], v[184:187], a[216:219]
v_mfma_f32_16x16x32_bf16 a[220:223], v[232:235], v[188:191], a[220:223]
s_waitcnt lgkmcnt(2)
v_mfma_f32_16x16x32_bf16 a[0:3], v[220:223], v[176:179], a[0:3]
v_mfma_f32_16x16x32_bf16 a[4:7], v[220:223], v[180:183], a[4:7]
v_mfma_f32_16x16x32_bf16 v[128:131], v[220:223], v[212:215], v[128:131]
ds_read_b64_tr_b16 v[232:233], v238 offset:45056
v_mfma_f32_16x16x32_bf16 a[8:11], v[220:223], v[184:187], a[8:11]
ds_read_b64_tr_b16 v[234:235], v238 offset:47104
v_mfma_f32_16x16x32_bf16 v[132:135], v[220:223], v[216:219], v[132:135]
v_mfma_f32_16x16x32_bf16 a[12:15], v[220:223], v[188:191], a[12:15]
v_mfma_f32_16x16x32_bf16 a[64:67], v[224:227], v[176:179], a[64:67]
v_mfma_f32_16x16x32_bf16 a[68:71], v[224:227], v[180:183], a[68:71]
v_mfma_f32_16x16x32_bf16 v[136:139], v[224:227], v[212:215], v[136:139]
ds_read_b64_tr_b16 v[220:221], v240 offset:32768
v_mfma_f32_16x16x32_bf16 a[72:75], v[224:227], v[184:187], a[72:75]
ds_read_b64_tr_b16 v[222:223], v240 offset:34816
v_mfma_f32_16x16x32_bf16 v[140:143], v[224:227], v[216:219], v[140:143]
v_mfma_f32_16x16x32_bf16 a[76:79], v[224:227], v[188:191], a[76:79]
s_waitcnt lgkmcnt(2)
v_mfma_f32_16x16x32_bf16 a[128:131], v[228:231], v[176:179], a[128:131]
ds_read_b64_tr_b16 v[224:225], v240 offset:36864
v_mfma_f32_16x16x32_bf16 a[132:135], v[228:231], v[180:183], a[132:135]
ds_read_b64_tr_b16 v[226:227], v240 offset:38912
v_mfma_f32_16x16x32_bf16 v[144:147], v[228:231], v[212:215], v[144:147]
v_mfma_f32_16x16x32_bf16 a[136:139], v[228:231], v[184:187], a[136:139]
v_mfma_f32_16x16x32_bf16 v[148:151], v[228:231], v[216:219], v[148:151]
v_mfma_f32_16x16x32_bf16 a[140:143], v[228:231], v[188:191], a[140:143]
ds_read_b64_tr_b16 v[228:229], v240 offset:40960
v_mfma_f32_16x16x32_bf16 a[192:195], v[232:235], v[176:179], a[192:195]
ds_read_b64_tr_b16 v[230:231], v240 offset:43008
v_mfma_f32_16x16x32_bf16 a[196:199], v[232:235], v[180:183], a[196:199]
v_mfma_f32_16x16x32_bf16 v[152:155], v[232:235], v[212:215], v[152:155]
v_mfma_f32_16x16x32_bf16 a[200:203], v[232:235], v[184:187], a[200:203]
v_mfma_f32_16x16x32_bf16 v[156:159], v[232:235], v[216:219], v[156:159]
v_mfma_f32_16x16x32_bf16 a[204:207], v[232:235], v[188:191], a[204:207]
s_waitcnt lgkmcnt(2)
ds_read_b64_tr_b16 v[232:233], v240 offset:45056
v_mfma_f32_16x16x32_bf16 a[32:35], v[220:223], v[176:179], a[32:35]
ds_read_b64_tr_b16 v[234:235], v240 offset:47104
v_mfma_f32_16x16x32_bf16 a[36:39], v[220:223], v[180:183], a[36:39]
v_mfma_f32_16x16x32_bf16 a[40:43], v[220:223], v[184:187], a[40:43]
v_mfma_f32_16x16x32_bf16 a[44:47], v[220:223], v[188:191], a[44:47]
ds_read_b64_tr_b16 v[220:221], v241 offset:32768
v_mfma_f32_16x16x32_bf16 a[96:99], v[224:227], v[176:179], a[96:99]
ds_read_b64_tr_b16 v[222:223], v241 offset:34816
v_mfma_f32_16x16x32_bf16 a[100:103], v[224:227], v[180:183], a[100:103]
v_mfma_f32_16x16x32_bf16 a[104:107], v[224:227], v[184:187], a[104:107]
v_mfma_f32_16x16x32_bf16 a[108:111], v[224:227], v[188:191], a[108:111]
s_waitcnt lgkmcnt(2)
ds_read_b64_tr_b16 v[224:225], v241 offset:36864
v_mfma_f32_16x16x32_bf16 a[160:163], v[228:231], v[176:179], a[160:163]
ds_read_b64_tr_b16 v[226:227], v241 offset:38912
v_mfma_f32_16x16x32_bf16 a[164:167], v[228:231], v[180:183], a[164:167]
v_mfma_f32_16x16x32_bf16 a[168:171], v[228:231], v[184:187], a[168:171]
v_mfma_f32_16x16x32_bf16 a[172:175], v[228:231], v[188:191], a[172:175]
ds_read_b64_tr_b16 v[228:229], v241 offset:40960
v_mfma_f32_16x16x32_bf16 a[224:227], v[232:235], v[176:179], a[224:227]
ds_read_b64_tr_b16 v[230:231], v241 offset:43008
v_mfma_f32_16x16x32_bf16 a[228:231], v[232:235], v[180:183], a[228:231]
v_mfma_f32_16x16x32_bf16 a[232:235], v[232:235], v[184:187], a[232:235]
v_mfma_f32_16x16x32_bf16 a[236:239], v[232:235], v[188:191], a[236:239]
s_waitcnt lgkmcnt(2)
ds_read_b64_tr_b16 v[232:233], v241 offset:45056
v_mfma_f32_16x16x32_bf16 a[48:51], v[220:223], v[176:179], a[48:51]
ds_read_b64_tr_b16 v[234:235], v241 offset:47104
v_mfma_f32_16x16x32_bf16 a[52:55], v[220:223], v[180:183], a[52:55]
v_mfma_f32_16x16x32_bf16 a[56:59], v[220:223], v[184:187], a[56:59]
v_mfma_f32_16x16x32_bf16 a[60:63], v[220:223], v[188:191], a[60:63]
v_mfma_f32_16x16x32_bf16 a[112:115], v[224:227], v[176:179], a[112:115]
v_mfma_f32_16x16x32_bf16 a[116:119], v[224:227], v[180:183], a[116:119]
v_mfma_f32_16x16x32_bf16 a[120:123], v[224:227], v[184:187], a[120:123]
v_mfma_f32_16x16x32_bf16 a[124:127], v[224:227], v[188:191], a[124:127]
s_waitcnt lgkmcnt(0)
v_mfma_f32_16x16x32_bf16 a[176:179], v[228:231], v[176:179], a[176:179]
v_mfma_f32_16x16x32_bf16 a[180:183], v[228:231], v[180:183], a[180:183]
v_mfma_f32_16x16x32_bf16 a[184:187], v[228:231], v[184:187], a[184:187]
v_mfma_f32_16x16x32_bf16 a[188:191], v[228:231], v[188:191], a[188:191]
v_mfma_f32_16x16x32_bf16 a[240:243], v[232:235], v[176:179], a[240:243]
v_mfma_f32_16x16x32_bf16 a[244:247], v[232:235], v[180:183], a[244:247]
v_mfma_f32_16x16x32_bf16 a[248:251], v[232:235], v[184:187], a[248:251]
v_mfma_f32_16x16x32_bf16 a[252:255], v[232:235], v[188:191], a[252:255]
s_waitcnt lgkmcnt(0)
s_barrier
s_add_u32 s30, s30, 16384
s_branch L_sloop0
L_slow1:
v_mov_b32 v160, 0xff800000
v_mov_b32 v161, 0xff800000
v_mov_b32 v162, 0xff800000
v_mov_b32 v163, 0xff800000
v_mov_b32 v164, 0xff800000
s_mov_b32 s30, 0
s_mov_b32 s31, 32
L_smax1:
s_add_u32 m0, s29, 0
s_nop 0
buffer_load_dwordx4 v246, s[12:15], s30 offen offset:0 nt lds
s_add_u32 m0, s29, 3968
s_nop 0
buffer_load_dwordx4 v246, s[12:15], s30 offen offset:128 nt lds
s_add_u32 m0, s29, 7936
s_nop 0
buffer_load_dwordx4 v246, s[12:15], s30 offen offset:256 nt lds
s_add_u32 m0, s29, 11904
s_nop 0
buffer_load_dwordx4 v246, s[12:15], s30 offen offset:384 nt lds
s_waitcnt vmcnt(0)
s_barrier
ds_read_b128 v[220:223], v236 offset:0
ds_read_b128 v[224:227], v237 offset:0
ds_read_b128 v[228:231], v236 offset:4096
ds_read_b128 v[232:235], v237 offset:4096
ds_read_b128 v[212:215], v236 offset:8192
ds_read_b128 v[216:219], v237 offset:8192
s_waitcnt lgkmcnt(5)
v_mfma_f32_16x16x32_bf16 v[176:179], v[220:223], v[0:3], 0
v_mfma_f32_16x16x32_bf16 v[180:183], v[220:223], v[32:35], 0
v_mfma_f32_16x16x32_bf16 v[184:187], v[220:223], v[64:67], 0
v_mfma_f32_16x16x32_bf16 v[188:191], v[220:223], v[96:99], 0
s_waitcnt lgkmcnt(4)
v_mfma_f32_16x16x32_bf16 v[176:179], v[224:227], v[4:7], v[176:179]
v_mfma_f32_16x16x32_bf16 v[180:183], v[224:227], v[36:39], v[180:183]
v_mfma_f32_16x16x32_bf16 v[184:187], v[224:227], v[68:71], v[184:187]
v_mfma_f32_16x16x32_bf16 v[188:191], v[224:227], v[100:103], v[188:191]
s_waitcnt lgkmcnt(0)
v_mfma_f32_16x16x32_bf16 v[176:179], v[228:231], v[8:11], v[176:179]
ds_read_b128 v[220:223], v236 offset:12288
v_mfma_f32_16x16x32_bf16 v[180:183], v[228:231], v[40:43], v[180:183]
v_mfma_f32_16x16x32_bf16 v[184:187], v[228:231], v[72:75], v[184:187]
v_mfma_f32_16x16x32_bf16 v[188:191], v[228:231], v[104:107], v[188:191]
v_mfma_f32_16x16x32_bf16 v[176:179], v[232:235], v[12:15], v[176:179]
ds_read_b128 v[224:227], v237 offset:12288
v_mfma_f32_16x16x32_bf16 v[180:183], v[232:235], v[44:47], v[180:183]
v_mfma_f32_16x16x32_bf16 v[184:187], v[232:235], v[76:79], v[184:187]
v_mfma_f32_16x16x32_bf16 v[188:191], v[232:235], v[108:111], v[188:191]
v_mfma_f32_16x16x32_bf16 v[176:179], v[212:215], v[16:19], v[176:179]
ds_read_b128 v[228:231], v236 offset:2048
v_mfma_f32_16x16x32_bf16 v[180:183], v[212:215], v[48:51], v[180:183]
v_mfma_f32_16x16x32_bf16 v[184:187], v[212:215], v[80:83], v[184:187]
v_mfma_f32_16x16x32_bf16 v[188:191], v[212:215], v[112:115], v[188:191]
v_mfma_f32_16x16x32_bf16 v[176:179], v[216:219], v[20:23], v[176:179]
ds_read_b128 v[232:235], v242 offset:0
v_mfma_f32_16x16x32_bf16 v[180:183], v[216:219], v[52:55], v[180:183]
ds_read_b128 v[212:215], v237 offset:2048
v_mfma_f32_16x16x32_bf16 v[184:187], v[216:219], v[84:87], v[184:187]
v_mfma_f32_16x16x32_bf16 v[188:191], v[216:219], v[116:119], v[188:191]
s_waitcnt lgkmcnt(2)
v_mfma_f32_16x16x32_bf16 v[176:179], v[220:223], v[24:27], v[176:179]
v_mfma_f32_16x16x32_bf16 v[180:183], v[220:223], v[56:59], v[180:183]
ds_read_b128 v[216:219], v243 offset:0
v_mfma_f32_16x16x32_bf16 v[184:187], v[220:223], v[88:91], v[184:187]
v_mfma_f32_16x16x32_bf16 v[188:191], v[220:223], v[120:123], v[188:191]
ds_read_b128 v[220:223], v236 offset:6144
v_mfma_f32_16x16x32_bf16 v[176:179], v[224:227], v[28:31], v[176:179]
v_mfma_f32_16x16x32_bf16 v[180:183], v[224:227], v[60:63], v[180:183]
v_mfma_f32_16x16x32_bf16 v[184:187], v[224:227], v[92:95], v[184:187]
v_mfma_f32_16x16x32_bf16 v[188:191], v[224:227], v[124:127], v[188:191]
ds_read_b128 v[224:227], v242 offset:2048
v_mfma_f32_16x16x32_bf16 v[192:195], v[228:231], v[0:3], 0
v_mfma_f32_16x16x32_bf16 v[196:199], v[228:231], v[32:35], 0
v_mfma_f32_16x16x32_bf16 v[200:203], v[228:231], v[64:67], 0
v_mfma_f32_16x16x32_bf16 v[204:207], v[228:231], v[96:99], 0
s_waitcnt lgkmcnt(1)
v_mfma_f32_16x16x32_bf16 v[208:211], v[228:231], v[232:235], 0
ds_read_b128 v[228:231], v237 offset:6144
v_mfma_f32_16x16x32_bf16 v[192:195], v[212:215], v[4:7], v[192:195]
ds_read_b128 v[232:235], v243 offset:2048
v_mfma_f32_16x16x32_bf16 v[196:199], v[212:215], v[36:39], v[196:199]
v_mfma_f32_16x16x32_bf16 v[200:203], v[212:215], v[68:71], v[200:203]
v_mfma_f32_16x16x32_bf16 v[204:207], v[212:215], v[100:103], v[204:207]
v_mfma_f32_16x16x32_bf16 v[208:211], v[212:215], v[216:219], v[208:211]
ds_read_b128 v[212:215], v236 offset:10240
v_mfma_f32_16x16x32_bf16 v[192:195], v[220:223], v[8:11], v[192:195]
ds_read_b128 v[216:219], v242 offset:4096
v_mfma_f32_16x16x32_bf16 v[196:199], v[220:223], v[40:43], v[196:199]
v_mfma_f32_16x16x32_bf16 v[200:203], v[220:223], v[72:75], v[200:203]
v_mfma_f32_16x16x32_bf16 v[204:207], v[220:223], v[104:107], v[204:207]
s_waitcnt lgkmcnt(2)
v_mfma_f32_16x16x32_bf16 v[208:211], v[220:223], v[224:227], v[208:211]
ds_read_b128 v[220:223], v237 offset:10240
v_mfma_f32_16x16x32_bf16 v[192:195], v[228:231], v[12:15], v[192:195]
ds_read_b128 v[224:227], v243 offset:4096
v_mfma_f32_16x16x32_bf16 v[196:199], v[228:231], v[44:47], v[196:199]
v_mfma_f32_16x16x32_bf16 v[200:203], v[228:231], v[76:79], v[200:203]
v_mfma_f32_16x16x32_bf16 v[204:207], v[228:231], v[108:111], v[204:207]
v_mfma_f32_16x16x32_bf16 v[208:211], v[228:231], v[232:235], v[208:211]
s_waitcnt lgkmcnt(2)
ds_read_b128 v[228:231], v236 offset:14336
v_mfma_f32_16x16x32_bf16 v[192:195], v[212:215], v[16:19], v[192:195]
ds_read_b128 v[232:235], v242 offset:6144
v_mfma_f32_16x16x32_bf16 v[196:199], v[212:215], v[48:51], v[196:199]
v_mfma_f32_16x16x32_bf16 v[200:203], v[212:215], v[80:83], v[200:203]
v_mfma_f32_16x16x32_bf16 v[204:207], v[212:215], v[112:115], v[204:207]
v_mfma_f32_16x16x32_bf16 v[208:211], v[212:215], v[216:219], v[208:211]
s_waitcnt lgkmcnt(2)
ds_read_b128 v[212:215], v237 offset:14336
v_mfma_f32_16x16x32_bf16 v[192:195], v[220:223], v[20:23], v[192:195]
ds_read_b128 v[216:219], v243 offset:6144
v_mfma_f32_16x16x32_bf16 v[196:199], v[220:223], v[52:55], v[196:199]
v_mfma_f32_16x16x32_bf16 v[200:203], v[220:223], v[84:87], v[200:203]
v_mfma_f32_16x16x32_bf16 v[204:207], v[220:223], v[116:119], v[204:207]
v_mfma_f32_16x16x32_bf16 v[208:211], v[220:223], v[224:227], v[208:211]
s_waitcnt lgkmcnt(2)
v_mfma_f32_16x16x32_bf16 v[192:195], v[228:231], v[24:27], v[192:195]
v_mfma_f32_16x16x32_bf16 v[196:199], v[228:231], v[56:59], v[196:199]
v_mfma_f32_16x16x32_bf16 v[200:203], v[228:231], v[88:91], v[200:203]
v_mfma_f32_16x16x32_bf16 v[204:207], v[228:231], v[120:123], v[204:207]
v_mfma_f32_16x16x32_bf16 v[208:211], v[228:231], v[232:235], v[208:211]
s_waitcnt lgkmcnt(0)
v_mfma_f32_16x16x32_bf16 v[192:195], v[212:215], v[28:31], v[192:195]
v_mfma_f32_16x16x32_bf16 v[196:199], v[212:215], v[60:63], v[196:199]
v_mfma_f32_16x16x32_bf16 v[200:203], v[212:215], v[92:95], v[200:203]
v_mfma_f32_16x16x32_bf16 v[204:207], v[212:215], v[124:127], v[204:207]
v_mfma_f32_16x16x32_bf16 v[208:211], v[212:215], v[216:219], v[208:211]
s_nop 7
v_max3_f32 v160, v160, v176, v177
v_max3_f32 v160, v160, v178, v179
v_max3_f32 v160, v160, v192, v193
v_max3_f32 v160, v160, v194, v195
v_max3_f32 v161, v161, v180, v181
v_max3_f32 v161, v161, v182, v183
v_max3_f32 v161, v161, v196, v197
v_max3_f32 v161, v161, v198, v199
v_max3_f32 v162, v162, v184, v185
v_max3_f32 v162, v162, v186, v187
v_max3_f32 v162, v162, v200, v201
v_max3_f32 v162, v162, v202, v203
v_max3_f32 v163, v163, v188, v189
v_max3_f32 v163, v163, v190, v191
v_max3_f32 v163, v163, v204, v205
v_max3_f32 v163, v163, v206, v207
v_max3_f32 v164, v164, v208, v209
v_max3_f32 v164, v164, v210, v211
s_waitcnt lgkmcnt(0)
s_barrier
s_add_u32 s30, s30, 16384
s_sub_u32 s31, s31, 1
s_cmp_lg_u32 s31, 0
s_cbranch_scc1 L_smax1
v_mov_b32 v165, v160
s_nop 1
v_permlane32_swap_b32 v165, v160
s_nop 1
v_max_f32 v160, v160, v165
v_mov_b32 v165, v160
s_nop 1
v_permlane16_swap_b32 v165, v160
s_nop 1
v_max_f32 v160, v160, v165
v_mov_b32 v165, v161
s_nop 1
v_permlane32_swap_b32 v165, v161
s_nop 1
v_max_f32 v161, v161, v165
v_mov_b32 v165, v161
s_nop 1
v_permlane16_swap_b32 v165, v161
s_nop 1
v_max_f32 v161, v161, v165
v_mov_b32 v165, v162
s_nop 1
v_permlane32_swap_b32 v165, v162
s_nop 1
v_max_f32 v162, v162, v165
v_mov_b32 v165, v162
s_nop 1
v_permlane16_swap_b32 v165, v162
s_nop 1
v_max_f32 v162, v162, v165
v_mov_b32 v165, v163
s_nop 1
v_permlane32_swap_b32 v165, v163
s_nop 1
v_max_f32 v163, v163, v165
v_mov_b32 v165, v163
s_nop 1
v_permlane16_swap_b32 v165, v163
s_nop 1
v_max_f32 v163, v163, v165
v_mov_b32 v165, v164
s_nop 1
v_permlane32_swap_b32 v165, v164
s_nop 1
v_max_f32 v164, v164, v165
v_mov_b32 v165, v164
s_nop 1
v_permlane16_swap_b32 v165, v164
s_nop 1
v_max_f32 v164, v164, v165
v_mbcnt_lo_u32_b32 v165, -1, 0
v_mbcnt_hi_u32_b32 v165, -1, v165
v_lshlrev_b32 v165, 2, v165
s_lshl_b32 s33, s28, 8
s_add_u32 s33, s33, 151552
v_add_u32 v166, s33, v165
s_xor_b32 s33, s28, 1
s_lshl_b32 s33, s33, 8
s_add_u32 s33, s33, 151552
v_add_u32 v167, s33, v165
ds_write_b32 v166, v164
s_waitcnt lgkmcnt(0)
s_barrier
ds_read_b32 v168, v167
s_waitcnt lgkmcnt(0)
v_max_f32 v164, v164, v168
v_accvgpr_write_b32 a0, 0
v_accvgpr_write_b32 a1, 0
v_accvgpr_write_b32 a2, 0
v_accvgpr_write_b32 a3, 0
v_accvgpr_write_b32 a4, 0
v_accvgpr_write_b32 a5, 0
v_accvgpr_write_b32 a6, 0
v_accvgpr_write_b32 a7, 0
v_accvgpr_write_b32 a8, 0
v_accvgpr_write_b32 a9, 0
v_accvgpr_write_b32 a10, 0
v_accvgpr_write_b32 a11, 0
v_accvgpr_write_b32 a12, 0
v_accvgpr_write_b32 a13, 0
v_accvgpr_write_b32 a14, 0
v_accvgpr_write_b32 a15, 0
v_accvgpr_write_b32 a16, 0
v_accvgpr_write_b32 a17, 0
v_accvgpr_write_b32 a18, 0
v_accvgpr_write_b32 a19, 0
v_accvgpr_write_b32 a20, 0
v_accvgpr_write_b32 a21, 0
v_accvgpr_write_b32 a22, 0
v_accvgpr_write_b32 a23, 0
v_accvgpr_write_b32 a24, 0
v_accvgpr_write_b32 a25, 0
v_accvgpr_write_b32 a26, 0
v_accvgpr_write_b32 a27, 0
v_accvgpr_write_b32 a28, 0
v_accvgpr_write_b32 a29, 0
v_accvgpr_write_b32 a30, 0
v_accvgpr_write_b32 a31, 0
v_accvgpr_write_b32 a32, 0
v_accvgpr_write_b32 a33, 0
v_accvgpr_write_b32 a34, 0
v_accvgpr_write_b32 a35, 0
v_accvgpr_write_b32 a36, 0
v_accvgpr_write_b32 a37, 0
v_accvgpr_write_b32 a38, 0
v_accvgpr_write_b32 a39, 0
v_accvgpr_write_b32 a40, 0
v_accvgpr_write_b32 a41, 0
v_accvgpr_write_b32 a42, 0
v_accvgpr_write_b32 a43, 0
v_accvgpr_write_b32 a44, 0
v_accvgpr_write_b32 a45, 0
v_accvgpr_write_b32 a46, 0
v_accvgpr_write_b32 a47, 0
v_accvgpr_write_b32 a48, 0
v_accvgpr_write_b32 a49, 0
v_accvgpr_write_b32 a50, 0
v_accvgpr_write_b32 a51, 0
v_accvgpr_write_b32 a52, 0
v_accvgpr_write_b32 a53, 0
v_accvgpr_write_b32 a54, 0
v_accvgpr_write_b32 a55, 0
v_accvgpr_write_b32 a56, 0
v_accvgpr_write_b32 a57, 0
v_accvgpr_write_b32 a58, 0
v_accvgpr_write_b32 a59, 0
v_accvgpr_write_b32 a60, 0
v_accvgpr_write_b32 a61, 0
v_accvgpr_write_b32 a62, 0
v_accvgpr_write_b32 a63, 0
v_accvgpr_write_b32 a64, 0
v_accvgpr_write_b32 a65, 0
v_accvgpr_write_b32 a66, 0
v_accvgpr_write_b32 a67, 0
v_accvgpr_write_b32 a68, 0
v_accvgpr_write_b32 a69, 0
v_accvgpr_write_b32 a70, 0
v_accvgpr_write_b32 a71, 0
v_accvgpr_write_b32 a72, 0
v_accvgpr_write_b32 a73, 0
v_accvgpr_write_b32 a74, 0
v_accvgpr_write_b32 a75, 0
v_accvgpr_write_b32 a76, 0
v_accvgpr_write_b32 a77, 0
v_accvgpr_write_b32 a78, 0
v_accvgpr_write_b32 a79, 0
v_accvgpr_write_b32 a80, 0
v_accvgpr_write_b32 a81, 0
v_accvgpr_write_b32 a82, 0
v_accvgpr_write_b32 a83, 0
v_accvgpr_write_b32 a84, 0
v_accvgpr_write_b32 a85, 0
v_accvgpr_write_b32 a86, 0
v_accvgpr_write_b32 a87, 0
v_accvgpr_write_b32 a88, 0
v_accvgpr_write_b32 a89, 0
v_accvgpr_write_b32 a90, 0
v_accvgpr_write_b32 a91, 0
v_accvgpr_write_b32 a92, 0
v_accvgpr_write_b32 a93, 0
v_accvgpr_write_b32 a94, 0
v_accvgpr_write_b32 a95, 0
v_accvgpr_write_b32 a96, 0
v_accvgpr_write_b32 a97, 0
v_accvgpr_write_b32 a98, 0
v_accvgpr_write_b32 a99, 0
v_accvgpr_write_b32 a100, 0
v_accvgpr_write_b32 a101, 0
v_accvgpr_write_b32 a102, 0
v_accvgpr_write_b32 a103, 0
v_accvgpr_write_b32 a104, 0
v_accvgpr_write_b32 a105, 0
v_accvgpr_write_b32 a106, 0
v_accvgpr_write_b32 a107, 0
v_accvgpr_write_b32 a108, 0
v_accvgpr_write_b32 a109, 0
v_accvgpr_write_b32 a110, 0
v_accvgpr_write_b32 a111, 0
v_accvgpr_write_b32 a112, 0
v_accvgpr_write_b32 a113, 0
v_accvgpr_write_b32 a114, 0
v_accvgpr_write_b32 a115, 0
v_accvgpr_write_b32 a116, 0
v_accvgpr_write_b32 a117, 0
v_accvgpr_write_b32 a118, 0
v_accvgpr_write_b32 a119, 0
v_accvgpr_write_b32 a120, 0
v_accvgpr_write_b32 a121, 0
v_accvgpr_write_b32 a122, 0
v_accvgpr_write_b32 a123, 0
v_accvgpr_write_b32 a124, 0
v_accvgpr_write_b32 a125, 0
v_accvgpr_write_b32 a126, 0
v_accvgpr_write_b32 a127, 0
v_accvgpr_write_b32 a128, 0
v_accvgpr_write_b32 a129, 0
v_accvgpr_write_b32 a130, 0
v_accvgpr_write_b32 a131, 0
v_accvgpr_write_b32 a132, 0
v_accvgpr_write_b32 a133, 0
v_accvgpr_write_b32 a134, 0
v_accvgpr_write_b32 a135, 0
v_accvgpr_write_b32 a136, 0
v_accvgpr_write_b32 a137, 0
v_accvgpr_write_b32 a138, 0
v_accvgpr_write_b32 a139, 0
v_accvgpr_write_b32 a140, 0
v_accvgpr_write_b32 a141, 0
v_accvgpr_write_b32 a142, 0
v_accvgpr_write_b32 a143, 0
v_accvgpr_write_b32 a144, 0
v_accvgpr_write_b32 a145, 0
v_accvgpr_write_b32 a146, 0
v_accvgpr_write_b32 a147, 0
v_accvgpr_write_b32 a148, 0
v_accvgpr_write_b32 a149, 0
v_accvgpr_write_b32 a150, 0
v_accvgpr_write_b32 a151, 0
v_accvgpr_write_b32 a152, 0
v_accvgpr_write_b32 a153, 0
v_accvgpr_write_b32 a154, 0
v_accvgpr_write_b32 a155, 0
v_accvgpr_write_b32 a156, 0
v_accvgpr_write_b32 a157, 0
v_accvgpr_write_b32 a158, 0
v_accvgpr_write_b32 a159, 0
v_accvgpr_write_b32 a160, 0
v_accvgpr_write_b32 a161, 0
v_accvgpr_write_b32 a162, 0
v_accvgpr_write_b32 a163, 0
v_accvgpr_write_b32 a164, 0
v_accvgpr_write_b32 a165, 0
v_accvgpr_write_b32 a166, 0
v_accvgpr_write_b32 a167, 0
v_accvgpr_write_b32 a168, 0
v_accvgpr_write_b32 a169, 0
v_accvgpr_write_b32 a170, 0
v_accvgpr_write_b32 a171, 0
v_accvgpr_write_b32 a172, 0
v_accvgpr_write_b32 a173, 0
v_accvgpr_write_b32 a174, 0
v_accvgpr_write_b32 a175, 0
v_accvgpr_write_b32 a176, 0
v_accvgpr_write_b32 a177, 0
v_accvgpr_write_b32 a178, 0
v_accvgpr_write_b32 a179, 0
v_accvgpr_write_b32 a180, 0
v_accvgpr_write_b32 a181, 0
v_accvgpr_write_b32 a182, 0
v_accvgpr_write_b32 a183, 0
v_accvgpr_write_b32 a184, 0
v_accvgpr_write_b32 a185, 0
v_accvgpr_write_b32 a186, 0
v_accvgpr_write_b32 a187, 0
v_accvgpr_write_b32 a188, 0
v_accvgpr_write_b32 a189, 0
v_accvgpr_write_b32 a190, 0
v_accvgpr_write_b32 a191, 0
v_accvgpr_write_b32 a192, 0
v_accvgpr_write_b32 a193, 0
v_accvgpr_write_b32 a194, 0
v_accvgpr_write_b32 a195, 0
v_accvgpr_write_b32 a196, 0
v_accvgpr_write_b32 a197, 0
v_accvgpr_write_b32 a198, 0
v_accvgpr_write_b32 a199, 0
v_accvgpr_write_b32 a200, 0
v_accvgpr_write_b32 a201, 0
v_accvgpr_write_b32 a202, 0
v_accvgpr_write_b32 a203, 0
v_accvgpr_write_b32 a204, 0
v_accvgpr_write_b32 a205, 0
v_accvgpr_write_b32 a206, 0
v_accvgpr_write_b32 a207, 0
v_accvgpr_write_b32 a208, 0
v_accvgpr_write_b32 a209, 0
v_accvgpr_write_b32 a210, 0
v_accvgpr_write_b32 a211, 0
v_accvgpr_write_b32 a212, 0
v_accvgpr_write_b32 a213, 0
v_accvgpr_write_b32 a214, 0
v_accvgpr_write_b32 a215, 0
v_accvgpr_write_b32 a216, 0
v_accvgpr_write_b32 a217, 0
v_accvgpr_write_b32 a218, 0
v_accvgpr_write_b32 a219, 0
v_accvgpr_write_b32 a220, 0
v_accvgpr_write_b32 a221, 0
v_accvgpr_write_b32 a222, 0
v_accvgpr_write_b32 a223, 0
v_accvgpr_write_b32 a224, 0
v_accvgpr_write_b32 a225, 0
v_accvgpr_write_b32 a226, 0
v_accvgpr_write_b32 a227, 0
v_accvgpr_write_b32 a228, 0
v_accvgpr_write_b32 a229, 0
v_accvgpr_write_b32 a230, 0
v_accvgpr_write_b32 a231, 0
v_accvgpr_write_b32 a232, 0
v_accvgpr_write_b32 a233, 0
v_accvgpr_write_b32 a234, 0
v_accvgpr_write_b32 a235, 0
v_accvgpr_write_b32 a236, 0
v_accvgpr_write_b32 a237, 0
v_accvgpr_write_b32 a238, 0
v_accvgpr_write_b32 a239, 0
v_accvgpr_write_b32 a240, 0
v_accvgpr_write_b32 a241, 0
v_accvgpr_write_b32 a242, 0
v_accvgpr_write_b32 a243, 0
v_accvgpr_write_b32 a244, 0
v_accvgpr_write_b32 a245, 0
v_accvgpr_write_b32 a246, 0
v_accvgpr_write_b32 a247, 0
v_accvgpr_write_b32 a248, 0
v_accvgpr_write_b32 a249, 0
v_accvgpr_write_b32 a250, 0
v_accvgpr_write_b32 a251, 0
v_accvgpr_write_b32 a252, 0
v_accvgpr_write_b32 a253, 0
v_accvgpr_write_b32 a254, 0
v_accvgpr_write_b32 a255, 0
v_mov_b32 v128, 0
v_mov_b32 v129, 0
v_mov_b32 v130, 0
v_mov_b32 v131, 0
v_mov_b32 v132, 0
v_mov_b32 v133, 0
v_mov_b32 v134, 0
v_mov_b32 v135, 0
v_mov_b32 v136, 0
v_mov_b32 v137, 0
v_mov_b32 v138, 0
v_mov_b32 v139, 0
v_mov_b32 v140, 0
v_mov_b32 v141, 0
v_mov_b32 v142, 0
v_mov_b32 v143, 0
v_mov_b32 v144, 0
v_mov_b32 v145, 0
v_mov_b32 v146, 0
v_mov_b32 v147, 0
v_mov_b32 v148, 0
v_mov_b32 v149, 0
v_mov_b32 v150, 0
v_mov_b32 v151, 0
v_mov_b32 v152, 0
v_mov_b32 v153, 0
v_mov_b32 v154, 0
v_mov_b32 v155, 0
v_mov_b32 v156, 0
v_mov_b32 v157, 0
v_mov_b32 v158, 0
v_mov_b32 v159, 0
v_mov_b32 v248, 0
v_mov_b32 v249, 0
v_mov_b32 v250, 0
v_mov_b32 v251, 0
v_mov_b32 v252, 0
s_mov_b32 s30, 0
s_mov_b32 s31, 32
L_sloop1:
s_add_u32 s36, s30, 16384
s_add_u32 m0, s29, 0
s_nop 0
buffer_load_dwordx4 v246, s[12:15], s30 offen offset:0 nt lds
s_add_u32 m0, s29, 3968
s_nop 0
buffer_load_dwordx4 v246, s[12:15], s30 offen offset:128 nt lds
s_add_u32 m0, s29, 7936
s_nop 0
buffer_load_dwordx4 v246, s[12:15], s30 offen offset:256 nt lds
s_add_u32 m0, s29, 11904
s_nop 0
buffer_load_dwordx4 v246, s[12:15], s30 offen offset:384 nt lds
s_add_u32 m0, s29, 98304
s_nop 0
buffer_load_dwordx4 v247, s[16:19], s36 offen offset:0 nt lds
s_add_u32 m0, s29, 102272
s_nop 0
buffer_load_dwordx4 v247, s[16:19], s36 offen offset:128 nt lds
s_add_u32 m0, s29, 106240
s_nop 0
buffer_load_dwordx4 v247, s[16:19], s36 offen offset:256 nt lds
s_add_u32 m0, s29, 110208
s_nop 0
buffer_load_dwordx4 v247, s[16:19], s36 offen offset:384 nt lds
s_waitcnt vmcnt(0)
s_barrier
ds_read_b128 v[220:223], v236 offset:0
ds_read_b128 v[224:227], v237 offset:0
ds_read_b128 v[228:231], v236 offset:4096
ds_read_b128 v[232:235], v237 offset:4096
ds_read_b128 v[212:215], v236 offset:8192
ds_read_b128 v[216:219], v237 offset:8192
s_waitcnt lgkmcnt(5)
v_mfma_f32_16x16x32_bf16 v[176:179], v[220:223], v[0:3], 0
v_mfma_f32_16x16x32_bf16 v[180:183], v[220:223], v[32:35], 0
v_mfma_f32_16x16x32_bf16 v[184:187], v[220:223], v[64:67], 0
v_mfma_f32_16x16x32_bf16 v[188:191], v[220:223], v[96:99], 0
s_waitcnt lgkmcnt(4)
v_mfma_f32_16x16x32_bf16 v[176:179], v[224:227], v[4:7], v[176:179]
v_mfma_f32_16x16x32_bf16 v[180:183], v[224:227], v[36:39], v[180:183]
v_mfma_f32_16x16x32_bf16 v[184:187], v[224:227], v[68:71], v[184:187]
v_mfma_f32_16x16x32_bf16 v[188:191], v[224:227], v[100:103], v[188:191]
s_waitcnt lgkmcnt(0)
v_mfma_f32_16x16x32_bf16 v[176:179], v[228:231], v[8:11], v[176:179]
ds_read_b128 v[220:223], v236 offset:12288
v_mfma_f32_16x16x32_bf16 v[180:183], v[228:231], v[40:43], v[180:183]
v_mfma_f32_16x16x32_bf16 v[184:187], v[228:231], v[72:75], v[184:187]
v_mfma_f32_16x16x32_bf16 v[188:191], v[228:231], v[104:107], v[188:191]
v_mfma_f32_16x16x32_bf16 v[176:179], v[232:235], v[12:15], v[176:179]
ds_read_b128 v[224:227], v237 offset:12288
v_mfma_f32_16x16x32_bf16 v[180:183], v[232:235], v[44:47], v[180:183]
v_mfma_f32_16x16x32_bf16 v[184:187], v[232:235], v[76:79], v[184:187]
v_mfma_f32_16x16x32_bf16 v[188:191], v[232:235], v[108:111], v[188:191]
v_mfma_f32_16x16x32_bf16 v[176:179], v[212:215], v[16:19], v[176:179]
ds_read_b128 v[228:231], v236 offset:2048
v_mfma_f32_16x16x32_bf16 v[180:183], v[212:215], v[48:51], v[180:183]
v_mfma_f32_16x16x32_bf16 v[184:187], v[212:215], v[80:83], v[184:187]
v_mfma_f32_16x16x32_bf16 v[188:191], v[212:215], v[112:115], v[188:191]
v_mfma_f32_16x16x32_bf16 v[176:179], v[216:219], v[20:23], v[176:179]
ds_read_b128 v[232:235], v242 offset:0
v_mfma_f32_16x16x32_bf16 v[180:183], v[216:219], v[52:55], v[180:183]
ds_read_b128 v[212:215], v237 offset:2048
v_mfma_f32_16x16x32_bf16 v[184:187], v[216:219], v[84:87], v[184:187]
v_mfma_f32_16x16x32_bf16 v[188:191], v[216:219], v[116:119], v[188:191]
s_waitcnt lgkmcnt(2)
v_mfma_f32_16x16x32_bf16 v[176:179], v[220:223], v[24:27], v[176:179]
v_mfma_f32_16x16x32_bf16 v[180:183], v[220:223], v[56:59], v[180:183]
ds_read_b128 v[216:219], v243 offset:0
v_mfma_f32_16x16x32_bf16 v[184:187], v[220:223], v[88:91], v[184:187]
v_mfma_f32_16x16x32_bf16 v[188:191], v[220:223], v[120:123], v[188:191]
ds_read_b128 v[220:223], v236 offset:6144
v_mfma_f32_16x16x32_bf16 v[176:179], v[224:227], v[28:31], v[176:179]
v_mfma_f32_16x16x32_bf16 v[180:183], v[224:227], v[60:63], v[180:183]
v_mfma_f32_16x16x32_bf16 v[184:187], v[224:227], v[92:95], v[184:187]
v_mfma_f32_16x16x32_bf16 v[188:191], v[224:227], v[124:127], v[188:191]
ds_read_b128 v[224:227], v242 offset:2048
v_mfma_f32_16x16x32_bf16 v[192:195], v[228:231], v[0:3], 0
v_mfma_f32_16x16x32_bf16 v[196:199], v[228:231], v[32:35], 0
v_mfma_f32_16x16x32_bf16 v[200:203], v[228:231], v[64:67], 0
v_mfma_f32_16x16x32_bf16 v[204:207], v[228:231], v[96:99], 0
s_waitcnt lgkmcnt(1)
v_mfma_f32_16x16x32_bf16 v[208:211], v[228:231], v[232:235], 0
ds_read_b128 v[228:231], v237 offset:6144
v_mfma_f32_16x16x32_bf16 v[192:195], v[212:215], v[4:7], v[192:195]
ds_read_b128 v[232:235], v243 offset:2048
v_mfma_f32_16x16x32_bf16 v[196:199], v[212:215], v[36:39], v[196:199]
v_mfma_f32_16x16x32_bf16 v[200:203], v[212:215], v[68:71], v[200:203]
v_mfma_f32_16x16x32_bf16 v[204:207], v[212:215], v[100:103], v[204:207]
v_mfma_f32_16x16x32_bf16 v[208:211], v[212:215], v[216:219], v[208:211]
ds_read_b128 v[212:215], v236 offset:10240
v_mfma_f32_16x16x32_bf16 v[192:195], v[220:223], v[8:11], v[192:195]
ds_read_b128 v[216:219], v242 offset:4096
v_mfma_f32_16x16x32_bf16 v[196:199], v[220:223], v[40:43], v[196:199]
v_mfma_f32_16x16x32_bf16 v[200:203], v[220:223], v[72:75], v[200:203]
v_mfma_f32_16x16x32_bf16 v[204:207], v[220:223], v[104:107], v[204:207]
s_waitcnt lgkmcnt(2)
v_mfma_f32_16x16x32_bf16 v[208:211], v[220:223], v[224:227], v[208:211]
ds_read_b128 v[220:223], v237 offset:10240
v_mfma_f32_16x16x32_bf16 v[192:195], v[228:231], v[12:15], v[192:195]
ds_read_b128 v[224:227], v243 offset:4096
v_mfma_f32_16x16x32_bf16 v[196:199], v[228:231], v[44:47], v[196:199]
v_mfma_f32_16x16x32_bf16 v[200:203], v[228:231], v[76:79], v[200:203]
v_mfma_f32_16x16x32_bf16 v[204:207], v[228:231], v[108:111], v[204:207]
v_mfma_f32_16x16x32_bf16 v[208:211], v[228:231], v[232:235], v[208:211]
s_waitcnt lgkmcnt(2)
ds_read_b128 v[228:231], v236 offset:14336
v_mfma_f32_16x16x32_bf16 v[192:195], v[212:215], v[16:19], v[192:195]
ds_read_b128 v[232:235], v242 offset:6144
v_mfma_f32_16x16x32_bf16 v[196:199], v[212:215], v[48:51], v[196:199]
v_mfma_f32_16x16x32_bf16 v[200:203], v[212:215], v[80:83], v[200:203]
v_mfma_f32_16x16x32_bf16 v[204:207], v[212:215], v[112:115], v[204:207]
v_mfma_f32_16x16x32_bf16 v[208:211], v[212:215], v[216:219], v[208:211]
s_waitcnt lgkmcnt(2)
ds_read_b128 v[212:215], v237 offset:14336
v_mfma_f32_16x16x32_bf16 v[192:195], v[220:223], v[20:23], v[192:195]
ds_read_b128 v[216:219], v243 offset:6144
v_mfma_f32_16x16x32_bf16 v[196:199], v[220:223], v[52:55], v[196:199]
v_mfma_f32_16x16x32_bf16 v[200:203], v[220:223], v[84:87], v[200:203]
v_mfma_f32_16x16x32_bf16 v[204:207], v[220:223], v[116:119], v[204:207]
v_mfma_f32_16x16x32_bf16 v[208:211], v[220:223], v[224:227], v[208:211]
s_waitcnt lgkmcnt(2)
v_mfma_f32_16x16x32_bf16 v[192:195], v[228:231], v[24:27], v[192:195]
v_mfma_f32_16x16x32_bf16 v[196:199], v[228:231], v[56:59], v[196:199]
v_mfma_f32_16x16x32_bf16 v[200:203], v[228:231], v[88:91], v[200:203]
v_mfma_f32_16x16x32_bf16 v[204:207], v[228:231], v[120:123], v[204:207]
v_mfma_f32_16x16x32_bf16 v[208:211], v[228:231], v[232:235], v[208:211]
s_waitcnt lgkmcnt(0)
v_mfma_f32_16x16x32_bf16 v[192:195], v[212:215], v[28:31], v[192:195]
v_mfma_f32_16x16x32_bf16 v[196:199], v[212:215], v[60:63], v[196:199]
v_mfma_f32_16x16x32_bf16 v[200:203], v[212:215], v[92:95], v[200:203]
v_mfma_f32_16x16x32_bf16 v[204:207], v[212:215], v[124:127], v[204:207]
v_mfma_f32_16x16x32_bf16 v[208:211], v[212:215], v[216:219], v[208:211]
s_nop 7
v_sub_f32 v176, v176, v160
v_sub_f32 v177, v177, v160
v_sub_f32 v178, v178, v160
v_sub_f32 v179, v179, v160
v_exp_f32 v176, v176
v_exp_f32 v177, v177
v_exp_f32 v178, v178
v_exp_f32 v179, v179
s_nop 0
v_add_f32 v248, v248, v176
v_add_f32 v248, v248, v177
v_add_f32 v248, v248, v178
v_add_f32 v248, v248, v179
v_cvt_pk_bf16_f32 v176, v176, v177
v_cvt_pk_bf16_f32 v177, v178, v179
v_sub_f32 v192, v192, v160
v_sub_f32 v193, v193, v160
v_sub_f32 v194, v194, v160
v_sub_f32 v195, v195, v160
v_exp_f32 v192, v192
v_exp_f32 v193, v193
v_exp_f32 v194, v194
v_exp_f32 v195, v195
s_nop 0
v_add_f32 v248, v248, v192
v_add_f32 v248, v248, v193
v_add_f32 v248, v248, v194
v_add_f32 v248, v248, v195
v_cvt_pk_bf16_f32 v178, v192, v193
v_cvt_pk_bf16_f32 v179, v194, v195
v_sub_f32 v180, v180, v161
v_sub_f32 v181, v181, v161
v_sub_f32 v182, v182, v161
v_sub_f32 v183, v183, v161
v_exp_f32 v180, v180
v_exp_f32 v181, v181
v_exp_f32 v182, v182
v_exp_f32 v183, v183
s_nop 0
v_add_f32 v249, v249, v180
v_add_f32 v249, v249, v181
v_add_f32 v249, v249, v182
v_add_f32 v249, v249, v183
v_cvt_pk_bf16_f32 v180, v180, v181
v_cvt_pk_bf16_f32 v181, v182, v183
v_sub_f32 v196, v196, v161
v_sub_f32 v197, v197, v161
v_sub_f32 v198, v198, v161
v_sub_f32 v199, v199, v161
v_exp_f32 v196, v196
v_exp_f32 v197, v197
v_exp_f32 v198, v198
v_exp_f32 v199, v199
s_nop 0
v_add_f32 v249, v249, v196
v_add_f32 v249, v249, v197
v_add_f32 v249, v249, v198
v_add_f32 v249, v249, v199
v_cvt_pk_bf16_f32 v182, v196, v197
v_cvt_pk_bf16_f32 v183, v198, v199
v_sub_f32 v184, v184, v162
v_sub_f32 v185, v185, v162
v_sub_f32 v186, v186, v162
v_sub_f32 v187, v187, v162
v_exp_f32 v184, v184
v_exp_f32 v185, v185
v_exp_f32 v186, v186
v_exp_f32 v187, v187
s_nop 0
v_add_f32 v250, v250, v184
v_add_f32 v250, v250, v185
v_add_f32 v250, v250, v186
v_add_f32 v250, v250, v187
v_cvt_pk_bf16_f32 v184, v184, v185
v_cvt_pk_bf16_f32 v185, v186, v187
v_sub_f32 v200, v200, v162
v_sub_f32 v201, v201, v162
v_sub_f32 v202, v202, v162
v_sub_f32 v203, v203, v162
v_exp_f32 v200, v200
v_exp_f32 v201, v201
v_exp_f32 v202, v202
v_exp_f32 v203, v203
s_nop 0
v_add_f32 v250, v250, v200
v_add_f32 v250, v250, v201
v_add_f32 v250, v250, v202
v_add_f32 v250, v250, v203
v_cvt_pk_bf16_f32 v186, v200, v201
v_cvt_pk_bf16_f32 v187, v202, v203
v_sub_f32 v188, v188, v163
v_sub_f32 v189, v189, v163
v_sub_f32 v190, v190, v163
v_sub_f32 v191, v191, v163
v_exp_f32 v188, v188
v_exp_f32 v189, v189
v_exp_f32 v190, v190
v_exp_f32 v191, v191
s_nop 0
v_add_f32 v251, v251, v188
v_add_f32 v251, v251, v189
v_add_f32 v251, v251, v190
v_add_f32 v251, v251, v191
v_cvt_pk_bf16_f32 v188, v188, v189
v_cvt_pk_bf16_f32 v189, v190, v191
v_sub_f32 v204, v204, v163
v_sub_f32 v205, v205, v163
v_sub_f32 v206, v206, v163
v_sub_f32 v207, v207, v163
v_exp_f32 v204, v204
v_exp_f32 v205, v205
v_exp_f32 v206, v206
v_exp_f32 v207, v207
s_nop 0
v_add_f32 v251, v251, v204
v_add_f32 v251, v251, v205
v_add_f32 v251, v251, v206
v_add_f32 v251, v251, v207
v_cvt_pk_bf16_f32 v190, v204, v205
v_cvt_pk_bf16_f32 v191, v206, v207
v_sub_f32 v208, v208, v164
v_sub_f32 v209, v209, v164
v_sub_f32 v210, v210, v164
v_sub_f32 v211, v211, v164
v_exp_f32 v208, v208
v_exp_f32 v209, v209
v_exp_f32 v210, v210
v_exp_f32 v211, v211
s_nop 0
v_add_f32 v252, v252, v208
v_add_f32 v252, v252, v209
v_add_f32 v252, v252, v210
v_add_f32 v252, v252, v211
v_cvt_pk_bf16_f32 v208, v208, v209
v_cvt_pk_bf16_f32 v209, v210, v211
ds_write_b64 v245, v[208:209] offset:2048
s_waitcnt lgkmcnt(0)
s_barrier
s_sub_u32 s31, s31, 1
s_cmp_eq_u32 s31, 0
s_cbranch_scc0 L_spv1
s_branch L_tail
L_spv1:
ds_read_b64_tr_b16 v[220:221], v239 offset:32768
ds_read_b64_tr_b16 v[222:223], v239 offset:34816
ds_read_b64_tr_b16 v[224:225], v239 offset:36864
ds_read_b64_tr_b16 v[226:227], v239 offset:38912
ds_read_b64_tr_b16 v[228:229], v239 offset:40960
ds_read_b64_tr_b16 v[230:231], v239 offset:43008
s_waitcnt lgkmcnt(4)
v_mfma_f32_16x16x32_bf16 a[16:19], v[220:223], v[176:179], a[16:19]
ds_read_b64_tr_b16 v[232:233], v239 offset:45056
v_mfma_f32_16x16x32_bf16 a[20:23], v[220:223], v[180:183], a[20:23]
ds_read_b64_tr_b16 v[234:235], v239 offset:47104
v_mfma_f32_16x16x32_bf16 a[24:27], v[220:223], v[184:187], a[24:27]
ds_read_b128 v[212:215], v244 offset:2048
v_mfma_f32_16x16x32_bf16 a[28:31], v[220:223], v[188:191], a[28:31]
s_waitcnt lgkmcnt(5)
ds_read_b128 v[216:219], v244 offset:3072
v_mfma_f32_16x16x32_bf16 a[80:83], v[224:227], v[176:179], a[80:83]
ds_read_b64_tr_b16 v[220:221], v238 offset:32768
v_mfma_f32_16x16x32_bf16 a[84:87], v[224:227], v[180:183], a[84:87]
ds_read_b64_tr_b16 v[222:223], v238 offset:34816
v_mfma_f32_16x16x32_bf16 a[88:91], v[224:227], v[184:187], a[88:91]
v_mfma_f32_16x16x32_bf16 a[92:95], v[224:227], v[188:191], a[92:95]
s_waitcnt lgkmcnt(4)
ds_read_b64_tr_b16 v[224:225], v238 offset:36864
v_mfma_f32_16x16x32_bf16 a[144:147], v[228:231], v[176:179], a[144:147]
ds_read_b64_tr_b16 v[226:227], v238 offset:38912
v_mfma_f32_16x16x32_bf16 a[148:151], v[228:231], v[180:183], a[148:151]
v_mfma_f32_16x16x32_bf16 a[152:155], v[228:231], v[184:187], a[152:155]
v_mfma_f32_16x16x32_bf16 a[156:159], v[228:231], v[188:191], a[156:159]
v_mfma_f32_16x16x32_bf16 a[208:211], v[232:235], v[176:179], a[208:211]
ds_read_b64_tr_b16 v[228:229], v238 offset:40960
v_mfma_f32_16x16x32_bf16 a[212:215], v[232:235], v[180:183], a[212:215]
ds_read_b64_tr_b16 v[230:231], v238 offset:43008
v_mfma_f32_16x16x32_bf16 a[216:219], v[232:235], v[184:187], a[216:219]
v_mfma_f32_16x16x32_bf16 a[220:223], v[232:235], v[188:191], a[220:223]
s_waitcnt lgkmcnt(2)
v_mfma_f32_16x16x32_bf16 a[0:3], v[220:223], v[176:179], a[0:3]
v_mfma_f32_16x16x32_bf16 a[4:7], v[220:223], v[180:183], a[4:7]
v_mfma_f32_16x16x32_bf16 v[128:131], v[220:223], v[212:215], v[128:131]
ds_read_b64_tr_b16 v[232:233], v238 offset:45056
v_mfma_f32_16x16x32_bf16 a[8:11], v[220:223], v[184:187], a[8:11]
ds_read_b64_tr_b16 v[234:235], v238 offset:47104
v_mfma_f32_16x16x32_bf16 v[132:135], v[220:223], v[216:219], v[132:135]
v_mfma_f32_16x16x32_bf16 a[12:15], v[220:223], v[188:191], a[12:15]
v_mfma_f32_16x16x32_bf16 a[64:67], v[224:227], v[176:179], a[64:67]
v_mfma_f32_16x16x32_bf16 a[68:71], v[224:227], v[180:183], a[68:71]
v_mfma_f32_16x16x32_bf16 v[136:139], v[224:227], v[212:215], v[136:139]
ds_read_b64_tr_b16 v[220:221], v240 offset:32768
v_mfma_f32_16x16x32_bf16 a[72:75], v[224:227], v[184:187], a[72:75]
ds_read_b64_tr_b16 v[222:223], v240 offset:34816
v_mfma_f32_16x16x32_bf16 v[140:143], v[224:227], v[216:219], v[140:143]
v_mfma_f32_16x16x32_bf16 a[76:79], v[224:227], v[188:191], a[76:79]
s_waitcnt lgkmcnt(2)
v_mfma_f32_16x16x32_bf16 a[128:131], v[228:231], v[176:179], a[128:131]
ds_read_b64_tr_b16 v[224:225], v240 offset:36864
v_mfma_f32_16x16x32_bf16 a[132:135], v[228:231], v[180:183], a[132:135]
ds_read_b64_tr_b16 v[226:227], v240 offset:38912
v_mfma_f32_16x16x32_bf16 v[144:147], v[228:231], v[212:215], v[144:147]
v_mfma_f32_16x16x32_bf16 a[136:139], v[228:231], v[184:187], a[136:139]
v_mfma_f32_16x16x32_bf16 v[148:151], v[228:231], v[216:219], v[148:151]
v_mfma_f32_16x16x32_bf16 a[140:143], v[228:231], v[188:191], a[140:143]
ds_read_b64_tr_b16 v[228:229], v240 offset:40960
v_mfma_f32_16x16x32_bf16 a[192:195], v[232:235], v[176:179], a[192:195]
ds_read_b64_tr_b16 v[230:231], v240 offset:43008
v_mfma_f32_16x16x32_bf16 a[196:199], v[232:235], v[180:183], a[196:199]
v_mfma_f32_16x16x32_bf16 v[152:155], v[232:235], v[212:215], v[152:155]
v_mfma_f32_16x16x32_bf16 a[200:203], v[232:235], v[184:187], a[200:203]
v_mfma_f32_16x16x32_bf16 v[156:159], v[232:235], v[216:219], v[156:159]
v_mfma_f32_16x16x32_bf16 a[204:207], v[232:235], v[188:191], a[204:207]
s_waitcnt lgkmcnt(2)
ds_read_b64_tr_b16 v[232:233], v240 offset:45056
v_mfma_f32_16x16x32_bf16 a[32:35], v[220:223], v[176:179], a[32:35]
ds_read_b64_tr_b16 v[234:235], v240 offset:47104
v_mfma_f32_16x16x32_bf16 a[36:39], v[220:223], v[180:183], a[36:39]
v_mfma_f32_16x16x32_bf16 a[40:43], v[220:223], v[184:187], a[40:43]
v_mfma_f32_16x16x32_bf16 a[44:47], v[220:223], v[188:191], a[44:47]
ds_read_b64_tr_b16 v[220:221], v241 offset:32768
v_mfma_f32_16x16x32_bf16 a[96:99], v[224:227], v[176:179], a[96:99]
ds_read_b64_tr_b16 v[222:223], v241 offset:34816
v_mfma_f32_16x16x32_bf16 a[100:103], v[224:227], v[180:183], a[100:103]
v_mfma_f32_16x16x32_bf16 a[104:107], v[224:227], v[184:187], a[104:107]
v_mfma_f32_16x16x32_bf16 a[108:111], v[224:227], v[188:191], a[108:111]
s_waitcnt lgkmcnt(2)
ds_read_b64_tr_b16 v[224:225], v241 offset:36864
v_mfma_f32_16x16x32_bf16 a[160:163], v[228:231], v[176:179], a[160:163]
ds_read_b64_tr_b16 v[226:227], v241 offset:38912
v_mfma_f32_16x16x32_bf16 a[164:167], v[228:231], v[180:183], a[164:167]
v_mfma_f32_16x16x32_bf16 a[168:171], v[228:231], v[184:187], a[168:171]
v_mfma_f32_16x16x32_bf16 a[172:175], v[228:231], v[188:191], a[172:175]
ds_read_b64_tr_b16 v[228:229], v241 offset:40960
v_mfma_f32_16x16x32_bf16 a[224:227], v[232:235], v[176:179], a[224:227]
ds_read_b64_tr_b16 v[230:231], v241 offset:43008
v_mfma_f32_16x16x32_bf16 a[228:231], v[232:235], v[180:183], a[228:231]
v_mfma_f32_16x16x32_bf16 a[232:235], v[232:235], v[184:187], a[232:235]
v_mfma_f32_16x16x32_bf16 a[236:239], v[232:235], v[188:191], a[236:239]
s_waitcnt lgkmcnt(2)
ds_read_b64_tr_b16 v[232:233], v241 offset:45056
v_mfma_f32_16x16x32_bf16 a[48:51], v[220:223], v[176:179], a[48:51]
ds_read_b64_tr_b16 v[234:235], v241 offset:47104
v_mfma_f32_16x16x32_bf16 a[52:55], v[220:223], v[180:183], a[52:55]
v_mfma_f32_16x16x32_bf16 a[56:59], v[220:223], v[184:187], a[56:59]
v_mfma_f32_16x16x32_bf16 a[60:63], v[220:223], v[188:191], a[60:63]
v_mfma_f32_16x16x32_bf16 a[112:115], v[224:227], v[176:179], a[112:115]
v_mfma_f32_16x16x32_bf16 a[116:119], v[224:227], v[180:183], a[116:119]
v_mfma_f32_16x16x32_bf16 a[120:123], v[224:227], v[184:187], a[120:123]
v_mfma_f32_16x16x32_bf16 a[124:127], v[224:227], v[188:191], a[124:127]
s_waitcnt lgkmcnt(0)
v_mfma_f32_16x16x32_bf16 a[176:179], v[228:231], v[176:179], a[176:179]
v_mfma_f32_16x16x32_bf16 a[180:183], v[228:231], v[180:183], a[180:183]
v_mfma_f32_16x16x32_bf16 a[184:187], v[228:231], v[184:187], a[184:187]
v_mfma_f32_16x16x32_bf16 a[188:191], v[228:231], v[188:191], a[188:191]
v_mfma_f32_16x16x32_bf16 a[240:243], v[232:235], v[176:179], a[240:243]
v_mfma_f32_16x16x32_bf16 a[244:247], v[232:235], v[180:183], a[244:247]
v_mfma_f32_16x16x32_bf16 a[248:251], v[232:235], v[184:187], a[248:251]
v_mfma_f32_16x16x32_bf16 a[252:255], v[232:235], v[188:191], a[252:255]
s_waitcnt lgkmcnt(0)
s_barrier
s_add_u32 s30, s30, 16384
s_branch L_sloop1
L_kend:
.globl reduce_kernel
.p2align 8
.type reduce_kernel,@function
reduce_kernel:
s_cmp_ge_u32 s2, 1008
s_cbranch_scc0 R_go
s_endpgm
R_go:
s_load_dwordx2 s[4:5], s[0:1], 96
s_load_dwordx2 s[6:7], s[0:1], 80
s_lshl_b32 s3, s2, 8
v_add_u32 v1, s3, v0
s_mov_b32 s8, 532611
s_mov_b32 s9, 1032192
s_mov_b32 s24, 0
s_mov_b32 s25, 129024
s_mov_b32 s26, 258048
s_mov_b32 s27, 387072
s_mov_b32 s28, 516096
s_mov_b32 s29, 645120
s_mov_b32 s30, 774144
s_mov_b32 s31, 903168
v_add_u32 v20, 0, v1
v_mul_hi_u32 v2, v20, s8
v_mul_u32_u24 v3, 8064, v2
v_sub_u32 v3, v20, v3
v_mul_lo_u32 v4, v2, s9
v_lshlrev_b32 v21, 4, v3
v_add_u32 v4, v4, v21
s_waitcnt lgkmcnt(0)
s_mov_b32 s12, s4
s_and_b32 s13, s5, 0xffff
s_mov_b32 s14, 33030144
s_mov_b32 s15, 0x20000
s_mov_b32 s16, s6
s_and_b32 s17, s7, 0xffff
s_mov_b32 s18, 4128768
s_mov_b32 s19, 0x20000
buffer_load_dwordx4 v[32:35], v4, s[12:15], s24 offen
buffer_load_dwordx4 v[36:39], v4, s[12:15], s25 offen
buffer_load_dwordx4 v[40:43], v4, s[12:15], s26 offen
buffer_load_dwordx4 v[44:47], v4, s[12:15], s27 offen
buffer_load_dwordx4 v[48:51], v4, s[12:15], s28 offen
buffer_load_dwordx4 v[52:55], v4, s[12:15], s29 offen
buffer_load_dwordx4 v[56:59], v4, s[12:15], s30 offen
buffer_load_dwordx4 v[60:63], v4, s[12:15], s31 offen
v_and_b32 v66, 63, v3
v_lshrrev_b32 v67, 6, v3
v_and_b32 v68, 1, v67
v_lshrrev_b32 v69, 1, v67
v_and_b32 v69, 1, v69
v_lshrrev_b32 v70, 2, v67
v_and_b32 v70, 3, v70
v_lshrrev_b32 v71, 4, v67
v_and_b32 v72, 15, v66
v_lshrrev_b32 v73, 4, v66
v_lshlrev_b32 v64, 5, v70
v_lshlrev_b32 v74, 4, v69
v_add_u32 v64, v64, v74
v_add_u32 v64, v64, v72
v_lshlrev_b32 v74, 1, v68
v_xor_b32 v74, v74, v70
v_lshlrev_b32 v75, 4, v74
v_xor_b32 v74, 1, v74
v_lshlrev_b32 v76, 4, v74
v_lshlrev_b32 v74, 6, v71
v_lshlrev_b32 v77, 2, v73
v_add_u32 v74, v74, v77
v_add_u32 v75, v75, v74
v_add_u32 v76, v76, v74
v_mov_b32 v65, v64
v_subrev_u32 v66, 7168, v3
v_lshrrev_b32 v67, 5, v66
v_and_b32 v68, 31, v66
v_lshlrev_b32 v68, 1, v68
v_and_b32 v69, 15, v68
v_lshrrev_b32 v70, 4, v68
v_and_b32 v71, 3, v67
v_lshrrev_b32 v72, 2, v67
v_lshlrev_b32 v72, 6, v72
v_lshlrev_b32 v71, 4, v71
v_add_u32 v72, v72, v71
v_lshlrev_b32 v70, 2, v70
v_add_u32 v72, v72, v70
v_add_u32 v69, 128, v69
v_add_u32 v73, 1, v69
v_cmp_le_u32 vcc, 7168, v3
s_nop 1
v_cndmask_b32 v64, v64, v69, vcc
v_cndmask_b32 v65, v65, v73, vcc
v_cndmask_b32 v75, v75, v72, vcc
v_cndmask_b32 v76, v76, v72, vcc
v_lshrrev_b32 v66, 4, v2
v_and_b32 v67, 15, v2
v_mul_u32_u24 v67, 144, v67
v_mul_u32_u24 v66, 448, v66
v_add_u32 v64, v64, v67
v_add_u32 v65, v65, v67
v_mul_u32_u24 v64, 896, v64
v_mul_u32_u24 v65, 896, v65
v_add_u32 v64, v64, v66
v_add_u32 v65, v65, v66
v_add_u32 v64, v64, v75
v_add_u32 v65, v65, v76
v_lshlrev_b32 v64, 1, v64
v_lshlrev_b32 v65, 1, v65
s_waitcnt vmcnt(7)
v_lshlrev_b32 v66, 16, v32
v_and_b32 v67, 0xffff0000, v32
v_lshlrev_b32 v68, 16, v33
v_and_b32 v69, 0xffff0000, v33
v_lshlrev_b32 v70, 16, v34
v_and_b32 v71, 0xffff0000, v34
v_lshlrev_b32 v72, 16, v35
v_and_b32 v73, 0xffff0000, v35
s_waitcnt vmcnt(6)
v_lshlrev_b32 v74, 16, v36
v_and_b32 v75, 0xffff0000, v36
v_add_f32 v66, v66, v74
v_add_f32 v67, v67, v75
v_lshlrev_b32 v74, 16, v37
v_and_b32 v75, 0xffff0000, v37
v_add_f32 v68, v68, v74
v_add_f32 v69, v69, v75
v_lshlrev_b32 v74, 16, v38
v_and_b32 v75, 0xffff0000, v38
v_add_f32 v70, v70, v74
v_add_f32 v71, v71, v75
v_lshlrev_b32 v74, 16, v39
v_and_b32 v75, 0xffff0000, v39
v_add_f32 v72, v72, v74
v_add_f32 v73, v73, v75
s_waitcnt vmcnt(5)
v_lshlrev_b32 v74, 16, v40
v_and_b32 v75, 0xffff0000, v40
v_add_f32 v66, v66, v74
v_add_f32 v67, v67, v75
v_lshlrev_b32 v74, 16, v41
v_and_b32 v75, 0xffff0000, v41
v_add_f32 v68, v68, v74
v_add_f32 v69, v69, v75
v_lshlrev_b32 v74, 16, v42
v_and_b32 v75, 0xffff0000, v42
v_add_f32 v70, v70, v74
v_add_f32 v71, v71, v75
v_lshlrev_b32 v74, 16, v43
v_and_b32 v75, 0xffff0000, v43
v_add_f32 v72, v72, v74
v_add_f32 v73, v73, v75
s_waitcnt vmcnt(4)
v_lshlrev_b32 v74, 16, v44
v_and_b32 v75, 0xffff0000, v44
v_add_f32 v66, v66, v74
v_add_f32 v67, v67, v75
v_lshlrev_b32 v74, 16, v45
v_and_b32 v75, 0xffff0000, v45
v_add_f32 v68, v68, v74
v_add_f32 v69, v69, v75
v_lshlrev_b32 v74, 16, v46
v_and_b32 v75, 0xffff0000, v46
v_add_f32 v70, v70, v74
v_add_f32 v71, v71, v75
v_lshlrev_b32 v74, 16, v47
v_and_b32 v75, 0xffff0000, v47
v_add_f32 v72, v72, v74
v_add_f32 v73, v73, v75
s_waitcnt vmcnt(3)
v_lshlrev_b32 v74, 16, v48
v_and_b32 v75, 0xffff0000, v48
v_add_f32 v66, v66, v74
v_add_f32 v67, v67, v75
v_lshlrev_b32 v74, 16, v49
v_and_b32 v75, 0xffff0000, v49
v_add_f32 v68, v68, v74
v_add_f32 v69, v69, v75
v_lshlrev_b32 v74, 16, v50
v_and_b32 v75, 0xffff0000, v50
v_add_f32 v70, v70, v74
v_add_f32 v71, v71, v75
v_lshlrev_b32 v74, 16, v51
v_and_b32 v75, 0xffff0000, v51
v_add_f32 v72, v72, v74
v_add_f32 v73, v73, v75
s_waitcnt vmcnt(2)
v_lshlrev_b32 v74, 16, v52
v_and_b32 v75, 0xffff0000, v52
v_add_f32 v66, v66, v74
v_add_f32 v67, v67, v75
v_lshlrev_b32 v74, 16, v53
v_and_b32 v75, 0xffff0000, v53
v_add_f32 v68, v68, v74
v_add_f32 v69, v69, v75
v_lshlrev_b32 v74, 16, v54
v_and_b32 v75, 0xffff0000, v54
v_add_f32 v70, v70, v74
v_add_f32 v71, v71, v75
v_lshlrev_b32 v74, 16, v55
v_and_b32 v75, 0xffff0000, v55
v_add_f32 v72, v72, v74
v_add_f32 v73, v73, v75
s_waitcnt vmcnt(1)
v_lshlrev_b32 v74, 16, v56
v_and_b32 v75, 0xffff0000, v56
v_add_f32 v66, v66, v74
v_add_f32 v67, v67, v75
v_lshlrev_b32 v74, 16, v57
v_and_b32 v75, 0xffff0000, v57
v_add_f32 v68, v68, v74
v_add_f32 v69, v69, v75
v_lshlrev_b32 v74, 16, v58
v_and_b32 v75, 0xffff0000, v58
v_add_f32 v70, v70, v74
v_add_f32 v71, v71, v75
v_lshlrev_b32 v74, 16, v59
v_and_b32 v75, 0xffff0000, v59
v_add_f32 v72, v72, v74
v_add_f32 v73, v73, v75
s_waitcnt vmcnt(0)
v_lshlrev_b32 v74, 16, v60
v_and_b32 v75, 0xffff0000, v60
v_add_f32 v66, v66, v74
v_add_f32 v67, v67, v75
v_lshlrev_b32 v74, 16, v61
v_and_b32 v75, 0xffff0000, v61
v_add_f32 v68, v68, v74
v_add_f32 v69, v69, v75
v_lshlrev_b32 v74, 16, v62
v_and_b32 v75, 0xffff0000, v62
v_add_f32 v70, v70, v74
v_add_f32 v71, v71, v75
v_lshlrev_b32 v74, 16, v63
v_and_b32 v75, 0xffff0000, v63
v_add_f32 v72, v72, v74
v_add_f32 v73, v73, v75
v_cvt_pk_bf16_f32 v76, v66, v67
v_cvt_pk_bf16_f32 v77, v68, v69
v_cvt_pk_bf16_f32 v78, v70, v71
v_cvt_pk_bf16_f32 v79, v72, v73
buffer_store_dwordx2 v[76:77], v64, s[16:19], 0 offen
buffer_store_dwordx2 v[78:79], v65, s[16:19], 0 offen
s_waitcnt vmcnt(0)
s_endpgm
R_end:
.section .rodata,"a"
.p2align 6
.amdhsa_kernel concat_heads__gqa_block_cached__gqa_block_cached__near_ridge_kernel
  .amdhsa_next_free_vgpr 512
  .amdhsa_next_free_sgpr 96
  .amdhsa_accum_offset 256
  .amdhsa_group_segment_fixed_size 0
  .amdhsa_kernarg_size 104
  .amdhsa_user_sgpr_count 2
  .amdhsa_user_sgpr_kernarg_segment_ptr 1
  .amdhsa_system_sgpr_workgroup_id_x 1
.end_amdhsa_kernel
.p2align 6
.amdhsa_kernel reduce_kernel
  .amdhsa_next_free_vgpr 88
  .amdhsa_next_free_sgpr 40
  .amdhsa_accum_offset 88
  .amdhsa_group_segment_fixed_size 0
  .amdhsa_kernarg_size 104
  .amdhsa_user_sgpr_count 2
  .amdhsa_user_sgpr_kernarg_segment_ptr 1
  .amdhsa_system_sgpr_workgroup_id_x 1
.end_amdhsa_kernel
```
